```python
import torch

def _softmax(x, axis=-1):
    return torch.softmax(x, dim=axis)

def _gelu(x):
    return torch.nn.functional.gelu(x, approximate='tanh')

def _silu(x):
    return torch.nn.functional.silu(x)

def _sigmoid(x):
    return torch.sigmoid(x)

def _layernorm(x, axis=-1, eps=1e-05):
    m = x.mean(dim=axis, keepdim=True)
    v = x.var(dim=axis, keepdim=True, unbiased=False)
    return (x - m) / torch.sqrt(v + eps)

def _scatter_add(tgt, idx, src, axis=0):
    return tgt.clone().index_add_(axis, idx, src)

def _segment_sum(src, seg, n):
    out = torch.zeros((n,) + src.shape[1:], dtype=src.dtype)
    return out.index_add_(0, seg, src)

def _pad(x, pw):
    flat = tuple((v for pair in reversed(pw) for v in pair))
    return torch.nn.functional.pad(x, flat)
kernel_name = 'concat_heads__ssm_conv_h3__memory_aug_recurrent_mem_tr__prompt'

def setup_inputs():

    _w = lambda a: (lambda t: t.to(torch.bfloat16) if t.is_floating_point() else t)(torch.as_tensor(a))

    def _A_setup():
        B, S, D = (1, 2048, 1024)
        ks = 4
        return {'q': _w((lambda *s: torch.randn(*s, dtype=torch.bfloat16) * 0.05)(B, S, D)), 'k': _w((lambda *s: torch.randn(*s, dtype=torch.bfloat16) * 0.4)(B, S, D)), 'v': _w((lambda *s: torch.randn(*s, dtype=torch.bfloat16) * 0.4)(B, S, D)), 'shift_k': _w((lambda *s: torch.randn(*s, dtype=torch.bfloat16) * 0.4)(D, ks) * 0.5), 'ssm_k': _w((lambda *s: torch.randn(*s, dtype=torch.bfloat16) * 0.4)(D, S) * (1.0 / S ** 0.5)), 'ssm_D': _w((lambda *s: torch.randn(*s, dtype=torch.bfloat16) * 0.4)(D))}
    _A_in = _A_setup()

    def _B_setup():
        B, S, Dm = (1, 2048, 1024)
        H, Dh = (32, 128)
        M, seg = (8, 32)
        seg = min(seg, S)
        S = S // seg * seg
        return {'x': _w((lambda *s: torch.randn(*s, dtype=torch.bfloat16) * 0.05)(B, S, Dm)), 'mem0': _w((lambda *s: torch.randn(*s, dtype=torch.bfloat16) * 0.4)(B, M, Dm)), 'Wq': _w((lambda *s: torch.randn(*s, dtype=torch.bfloat16) * 6.4)(Dm, H, Dh) * Dm ** (-0.5)), 'Wk': _w((lambda *s: torch.randn(*s, dtype=torch.bfloat16) * 6.4)(Dm, H, Dh) * Dm ** (-0.5)), 'Wv': _w((lambda *s: torch.randn(*s, dtype=torch.bfloat16) * 0.4)(Dm, H, Dh) * Dm ** (-0.5)), 'Wo': _w((lambda *s: torch.randn(*s, dtype=torch.bfloat16) * 0.4)(H, Dh, Dm) * (H * Dh) ** (-0.5)), 'seg_len': seg}
    _B_in = _B_setup()
    return {'A_q': _A_in['q'], 'A_k': _A_in['k'], 'A_v': _A_in['v'], 'A_shift_k': _A_in['shift_k'], 'A_ssm_k': _A_in['ssm_k'], 'A_ssm_D': _A_in['ssm_D'], 'B_x': _B_in['x'], 'B_mem0': _B_in['mem0'], 'B_Wq': _B_in['Wq'], 'B_Wk': _B_in['Wk'], 'B_Wv': _B_in['Wv'], 'B_Wo': _B_in['Wo'], 'B_seg_len': _B_in['seg_len']}

def reference(A_q, A_k, A_v, A_shift_k, A_ssm_k, A_ssm_D, B_x, B_mem0, B_Wq, B_Wk, B_Wv, B_Wo, B_seg_len):

    def _A_ref(q, k, v, shift_k, ssm_k, ssm_D):
        B, S, D = q.shape
        ks = shift_k.shape[-1]
        k_pad = _pad(k, ((0, 0), (ks - 1, 0), (0, 0)))
        k_shift = torch.zeros_like(k)
        for t in range(ks):
            k_shift = k_shift + k_pad[:, t:t + S, :] * shift_k[:, ks - 1 - t][None, None, :]
        kv = k_shift * v
        L = 2 * S
        kv_pad = _pad(kv, ((0, 0), (0, S), (0, 0)))
        kf_pad = _pad(ssm_k, ((0, 0), (0, S)))
        kv_f = (lambda x, axes=(-2, -1): torch.fft.rfft2(x.float(), dim=axes))(kv_pad[:, None, :, :], axes=(1, 2))
        kf_f = (lambda x, axes=(-2, -1): torch.fft.rfft2(x.float(), dim=axes))(kf_pad[:, None, :], axes=(1, 2))
        kf_f = (lambda x, *d: x.permute(*d))(kf_f, 1, 2, 0)
        y_f = kv_f * kf_f[None, :, :, :]
        y = (lambda x, s, axes=(-2, -1): torch.fft.irfft2(x, s=s, dim=axes).to(torch.bfloat16))(y_f, (1, L), axes=(1, 2))[:, 0, :S, :]
        y = y + kv * ssm_D[None, None, :]
        return q * y

    def _B_ref(x, mem0, Wq, Wk, Wv, Wo, seg_len):
        B, S, Dm = x.shape
        H, Dh = (Wq.shape[1], Wq.shape[2])
        M = mem0.shape[1]
        scale = Dh ** (-0.5)
        n_seg = S // seg_len
        L = M + seg_len
        idx = torch.arange(L)
        mask = (idx[:, None] < M) | (idx[:, None] >= idx[None, :])
        mem = mem0
        outs = []
        for s in range(n_seg):
            xs = x[:, s * seg_len:(s + 1) * seg_len, :].clone()
            h = torch.concatenate([mem, xs], axis=1)
            q = torch.einsum('btd,dhe->bhte', h, Wq)
            k = torch.einsum('btd,dhe->bhte', h, Wk)
            v = torch.einsum('btd,dhe->bhte', h, Wv)
            scores = torch.einsum('bhqe,bhke->bhqk', q, k) * scale
            scores = torch.where(mask[None, None], scores, -1000000000.0)
            p = _softmax(scores, axis=-1)
            o = torch.einsum('bhqk,bhke->bhqe', p, v)
            o = torch.einsum('bhte,hed->btd', o, Wo)
            mem = o[:, :M, :].clone()
            outs.append(o[:, M:, :])
        return torch.concatenate(outs, axis=1)
    a = _A_ref(A_q, A_k, A_v, A_shift_k, A_ssm_k, A_ssm_D)
    b = _B_ref(B_x, B_mem0, B_Wq, B_Wk, B_Wv, B_Wo, B_seg_len)
    return torch.concatenate([a, b], axis=-1)
```

```asm
; @launch grid=(256,1,1) block=(256,1,1) lds=163840
.amdgcn_target "amdgcn-amd-amdhsa--gfx950"
.text
.globl concat_heads__ssm_conv_h3__memory_aug_recurrent_mem_tr__prompt_kernel
.p2align 8
.type concat_heads__ssm_conv_h3__memory_aug_recurrent_mem_tr__prompt_kernel,@function
concat_heads__ssm_conv_h3__memory_aug_recurrent_mem_tr__prompt_kernel:
    s_cmp_ge_u32 s2, 256
    s_cbranch_scc1 L_exit
    v_lshrrev_b32 v1, 6, v0
    s_nop 0
    v_readfirstlane_b32 s100, v1
    v_and_b32 v0, 63, v0
    s_mov_b32 s101, 0
    s_getreg_b32 s3, hwreg(HW_REG_XCC_ID)
    s_and_b32 s3, s3, 7
    s_and_b32 s2, s2, 248
    s_or_b32 s2, s2, s3
L_restart:
    s_load_dwordx2 s[4:5], s[0:1], 120
    s_load_dwordx2 s[8:9], s[0:1], 64
    s_load_dwordx2 s[12:13], s[0:1], 72
    s_load_dwordx2 s[16:17], s[0:1], 80
    s_load_dwordx2 s[20:21], s[0:1], 88
    s_load_dwordx2 s[24:25], s[0:1], 56
    s_load_dwordx2 s[28:29], s[0:1], 112
    s_load_dwordx2 s[32:33], s[0:1], 48
    s_load_dwordx2 s[36:37], s[0:1], 72
    s_load_dwordx2 s[80:81], s[0:1], 104
    s_load_dwordx2 s[84:85], s[0:1], 0
    s_load_dwordx2 s[88:89], s[0:1], 8
    s_load_dwordx2 s[92:93], s[0:1], 16
    s_load_dwordx2 s[96:97], s[0:1], 32
    s_mov_b32 s6, 0x10000000
    s_mov_b32 s7, 0x20000
    s_mov_b32 s10, 0x800000
    s_mov_b32 s11, 0x20000
    s_mov_b32 s14, 0x800000
    s_mov_b32 s15, 0x20000
    s_mov_b32 s18, 0x800000
    s_mov_b32 s19, 0x20000
    s_mov_b32 s22, 0x800000
    s_mov_b32 s23, 0x20000
    s_mov_b32 s26, 0x4000
    s_mov_b32 s27, 0x20000
    s_mov_b32 s30, 0x100
    s_mov_b32 s31, 0x20000
    s_mov_b32 s34, 0x400000
    s_mov_b32 s35, 0x20000
    s_mov_b32 s38, 0x800000
    s_mov_b32 s39, 0x20000
    s_mov_b32 s82, 0x800000
    s_mov_b32 s83, 0x20000
    s_mov_b32 s86, 0x400000
    s_mov_b32 s87, 0x20000
    s_mov_b32 s90, 0x400000
    s_mov_b32 s91, 0x20000
    s_mov_b32 s94, 0x400000
    s_mov_b32 s95, 0x20000
    s_mov_b32 s98, 0x400000
    s_mov_b32 s99, 0x20000
    s_waitcnt lgkmcnt(0)
    s_cmp_eq_u32 s100, 3
    s_cbranch_scc0 Ltc_1
    s_getpc_b64 s[40:41]
L_pc:
    s_lshr_b32 s42, s2, 3
    s_lshl_b32 s42, s42, 12
    v_lshlrev_b32 v1, 6, v0
    v_add_u32 v1, s42, v1
    v_min_u32 v1, L_code_end-L_pc-4, v1
    global_load_dword v15, v1, s[40:41]
Ltc_1:
    s_and_b32 s3, s2, 7
    s_cmp_ge_u32 s3, 4
    s_cbranch_scc1 L_side
    s_and_b32 s33, s2, 7
    s_lshr_b32 s34, s2, 3
    s_and_b32 s36, s34, 7
    s_lshr_b32 s35, s34, 3
    s_mul_i32 s49, s33, 4
    s_add_u32 s35, s35, s49
    s_mov_b32 s32, s100
    s_bitcmp1_b32 s36, 1
    s_cselect_b64 s[88:89], s[12:13], s[8:9]
    s_mov_b32 s90, 0x800000
    s_mov_b32 s91, 0x20000
    v_bfe_u32 v27, v0, 3, 3
    v_lshlrev_b32 v24, 13, v27
    v_bfe_u32 v27, v0, 0, 3
    v_lshl_add_u32 v24, v27, 4, v24
    s_lshl_b32 s53, s35, 9
    s_lshl_b32 s49, s32, 21
    s_add_u32 s53, s53, s49
    s_lshr_b32 s49, s36, 2
    s_lshl_b32 s49, s49, 8
    s_and_b32 s50, s36, 1
    s_lshl_b32 s50, s50, 7
    s_add_u32 s49, s49, s50
    s_add_u32 s49, s49, s53
    s_lshl_b32 s50, s32, 15
    s_add_u32 m0, s50, 0
    s_nop 0
    buffer_load_dwordx4 v24, s[88:91], s49 offen lds
    s_add_u32 s49, s49, 0x10000
    s_add_u32 m0, s50, 1024
    s_nop 0
    buffer_load_dwordx4 v24, s[88:91], s49 offen lds
    s_add_u32 s49, s49, 0x10000
    s_add_u32 m0, s50, 2048
    s_nop 0
    buffer_load_dwordx4 v24, s[88:91], s49 offen lds
    s_add_u32 s49, s49, 0x10000
    s_add_u32 m0, s50, 3072
    s_nop 0
    buffer_load_dwordx4 v24, s[88:91], s49 offen lds
    s_add_u32 s49, s49, 0x10000
    s_add_u32 m0, s50, 4096
    s_nop 0
    buffer_load_dwordx4 v24, s[88:91], s49 offen lds
    s_add_u32 s49, s49, 0x10000
    s_add_u32 m0, s50, 5120
    s_nop 0
    buffer_load_dwordx4 v24, s[88:91], s49 offen lds
    s_add_u32 s49, s49, 0x10000
    s_add_u32 m0, s50, 6144
    s_nop 0
    buffer_load_dwordx4 v24, s[88:91], s49 offen lds
    s_add_u32 s49, s49, 0x10000
    s_add_u32 m0, s50, 7168
    s_nop 0
    buffer_load_dwordx4 v24, s[88:91], s49 offen lds
    s_add_u32 s49, s49, 0x10000
    s_add_u32 m0, s50, 8192
    s_nop 0
    buffer_load_dwordx4 v24, s[88:91], s49 offen lds
    s_add_u32 s49, s49, 0x10000
    s_add_u32 m0, s50, 9216
    s_nop 0
    buffer_load_dwordx4 v24, s[88:91], s49 offen lds
    s_add_u32 s49, s49, 0x10000
    s_add_u32 m0, s50, 10240
    s_nop 0
    buffer_load_dwordx4 v24, s[88:91], s49 offen lds
    s_add_u32 s49, s49, 0x10000
    s_add_u32 m0, s50, 11264
    s_nop 0
    buffer_load_dwordx4 v24, s[88:91], s49 offen lds
    s_add_u32 s49, s49, 0x10000
    s_add_u32 m0, s50, 12288
    s_nop 0
    buffer_load_dwordx4 v24, s[88:91], s49 offen lds
    s_add_u32 s49, s49, 0x10000
    s_add_u32 m0, s50, 13312
    s_nop 0
    buffer_load_dwordx4 v24, s[88:91], s49 offen lds
    s_add_u32 s49, s49, 0x10000
    s_add_u32 m0, s50, 14336
    s_nop 0
    buffer_load_dwordx4 v24, s[88:91], s49 offen lds
    s_add_u32 s49, s49, 0x10000
    s_add_u32 m0, s50, 15360
    s_nop 0
    buffer_load_dwordx4 v24, s[88:91], s49 offen lds
    s_add_u32 s49, s49, 0x10000
    s_add_u32 m0, s50, 16384
    s_nop 0
    buffer_load_dwordx4 v24, s[88:91], s49 offen lds
    s_add_u32 s49, s49, 0x10000
    s_add_u32 m0, s50, 17408
    s_nop 0
    buffer_load_dwordx4 v24, s[88:91], s49 offen lds
    s_add_u32 s49, s49, 0x10000
    s_add_u32 m0, s50, 18432
    s_nop 0
    buffer_load_dwordx4 v24, s[88:91], s49 offen lds
    s_add_u32 s49, s49, 0x10000
    s_add_u32 m0, s50, 19456
    s_nop 0
    buffer_load_dwordx4 v24, s[88:91], s49 offen lds
    s_add_u32 s49, s49, 0x10000
    s_add_u32 m0, s50, 20480
    s_nop 0
    buffer_load_dwordx4 v24, s[88:91], s49 offen lds
    s_add_u32 s49, s49, 0x10000
    s_add_u32 m0, s50, 21504
    s_nop 0
    buffer_load_dwordx4 v24, s[88:91], s49 offen lds
    s_add_u32 s49, s49, 0x10000
    s_add_u32 m0, s50, 22528
    s_nop 0
    buffer_load_dwordx4 v24, s[88:91], s49 offen lds
    s_add_u32 s49, s49, 0x10000
    s_add_u32 m0, s50, 23552
    s_nop 0
    buffer_load_dwordx4 v24, s[88:91], s49 offen lds
    s_add_u32 s49, s49, 0x10000
    s_add_u32 m0, s50, 24576
    s_nop 0
    buffer_load_dwordx4 v24, s[88:91], s49 offen lds
    s_add_u32 s49, s49, 0x10000
    s_add_u32 m0, s50, 25600
    s_nop 0
    buffer_load_dwordx4 v24, s[88:91], s49 offen lds
    s_add_u32 s49, s49, 0x10000
    s_add_u32 m0, s50, 26624
    s_nop 0
    buffer_load_dwordx4 v24, s[88:91], s49 offen lds
    s_add_u32 s49, s49, 0x10000
    s_add_u32 m0, s50, 27648
    s_nop 0
    buffer_load_dwordx4 v24, s[88:91], s49 offen lds
    s_add_u32 s49, s49, 0x10000
    s_add_u32 m0, s50, 28672
    s_nop 0
    buffer_load_dwordx4 v24, s[88:91], s49 offen lds
    s_add_u32 s49, s49, 0x10000
    s_add_u32 m0, s50, 29696
    s_nop 0
    buffer_load_dwordx4 v24, s[88:91], s49 offen lds
    s_add_u32 s49, s49, 0x10000
    s_add_u32 m0, s50, 30720
    s_nop 0
    buffer_load_dwordx4 v24, s[88:91], s49 offen lds
    s_add_u32 s49, s49, 0x10000
    s_add_u32 m0, s50, 31744
    s_nop 0
    buffer_load_dwordx4 v24, s[88:91], s49 offen lds
    s_add_u32 s49, s49, 0x10000
    s_or_b32 s3, s100, s101
    s_cbranch_scc1 Lcl_2
    s_lshr_b32 s49, s2, 3
    s_lshl_b32 s49, 1, s49
    s_and_b32 s50, s2, 7
    s_lshl_b32 s50, s50, 2
    v_mov_b32 v15, s49
    s_mov_b64 exec, 1
    buffer_atomic_or v15, off, s[28:31], s50 offset:192 sc0 sc1
    s_mov_b64 exec, -1
Lcl_2:
    s_xor_b32 s54, s36, 4
    s_lshl_b32 s49, s54, 6
    s_add_u32 s49, s49, s53
    s_mov_b32 s57, s49
    v_bfe_u32 v27, v0, 2, 4
    v_lshlrev_b32 v24, 13, v27
    v_bfe_u32 v27, v0, 0, 2
    v_lshl_add_u32 v24, v27, 4, v24
    s_lshl_b32 s49, s36, 8
    v_mov_b32 v22, s49
    v_bfe_u32 v27, v0, 4, 2
    v_lshl_add_u32 v22, v27, 11, v22
    v_bfe_u32 v27, v0, 0, 4
    v_lshl_add_u32 v22, v27, 4, v22
    s_lshl_b32 s59, s35, 19
    s_lshl_b32 s50, s32, 17
    s_add_u32 s59, s59, s50
    buffer_load_dwordx4 v[64:67], v24, s[16:19], s57 offen
    s_add_u32 s57, s57, 0x20000
    buffer_load_dwordx4 v[68:71], v24, s[16:19], s57 offen
    s_add_u32 s57, s57, 0x20000
    buffer_load_dwordx4 v[72:75], v24, s[16:19], s57 offen
    s_add_u32 s57, s57, 0x20000
    buffer_load_dwordx4 v[76:79], v24, s[16:19], s57 offen
    s_add_u32 s57, s57, 0x20000
    s_mov_b32 s39, 0x61a80
    s_mov_b32 s66, 0x3e0293ee
    s_mov_b32 s67, 0x3e0293ee
    s_mov_b32 s60, 0xcccccccc
    s_mov_b32 s61, 0xcccccccc
    s_mov_b32 s86, 0x00ff00ff
    s_mov_b32 s87, 0x00ff00ff
    v_lshlrev_b32 v1, 4, v0
    v_lshlrev_b32 v2, 2, v0
    v_mov_b32 v28, -1
    v_mov_b32 v29, -1
    v_mov_b32 v30, -1
    v_mov_b32 v31, -1
    v_mov_b32 v16, 0x4444
    v_mov_b32 v17, 0xeeee
    v_cndmask_b32 v10, v16, v17, s[60:61]
    v_bfe_u32 v27, v0, 0, 6
    v_lshlrev_b32 v11, 7, v27
    v_bfe_u32 v27, v0, 4, 1
    v_lshlrev_b32 v12, 12, v27
    v_bfe_u32 v27, v0, 5, 1
    v_lshl_add_u32 v12, v27, 14, v12
    v_bfe_u32 v27, v0, 0, 4
    v_lshl_add_u32 v12, v27, 4, v12
    v_bfe_u32 v27, v0, 2, 2
    v_lshlrev_b32 v13, 8, v27
    v_bfe_u32 v27, v0, 4, 2
    v_lshl_add_u32 v13, v27, 6, v13
    v_bfe_u32 v27, v0, 0, 2
    v_lshl_add_u32 v13, v27, 4, v13
    v_bfe_u32 v27, v0, 0, 6
    v_lshlrev_b32 v14, 2, v27
    s_mul_i32 s49, s32, 4864
    v_mov_b32 v3, s49
    v_bfe_u32 v27, v0, 0, 4
    v_lshl_add_u32 v3, v27, 3, v3
    v_bfe_u32 v27, v0, 4, 2
    v_lshl_add_u32 v3, v27, 7, v3
    v_bfe_u32 v27, v0, 4, 2
    v_lshl_add_u32 v3, v27, 6, v3
    s_lshr_b32 s49, s32, 1
    s_mul_i32 s49, s49, 1552
    s_and_b32 s50, s32, 1
    s_lshl_b32 s50, s50, 6
    s_add_u32 s49, s49, s50
    v_mov_b32 v4, s49
    v_bfe_u32 v27, v0, 0, 1
    v_lshl_add_u32 v4, v27, 9, v4
    v_bfe_u32 v27, v0, 0, 1
    v_lshl_add_u32 v4, v27, 8, v4
    v_bfe_u32 v27, v0, 0, 1
    v_lshl_add_u32 v4, v27, 3, v4
    v_bfe_u32 v27, v0, 4, 2
    v_lshl_add_u32 v4, v27, 7, v4
    v_bfe_u32 v27, v0, 4, 2
    v_lshl_add_u32 v4, v27, 6, v4
    v_bfe_u32 v27, v0, 1, 1
    v_lshl_add_u32 v4, v27, 5, v4
    v_bfe_u32 v27, v0, 3, 1
    v_lshl_add_u32 v4, v27, 4, v4
    v_bfe_u32 v27, v0, 2, 1
    v_lshl_add_u32 v4, v27, 2, v4
    v_add_u32 v5, 8, v4
    v_bfe_u32 v16, v0, 2, 1
    v_lshlrev_b32 v16, 4, v16
    v_mov_b32 v17, 0x3f80
    v_lshlrev_b32 v16, v16, v17
    v_bfe_u32 v17, v0, 0, 2
    v_cmp_eq_u32 vcc, 0, v17
    s_nop 1
    v_cndmask_b32 v240, 0, v16, vcc
    v_cmp_eq_u32 vcc, 1, v17
    s_nop 1
    v_cndmask_b32 v241, 0, v16, vcc
    v_cmp_eq_u32 vcc, 2, v17
    s_nop 1
    v_cndmask_b32 v242, 0, v16, vcc
    v_cmp_eq_u32 vcc, 3, v17
    s_nop 1
    v_cndmask_b32 v243, 0, v16, vcc
    s_and_b32 s52, s32, 1
    s_lshl_b32 s49, s52, 10
    s_add_u32 s49, s49, 20480
    v_add_u32 v6, s49, v2
    v_mov_b32 v7, s49
    v_bfe_u32 v27, v0, 2, 4
    v_lshl_add_u32 v7, v27, 4, v7
    v_bfe_u32 v27, v0, 0, 1
    v_lshl_add_u32 v7, v27, 3, v7
    v_bfe_u32 v27, v0, 1, 1
    v_lshl_add_u32 v7, v27, 2, v7
    s_cmp_lt_u32 s32, 2
    s_cbranch_scc1 Li_3
    v_mov_b32 v6, 20480
    v_bfe_u32 v27, v0, 5, 1
    v_lshl_add_u32 v6, v27, 9, v6
    v_bfe_u32 v27, v0, 3, 1
    v_lshl_add_u32 v6, v27, 8, v6
    v_bfe_u32 v27, v0, 0, 2
    v_lshl_add_u32 v6, v27, 6, v6
    v_bfe_u32 v27, v0, 4, 1
    v_lshl_add_u32 v6, v27, 5, v6
    v_bfe_u32 v27, v0, 2, 1
    v_lshl_add_u32 v6, v27, 3, v6
    v_add_u32 v7, 1552, v4
    v_add_u32 v12, 1560, v4
Li_3:
    s_lshl_b32 s49, s52, 13
    s_add_u32 s49, s49, 32768
    s_mov_b32 s65, s49
    v_mov_b32 v8, s49
    v_bfe_u32 v27, v0, 2, 4
    v_lshl_add_u32 v8, v27, 6, v8
    v_bfe_u32 v27, v0, 0, 1
    v_lshl_add_u32 v8, v27, 5, v8
    v_bfe_u32 v27, v0, 1, 1
    v_lshl_add_u32 v8, v27, 4, v8
    v_add_u32 v9, 65536, v1
    s_mul_i32 s46, s35, 12288
    s_add_u32 s46, s46, 0x4b00000
    s_lshl_b32 s49, s36, 10
    s_lshl_b32 s50, s32, 8
    s_add_u32 s49, s49, s50
    s_add_u32 s40, s46, s49
    s_lshl_b32 s51, s35, 13
    s_add_u32 s51, s51, 0x4000000
    s_add_u32 s96, s51, s49
    s_sub_u32 s96, s96, 2048
    s_bitcmp1_b32 s36, 1
    s_cselect_b32 s96, s96, 0x10000000
    s_lshl_b32 s49, s54, 9
    s_lshl_b32 s50, s52, 8
    s_add_u32 s49, s49, s50
    s_add_u32 s41, s46, s49
    s_add_u32 s41, s41, 8192
    s_and_b32 s50, s49, 2048
    s_add_u32 s49, s49, s50
    s_add_u32 s47, s51, s49
    s_min_u32 s49, s32, 2
    s_lshl_b32 s49, s49, 12
    s_add_u32 s46, s46, s49
    s_lshl_b32 s49, s36, 1
    s_add_u32 s49, s49, s52
    s_lshl_b32 s49, s49, 15
    s_and_b32 s50, s35, 8
    s_add_u32 s50, s50, s35
    s_lshl_b32 s50, s50, 10
    s_add_u32 s42, s49, s50
    s_add_u32 s42, s42, 0xa000000
    s_lshl_b32 s49, s34, 1
    s_add_u32 s49, s49, s52
    s_mul_i32 s49, s49, 1
    s_lshr_b32 s50, s49, 2
    s_lshl_b32 s43, s50, 15
    s_and_b32 s50, s49, 3
    s_lshl_b32 s50, s50, 8
    s_add_u32 s43, s43, s50
    s_add_u32 s43, s43, 0xa000000
    s_lshl_b32 s45, s33, 14
    s_add_u32 s45, s45, 0x4a00000
    s_lshl_b32 s49, s49, 8
    s_add_u32 s44, s45, s49
    s_lshl_b32 s49, s32, 12
    s_add_u32 s45, s45, s49
    s_lshl_b32 s48, s35, 1
    s_add_u32 s48, s48, s52
    s_lshl_b32 s48, s48, 12
    s_and_b32 s49, s36, 1
    s_lshl_b32 s49, s49, 12
    s_lshl_b32 s84, s35, 13
    s_add_u32 s84, s84, s49
    s_bfe_u32 s49, s36, 0x10001
    s_lshl_b32 s49, s49, 17
    s_add_u32 s84, s84, s49
    s_lshr_b32 s49, s36, 2
    s_mul_i32 s49, s49, 0x1040000
    s_add_u32 s84, s84, s49
    s_add_u32 s84, s84, 0x80000
    s_lshl_b32 s49, s52, 11
    s_add_u32 s84, s84, s49
    s_lshl_b32 s49, s32, 15
    v_mov_b32 v25, s49
    v_bfe_u32 v27, v0, 0, 2
    v_lshl_add_u32 v25, v27, 3, v25
    v_bfe_u32 v27, v0, 4, 1
    v_lshl_add_u32 v25, v27, 11, v25
    v_bfe_u32 v27, v0, 5, 1
    v_lshl_add_u32 v25, v27, 8, v25
    v_bfe_u32 v27, v0, 2, 2
    v_lshl_add_u32 v25, v27, 6, v25
    v_mov_b32 v26, s49
    v_bfe_u32 v27, v0, 0, 2
    v_lshl_add_u32 v26, v27, 3, v26
    v_bfe_u32 v27, v0, 4, 1
    v_lshl_add_u32 v26, v27, 12, v26
    v_bfe_u32 v27, v0, 5, 1
    v_lshl_add_u32 v26, v27, 9, v26
    v_bfe_u32 v27, v0, 2, 2
    v_lshl_add_u32 v26, v27, 7, v26
    v_add_u32 v23, s49, v1
    buffer_load_dwordx4 v[80:83], v24, s[16:19], s57 offen
    s_add_u32 s57, s57, 0x20000
    buffer_load_dwordx4 v[84:87], v24, s[16:19], s57 offen
    s_add_u32 s57, s57, 0x20000
    buffer_load_dwordx4 v[88:91], v24, s[16:19], s57 offen
    s_add_u32 s57, s57, 0x20000
    buffer_load_dwordx4 v[92:95], v24, s[16:19], s57 offen
    s_add_u32 s57, s57, 0x20000
    s_waitcnt vmcnt(32)
    ds_read_b64_tr_b16 a[0:1], v26 offset:0
    ds_read_b64_tr_b16 a[2:3], v26 offset:2048
    ds_read_b64_tr_b16 a[4:5], v26 offset:1024
    ds_read_b64_tr_b16 a[6:7], v26 offset:3072
    s_waitcnt lgkmcnt(4)
    ds_read_b64_tr_b16 a[32:33], v26 offset:32
    ds_read_b64_tr_b16 a[34:35], v26 offset:2080
    ds_read_b64_tr_b16 a[36:37], v26 offset:1056
    ds_read_b64_tr_b16 a[38:39], v26 offset:3104
    s_waitcnt lgkmcnt(4)
    ds_read_b64_tr_b16 a[64:65], v26 offset:64
    ds_read_b64_tr_b16 a[66:67], v26 offset:2112
    ds_read_b64_tr_b16 a[68:69], v26 offset:1088
    ds_read_b64_tr_b16 a[70:71], v26 offset:3136
    s_waitcnt lgkmcnt(4)
    ds_read_b64_tr_b16 a[96:97], v26 offset:96
    ds_read_b64_tr_b16 a[98:99], v26 offset:2144
    ds_read_b64_tr_b16 a[100:101], v26 offset:1120
    ds_read_b64_tr_b16 a[102:103], v26 offset:3168
    s_waitcnt lgkmcnt(4)
    s_waitcnt lgkmcnt(0)
    buffer_load_dwordx4 v[96:99], v24, s[16:19], s57 offen
    s_add_u32 s57, s57, 0x20000
    buffer_load_dwordx4 v[100:103], v24, s[16:19], s57 offen
    s_add_u32 s57, s57, 0x20000
    buffer_load_dwordx4 v[104:107], v24, s[16:19], s57 offen
    s_add_u32 s57, s57, 0x20000
    buffer_load_dwordx4 v[108:111], v24, s[16:19], s57 offen
    s_add_u32 s57, s57, 0x20000
    s_waitcnt vmcnt(28)
    ds_read_b64_tr_b16 a[8:9], v26 offset:8192
    ds_read_b64_tr_b16 a[10:11], v26 offset:10240
    ds_read_b64_tr_b16 a[12:13], v26 offset:9216
    ds_read_b64_tr_b16 a[14:15], v26 offset:11264
    s_waitcnt lgkmcnt(4)
    ds_read_b64_tr_b16 a[40:41], v26 offset:8224
    ds_read_b64_tr_b16 a[42:43], v26 offset:10272
    ds_read_b64_tr_b16 a[44:45], v26 offset:9248
    ds_read_b64_tr_b16 a[46:47], v26 offset:11296
    s_waitcnt lgkmcnt(4)
    ds_read_b64_tr_b16 a[72:73], v26 offset:8256
    ds_read_b64_tr_b16 a[74:75], v26 offset:10304
    ds_read_b64_tr_b16 a[76:77], v26 offset:9280
    ds_read_b64_tr_b16 a[78:79], v26 offset:11328
    s_waitcnt lgkmcnt(4)
    ds_read_b64_tr_b16 a[104:105], v26 offset:8288
    ds_read_b64_tr_b16 a[106:107], v26 offset:10336
    ds_read_b64_tr_b16 a[108:109], v26 offset:9312
    ds_read_b64_tr_b16 a[110:111], v26 offset:11360
    s_waitcnt lgkmcnt(4)
    s_waitcnt lgkmcnt(0)
    buffer_load_dwordx4 v[112:115], v24, s[16:19], s57 offen
    s_add_u32 s57, s57, 0x20000
    buffer_load_dwordx4 v[116:119], v24, s[16:19], s57 offen
    s_add_u32 s57, s57, 0x20000
    buffer_load_dwordx4 v[120:123], v24, s[16:19], s57 offen
    s_add_u32 s57, s57, 0x20000
    buffer_load_dwordx4 v[124:127], v24, s[16:19], s57 offen
    s_add_u32 s57, s57, 0x20000
    s_waitcnt vmcnt(24)
    ds_read_b64_tr_b16 a[16:17], v26 offset:16384
    ds_read_b64_tr_b16 a[18:19], v26 offset:18432
    ds_read_b64_tr_b16 a[20:21], v26 offset:17408
    ds_read_b64_tr_b16 a[22:23], v26 offset:19456
    s_waitcnt lgkmcnt(4)
    ds_read_b64_tr_b16 a[48:49], v26 offset:16416
    ds_read_b64_tr_b16 a[50:51], v26 offset:18464
    ds_read_b64_tr_b16 a[52:53], v26 offset:17440
    ds_read_b64_tr_b16 a[54:55], v26 offset:19488
    s_waitcnt lgkmcnt(4)
    ds_read_b64_tr_b16 a[80:81], v26 offset:16448
    ds_read_b64_tr_b16 a[82:83], v26 offset:18496
    ds_read_b64_tr_b16 a[84:85], v26 offset:17472
    ds_read_b64_tr_b16 a[86:87], v26 offset:19520
    s_waitcnt lgkmcnt(4)
    ds_read_b64_tr_b16 a[112:113], v26 offset:16480
    ds_read_b64_tr_b16 a[114:115], v26 offset:18528
    ds_read_b64_tr_b16 a[116:117], v26 offset:17504
    ds_read_b64_tr_b16 a[118:119], v26 offset:19552
    s_waitcnt lgkmcnt(4)
    s_waitcnt lgkmcnt(0)
    buffer_load_dwordx4 v[128:131], v22, s[20:23], s59 offen
    s_add_u32 s59, s59, 8192
    buffer_load_dwordx4 v[132:135], v22, s[20:23], s59 offen
    s_add_u32 s59, s59, 8192
    buffer_load_dwordx4 v[136:139], v22, s[20:23], s59 offen
    s_add_u32 s59, s59, 8192
    buffer_load_dwordx4 v[140:143], v22, s[20:23], s59 offen
    s_add_u32 s59, s59, 8192
    s_waitcnt vmcnt(20)
    ds_read_b64_tr_b16 a[24:25], v26 offset:24576
    ds_read_b64_tr_b16 a[26:27], v26 offset:26624
    ds_read_b64_tr_b16 a[28:29], v26 offset:25600
    ds_read_b64_tr_b16 a[30:31], v26 offset:27648
    s_waitcnt lgkmcnt(4)
    ds_read_b64_tr_b16 a[56:57], v26 offset:24608
    ds_read_b64_tr_b16 a[58:59], v26 offset:26656
    ds_read_b64_tr_b16 a[60:61], v26 offset:25632
    ds_read_b64_tr_b16 a[62:63], v26 offset:27680
    s_waitcnt lgkmcnt(4)
    ds_read_b64_tr_b16 a[88:89], v26 offset:24640
    ds_read_b64_tr_b16 a[90:91], v26 offset:26688
    ds_read_b64_tr_b16 a[92:93], v26 offset:25664
    ds_read_b64_tr_b16 a[94:95], v26 offset:27712
    s_waitcnt lgkmcnt(4)
    ds_read_b64_tr_b16 a[120:121], v26 offset:24672
    ds_read_b64_tr_b16 a[122:123], v26 offset:26720
    ds_read_b64_tr_b16 a[124:125], v26 offset:25696
    ds_read_b64_tr_b16 a[126:127], v26 offset:27744
    s_waitcnt lgkmcnt(4)
    s_waitcnt lgkmcnt(0)
    s_cmp_lg_u32 s101, 0
    s_cbranch_scc1 Lvr_7
    v_mov_b32 v16, 163824
    s_cmp_eq_u32 s100, 0
    s_cbranch_scc0 Lvr_6
    s_mov_b32 s3, s2
    s_mov_b32 vcc_hi, 600
Lvr_4:
    v_readfirstlane_b32 s50, v15
    s_lshr_b32 s49, s2, 3
    s_bitcmp1_b32 s50, s49
    s_cbranch_scc0 Lvr_5
    s_cmp_eq_u32 s50, -1
    s_cselect_b32 s49, 1, 8
    s_add_u32 s2, s2, s49
    s_and_b32 s2, s2, 255
    s_lshr_b32 s49, s2, 3
    s_lshl_b32 s49, 1, s49
    s_and_b32 s50, s2, 7
    s_lshl_b32 s50, s50, 2
    v_mov_b32 v15, s49
    s_mov_b64 exec, 1
    buffer_atomic_or v15, off, s[28:31], s50 offset:192 sc0 sc1
    s_mov_b64 exec, -1
    s_waitcnt vmcnt(0)
    s_sub_u32 vcc_hi, vcc_hi, 1
    s_cbranch_scc0 Lvr_4
    s_mov_b32 s2, 256
Lvr_5:
    v_mov_b32 v17, s2
    s_mov_b32 s2, s3
    ds_write_b32 v16, v17
    s_waitcnt lgkmcnt(0)
Lvr_6:
    s_barrier
    ds_read_b32 v17, v16
    s_mov_b32 s101, 1
    s_waitcnt lgkmcnt(0)
    v_readfirstlane_b32 s49, v17
    s_nop 0
    s_cmp_eq_u32 s49, s2
    s_cbranch_scc1 Lvr_7
    s_cmp_ge_u32 s49, 256
    s_cbranch_scc1 L_exit
    s_and_b32 s2, s49, 255
    s_waitcnt vmcnt(0)
    s_barrier
    s_branch L_restart
Lvr_7:
    s_lshl_b32 s85, s35, 10
    s_add_u32 s85, s85, 0x4dc0000
    s_or_b32 s51, s36, s32
    s_cselect_b32 s49, 0x10000000, s85
    v_mov_b32 v17, 0
    buffer_store_dword v17, v1, s[4:7], s49 offen sc1
    buffer_load_dwordx4 v[144:147], v22, s[20:23], s59 offen
    s_add_u32 s59, s59, 8192
    buffer_load_dwordx4 v[148:151], v22, s[20:23], s59 offen
    s_add_u32 s59, s59, 8192
    buffer_load_dwordx4 v[152:155], v22, s[20:23], s59 offen
    s_add_u32 s59, s59, 8192
    buffer_load_dwordx4 v[156:159], v22, s[20:23], s59 offen
    s_add_u32 s59, s59, 8192
    buffer_load_dwordx4 v[160:163], v22, s[20:23], s59 offen
    s_add_u32 s59, s59, 8192
    buffer_load_dwordx4 v[164:167], v22, s[20:23], s59 offen
    s_add_u32 s59, s59, 8192
    s_and_b32 s53, s34, 15
    s_lshl_b32 s53, s53, 16
    s_lshr_b32 s50, s34, 4
    s_lshl2_add_u32 s50, s50, s33
    s_lshl_b32 s50, s50, 8
    s_add_u32 s53, s53, s50
    s_add_u32 s53, s53, 0xa900000
    s_add_u32 s49, s40, 0x0
    buffer_store_dword v28, v2, s[4:7], s49 offen offset:0 sc1
    s_add_u32 s49, s41, 0x0
    s_add_u32 s50, s53, 0
    s_cmp_eq_u32 s32, 1
    s_cselect_b32 s49, s50, s49
    buffer_store_dword v28, v2, s[4:7], s49 offen offset:0 sc1
    s_lshr_b32 s49, s32, 1
    s_lshl_b32 s49, s49, 13
    s_add_u32 s49, s49, s42
    s_add_u32 s49, s49, 0x0
    buffer_store_dwordx4 v[28:31], v1, s[4:7], s49 offen offset:0 sc1
    s_add_u32 s49, s44, 0x0
    buffer_store_dword v28, v14, s[4:7], s49 offen offset:0 sc1
    s_add_u32 s49, s40, 0x30000
    buffer_store_dword v28, v2, s[4:7], s49 offen offset:0 sc1
    s_add_u32 s49, s41, 0x30000
    s_add_u32 s50, s53, 8192
    s_cmp_eq_u32 s32, 1
    s_cselect_b32 s49, s50, s49
    buffer_store_dword v28, v2, s[4:7], s49 offen offset:0 sc1
    s_lshr_b32 s49, s32, 1
    s_lshl_b32 s49, s49, 13
    s_add_u32 s49, s49, s42
    s_add_u32 s49, s49, 0x80000
    buffer_store_dwordx4 v[28:31], v1, s[4:7], s49 offen offset:0 sc1
    s_add_u32 s49, s44, 0x20000
    buffer_store_dword v28, v14, s[4:7], s49 offen offset:0 sc1
    s_add_u32 s49, s40, 0x60000
    buffer_store_dword v28, v2, s[4:7], s49 offen offset:0 sc1
    s_add_u32 s49, s41, 0x60000
    s_add_u32 s50, s53, 20480
    s_cmp_eq_u32 s32, 1
    s_cselect_b32 s49, s50, s49
    buffer_store_dword v28, v2, s[4:7], s49 offen offset:0 sc1
    s_add_u32 s49, s44, 0x40000
    buffer_store_dword v28, v14, s[4:7], s49 offen offset:0 sc1
    s_add_u32 s49, s40, 0x90000
    buffer_store_dword v28, v2, s[4:7], s49 offen offset:0 sc1
    s_add_u32 s49, s41, 0x90000
    s_add_u32 s50, s53, 28672
    s_cmp_eq_u32 s32, 1
    s_cselect_b32 s49, s50, s49
    buffer_store_dword v28, v2, s[4:7], s49 offen offset:0 sc1
    s_add_u32 s49, s44, 0x60000
    buffer_store_dword v28, v14, s[4:7], s49 offen offset:0 sc1
    buffer_load_dwordx4 v[168:171], v22, s[20:23], s59 offen
    s_add_u32 s59, s59, 8192
    buffer_load_dwordx4 v[172:175], v22, s[20:23], s59 offen
    s_add_u32 s59, s59, 8192
    buffer_load_dwordx4 v[176:179], v22, s[20:23], s59 offen
    s_add_u32 s59, s59, 8192
    buffer_load_dwordx4 v[180:183], v22, s[20:23], s59 offen
    s_add_u32 s59, s59, 8192
    buffer_load_dwordx4 v[184:187], v22, s[20:23], s59 offen
    s_add_u32 s59, s59, 8192
    buffer_load_dwordx4 v[188:191], v22, s[20:23], s59 offen
    s_add_u32 s59, s59, 8192
    s_waitcnt vmcnt(30)
    s_lshl_b32 s49, s32, 9
    v_mov_b32 v24, s49
    v_bfe_u32 v27, v0, 2, 2
    v_lshl_add_u32 v24, v27, 12, v24
    v_bfe_u32 v27, v0, 0, 1
    v_lshl_add_u32 v24, v27, 11, v24
    v_bfe_u32 v27, v0, 4, 2
    v_lshl_add_u32 v24, v27, 3, v24
    v_bfe_u32 v27, v0, 1, 1
    v_lshl_add_u32 v24, v27, 2, v24
    buffer_load_dword v224, v24, s[24:27], 0 offen offset:0
    buffer_load_dword v225, v24, s[24:27], 0 offen offset:32
    buffer_load_dword v226, v24, s[24:27], 0 offen offset:64
    buffer_load_dword v227, v24, s[24:27], 0 offen offset:96
    buffer_load_dword v228, v24, s[24:27], 0 offen offset:128
    buffer_load_dword v229, v24, s[24:27], 0 offen offset:160
    buffer_load_dword v230, v24, s[24:27], 0 offen offset:192
    buffer_load_dword v231, v24, s[24:27], 0 offen offset:224
    buffer_load_dword v232, v24, s[24:27], 0 offen offset:256
    buffer_load_dword v233, v24, s[24:27], 0 offen offset:288
    buffer_load_dword v234, v24, s[24:27], 0 offen offset:320
    buffer_load_dword v235, v24, s[24:27], 0 offen offset:352
    buffer_load_dword v236, v24, s[24:27], 0 offen offset:384
    buffer_load_dword v237, v24, s[24:27], 0 offen offset:416
    buffer_load_dword v238, v24, s[24:27], 0 offen offset:448
    buffer_load_dword v239, v24, s[24:27], 0 offen offset:480
    ds_write_b128 v23, v[64:67] offset:0
    ds_write_b128 v23, v[68:71] offset:1024
    ds_write_b128 v23, v[72:75] offset:2048
    ds_write_b128 v23, v[76:79] offset:3072
    ds_write_b128 v23, v[80:83] offset:4096
    ds_write_b128 v23, v[84:87] offset:5120
    ds_write_b128 v23, v[88:91] offset:6144
    ds_write_b128 v23, v[92:95] offset:7168
    s_waitcnt lgkmcnt(0)
    ds_write_b128 v23, v[96:99] offset:8192
    ds_write_b128 v23, v[100:103] offset:9216
    ds_write_b128 v23, v[104:107] offset:10240
    ds_write_b128 v23, v[108:111] offset:11264
    ds_write_b128 v23, v[112:115] offset:12288
    ds_write_b128 v23, v[116:119] offset:13312
    ds_write_b128 v23, v[120:123] offset:14336
    ds_write_b128 v23, v[124:127] offset:15360
    s_waitcnt lgkmcnt(0)
    ds_read_b64_tr_b16 a[128:129], v25 offset:0
    ds_read_b64_tr_b16 a[130:131], v25 offset:1024
    ds_read_b64_tr_b16 a[132:133], v25 offset:512
    ds_read_b64_tr_b16 a[134:135], v25 offset:1536
    s_waitcnt lgkmcnt(4)
    ds_read_b64_tr_b16 a[160:161], v25 offset:32
    ds_read_b64_tr_b16 a[162:163], v25 offset:1056
    ds_read_b64_tr_b16 a[164:165], v25 offset:544
    ds_read_b64_tr_b16 a[166:167], v25 offset:1568
    s_waitcnt lgkmcnt(4)
    ds_read_b64_tr_b16 a[136:137], v25 offset:4096
    ds_read_b64_tr_b16 a[138:139], v25 offset:5120
    ds_read_b64_tr_b16 a[140:141], v25 offset:4608
    ds_read_b64_tr_b16 a[142:143], v25 offset:5632
    s_waitcnt lgkmcnt(4)
    ds_read_b64_tr_b16 a[168:169], v25 offset:4128
    ds_read_b64_tr_b16 a[170:171], v25 offset:5152
    ds_read_b64_tr_b16 a[172:173], v25 offset:4640
    ds_read_b64_tr_b16 a[174:175], v25 offset:5664
    s_waitcnt lgkmcnt(4)
    ds_read_b64_tr_b16 a[144:145], v25 offset:8192
    ds_read_b64_tr_b16 a[146:147], v25 offset:9216
    ds_read_b64_tr_b16 a[148:149], v25 offset:8704
    ds_read_b64_tr_b16 a[150:151], v25 offset:9728
    s_waitcnt lgkmcnt(4)
    ds_read_b64_tr_b16 a[176:177], v25 offset:8224
    ds_read_b64_tr_b16 a[178:179], v25 offset:9248
    ds_read_b64_tr_b16 a[180:181], v25 offset:8736
    ds_read_b64_tr_b16 a[182:183], v25 offset:9760
    s_waitcnt lgkmcnt(4)
    ds_read_b64_tr_b16 a[152:153], v25 offset:12288
    ds_read_b64_tr_b16 a[154:155], v25 offset:13312
    ds_read_b64_tr_b16 a[156:157], v25 offset:12800
    ds_read_b64_tr_b16 a[158:159], v25 offset:13824
    s_waitcnt lgkmcnt(4)
    ds_read_b64_tr_b16 a[184:185], v25 offset:12320
    ds_read_b64_tr_b16 a[186:187], v25 offset:13344
    ds_read_b64_tr_b16 a[188:189], v25 offset:12832
    ds_read_b64_tr_b16 a[190:191], v25 offset:13856
    s_waitcnt lgkmcnt(4)
    s_waitcnt lgkmcnt(0)
    s_waitcnt vmcnt(16)
    s_or_b32 s49, s36, s32
    s_cbranch_scc1 Lct_8
    v_mov_b32 v21, 1
    s_mov_b64 exec, 1
    buffer_atomic_add v21, off, s[28:31], 0 offset:128 sc1
    s_mov_b64 exec, -1
Lct_8:
    v_lshrrev_b32 v18, 4, v0
    v_lshlrev_b32 v18, 5, v18
    v_xor_b32 v18, v18, v23
    v_xor_b32 v19, 128, v18
    ds_write_b128 v18, v[128:131] offset:16384
    ds_write_b128 v19, v[132:135] offset:17408
    ds_write_b128 v18, v[136:139] offset:18432
    ds_write_b128 v19, v[140:143] offset:19456
    ds_write_b128 v18, v[144:147] offset:20480
    ds_write_b128 v19, v[148:151] offset:21504
    ds_write_b128 v18, v[152:155] offset:22528
    ds_write_b128 v19, v[156:159] offset:23552
    s_waitcnt lgkmcnt(0)
    ds_write_b128 v18, v[160:163] offset:24576
    ds_write_b128 v19, v[164:167] offset:25600
    ds_write_b128 v18, v[168:171] offset:26624
    ds_write_b128 v19, v[172:175] offset:27648
    ds_write_b128 v18, v[176:179] offset:28672
    ds_write_b128 v19, v[180:183] offset:29696
    ds_write_b128 v18, v[184:187] offset:30720
    ds_write_b128 v19, v[188:191] offset:31744
    s_waitcnt lgkmcnt(0)
    s_waitcnt vmcnt(0)
    s_barrier
    s_and_b32 s49, s36, 3
    s_lshl2_add_u32 s49, s49, s32
    s_cmp_eq_u32 s49, 0
    s_cbranch_scc0 Lms_9
    s_and_b32 s49, s34, 15
    s_lshl_b32 s49, s49, 16
    s_lshr_b32 s50, s34, 4
    s_lshl2_add_u32 s50, s50, s33
    s_lshl_b32 s50, s50, 8
    s_add_u32 s49, s49, s50
    s_add_u32 s49, s49, 0xa900000
    s_mov_b32 s53, -1
    s_mov_b32 s54, -1
    s_memtime s[62:63]
    s_waitcnt lgkmcnt(0)
    s_mov_b32 s50, s62
    buffer_load_dword v16, off, s[4:7], s49 sc1
    s_waitcnt vmcnt(0)
    s_memtime s[62:63]
    s_waitcnt lgkmcnt(0)
    s_sub_u32 s50, s62, s50
    s_min_u32 s53, s53, s50
    s_add_u32 s49, s49, 8192
    s_memtime s[62:63]
    s_waitcnt lgkmcnt(0)
    s_mov_b32 s50, s62
    buffer_load_dword v16, off, s[4:7], s49 sc1
    s_waitcnt vmcnt(0)
    s_memtime s[62:63]
    s_waitcnt lgkmcnt(0)
    s_sub_u32 s50, s62, s50
    s_min_u32 s54, s54, s50
    s_add_u32 s49, s49, 12288
    s_memtime s[62:63]
    s_waitcnt lgkmcnt(0)
    s_mov_b32 s50, s62
    buffer_load_dword v16, off, s[4:7], s49 sc1
    s_waitcnt vmcnt(0)
    s_memtime s[62:63]
    s_waitcnt lgkmcnt(0)
    s_sub_u32 s50, s62, s50
    s_min_u32 s53, s53, s50
    s_add_u32 s49, s49, 8192
    s_memtime s[62:63]
    s_waitcnt lgkmcnt(0)
    s_mov_b32 s50, s62
    buffer_load_dword v16, off, s[4:7], s49 sc1
    s_waitcnt vmcnt(0)
    s_memtime s[62:63]
    s_waitcnt lgkmcnt(0)
    s_sub_u32 s50, s62, s50
    s_min_u32 s54, s54, s50
    s_add_u32 s49, s49, 4096
    s_cmp_le_u32 s53, s54
    s_cselect_b32 s49, 1, 0x10001
    v_mov_b32 v16, s49
    s_mov_b64 exec, 1
    buffer_atomic_add v16, off, s[28:31], 0 offset:32 sc1
    s_mov_b64 exec, -1
Lms_9:
    s_getreg_b32 s49, hwreg(HW_REG_XCC_ID)
    s_and_b32 s49, s49, 15
    s_mul_i32 s50, s49, s49
    s_lshl_b32 s50, s50, 18
    s_lshl_b32 s49, s49, 8
    s_add_u32 s49, s49, s50
    s_add_u32 s38, s49, 1
    s_cmp_eq_u32 s32, 0
    s_cbranch_scc0 Lann_10
    s_lshl_b32 s50, s33, 2
    v_mov_b32 v22, s38
    s_mov_b64 exec, 1
    buffer_atomic_add v22, off, s[28:31], s50 offset:16 sc1
    s_mov_b64 exec, -1
Lann_10:
    s_cmp_lt_u32 s32, 2
    s_cbranch_scc1 Li_11
    s_lshl_b32 s49, s52, 7
    v_mov_b32 v25, 16384
    v_bfe_u32 v27, v0, 2, 4
    v_lshl_add_u32 v25, v27, 8, v25
    v_bfe_u32 v27, v0, 2, 3
    v_lshl_add_u32 v25, v27, 5, v25
    v_bfe_u32 v27, v0, 0, 2
    v_lshl_add_u32 v25, v27, 3, v25
    v_xor_b32 v25, s49, v25
    v_xor_b32 v18, 0, v25
    v_add_u32 v19, 0x10000, v18
    ds_read_b64_tr_b16 a[192:193], v18 offset:0
    ds_read_b64_tr_b16 a[194:195], v18 offset:4096
    ds_read_b64_tr_b16 a[196:197], v18 offset:8192
    ds_read_b64_tr_b16 a[198:199], v18 offset:12288
    ds_read_b64_tr_b16 a[200:201], v18 offset:32768
    ds_read_b64_tr_b16 a[202:203], v18 offset:36864
    ds_read_b64_tr_b16 a[204:205], v18 offset:40960
    ds_read_b64_tr_b16 a[206:207], v18 offset:45056
    s_waitcnt lgkmcnt(6)
    ds_read_b64_tr_b16 a[208:209], v19 offset:0
    ds_read_b64_tr_b16 a[210:211], v19 offset:4096
    ds_read_b64_tr_b16 a[212:213], v19 offset:8192
    ds_read_b64_tr_b16 a[214:215], v19 offset:12288
    ds_read_b64_tr_b16 a[216:217], v19 offset:32768
    ds_read_b64_tr_b16 a[218:219], v19 offset:36864
    ds_read_b64_tr_b16 a[220:221], v19 offset:40960
    ds_read_b64_tr_b16 a[222:223], v19 offset:45056
    s_waitcnt lgkmcnt(6)
    v_xor_b32 v18, 32, v25
    v_add_u32 v19, 0x10000, v18
    ds_read_b64_tr_b16 a[224:225], v18 offset:0
    ds_read_b64_tr_b16 a[226:227], v18 offset:4096
    ds_read_b64_tr_b16 a[228:229], v18 offset:8192
    ds_read_b64_tr_b16 a[230:231], v18 offset:12288
    ds_read_b64_tr_b16 a[232:233], v18 offset:32768
    ds_read_b64_tr_b16 a[234:235], v18 offset:36864
    ds_read_b64_tr_b16 a[236:237], v18 offset:40960
    ds_read_b64_tr_b16 a[238:239], v18 offset:45056
    s_waitcnt lgkmcnt(6)
    ds_read_b64_tr_b16 a[240:241], v19 offset:0
    ds_read_b64_tr_b16 a[242:243], v19 offset:4096
    ds_read_b64_tr_b16 a[244:245], v19 offset:8192
    ds_read_b64_tr_b16 a[246:247], v19 offset:12288
    ds_read_b64_tr_b16 a[248:249], v19 offset:32768
    ds_read_b64_tr_b16 a[250:251], v19 offset:36864
    ds_read_b64_tr_b16 a[252:253], v19 offset:40960
    ds_read_b64_tr_b16 a[254:255], v19 offset:45056
    s_waitcnt lgkmcnt(6)
    v_xor_b32 v18, 64, v25
    v_add_u32 v19, 0x10000, v18
    ds_read_b64_tr_b16 v[128:129], v18 offset:0
    ds_read_b64_tr_b16 v[130:131], v18 offset:4096
    ds_read_b64_tr_b16 v[132:133], v18 offset:8192
    ds_read_b64_tr_b16 v[134:135], v18 offset:12288
    ds_read_b64_tr_b16 v[136:137], v18 offset:32768
    ds_read_b64_tr_b16 v[138:139], v18 offset:36864
    ds_read_b64_tr_b16 v[140:141], v18 offset:40960
    ds_read_b64_tr_b16 v[142:143], v18 offset:45056
    s_waitcnt lgkmcnt(6)
    ds_read_b64_tr_b16 v[144:145], v19 offset:0
    ds_read_b64_tr_b16 v[146:147], v19 offset:4096
    ds_read_b64_tr_b16 v[148:149], v19 offset:8192
    ds_read_b64_tr_b16 v[150:151], v19 offset:12288
    ds_read_b64_tr_b16 v[152:153], v19 offset:32768
    ds_read_b64_tr_b16 v[154:155], v19 offset:36864
    ds_read_b64_tr_b16 v[156:157], v19 offset:40960
    ds_read_b64_tr_b16 v[158:159], v19 offset:45056
    s_waitcnt lgkmcnt(6)
    v_xor_b32 v18, 96, v25
    v_add_u32 v19, 0x10000, v18
    ds_read_b64_tr_b16 v[160:161], v18 offset:0
    ds_read_b64_tr_b16 v[162:163], v18 offset:4096
    ds_read_b64_tr_b16 v[164:165], v18 offset:8192
    ds_read_b64_tr_b16 v[166:167], v18 offset:12288
    ds_read_b64_tr_b16 v[168:169], v18 offset:32768
    ds_read_b64_tr_b16 v[170:171], v18 offset:36864
    ds_read_b64_tr_b16 v[172:173], v18 offset:40960
    ds_read_b64_tr_b16 v[174:175], v18 offset:45056
    s_waitcnt lgkmcnt(6)
    ds_read_b64_tr_b16 v[176:177], v19 offset:0
    ds_read_b64_tr_b16 v[178:179], v19 offset:4096
    ds_read_b64_tr_b16 v[180:181], v19 offset:8192
    ds_read_b64_tr_b16 v[182:183], v19 offset:12288
    ds_read_b64_tr_b16 v[184:185], v19 offset:32768
    ds_read_b64_tr_b16 v[186:187], v19 offset:36864
    ds_read_b64_tr_b16 v[188:189], v19 offset:40960
    ds_read_b64_tr_b16 v[190:191], v19 offset:45056
    s_waitcnt lgkmcnt(6)
    s_waitcnt lgkmcnt(0)
    v_mov_b32 v70, 0
    v_mov_b32 v71, 0
    v_mov_b32 v78, 0
    v_mov_b32 v79, 0
    v_mov_b32 v86, 0
    v_mov_b32 v87, 0
    v_mov_b32 v94, 0
    v_mov_b32 v95, 0
    v_mov_b32 v102, 0
    v_mov_b32 v103, 0
    v_mov_b32 v110, 0
    v_mov_b32 v111, 0
    v_mov_b32 v118, 0
    v_mov_b32 v119, 0
    v_mov_b32 v126, 0
    v_mov_b32 v127, 0
Li_11:
    s_barrier
    v_bfe_u32 v17, v0, 1, 2
    v_and_b32 v18, 1, v0
    v_lshlrev_b32 v18, 7, v18
    v_lshl_add_u32 v19, v17, 17, v18
    v_mul_u32_u24 v17, 0x30000, v17
    v_add_u32 v17, v17, v18
    s_mov_b64 exec, 0xff
    buffer_load_dword v20, v17, s[4:7], s40 offen sc1
    buffer_load_dword v21, v17, s[4:7], s41 offen sc1
    buffer_load_dword v22, v19, s[4:7], s44 offen sc1
    s_mov_b64 exec, -1
    s_cmp_eq_u32 s32, 1
    s_cbranch_scc0 Lkv_14
Lkv_12:
    buffer_load_dword v16, off, s[28:31], 0 offset:128 sc1
    s_waitcnt vmcnt(0)
    v_readfirstlane_b32 s50, v16
    s_nop 0
    s_cmp_eq_u32 s50, 16
    s_cbranch_scc1 Lkv_13
    s_sleep 4
    s_sub_u32 s39, s39, 1
    s_cbranch_scc0 Lkv_12
    s_branch L_chain_fail
Lkv_13:
Lkv_15:
    buffer_load_dword v16, off, s[4:7], s85 sc1
    s_waitcnt vmcnt(0)
    v_readfirstlane_b32 s50, v16
    s_nop 0
    s_cmp_eq_u32 s50, 8
    s_cbranch_scc1 Lkv_16
    s_sleep 4
    s_sub_u32 s39, s39, 1
    s_cbranch_scc0 Lkv_15
    s_branch L_chain_fail
Lkv_16:
Lkv_14:
    s_barrier
    s_mov_b32 s37, 0
    s_cmp_ge_u32 s32, 2
    s_cbranch_scc1 Li_17
    s_lshl_b32 s49, s37, 18
    s_add_u32 s49, s49, s48
    s_and_b32 s50, s32, 1
    s_lshl_b32 s50, s50, 13
    s_add_u32 s50, s50, 32768
    s_add_u32 s49, s49, 0x0
    s_add_u32 m0, s50, 0
    s_nop 0
    buffer_load_dwordx4 v1, s[4:7], s49 offen offset:0 sc1 lds
    buffer_load_dwordx4 v1, s[4:7], s49 offen offset:1024 sc1 lds
    buffer_load_dwordx4 v1, s[4:7], s49 offen offset:2048 sc1 lds
    buffer_load_dwordx4 v1, s[4:7], s49 offen offset:3072 sc1 lds
    s_add_u32 s49, s49, 0x20000
    s_add_u32 m0, s50, 4096
    s_nop 0
    buffer_load_dwordx4 v1, s[4:7], s49 offen offset:0 sc1 lds
    buffer_load_dwordx4 v1, s[4:7], s49 offen offset:1024 sc1 lds
    buffer_load_dwordx4 v1, s[4:7], s49 offen offset:2048 sc1 lds
    buffer_load_dwordx4 v1, s[4:7], s49 offen offset:3072 sc1 lds
    s_mov_b32 s51, 1
    s_lshl_b32 s49, s51, 18
    s_add_u32 s49, s49, s48
    s_and_b32 s50, s32, 1
    s_lshl_b32 s50, s50, 13
    s_add_u32 s50, s50, 81920
    s_add_u32 s49, s49, 0x1000000
    s_add_u32 m0, s50, 0
    s_nop 0
    buffer_load_dwordx4 v1, s[4:7], s49 offen offset:0 sc1 lds
    buffer_load_dwordx4 v1, s[4:7], s49 offen offset:1024 sc1 lds
    buffer_load_dwordx4 v1, s[4:7], s49 offen offset:2048 sc1 lds
    buffer_load_dwordx4 v1, s[4:7], s49 offen offset:3072 sc1 lds
    s_add_u32 s49, s49, 0x20000
    s_add_u32 m0, s50, 4096
    s_nop 0
    buffer_load_dwordx4 v1, s[4:7], s49 offen offset:0 sc1 lds
    buffer_load_dwordx4 v1, s[4:7], s49 offen offset:1024 sc1 lds
    buffer_load_dwordx4 v1, s[4:7], s49 offen offset:2048 sc1 lds
    buffer_load_dwordx4 v1, s[4:7], s49 offen offset:3072 sc1 lds
    v_mov_b32 v19, 0
    ds_write_b32 v6, v19 offset:768
    s_branch Li_18
Li_17:
    s_lshl_b32 s49, s37, 18
    s_add_u32 s49, s49, s48
    s_and_b32 s50, s32, 1
    s_lshl_b32 s50, s50, 13
    s_add_u32 s50, s50, 65536
    s_add_u32 s49, s49, 0x1000000
    s_add_u32 m0, s50, 0
    s_nop 0
    buffer_load_dwordx4 v1, s[4:7], s49 offen offset:0 sc1 lds
    buffer_load_dwordx4 v1, s[4:7], s49 offen offset:1024 sc1 lds
    buffer_load_dwordx4 v1, s[4:7], s49 offen offset:2048 sc1 lds
    buffer_load_dwordx4 v1, s[4:7], s49 offen offset:3072 sc1 lds
    s_add_u32 s49, s49, 0x20000
    s_add_u32 m0, s50, 4096
    s_nop 0
    buffer_load_dwordx4 v1, s[4:7], s49 offen offset:0 sc1 lds
    buffer_load_dwordx4 v1, s[4:7], s49 offen offset:1024 sc1 lds
    buffer_load_dwordx4 v1, s[4:7], s49 offen offset:2048 sc1 lds
    buffer_load_dwordx4 v1, s[4:7], s49 offen offset:3072 sc1 lds
Li_18:
    s_waitcnt vmcnt(0) lgkmcnt(0)
    s_barrier
    s_cmp_lt_u32 s32, 2
    s_cbranch_scc1 Li_19
    ds_read_b128 v[192:195], v9 offset:0
    ds_read_b128 v[196:199], v9 offset:1024
    ds_read_b128 v[200:203], v9 offset:2048
    ds_read_b128 v[204:207], v9 offset:3072
    ds_read_b128 v[208:211], v9 offset:4096
    ds_read_b128 v[212:215], v9 offset:5120
    ds_read_b128 v[216:219], v9 offset:6144
    s_waitcnt lgkmcnt(6)
    v_mfma_f32_16x16x32_bf16 v[32:35], v[192:195], a[192:195], 0
    v_mfma_f32_16x16x32_bf16 v[36:39], v[192:195], a[224:227], 0
    v_mfma_f32_16x16x32_bf16 v[40:43], v[192:195], v[128:131], 0
    v_mfma_f32_16x16x32_bf16 v[44:47], v[192:195], v[160:163], 0
    ds_read_b128 v[220:223], v9 offset:7168
    s_waitcnt lgkmcnt(6)
    v_mfma_f32_16x16x32_bf16 v[32:35], v[196:199], a[196:199], v[32:35]
    v_mfma_f32_16x16x32_bf16 v[36:39], v[196:199], a[228:231], v[36:39]
    v_mfma_f32_16x16x32_bf16 v[40:43], v[196:199], v[132:135], v[40:43]
    v_mfma_f32_16x16x32_bf16 v[44:47], v[196:199], v[164:167], v[44:47]
    ds_read_b128 v[192:195], v9 offset:8192
    s_waitcnt lgkmcnt(6)
    v_mfma_f32_16x16x32_bf16 v[32:35], v[200:203], a[200:203], v[32:35]
    v_mfma_f32_16x16x32_bf16 v[36:39], v[200:203], a[232:235], v[36:39]
    v_mfma_f32_16x16x32_bf16 v[40:43], v[200:203], v[136:139], v[40:43]
    v_mfma_f32_16x16x32_bf16 v[44:47], v[200:203], v[168:171], v[44:47]
    ds_read_b128 v[196:199], v9 offset:9216
    s_waitcnt lgkmcnt(6)
    v_mfma_f32_16x16x32_bf16 v[32:35], v[204:207], a[204:207], v[32:35]
    v_mfma_f32_16x16x32_bf16 v[36:39], v[204:207], a[236:239], v[36:39]
    v_mfma_f32_16x16x32_bf16 v[40:43], v[204:207], v[140:143], v[40:43]
    v_mfma_f32_16x16x32_bf16 v[44:47], v[204:207], v[172:175], v[44:47]
    ds_read_b128 v[200:203], v9 offset:10240
    s_waitcnt lgkmcnt(6)
    v_mfma_f32_16x16x32_bf16 v[48:51], v[208:211], a[192:195], 0
    v_mfma_f32_16x16x32_bf16 v[52:55], v[208:211], a[224:227], 0
    v_mfma_f32_16x16x32_bf16 v[56:59], v[208:211], v[128:131], 0
    v_mfma_f32_16x16x32_bf16 v[60:63], v[208:211], v[160:163], 0
    ds_read_b128 v[204:207], v9 offset:11264
    s_waitcnt lgkmcnt(6)
    v_mfma_f32_16x16x32_bf16 v[48:51], v[212:215], a[196:199], v[48:51]
    v_mfma_f32_16x16x32_bf16 v[52:55], v[212:215], a[228:231], v[52:55]
    v_mfma_f32_16x16x32_bf16 v[56:59], v[212:215], v[132:135], v[56:59]
    v_mfma_f32_16x16x32_bf16 v[60:63], v[212:215], v[164:167], v[60:63]
    ds_read_b128 v[208:211], v9 offset:12288
    s_waitcnt lgkmcnt(6)
    v_mfma_f32_16x16x32_bf16 v[48:51], v[216:219], a[200:203], v[48:51]
    v_cvt_pk_bf16_f32 v64, v32, v33
    v_mfma_f32_16x16x32_bf16 v[52:55], v[216:219], a[232:235], v[52:55]
    v_cvt_pk_bf16_f32 v80, v36, v37
    v_mfma_f32_16x16x32_bf16 v[56:59], v[216:219], v[136:139], v[56:59]
    v_cvt_pk_bf16_f32 v96, v40, v41
    v_mfma_f32_16x16x32_bf16 v[60:63], v[216:219], v[168:171], v[60:63]
    v_cvt_pk_bf16_f32 v112, v44, v45
    ds_read_b128 v[212:215], v9 offset:13312
    s_waitcnt lgkmcnt(6)
    v_mfma_f32_16x16x32_bf16 v[48:51], v[220:223], a[204:207], v[48:51]
    v_cvt_pk_bf16_f32 v65, v34, v35
    v_mfma_f32_16x16x32_bf16 v[52:55], v[220:223], a[236:239], v[52:55]
    v_cvt_pk_bf16_f32 v81, v38, v39
    v_mfma_f32_16x16x32_bf16 v[56:59], v[220:223], v[140:143], v[56:59]
    v_cvt_pk_bf16_f32 v97, v42, v43
    v_mfma_f32_16x16x32_bf16 v[60:63], v[220:223], v[172:175], v[60:63]
    v_cvt_pk_bf16_f32 v113, v46, v47
    ds_read_b128 v[216:219], v9 offset:14336
    s_waitcnt lgkmcnt(6)
    v_mfma_f32_16x16x32_bf16 v[32:35], v[192:195], a[208:211], 0
    v_mfma_f32_16x16x32_bf16 v[36:39], v[192:195], a[240:243], 0
    v_mfma_f32_16x16x32_bf16 v[40:43], v[192:195], v[144:147], 0
    v_mfma_f32_16x16x32_bf16 v[44:47], v[192:195], v[176:179], 0
    ds_read_b128 v[220:223], v9 offset:15360
    s_waitcnt lgkmcnt(6)
    v_mfma_f32_16x16x32_bf16 v[32:35], v[196:199], a[212:215], v[32:35]
    v_mfma_f32_16x16x32_bf16 v[36:39], v[196:199], a[244:247], v[36:39]
    v_mfma_f32_16x16x32_bf16 v[40:43], v[196:199], v[148:151], v[40:43]
    v_mfma_f32_16x16x32_bf16 v[44:47], v[196:199], v[180:183], v[44:47]
    s_waitcnt lgkmcnt(5)
    v_mfma_f32_16x16x32_bf16 v[32:35], v[200:203], a[216:219], v[32:35]
    v_cvt_pk_bf16_f32 v66, v48, v49
    v_mfma_f32_16x16x32_bf16 v[36:39], v[200:203], a[248:251], v[36:39]
    v_cvt_pk_bf16_f32 v82, v52, v53
    v_mfma_f32_16x16x32_bf16 v[40:43], v[200:203], v[152:155], v[40:43]
    v_cvt_pk_bf16_f32 v98, v56, v57
    v_mfma_f32_16x16x32_bf16 v[44:47], v[200:203], v[184:187], v[44:47]
    v_cvt_pk_bf16_f32 v114, v60, v61
    s_waitcnt lgkmcnt(4)
    v_mfma_f32_16x16x32_bf16 v[32:35], v[204:207], a[220:223], v[32:35]
    v_cvt_pk_bf16_f32 v67, v50, v51
    v_mfma_f32_16x16x32_bf16 v[36:39], v[204:207], a[252:255], v[36:39]
    v_cvt_pk_bf16_f32 v83, v54, v55
    v_mfma_f32_16x16x32_bf16 v[40:43], v[204:207], v[156:159], v[40:43]
    v_cvt_pk_bf16_f32 v99, v58, v59
    v_mfma_f32_16x16x32_bf16 v[44:47], v[204:207], v[188:191], v[44:47]
    v_cvt_pk_bf16_f32 v115, v62, v63
    s_waitcnt lgkmcnt(3)
    v_mfma_f32_16x16x32_bf16 v[48:51], v[208:211], a[208:211], 0
    v_mfma_f32_16x16x32_bf16 v[52:55], v[208:211], a[240:243], 0
    v_mfma_f32_16x16x32_bf16 v[56:59], v[208:211], v[144:147], 0
    v_mfma_f32_16x16x32_bf16 v[60:63], v[208:211], v[176:179], 0
    s_waitcnt lgkmcnt(2)
    v_mfma_f32_16x16x32_bf16 v[48:51], v[212:215], a[212:215], v[48:51]
    v_mfma_f32_16x16x32_bf16 v[52:55], v[212:215], a[244:247], v[52:55]
    v_mfma_f32_16x16x32_bf16 v[56:59], v[212:215], v[148:151], v[56:59]
    v_mfma_f32_16x16x32_bf16 v[60:63], v[212:215], v[180:183], v[60:63]
    s_waitcnt lgkmcnt(1)
    v_mfma_f32_16x16x32_bf16 v[48:51], v[216:219], a[216:219], v[48:51]
    v_cvt_pk_bf16_f32 v72, v32, v33
    v_mfma_f32_16x16x32_bf16 v[52:55], v[216:219], a[248:251], v[52:55]
    v_cvt_pk_bf16_f32 v88, v36, v37
    v_mfma_f32_16x16x32_bf16 v[56:59], v[216:219], v[152:155], v[56:59]
    v_cvt_pk_bf16_f32 v104, v40, v41
    v_mfma_f32_16x16x32_bf16 v[60:63], v[216:219], v[184:187], v[60:63]
    v_cvt_pk_bf16_f32 v120, v44, v45
    s_waitcnt lgkmcnt(0)
    v_mfma_f32_16x16x32_bf16 v[48:51], v[220:223], a[220:223], v[48:51]
    v_cvt_pk_bf16_f32 v73, v34, v35
    v_mfma_f32_16x16x32_bf16 v[52:55], v[220:223], a[252:255], v[52:55]
    v_cvt_pk_bf16_f32 v89, v38, v39
    v_mfma_f32_16x16x32_bf16 v[56:59], v[220:223], v[156:159], v[56:59]
    v_cvt_pk_bf16_f32 v105, v42, v43
    v_mfma_f32_16x16x32_bf16 v[60:63], v[220:223], v[188:191], v[60:63]
    v_cvt_pk_bf16_f32 v121, v46, v47
    s_nop 0
    v_cvt_pk_bf16_f32 v74, v48, v49
    v_cvt_pk_bf16_f32 v75, v50, v51
    v_cvt_pk_bf16_f32 v90, v52, v53
    v_cvt_pk_bf16_f32 v91, v54, v55
    v_cvt_pk_bf16_f32 v106, v56, v57
    v_cvt_pk_bf16_f32 v107, v58, v59
    v_cvt_pk_bf16_f32 v122, v60, v61
    v_cvt_pk_bf16_f32 v123, v62, v63
    v_xor_b32 v9, 0x4000, v9
Li_19:
    s_load_dwordx2 s[8:9], s[0:1], 0
    s_load_dwordx2 s[12:13], s[0:1], 32
    s_load_dwordx2 s[16:17], s[0:1], 40
    s_mov_b32 s10, 0x400000
    s_mov_b32 s14, 0x400000
    s_lshl_b32 s20, s33, 5
    s_add_u32 s20, s20, s34
    s_lshl_b32 s21, s20, 4
    s_waitcnt lgkmcnt(0)
    s_load_dwordx4 s[68:71], s[16:17], s21
    s_waitcnt lgkmcnt(0)
    s_and_b32 s53, s37, 3
    s_mul_i32 s53, s53, 196608
    s_add_u32 s53, s53, s40
    s_and_b32 s54, s37, 3
    s_mul_i32 s54, s54, 196608
    s_add_u32 s54, s54, s41
    s_and_b32 s55, s37, 3
    s_mul_i32 s55, s55, 196608
    s_add_u32 s55, s55, s46
    v_mov_b64 v[32:33], 0
    v_mov_b64 v[34:35], 0
    v_mov_b64 v[36:37], 0
    v_mov_b64 v[38:39], 0
    v_mov_b64 v[40:41], 0
    v_mov_b64 v[42:43], 0
    v_mov_b64 v[44:45], 0
    v_mov_b64 v[46:47], 0
    v_mov_b64 v[48:49], 0
    v_mov_b64 v[50:51], 0
    v_mov_b64 v[52:53], 0
    v_mov_b64 v[54:55], 0
    v_smfmac_f32_16x16x64_bf16 v[32:35], v[224:227], a[0:7], v10
    v_smfmac_f32_16x16x64_bf16 v[36:39], v[224:227], a[32:39], v10
    v_smfmac_f32_16x16x64_bf16 v[40:43], v[224:227], a[64:71], v10
    v_smfmac_f32_16x16x64_bf16 v[44:47], v[224:227], a[96:103], v10
    v_smfmac_f32_16x16x64_bf16 v[48:51], v[224:227], a[128:135], v10
    v_smfmac_f32_16x16x64_bf16 v[52:55], v[224:227], a[160:167], v10
    v_smfmac_f32_16x16x64_bf16 v[32:35], v[228:231], a[8:15], v10
    v_smfmac_f32_16x16x64_bf16 v[36:39], v[228:231], a[40:47], v10
    v_smfmac_f32_16x16x64_bf16 v[40:43], v[228:231], a[72:79], v10
    v_smfmac_f32_16x16x64_bf16 v[44:47], v[228:231], a[104:111], v10
    v_smfmac_f32_16x16x64_bf16 v[48:51], v[228:231], a[136:143], v10
    v_smfmac_f32_16x16x64_bf16 v[52:55], v[228:231], a[168:175], v10
    v_smfmac_f32_16x16x64_bf16 v[32:35], v[232:235], a[16:23], v10
    v_smfmac_f32_16x16x64_bf16 v[36:39], v[232:235], a[48:55], v10
    v_smfmac_f32_16x16x64_bf16 v[40:43], v[232:235], a[80:87], v10
    v_smfmac_f32_16x16x64_bf16 v[44:47], v[232:235], a[112:119], v10
    v_smfmac_f32_16x16x64_bf16 v[48:51], v[232:235], a[144:151], v10
    v_smfmac_f32_16x16x64_bf16 v[52:55], v[232:235], a[176:183], v10
    v_smfmac_f32_16x16x64_bf16 v[32:35], v[236:239], a[24:31], v10
    v_smfmac_f32_16x16x64_bf16 v[36:39], v[236:239], a[56:63], v10
    v_smfmac_f32_16x16x64_bf16 v[40:43], v[236:239], a[88:95], v10
    v_smfmac_f32_16x16x64_bf16 v[44:47], v[236:239], a[120:127], v10
    v_smfmac_f32_16x16x64_bf16 v[48:51], v[236:239], a[152:159], v10
    v_smfmac_f32_16x16x64_bf16 v[52:55], v[236:239], a[184:191], v10
    v_min_u32 v17, 16, v2
    s_cmp_eq_u32 s32, 0
    s_cbranch_scc0 Lw_22
Lw_20:
    buffer_load_dword v16, v17, s[28:31], 0 offen offset:16 sc1
    s_waitcnt vmcnt(0)
    v_and_b32 v18, 0xff, v16
    v_cmp_ne_u32 vcc, 32, v18
    s_nop 0
    s_cbranch_vccz Lw_21
    s_sleep 12
    s_sub_u32 s39, s39, 1
    s_cbranch_scc0 Lw_20
    s_branch L_chain_fail
Lw_21:
    ds_write_b32 v17, v16 offset:24576
    s_waitcnt lgkmcnt(0)
Lw_22:
    s_barrier
    ds_read_b32 v16, v17 offset:24576
    s_waitcnt lgkmcnt(0)
    v_readlane_b32 s50, v16, 4
    s_nop 0
    s_cmp_gt_u32 s50, 0x100020
    s_cselect_b32 s50, 2, 0
    s_lshl_b32 s50, s50, 12
    s_add_u32 s42, s42, s50
    s_add_u32 s43, s43, s50
    v_readlane_b32 s49, v16, s33
    s_mul_i32 s38, s38, 32
    s_cmp_eq_u32 s49, s38
    s_cselect_b32 s38, 1, 0
    s_cmp_eq_u32 s38, 1
    s_cbranch_scc0 L_remote
    s_cmp_ge_u32 s32, 2
    s_cbranch_scc1 L_Hl
    v_mov_b32 v56, 0
    v_mov_b32 v57, 0
    v_mov_b32 v58, 0
    v_mov_b32 v59, 0
    v_mov_b32 v60, 0
    v_mov_b32 v61, 0
    v_mov_b32 v62, 0
    v_mov_b32 v63, 0
L_loop_Sl:
    v_pk_add_f32 v[32:33], v[32:33], v[34:35]
    ds_write_b64 v3, v[32:33] offset:0
    v_pk_add_f32 v[36:37], v[36:37], v[38:39]
    ds_write_b64 v3, v[36:37] offset:776
    v_pk_add_f32 v[40:41], v[40:41], v[42:43]
    ds_write_b64 v3, v[40:41] offset:1552
    v_pk_add_f32 v[44:45], v[44:45], v[46:47]
    ds_write_b64 v3, v[44:45] offset:2328
    v_pk_add_f32 v[48:49], v[48:49], v[50:51]
    ds_write_b64 v3, v[48:49] offset:3104
    v_pk_add_f32 v[52:53], v[52:53], v[54:55]
    ds_write_b64 v3, v[52:53] offset:3880
L_loopw_Sl:
    s_waitcnt lgkmcnt(0)
    s_barrier
    ds_read2st64_b32 v[208:209], v4 offset0:0 offset1:19
    ds_read2st64_b32 v[210:211], v4 offset0:38 offset1:57
    ds_read2st64_b32 v[212:213], v5 offset0:0 offset1:19
    ds_read2st64_b32 v[214:215], v5 offset0:38 offset1:57
    s_waitcnt lgkmcnt(2)
    v_pk_add_f32 v[208:209], v[208:209], v[210:211]
    v_add_f32 v208, v208, v209
    s_waitcnt lgkmcnt(0)
    v_pk_add_f32 v[212:213], v[212:213], v[214:215]
    v_add_f32 v212, v212, v213
    v_cvt_pk_bf16_f32 v26, v208, v212
    buffer_store_dword v26, v2, s[4:7], s53 offen offset:0
    s_lshl_b32 s97, s37, 17
    s_add_u32 s97, s97, s96
    s_cmp_eq_u32 s37, 63
    s_cbranch_scc1 L_lastk
    ds_read_b128 v[64:67], v8 offset:0
    ds_read_b128 v[68:71], v8 offset:1024
    ds_read_b128 v[72:75], v8 offset:2048
    ds_read_b128 v[76:79], v8 offset:3072
    ds_read_b128 v[80:83], v8 offset:4096
    ds_read_b128 v[84:87], v8 offset:5120
    ds_read_b128 v[88:91], v8 offset:6144
    ds_read_b128 v[92:95], v8 offset:7168
    s_min_u32 s51, s37, 60
    s_lshl_b32 s51, s51, 18
    s_add_u32 s51, s51, s84
    s_and_b32 s56, s37, 15
    s_lshl_b32 s56, s56, 19
    s_add_u32 s56, s56, s43
    s_and_b32 s52, s37, 4
    s_lshl_b32 s52, s52, 11
    s_xor_b32 s56, s56, s52
    s_and_b32 s57, s37, 3
    s_mul_i32 s57, s57, 131072
    s_add_u32 s57, s57, s44
    s_and_b32 s59, s37, 3
    s_mul_i32 s59, s59, 131072
    s_add_u32 s59, s59, s45
    s_and_b32 s54, s37, 3
    s_xor_b32 s54, s54, 2
    s_mul_i32 s54, s54, 196608
    s_add_u32 s54, s54, s40
    s_and_b32 s58, s37, 3
    s_xor_b32 s58, s58, 2
    s_mul_i32 s58, s58, 131072
    s_add_u32 s58, s58, s44
    v_mov_b64 v[32:33], 0
    v_mov_b64 v[34:35], 0
    v_mov_b64 v[36:37], 0
    buffer_load_dwordx4 v[192:195], v1, s[4:7], s55 offen offset:0 sc1
    buffer_load_dwordx4 v[196:199], v1, s[4:7], s55 offen offset:1024 sc1
    buffer_load_dwordx4 v[200:203], v1, s[4:7], s55 offen offset:2048 sc1
    buffer_load_dwordx4 v[204:207], v1, s[4:7], s55 offen offset:3072 sc1
    v_mov_b64 v[38:39], 0
    v_mov_b64 v[40:41], 0
    v_mov_b64 v[42:43], 0
    v_mov_b64 v[44:45], 0
    v_mov_b64 v[46:47], 0
    v_mov_b64 v[48:49], 0
    v_mov_b64 v[50:51], 0
    v_mov_b64 v[52:53], 0
    v_mov_b64 v[54:55], 0
    s_waitcnt lgkmcnt(0)
L_hopc_Sl:
    s_waitcnt vmcnt(3)
    v_smfmac_f32_16x16x64_bf16 v[56:59], v[192:195], v[64:71], v10
    v_max3_u32 v16, v192, v192, v193
    v_smfmac_f32_16x16x64_bf16 v[60:63], v[192:195], v[80:87], v10
    v_max3_u32 v16, v16, v194, v195
    s_waitcnt vmcnt(2)
    v_smfmac_f32_16x16x64_bf16 v[56:59], v[196:199], v[72:79], v10
    v_max3_u32 v16, v16, v196, v197
    v_smfmac_f32_16x16x64_bf16 v[60:63], v[196:199], v[88:95], v10
    v_max3_u32 v16, v16, v198, v199
    s_waitcnt vmcnt(1)
    v_mfma_f32_16x16x32_bf16 v[228:231], v[192:195], v[200:203], 0
    v_max3_u32 v16, v16, v200, v201
    v_max3_u32 v16, v16, v202, v203
    s_waitcnt vmcnt(0)
    v_mfma_f32_16x16x32_bf16 v[228:231], v[196:199], v[204:207], v[228:231]
    v_max3_u32 v16, v16, v204, v205
    v_max3_u32 v16, v16, v206, v207
    v_cmp_eq_u32 vcc, -1, v16
    v_pk_add_f32 v[18:19], v[56:57], v[58:59]
    v_pk_add_f32 v[20:21], v[60:61], v[62:63]
    s_cbranch_vccnz L_cretry_Sl
    s_nop 1
    v_cndmask_b32 v22, v228, v230, s[60:61]
    v_cndmask_b32 v23, v229, v231, s[60:61]
    s_nop 0
    v_add_f32_dpp v22, v22, v22 quad_perm:[2,3,0,1] row_mask:0xf bank_mask:0xf
    v_add_f32_dpp v23, v23, v23 quad_perm:[2,3,0,1] row_mask:0xf bank_mask:0xf
    v_max3_f32 v24, v18, v20, v22
    v_max3_f32 v25, v19, v21, v23
    s_nop 0
    v_max_f32_dpp v24, v24, v24 row_ror:8 row_mask:0xf bank_mask:0xf
    v_max_f32_dpp v25, v25, v25 row_ror:8 row_mask:0xf bank_mask:0xf
    s_nop 0
    v_max_f32_dpp v24, v24, v24 row_ror:4 row_mask:0xf bank_mask:0xf
    v_max_f32_dpp v25, v25, v25 row_ror:4 row_mask:0xf bank_mask:0xf
    s_nop 0
    v_max_f32_dpp v24, v24, v24 row_ror:2 row_mask:0xf bank_mask:0xf
    v_max_f32_dpp v25, v25, v25 row_ror:2 row_mask:0xf bank_mask:0xf
    s_nop 0
    v_max_f32_dpp v24, v24, v24 row_ror:1 row_mask:0xf bank_mask:0xf
    v_max_f32_dpp v25, v25, v25 row_ror:1 row_mask:0xf bank_mask:0xf
    v_pk_mul_f32 v[24:25], v[24:25], s[66:67]
    v_pk_fma_f32 v[18:19], v[18:19], s[66:67], v[24:25] neg_lo:[0,0,1] neg_hi:[0,0,1]
    v_pk_fma_f32 v[20:21], v[20:21], s[66:67], v[24:25] neg_lo:[0,0,1] neg_hi:[0,0,1]
    v_pk_fma_f32 v[22:23], v[22:23], s[66:67], v[24:25] neg_lo:[0,0,1] neg_hi:[0,0,1]
    v_exp_f32 v18, v18
    v_exp_f32 v19, v19
    v_exp_f32 v20, v20
    v_exp_f32 v21, v21
    v_exp_f32 v22, v22
    v_exp_f32 v23, v23
    v_pk_add_f32 v[24:25], v[18:19], v[20:21]
    v_fma_f32 v24, v22, 0.5, v24
    v_fma_f32 v25, v23, 0.5, v25
    s_nop 0
    v_add_f32_dpp v24, v24, v24 row_ror:8 row_mask:0xf bank_mask:0xf
    v_add_f32_dpp v25, v25, v25 row_ror:8 row_mask:0xf bank_mask:0xf
    s_nop 0
    v_add_f32_dpp v24, v24, v24 row_ror:4 row_mask:0xf bank_mask:0xf
    v_add_f32_dpp v25, v25, v25 row_ror:4 row_mask:0xf bank_mask:0xf
    s_nop 0
    v_add_f32_dpp v24, v24, v24 row_ror:2 row_mask:0xf bank_mask:0xf
    v_add_f32_dpp v25, v25, v25 row_ror:2 row_mask:0xf bank_mask:0xf
    s_nop 0
    v_add_f32_dpp v24, v24, v24 row_ror:1 row_mask:0xf bank_mask:0xf
    v_add_f32_dpp v25, v25, v25 row_ror:1 row_mask:0xf bank_mask:0xf
    v_rcp_f32 v24, v24
    v_rcp_f32 v25, v25
    s_nop 0
    v_pk_mul_f32 v[18:19], v[18:19], v[24:25]
    v_pk_mul_f32 v[20:21], v[20:21], v[24:25]
    v_pk_mul_f32 v[22:23], v[22:23], v[24:25]
    v_cvt_pk_bf16_f32 v228, v18, v19
    v_cvt_pk_bf16_f32 v229, v20, v21
    v_cvt_pk_bf16_f32 v230, v22, v23
    ds_write2_b32 v6, v228, v229 offset0:0 offset1:64
    ds_write_b32 v7, v230 offset:512
    s_waitcnt lgkmcnt(0)
    s_barrier
    s_add_u32 s37, s37, 1
    s_and_b32 s53, s37, 3
    s_mul_i32 s53, s53, 196608
    s_add_u32 s53, s53, s40
    s_and_b32 s55, s37, 3
    s_mul_i32 s55, s55, 196608
    s_add_u32 s55, s55, s46
    v_mov_b64 v[56:57], 0
    v_mov_b64 v[58:59], 0
    v_mov_b64 v[60:61], 0
    v_mov_b64 v[62:63], 0
    v_xor_b32 v8, 0x4000, v8
    s_cmp_lt_u32 s37, 55
    s_cbranch_scc1 Lls_23
    s_cmp_eq_u32 s37, 55
    s_cbranch_scc0 Lls_24
    s_lshl_b32 s22, s20, 15
    s_lshl_b32 s23, s32, 13
    s_add_u32 s22, s22, s23
    v_mov_b32 v188, s22
    v_bfe_u32 v190, v0, 0, 6
    v_lshl_add_u32 v188, v190, 4, v188
    v_subrev_u32 v189, 8, v188
    buffer_load_dwordx2 v[96:97], v189, s[12:15], 0 offen offset:0
    buffer_load_dwordx4 v[98:101], v188, s[12:15], 0 offen offset:0
Lls_24:
    s_cmp_eq_u32 s37, 56
    s_cbranch_scc0 Lls_25
    buffer_load_dwordx2 v[102:103], v188, s[12:15], 0 offen offset:1016
    buffer_load_dwordx4 v[104:107], v188, s[12:15], 0 offen offset:1024
Lls_25:
    s_cmp_eq_u32 s37, 57
    s_cbranch_scc0 Lls_26
    v_add_u32 v188, 4096, v188
    v_subrev_u32 v189, 8, v188
    buffer_load_dwordx2 v[120:121], v189, s[12:15], 0 offen offset:0
    buffer_load_dwordx4 v[122:125], v188, s[12:15], 0 offen offset:0
Lls_26:
    s_cmp_eq_u32 s37, 58
    s_cbranch_scc0 Lls_27
    buffer_load_dwordx2 v[126:127], v188, s[12:15], 0 offen offset:1016
    buffer_load_dwordx4 v[128:131], v188, s[12:15], 0 offen offset:1024
Lls_27:
    s_cmp_eq_u32 s37, 59
    s_cbranch_scc0 Lls_28
    s_lshl_b32 s23, s20, 15
    s_lshl_b32 s22, s32, 10
    s_add_u32 s23, s23, s22
    s_add_u32 s23, s23, 0x9200000
    s_cmp_lt_u32 s32, 2
    s_cselect_b32 s23, s23, 0x10000000
    v_lshlrev_b32 v189, 4, v0
    buffer_load_dwordx4 v[144:147], v189, s[4:7], s23 offen sc1
    s_add_u32 s23, s23, 4096
    buffer_load_dwordx4 v[148:151], v189, s[4:7], s23 offen sc1
Lls_28:
    s_cmp_eq_u32 s37, 60
    s_cbranch_scc0 Lls_29
    s_add_u32 s23, s23, 4096
    buffer_load_dwordx4 v[152:155], v189, s[4:7], s23 offen sc1
    s_add_u32 s23, s23, 4096
    buffer_load_dwordx4 v[156:159], v189, s[4:7], s23 offen sc1
Lls_29:
    s_cmp_eq_u32 s37, 61
    s_cbranch_scc0 Lls_30
    s_add_u32 s23, s23, 4096
    buffer_load_dwordx4 v[160:163], v189, s[4:7], s23 offen sc1
    s_add_u32 s23, s23, 4096
    buffer_load_dwordx4 v[164:167], v189, s[4:7], s23 offen sc1
Lls_30:
    s_cmp_eq_u32 s37, 62
    s_cbranch_scc0 Lls_31
    s_add_u32 s23, s23, 4096
    buffer_load_dwordx4 v[168:171], v189, s[4:7], s23 offen sc1
    s_add_u32 s23, s23, 4096
    buffer_load_dwordx4 v[172:175], v189, s[4:7], s23 offen sc1
    s_add_u32 s23, s23, 4096
Lls_31:
Lls_23:
    s_mov_b64 exec, 0xffff
    buffer_load_dword v27, v11, s[4:7], s51 offen sc1
    s_mov_b64 exec, -1
    buffer_store_dword v26, v2, s[4:7], s97 offen offset:0 sc1
    buffer_store_dword v28, v2, s[4:7], s54 offen offset:0
    buffer_store_dword v28, v14, s[4:7], s58 offen offset:0
    s_barrier
L_hopa_Sl:
    buffer_load_dwordx4 v[192:195], v12, s[4:7], s56 offen offset:0 sc1
    buffer_load_dwordx4 v[196:199], v12, s[4:7], s56 offen offset:1024 sc1
    buffer_load_dwordx4 v[200:203], v12, s[4:7], s56 offen offset:2048 sc1
    buffer_load_dwordx4 v[204:207], v12, s[4:7], s56 offen offset:3072 sc1
    s_mov_b64 exec, -1
    s_waitcnt vmcnt(3)
    v_mfma_f32_16x16x32_bf16 v[232:235], v[192:195], v[240:243], 0
    s_waitcnt vmcnt(2)
    v_mfma_f32_16x16x32_bf16 v[232:235], v[196:199], v[240:243], v[232:235]
    s_waitcnt vmcnt(1)
    v_mfma_f32_16x16x32_bf16 v[232:235], v[200:203], v[240:243], v[232:235]
    s_waitcnt vmcnt(0)
    v_mfma_f32_16x16x32_bf16 v[232:235], v[204:207], v[240:243], v[232:235]
    s_nop 7
    v_pk_add_f32 v[16:17], v[232:233], v[234:235]
    v_cvt_pk_bf16_f32 v232, v232, v233
    v_cvt_pk_bf16_f32 v233, v234, v235
    v_cmp_u_f32 vcc, v16, v17
    v_cndmask_b32 v232, v233, v232, s[86:87]
    s_cbranch_vccnz L_aslow_Sl
L_aok_Sl:
    buffer_store_dword v232, v14, s[4:7], s57 offen offset:0
L_askip_Sl:
    s_barrier
    buffer_load_dwordx4 v[192:195], v13, s[4:7], s59 offen offset:0 sc1
    buffer_load_dwordx4 v[196:199], v13, s[4:7], s59 offen offset:1024 sc1
    buffer_load_dwordx4 v[200:203], v13, s[4:7], s59 offen offset:2048 sc1
    buffer_load_dwordx4 v[204:207], v13, s[4:7], s59 offen offset:3072 sc1
    s_waitcnt vmcnt(3)
    v_max3_u32 v16, v192, v193, v194
    v_max_u32 v16, v16, v195
    v_cmp_eq_u32 vcc, -1, v16
    s_nop 0
    s_cbranch_vccnz L_qf0123_Sl
    v_smfmac_f32_16x16x64_bf16 v[32:35], v[192:195], a[0:7], v10
    v_smfmac_f32_16x16x64_bf16 v[36:39], v[192:195], a[32:39], v10
    s_waitcnt vmcnt(2)
    v_max3_u32 v16, v196, v197, v198
    v_smfmac_f32_16x16x64_bf16 v[40:43], v[192:195], a[64:71], v10
    v_max_u32 v16, v16, v199
    v_cmp_eq_u32 vcc, -1, v16
    v_smfmac_f32_16x16x64_bf16 v[44:47], v[192:195], a[96:103], v10
    v_smfmac_f32_16x16x64_bf16 v[48:51], v[192:195], a[128:135], v10
    v_smfmac_f32_16x16x64_bf16 v[52:55], v[192:195], a[160:167], v10
    s_cbranch_vccnz L_qf123_Sl
    v_smfmac_f32_16x16x64_bf16 v[32:35], v[196:199], a[8:15], v10
    v_smfmac_f32_16x16x64_bf16 v[36:39], v[196:199], a[40:47], v10
    s_waitcnt vmcnt(1)
    v_max3_u32 v16, v200, v201, v202
    v_smfmac_f32_16x16x64_bf16 v[40:43], v[196:199], a[72:79], v10
    v_max_u32 v16, v16, v203
    v_cmp_eq_u32 vcc, -1, v16
    v_smfmac_f32_16x16x64_bf16 v[44:47], v[196:199], a[104:111], v10
    v_smfmac_f32_16x16x64_bf16 v[48:51], v[196:199], a[136:143], v10
    v_smfmac_f32_16x16x64_bf16 v[52:55], v[196:199], a[168:175], v10
    s_cbranch_vccnz L_qf23_Sl
    v_smfmac_f32_16x16x64_bf16 v[32:35], v[200:203], a[16:23], v10
    v_smfmac_f32_16x16x64_bf16 v[36:39], v[200:203], a[48:55], v10
    s_waitcnt vmcnt(0)
    v_max3_u32 v16, v204, v205, v206
    v_smfmac_f32_16x16x64_bf16 v[40:43], v[200:203], a[80:87], v10
    v_max_u32 v16, v16, v207
    v_cmp_eq_u32 vcc, -1, v16
    v_smfmac_f32_16x16x64_bf16 v[44:47], v[200:203], a[112:119], v10
    v_smfmac_f32_16x16x64_bf16 v[48:51], v[200:203], a[144:151], v10
    v_smfmac_f32_16x16x64_bf16 v[52:55], v[200:203], a[176:183], v10
    s_cbranch_vccnz L_qf3_Sl
    v_smfmac_f32_16x16x64_bf16 v[32:35], v[204:207], a[24:31], v10
    v_smfmac_f32_16x16x64_bf16 v[36:39], v[204:207], a[56:63], v10
    v_smfmac_f32_16x16x64_bf16 v[40:43], v[204:207], a[88:95], v10
    v_smfmac_f32_16x16x64_bf16 v[44:47], v[204:207], a[120:127], v10
    v_smfmac_f32_16x16x64_bf16 v[48:51], v[204:207], a[152:159], v10
    v_smfmac_f32_16x16x64_bf16 v[52:55], v[204:207], a[184:191], v10
    s_nop 2
    v_pk_add_f32 v[32:33], v[32:33], v[34:35]
    ds_write_b64 v3, v[32:33] offset:0
    v_pk_add_f32 v[36:37], v[36:37], v[38:39]
    ds_write_b64 v3, v[36:37] offset:776
    v_pk_add_f32 v[40:41], v[40:41], v[42:43]
    ds_write_b64 v3, v[40:41] offset:1552
    v_pk_add_f32 v[44:45], v[44:45], v[46:47]
    ds_write_b64 v3, v[44:45] offset:2328
    v_pk_add_f32 v[48:49], v[48:49], v[50:51]
    ds_write_b64 v3, v[48:49] offset:3104
    v_pk_add_f32 v[52:53], v[52:53], v[54:55]
    ds_write_b64 v3, v[52:53] offset:3880
    s_branch L_loopw_Sl
L_qf0123_Sl:
    buffer_load_dwordx4 v[192:195], v13, s[4:7], s59 offen offset:0 sc1
    s_waitcnt vmcnt(3)
    v_max3_u32 v16, v196, v197, v198
    v_max_u32 v16, v16, v199
    v_cmp_eq_u32 vcc, -1, v16
L_qt1230_Sl:
    s_nop 0
    s_cbranch_vccnz L_qf1230_Sl
    v_smfmac_f32_16x16x64_bf16 v[32:35], v[196:199], a[8:15], v10
    v_smfmac_f32_16x16x64_bf16 v[36:39], v[196:199], a[40:47], v10
    v_smfmac_f32_16x16x64_bf16 v[40:43], v[196:199], a[72:79], v10
    v_smfmac_f32_16x16x64_bf16 v[44:47], v[196:199], a[104:111], v10
    s_waitcnt vmcnt(2)
    v_max3_u32 v16, v200, v201, v202
    v_smfmac_f32_16x16x64_bf16 v[48:51], v[196:199], a[136:143], v10
    v_max_u32 v16, v16, v203
    v_cmp_eq_u32 vcc, -1, v16
    v_smfmac_f32_16x16x64_bf16 v[52:55], v[196:199], a[168:175], v10
L_qt230_Sl:
    s_cbranch_vccnz L_qf230_Sl
    v_smfmac_f32_16x16x64_bf16 v[32:35], v[200:203], a[16:23], v10
    v_smfmac_f32_16x16x64_bf16 v[36:39], v[200:203], a[48:55], v10
    v_smfmac_f32_16x16x64_bf16 v[40:43], v[200:203], a[80:87], v10
    v_smfmac_f32_16x16x64_bf16 v[44:47], v[200:203], a[112:119], v10
    s_waitcnt vmcnt(1)
    v_max3_u32 v16, v204, v205, v206
    v_smfmac_f32_16x16x64_bf16 v[48:51], v[200:203], a[144:151], v10
    v_max_u32 v16, v16, v207
    v_cmp_eq_u32 vcc, -1, v16
    v_smfmac_f32_16x16x64_bf16 v[52:55], v[200:203], a[176:183], v10
L_qt30_Sl:
    s_cbranch_vccnz L_qf30_Sl
    v_smfmac_f32_16x16x64_bf16 v[32:35], v[204:207], a[24:31], v10
    v_smfmac_f32_16x16x64_bf16 v[36:39], v[204:207], a[56:63], v10
    v_smfmac_f32_16x16x64_bf16 v[40:43], v[204:207], a[88:95], v10
    v_smfmac_f32_16x16x64_bf16 v[44:47], v[204:207], a[120:127], v10
    s_waitcnt vmcnt(0)
    v_max3_u32 v16, v192, v193, v194
    v_smfmac_f32_16x16x64_bf16 v[48:51], v[204:207], a[152:159], v10
    v_max_u32 v16, v16, v195
    v_cmp_eq_u32 vcc, -1, v16
    v_smfmac_f32_16x16x64_bf16 v[52:55], v[204:207], a[184:191], v10
L_qt0_Sl:
    s_cbranch_vccnz L_qf0_Sl
    v_smfmac_f32_16x16x64_bf16 v[32:35], v[192:195], a[0:7], v10
    v_smfmac_f32_16x16x64_bf16 v[36:39], v[192:195], a[32:39], v10
    v_smfmac_f32_16x16x64_bf16 v[40:43], v[192:195], a[64:71], v10
    v_smfmac_f32_16x16x64_bf16 v[44:47], v[192:195], a[96:103], v10
    v_smfmac_f32_16x16x64_bf16 v[48:51], v[192:195], a[128:135], v10
    v_smfmac_f32_16x16x64_bf16 v[52:55], v[192:195], a[160:167], v10
    s_nop 2
    v_pk_add_f32 v[32:33], v[32:33], v[34:35]
    ds_write_b64 v3, v[32:33] offset:0
    v_pk_add_f32 v[36:37], v[36:37], v[38:39]
    ds_write_b64 v3, v[36:37] offset:776
    v_pk_add_f32 v[40:41], v[40:41], v[42:43]
    ds_write_b64 v3, v[40:41] offset:1552
    v_pk_add_f32 v[44:45], v[44:45], v[46:47]
    ds_write_b64 v3, v[44:45] offset:2328
    v_pk_add_f32 v[48:49], v[48:49], v[50:51]
    ds_write_b64 v3, v[48:49] offset:3104
    v_pk_add_f32 v[52:53], v[52:53], v[54:55]
    ds_write_b64 v3, v[52:53] offset:3880
    s_branch L_loopw_Sl
L_qf123_Sl:
    buffer_load_dwordx4 v[196:199], v13, s[4:7], s59 offen offset:1024 sc1
    s_waitcnt vmcnt(2)
    v_max3_u32 v16, v200, v201, v202
    v_max_u32 v16, v16, v203
    v_cmp_eq_u32 vcc, -1, v16
L_qt231_Sl:
    s_nop 0
    s_cbranch_vccnz L_qf231_Sl
    v_smfmac_f32_16x16x64_bf16 v[32:35], v[200:203], a[16:23], v10
    v_smfmac_f32_16x16x64_bf16 v[36:39], v[200:203], a[48:55], v10
    v_smfmac_f32_16x16x64_bf16 v[40:43], v[200:203], a[80:87], v10
    v_smfmac_f32_16x16x64_bf16 v[44:47], v[200:203], a[112:119], v10
    s_waitcnt vmcnt(1)
    v_max3_u32 v16, v204, v205, v206
    v_smfmac_f32_16x16x64_bf16 v[48:51], v[200:203], a[144:151], v10
    v_max_u32 v16, v16, v207
    v_cmp_eq_u32 vcc, -1, v16
    v_smfmac_f32_16x16x64_bf16 v[52:55], v[200:203], a[176:183], v10
L_qt31_Sl:
    s_cbranch_vccnz L_qf31_Sl
    v_smfmac_f32_16x16x64_bf16 v[32:35], v[204:207], a[24:31], v10
    v_smfmac_f32_16x16x64_bf16 v[36:39], v[204:207], a[56:63], v10
    v_smfmac_f32_16x16x64_bf16 v[40:43], v[204:207], a[88:95], v10
    v_smfmac_f32_16x16x64_bf16 v[44:47], v[204:207], a[120:127], v10
    s_waitcnt vmcnt(0)
    v_max3_u32 v16, v196, v197, v198
    v_smfmac_f32_16x16x64_bf16 v[48:51], v[204:207], a[152:159], v10
    v_max_u32 v16, v16, v199
    v_cmp_eq_u32 vcc, -1, v16
    v_smfmac_f32_16x16x64_bf16 v[52:55], v[204:207], a[184:191], v10
L_qt1_Sl:
    s_cbranch_vccnz L_qf1_Sl
    v_smfmac_f32_16x16x64_bf16 v[32:35], v[196:199], a[8:15], v10
    v_smfmac_f32_16x16x64_bf16 v[36:39], v[196:199], a[40:47], v10
    v_smfmac_f32_16x16x64_bf16 v[40:43], v[196:199], a[72:79], v10
    v_smfmac_f32_16x16x64_bf16 v[44:47], v[196:199], a[104:111], v10
    v_smfmac_f32_16x16x64_bf16 v[48:51], v[196:199], a[136:143], v10
    v_smfmac_f32_16x16x64_bf16 v[52:55], v[196:199], a[168:175], v10
    s_nop 2
    v_pk_add_f32 v[32:33], v[32:33], v[34:35]
    ds_write_b64 v3, v[32:33] offset:0
    v_pk_add_f32 v[36:37], v[36:37], v[38:39]
    ds_write_b64 v3, v[36:37] offset:776
    v_pk_add_f32 v[40:41], v[40:41], v[42:43]
    ds_write_b64 v3, v[40:41] offset:1552
    v_pk_add_f32 v[44:45], v[44:45], v[46:47]
    ds_write_b64 v3, v[44:45] offset:2328
    v_pk_add_f32 v[48:49], v[48:49], v[50:51]
    ds_write_b64 v3, v[48:49] offset:3104
    v_pk_add_f32 v[52:53], v[52:53], v[54:55]
    ds_write_b64 v3, v[52:53] offset:3880
    s_branch L_loopw_Sl
L_qf23_Sl:
    buffer_load_dwordx4 v[200:203], v13, s[4:7], s59 offen offset:2048 sc1
    s_waitcnt vmcnt(1)
    v_max3_u32 v16, v204, v205, v206
    v_max_u32 v16, v16, v207
    v_cmp_eq_u32 vcc, -1, v16
L_qt32_Sl:
    s_nop 0
    s_cbranch_vccnz L_qf32_Sl
    v_smfmac_f32_16x16x64_bf16 v[32:35], v[204:207], a[24:31], v10
    v_smfmac_f32_16x16x64_bf16 v[36:39], v[204:207], a[56:63], v10
    v_smfmac_f32_16x16x64_bf16 v[40:43], v[204:207], a[88:95], v10
    v_smfmac_f32_16x16x64_bf16 v[44:47], v[204:207], a[120:127], v10
    s_waitcnt vmcnt(0)
    v_max3_u32 v16, v200, v201, v202
    v_smfmac_f32_16x16x64_bf16 v[48:51], v[204:207], a[152:159], v10
    v_max_u32 v16, v16, v203
    v_cmp_eq_u32 vcc, -1, v16
    v_smfmac_f32_16x16x64_bf16 v[52:55], v[204:207], a[184:191], v10
L_qt2_Sl:
    s_cbranch_vccnz L_qf2_Sl
    v_smfmac_f32_16x16x64_bf16 v[32:35], v[200:203], a[16:23], v10
    v_smfmac_f32_16x16x64_bf16 v[36:39], v[200:203], a[48:55], v10
    v_smfmac_f32_16x16x64_bf16 v[40:43], v[200:203], a[80:87], v10
    v_smfmac_f32_16x16x64_bf16 v[44:47], v[200:203], a[112:119], v10
    v_smfmac_f32_16x16x64_bf16 v[48:51], v[200:203], a[144:151], v10
    v_smfmac_f32_16x16x64_bf16 v[52:55], v[200:203], a[176:183], v10
    s_nop 2
    v_pk_add_f32 v[32:33], v[32:33], v[34:35]
    ds_write_b64 v3, v[32:33] offset:0
    v_pk_add_f32 v[36:37], v[36:37], v[38:39]
    ds_write_b64 v3, v[36:37] offset:776
    v_pk_add_f32 v[40:41], v[40:41], v[42:43]
    ds_write_b64 v3, v[40:41] offset:1552
    v_pk_add_f32 v[44:45], v[44:45], v[46:47]
    ds_write_b64 v3, v[44:45] offset:2328
    v_pk_add_f32 v[48:49], v[48:49], v[50:51]
    ds_write_b64 v3, v[48:49] offset:3104
    v_pk_add_f32 v[52:53], v[52:53], v[54:55]
    ds_write_b64 v3, v[52:53] offset:3880
    s_branch L_loopw_Sl
L_qf3_Sl:
    buffer_load_dwordx4 v[204:207], v13, s[4:7], s59 offen offset:3072 sc1
    s_sub_u32 s39, s39, 1
    s_cbranch_scc1 L_chain_fail
    s_waitcnt vmcnt(0)
    v_max3_u32 v16, v204, v205, v206
    v_max_u32 v16, v16, v207
    v_cmp_eq_u32 vcc, -1, v16
L_qt3_Sl:
    s_nop 0
    s_cbranch_vccnz L_qf3_Sl
    v_smfmac_f32_16x16x64_bf16 v[32:35], v[204:207], a[24:31], v10
    v_smfmac_f32_16x16x64_bf16 v[36:39], v[204:207], a[56:63], v10
    v_smfmac_f32_16x16x64_bf16 v[40:43], v[204:207], a[88:95], v10
    v_smfmac_f32_16x16x64_bf16 v[44:47], v[204:207], a[120:127], v10
    v_smfmac_f32_16x16x64_bf16 v[48:51], v[204:207], a[152:159], v10
    v_smfmac_f32_16x16x64_bf16 v[52:55], v[204:207], a[184:191], v10
    s_nop 2
    v_pk_add_f32 v[32:33], v[32:33], v[34:35]
    ds_write_b64 v3, v[32:33] offset:0
    v_pk_add_f32 v[36:37], v[36:37], v[38:39]
    ds_write_b64 v3, v[36:37] offset:776
    v_pk_add_f32 v[40:41], v[40:41], v[42:43]
    ds_write_b64 v3, v[40:41] offset:1552
    v_pk_add_f32 v[44:45], v[44:45], v[46:47]
    ds_write_b64 v3, v[44:45] offset:2328
    v_pk_add_f32 v[48:49], v[48:49], v[50:51]
    ds_write_b64 v3, v[48:49] offset:3104
    v_pk_add_f32 v[52:53], v[52:53], v[54:55]
    ds_write_b64 v3, v[52:53] offset:3880
    s_branch L_loopw_Sl
L_qf1230_Sl:
    buffer_load_dwordx4 v[196:199], v13, s[4:7], s59 offen offset:1024 sc1
    s_waitcnt vmcnt(3)
    v_max3_u32 v16, v200, v201, v202
    v_max_u32 v16, v16, v203
    v_cmp_eq_u32 vcc, -1, v16
L_qt2301_Sl:
    s_nop 0
    s_cbranch_vccnz L_qf2301_Sl
    v_smfmac_f32_16x16x64_bf16 v[32:35], v[200:203], a[16:23], v10
    v_smfmac_f32_16x16x64_bf16 v[36:39], v[200:203], a[48:55], v10
    v_smfmac_f32_16x16x64_bf16 v[40:43], v[200:203], a[80:87], v10
    v_smfmac_f32_16x16x64_bf16 v[44:47], v[200:203], a[112:119], v10
    s_waitcnt vmcnt(2)
    v_max3_u32 v16, v204, v205, v206
    v_smfmac_f32_16x16x64_bf16 v[48:51], v[200:203], a[144:151], v10
    v_max_u32 v16, v16, v207
    v_cmp_eq_u32 vcc, -1, v16
    v_smfmac_f32_16x16x64_bf16 v[52:55], v[200:203], a[176:183], v10
L_qt301_Sl:
    s_cbranch_vccnz L_qf301_Sl
    v_smfmac_f32_16x16x64_bf16 v[32:35], v[204:207], a[24:31], v10
    v_smfmac_f32_16x16x64_bf16 v[36:39], v[204:207], a[56:63], v10
    v_smfmac_f32_16x16x64_bf16 v[40:43], v[204:207], a[88:95], v10
    v_smfmac_f32_16x16x64_bf16 v[44:47], v[204:207], a[120:127], v10
    s_waitcnt vmcnt(1)
    v_max3_u32 v16, v192, v193, v194
    v_smfmac_f32_16x16x64_bf16 v[48:51], v[204:207], a[152:159], v10
    v_max_u32 v16, v16, v195
    v_cmp_eq_u32 vcc, -1, v16
    v_smfmac_f32_16x16x64_bf16 v[52:55], v[204:207], a[184:191], v10
L_qt01_Sl:
    s_cbranch_vccnz L_qf01_Sl
    v_smfmac_f32_16x16x64_bf16 v[32:35], v[192:195], a[0:7], v10
    v_smfmac_f32_16x16x64_bf16 v[36:39], v[192:195], a[32:39], v10
    v_smfmac_f32_16x16x64_bf16 v[40:43], v[192:195], a[64:71], v10
    v_smfmac_f32_16x16x64_bf16 v[44:47], v[192:195], a[96:103], v10
    s_waitcnt vmcnt(0)
    v_max3_u32 v16, v196, v197, v198
    v_smfmac_f32_16x16x64_bf16 v[48:51], v[192:195], a[128:135], v10
    v_max_u32 v16, v16, v199
    v_cmp_eq_u32 vcc, -1, v16
    v_smfmac_f32_16x16x64_bf16 v[52:55], v[192:195], a[160:167], v10
    s_branch L_qt1_Sl
L_qf230_Sl:
    buffer_load_dwordx4 v[200:203], v13, s[4:7], s59 offen offset:2048 sc1
    s_waitcnt vmcnt(2)
    v_max3_u32 v16, v204, v205, v206
    v_max_u32 v16, v16, v207
    v_cmp_eq_u32 vcc, -1, v16
L_qt302_Sl:
    s_nop 0
    s_cbranch_vccnz L_qf302_Sl
    v_smfmac_f32_16x16x64_bf16 v[32:35], v[204:207], a[24:31], v10
    v_smfmac_f32_16x16x64_bf16 v[36:39], v[204:207], a[56:63], v10
    v_smfmac_f32_16x16x64_bf16 v[40:43], v[204:207], a[88:95], v10
    v_smfmac_f32_16x16x64_bf16 v[44:47], v[204:207], a[120:127], v10
    s_waitcnt vmcnt(1)
    v_max3_u32 v16, v192, v193, v194
    v_smfmac_f32_16x16x64_bf16 v[48:51], v[204:207], a[152:159], v10
    v_max_u32 v16, v16, v195
    v_cmp_eq_u32 vcc, -1, v16
    v_smfmac_f32_16x16x64_bf16 v[52:55], v[204:207], a[184:191], v10
L_qt02_Sl:
    s_cbranch_vccnz L_qf02_Sl
    v_smfmac_f32_16x16x64_bf16 v[32:35], v[192:195], a[0:7], v10
    v_smfmac_f32_16x16x64_bf16 v[36:39], v[192:195], a[32:39], v10
    v_smfmac_f32_16x16x64_bf16 v[40:43], v[192:195], a[64:71], v10
    v_smfmac_f32_16x16x64_bf16 v[44:47], v[192:195], a[96:103], v10
    s_waitcnt vmcnt(0)
    v_max3_u32 v16, v200, v201, v202
    v_smfmac_f32_16x16x64_bf16 v[48:51], v[192:195], a[128:135], v10
    v_max_u32 v16, v16, v203
    v_cmp_eq_u32 vcc, -1, v16
    v_smfmac_f32_16x16x64_bf16 v[52:55], v[192:195], a[160:167], v10
    s_branch L_qt2_Sl
L_qf30_Sl:
    buffer_load_dwordx4 v[204:207], v13, s[4:7], s59 offen offset:3072 sc1
    s_sub_u32 s39, s39, 1
    s_cbranch_scc1 L_chain_fail
    s_waitcnt vmcnt(1)
    v_max3_u32 v16, v192, v193, v194
    v_max_u32 v16, v16, v195
    v_cmp_eq_u32 vcc, -1, v16
L_qt03_Sl:
    s_nop 0
    s_cbranch_vccnz L_qf03_Sl
    v_smfmac_f32_16x16x64_bf16 v[32:35], v[192:195], a[0:7], v10
    v_smfmac_f32_16x16x64_bf16 v[36:39], v[192:195], a[32:39], v10
    v_smfmac_f32_16x16x64_bf16 v[40:43], v[192:195], a[64:71], v10
    v_smfmac_f32_16x16x64_bf16 v[44:47], v[192:195], a[96:103], v10
    s_waitcnt vmcnt(0)
    v_max3_u32 v16, v204, v205, v206
    v_smfmac_f32_16x16x64_bf16 v[48:51], v[192:195], a[128:135], v10
    v_max_u32 v16, v16, v207
    v_cmp_eq_u32 vcc, -1, v16
    v_smfmac_f32_16x16x64_bf16 v[52:55], v[192:195], a[160:167], v10
    s_branch L_qt3_Sl
L_qf0_Sl:
    buffer_load_dwordx4 v[192:195], v13, s[4:7], s59 offen offset:0 sc1
    s_sub_u32 s39, s39, 1
    s_cbranch_scc1 L_chain_fail
    s_waitcnt vmcnt(0)
    v_max3_u32 v16, v192, v193, v194
    v_max_u32 v16, v16, v195
    v_cmp_eq_u32 vcc, -1, v16
    s_nop 0
    s_cbranch_vccnz L_qf0_Sl
    s_branch L_qt0_Sl
L_qf231_Sl:
    buffer_load_dwordx4 v[200:203], v13, s[4:7], s59 offen offset:2048 sc1
    s_waitcnt vmcnt(2)
    v_max3_u32 v16, v204, v205, v206
    v_max_u32 v16, v16, v207
    v_cmp_eq_u32 vcc, -1, v16
L_qt312_Sl:
    s_nop 0
    s_cbranch_vccnz L_qf312_Sl
    v_smfmac_f32_16x16x64_bf16 v[32:35], v[204:207], a[24:31], v10
    v_smfmac_f32_16x16x64_bf16 v[36:39], v[204:207], a[56:63], v10
    v_smfmac_f32_16x16x64_bf16 v[40:43], v[204:207], a[88:95], v10
    v_smfmac_f32_16x16x64_bf16 v[44:47], v[204:207], a[120:127], v10
    s_waitcnt vmcnt(1)
    v_max3_u32 v16, v196, v197, v198
    v_smfmac_f32_16x16x64_bf16 v[48:51], v[204:207], a[152:159], v10
    v_max_u32 v16, v16, v199
    v_cmp_eq_u32 vcc, -1, v16
    v_smfmac_f32_16x16x64_bf16 v[52:55], v[204:207], a[184:191], v10
L_qt12_Sl:
    s_cbranch_vccnz L_qf12_Sl
    v_smfmac_f32_16x16x64_bf16 v[32:35], v[196:199], a[8:15], v10
    v_smfmac_f32_16x16x64_bf16 v[36:39], v[196:199], a[40:47], v10
    v_smfmac_f32_16x16x64_bf16 v[40:43], v[196:199], a[72:79], v10
    v_smfmac_f32_16x16x64_bf16 v[44:47], v[196:199], a[104:111], v10
    s_waitcnt vmcnt(0)
    v_max3_u32 v16, v200, v201, v202
    v_smfmac_f32_16x16x64_bf16 v[48:51], v[196:199], a[136:143], v10
    v_max_u32 v16, v16, v203
    v_cmp_eq_u32 vcc, -1, v16
    v_smfmac_f32_16x16x64_bf16 v[52:55], v[196:199], a[168:175], v10
    s_branch L_qt2_Sl
L_qf31_Sl:
    buffer_load_dwordx4 v[204:207], v13, s[4:7], s59 offen offset:3072 sc1
    s_sub_u32 s39, s39, 1
    s_cbranch_scc1 L_chain_fail
    s_waitcnt vmcnt(1)
    v_max3_u32 v16, v196, v197, v198
    v_max_u32 v16, v16, v199
    v_cmp_eq_u32 vcc, -1, v16
L_qt13_Sl:
    s_nop 0
    s_cbranch_vccnz L_qf13_Sl
    v_smfmac_f32_16x16x64_bf16 v[32:35], v[196:199], a[8:15], v10
    v_smfmac_f32_16x16x64_bf16 v[36:39], v[196:199], a[40:47], v10
    v_smfmac_f32_16x16x64_bf16 v[40:43], v[196:199], a[72:79], v10
    v_smfmac_f32_16x16x64_bf16 v[44:47], v[196:199], a[104:111], v10
    s_waitcnt vmcnt(0)
    v_max3_u32 v16, v204, v205, v206
    v_smfmac_f32_16x16x64_bf16 v[48:51], v[196:199], a[136:143], v10
    v_max_u32 v16, v16, v207
    v_cmp_eq_u32 vcc, -1, v16
    v_smfmac_f32_16x16x64_bf16 v[52:55], v[196:199], a[168:175], v10
    s_branch L_qt3_Sl
L_qf1_Sl:
    buffer_load_dwordx4 v[196:199], v13, s[4:7], s59 offen offset:1024 sc1
    s_sub_u32 s39, s39, 1
    s_cbranch_scc1 L_chain_fail
    s_waitcnt vmcnt(0)
    v_max3_u32 v16, v196, v197, v198
    v_max_u32 v16, v16, v199
    v_cmp_eq_u32 vcc, -1, v16
    s_nop 0
    s_cbranch_vccnz L_qf1_Sl
    s_branch L_qt1_Sl
L_qf32_Sl:
    buffer_load_dwordx4 v[204:207], v13, s[4:7], s59 offen offset:3072 sc1
    s_sub_u32 s39, s39, 1
    s_cbranch_scc1 L_chain_fail
    s_waitcnt vmcnt(1)
    v_max3_u32 v16, v200, v201, v202
    v_max_u32 v16, v16, v203
    v_cmp_eq_u32 vcc, -1, v16
L_qt23_Sl:
    s_nop 0
    s_cbranch_vccnz L_qf23_Sl
    v_smfmac_f32_16x16x64_bf16 v[32:35], v[200:203], a[16:23], v10
    v_smfmac_f32_16x16x64_bf16 v[36:39], v[200:203], a[48:55], v10
    v_smfmac_f32_16x16x64_bf16 v[40:43], v[200:203], a[80:87], v10
    v_smfmac_f32_16x16x64_bf16 v[44:47], v[200:203], a[112:119], v10
    s_waitcnt vmcnt(0)
    v_max3_u32 v16, v204, v205, v206
    v_smfmac_f32_16x16x64_bf16 v[48:51], v[200:203], a[144:151], v10
    v_max_u32 v16, v16, v207
    v_cmp_eq_u32 vcc, -1, v16
    v_smfmac_f32_16x16x64_bf16 v[52:55], v[200:203], a[176:183], v10
    s_branch L_qt3_Sl
L_qf2_Sl:
    buffer_load_dwordx4 v[200:203], v13, s[4:7], s59 offen offset:2048 sc1
    s_sub_u32 s39, s39, 1
    s_cbranch_scc1 L_chain_fail
    s_waitcnt vmcnt(0)
    v_max3_u32 v16, v200, v201, v202
    v_max_u32 v16, v16, v203
    v_cmp_eq_u32 vcc, -1, v16
    s_nop 0
    s_cbranch_vccnz L_qf2_Sl
    s_branch L_qt2_Sl
L_qf2301_Sl:
    buffer_load_dwordx4 v[200:203], v13, s[4:7], s59 offen offset:2048 sc1
    s_waitcnt vmcnt(3)
    v_max3_u32 v16, v204, v205, v206
    v_max_u32 v16, v16, v207
    v_cmp_eq_u32 vcc, -1, v16
L_qt3012_Sl:
    s_nop 0
    s_cbranch_vccnz L_qf3012_Sl
    v_smfmac_f32_16x16x64_bf16 v[32:35], v[204:207], a[24:31], v10
    v_smfmac_f32_16x16x64_bf16 v[36:39], v[204:207], a[56:63], v10
    v_smfmac_f32_16x16x64_bf16 v[40:43], v[204:207], a[88:95], v10
    v_smfmac_f32_16x16x64_bf16 v[44:47], v[204:207], a[120:127], v10
    s_waitcnt vmcnt(2)
    v_max3_u32 v16, v192, v193, v194
    v_smfmac_f32_16x16x64_bf16 v[48:51], v[204:207], a[152:159], v10
    v_max_u32 v16, v16, v195
    v_cmp_eq_u32 vcc, -1, v16
    v_smfmac_f32_16x16x64_bf16 v[52:55], v[204:207], a[184:191], v10
L_qt012_Sl:
    s_cbranch_vccnz L_qf012_Sl
    v_smfmac_f32_16x16x64_bf16 v[32:35], v[192:195], a[0:7], v10
    v_smfmac_f32_16x16x64_bf16 v[36:39], v[192:195], a[32:39], v10
    v_smfmac_f32_16x16x64_bf16 v[40:43], v[192:195], a[64:71], v10
    v_smfmac_f32_16x16x64_bf16 v[44:47], v[192:195], a[96:103], v10
    s_waitcnt vmcnt(1)
    v_max3_u32 v16, v196, v197, v198
    v_smfmac_f32_16x16x64_bf16 v[48:51], v[192:195], a[128:135], v10
    v_max_u32 v16, v16, v199
    v_cmp_eq_u32 vcc, -1, v16
    v_smfmac_f32_16x16x64_bf16 v[52:55], v[192:195], a[160:167], v10
    s_branch L_qt12_Sl
L_qf301_Sl:
    buffer_load_dwordx4 v[204:207], v13, s[4:7], s59 offen offset:3072 sc1
    s_sub_u32 s39, s39, 1
    s_cbranch_scc1 L_chain_fail
    s_waitcnt vmcnt(2)
    v_max3_u32 v16, v192, v193, v194
    v_max_u32 v16, v16, v195
    v_cmp_eq_u32 vcc, -1, v16
L_qt013_Sl:
    s_nop 0
    s_cbranch_vccnz L_qf013_Sl
    v_smfmac_f32_16x16x64_bf16 v[32:35], v[192:195], a[0:7], v10
    v_smfmac_f32_16x16x64_bf16 v[36:39], v[192:195], a[32:39], v10
    v_smfmac_f32_16x16x64_bf16 v[40:43], v[192:195], a[64:71], v10
    v_smfmac_f32_16x16x64_bf16 v[44:47], v[192:195], a[96:103], v10
    s_waitcnt vmcnt(1)
    v_max3_u32 v16, v196, v197, v198
    v_smfmac_f32_16x16x64_bf16 v[48:51], v[192:195], a[128:135], v10
    v_max_u32 v16, v16, v199
    v_cmp_eq_u32 vcc, -1, v16
    v_smfmac_f32_16x16x64_bf16 v[52:55], v[192:195], a[160:167], v10
    s_branch L_qt13_Sl
L_qf01_Sl:
    buffer_load_dwordx4 v[192:195], v13, s[4:7], s59 offen offset:0 sc1
    s_waitcnt vmcnt(1)
    v_max3_u32 v16, v196, v197, v198
    v_max_u32 v16, v16, v199
    v_cmp_eq_u32 vcc, -1, v16
L_qt10_Sl:
    s_nop 0
    s_cbranch_vccnz L_qf10_Sl
    v_smfmac_f32_16x16x64_bf16 v[32:35], v[196:199], a[8:15], v10
    v_smfmac_f32_16x16x64_bf16 v[36:39], v[196:199], a[40:47], v10
    v_smfmac_f32_16x16x64_bf16 v[40:43], v[196:199], a[72:79], v10
    v_smfmac_f32_16x16x64_bf16 v[44:47], v[196:199], a[104:111], v10
    s_waitcnt vmcnt(0)
    v_max3_u32 v16, v192, v193, v194
    v_smfmac_f32_16x16x64_bf16 v[48:51], v[196:199], a[136:143], v10
    v_max_u32 v16, v16, v195
    v_cmp_eq_u32 vcc, -1, v16
    v_smfmac_f32_16x16x64_bf16 v[52:55], v[196:199], a[168:175], v10
    s_branch L_qt0_Sl
L_qf302_Sl:
    buffer_load_dwordx4 v[204:207], v13, s[4:7], s59 offen offset:3072 sc1
    s_sub_u32 s39, s39, 1
    s_cbranch_scc1 L_chain_fail
    s_waitcnt vmcnt(2)
    v_max3_u32 v16, v192, v193, v194
    v_max_u32 v16, v16, v195
    v_cmp_eq_u32 vcc, -1, v16
L_qt023_Sl:
    s_nop 0
    s_cbranch_vccnz L_qf023_Sl
    v_smfmac_f32_16x16x64_bf16 v[32:35], v[192:195], a[0:7], v10
    v_smfmac_f32_16x16x64_bf16 v[36:39], v[192:195], a[32:39], v10
    v_smfmac_f32_16x16x64_bf16 v[40:43], v[192:195], a[64:71], v10
    v_smfmac_f32_16x16x64_bf16 v[44:47], v[192:195], a[96:103], v10
    s_waitcnt vmcnt(1)
    v_max3_u32 v16, v200, v201, v202
    v_smfmac_f32_16x16x64_bf16 v[48:51], v[192:195], a[128:135], v10
    v_max_u32 v16, v16, v203
    v_cmp_eq_u32 vcc, -1, v16
    v_smfmac_f32_16x16x64_bf16 v[52:55], v[192:195], a[160:167], v10
    s_branch L_qt23_Sl
L_qf02_Sl:
    buffer_load_dwordx4 v[192:195], v13, s[4:7], s59 offen offset:0 sc1
    s_waitcnt vmcnt(1)
    v_max3_u32 v16, v200, v201, v202
    v_max_u32 v16, v16, v203
    v_cmp_eq_u32 vcc, -1, v16
L_qt20_Sl:
    s_nop 0
    s_cbranch_vccnz L_qf20_Sl
    v_smfmac_f32_16x16x64_bf16 v[32:35], v[200:203], a[16:23], v10
    v_smfmac_f32_16x16x64_bf16 v[36:39], v[200:203], a[48:55], v10
    v_smfmac_f32_16x16x64_bf16 v[40:43], v[200:203], a[80:87], v10
    v_smfmac_f32_16x16x64_bf16 v[44:47], v[200:203], a[112:119], v10
    s_waitcnt vmcnt(0)
    v_max3_u32 v16, v192, v193, v194
    v_smfmac_f32_16x16x64_bf16 v[48:51], v[200:203], a[144:151], v10
    v_max_u32 v16, v16, v195
    v_cmp_eq_u32 vcc, -1, v16
    v_smfmac_f32_16x16x64_bf16 v[52:55], v[200:203], a[176:183], v10
    s_branch L_qt0_Sl
L_qf03_Sl:
    buffer_load_dwordx4 v[192:195], v13, s[4:7], s59 offen offset:0 sc1
    s_waitcnt vmcnt(1)
    v_max3_u32 v16, v204, v205, v206
    v_max_u32 v16, v16, v207
    v_cmp_eq_u32 vcc, -1, v16
    s_nop 0
    s_cbranch_vccnz L_qf30_Sl
    s_branch L_qt30_Sl
L_qf312_Sl:
    buffer_load_dwordx4 v[204:207], v13, s[4:7], s59 offen offset:3072 sc1
    s_sub_u32 s39, s39, 1
    s_cbranch_scc1 L_chain_fail
    s_waitcnt vmcnt(2)
    v_max3_u32 v16, v196, v197, v198
    v_max_u32 v16, v16, v199
    v_cmp_eq_u32 vcc, -1, v16
L_qt123_Sl:
    s_nop 0
    s_cbranch_vccnz L_qf123_Sl
    v_smfmac_f32_16x16x64_bf16 v[32:35], v[196:199], a[8:15], v10
    v_smfmac_f32_16x16x64_bf16 v[36:39], v[196:199], a[40:47], v10
    v_smfmac_f32_16x16x64_bf16 v[40:43], v[196:199], a[72:79], v10
    v_smfmac_f32_16x16x64_bf16 v[44:47], v[196:199], a[104:111], v10
    s_waitcnt vmcnt(1)
    v_max3_u32 v16, v200, v201, v202
    v_smfmac_f32_16x16x64_bf16 v[48:51], v[196:199], a[136:143], v10
    v_max_u32 v16, v16, v203
    v_cmp_eq_u32 vcc, -1, v16
    v_smfmac_f32_16x16x64_bf16 v[52:55], v[196:199], a[168:175], v10
    s_branch L_qt23_Sl
L_qf12_Sl:
    buffer_load_dwordx4 v[196:199], v13, s[4:7], s59 offen offset:1024 sc1
    s_waitcnt vmcnt(1)
    v_max3_u32 v16, v200, v201, v202
    v_max_u32 v16, v16, v203
    v_cmp_eq_u32 vcc, -1, v16
L_qt21_Sl:
    s_nop 0
    s_cbranch_vccnz L_qf21_Sl
    v_smfmac_f32_16x16x64_bf16 v[32:35], v[200:203], a[16:23], v10
    v_smfmac_f32_16x16x64_bf16 v[36:39], v[200:203], a[48:55], v10
    v_smfmac_f32_16x16x64_bf16 v[40:43], v[200:203], a[80:87], v10
    v_smfmac_f32_16x16x64_bf16 v[44:47], v[200:203], a[112:119], v10
    s_waitcnt vmcnt(0)
    v_max3_u32 v16, v196, v197, v198
    v_smfmac_f32_16x16x64_bf16 v[48:51], v[200:203], a[144:151], v10
    v_max_u32 v16, v16, v199
    v_cmp_eq_u32 vcc, -1, v16
    v_smfmac_f32_16x16x64_bf16 v[52:55], v[200:203], a[176:183], v10
    s_branch L_qt1_Sl
L_qf13_Sl:
    buffer_load_dwordx4 v[196:199], v13, s[4:7], s59 offen offset:1024 sc1
    s_waitcnt vmcnt(1)
    v_max3_u32 v16, v204, v205, v206
    v_max_u32 v16, v16, v207
    v_cmp_eq_u32 vcc, -1, v16
    s_nop 0
    s_cbranch_vccnz L_qf31_Sl
    s_branch L_qt31_Sl
L_qf3012_Sl:
    buffer_load_dwordx4 v[204:207], v13, s[4:7], s59 offen offset:3072 sc1
    s_sub_u32 s39, s39, 1
    s_cbranch_scc1 L_chain_fail
    s_waitcnt vmcnt(3)
    v_max3_u32 v16, v192, v193, v194
    v_max_u32 v16, v16, v195
    v_cmp_eq_u32 vcc, -1, v16
L_qt0123_Sl:
    s_nop 0
    s_cbranch_vccnz L_qf0123_Sl
    v_smfmac_f32_16x16x64_bf16 v[32:35], v[192:195], a[0:7], v10
    v_smfmac_f32_16x16x64_bf16 v[36:39], v[192:195], a[32:39], v10
    v_smfmac_f32_16x16x64_bf16 v[40:43], v[192:195], a[64:71], v10
    v_smfmac_f32_16x16x64_bf16 v[44:47], v[192:195], a[96:103], v10
    s_waitcnt vmcnt(2)
    v_max3_u32 v16, v196, v197, v198
    v_smfmac_f32_16x16x64_bf16 v[48:51], v[192:195], a[128:135], v10
    v_max_u32 v16, v16, v199
    v_cmp_eq_u32 vcc, -1, v16
    v_smfmac_f32_16x16x64_bf16 v[52:55], v[192:195], a[160:167], v10
    s_branch L_qt123_Sl
L_qf012_Sl:
    buffer_load_dwordx4 v[192:195], v13, s[4:7], s59 offen offset:0 sc1
    s_waitcnt vmcnt(2)
    v_max3_u32 v16, v196, v197, v198
    v_max_u32 v16, v16, v199
    v_cmp_eq_u32 vcc, -1, v16
L_qt120_Sl:
    s_nop 0
    s_cbranch_vccnz L_qf120_Sl
    v_smfmac_f32_16x16x64_bf16 v[32:35], v[196:199], a[8:15], v10
    v_smfmac_f32_16x16x64_bf16 v[36:39], v[196:199], a[40:47], v10
    v_smfmac_f32_16x16x64_bf16 v[40:43], v[196:199], a[72:79], v10
    v_smfmac_f32_16x16x64_bf16 v[44:47], v[196:199], a[104:111], v10
    s_waitcnt vmcnt(1)
    v_max3_u32 v16, v200, v201, v202
    v_smfmac_f32_16x16x64_bf16 v[48:51], v[196:199], a[136:143], v10
    v_max_u32 v16, v16, v203
    v_cmp_eq_u32 vcc, -1, v16
    v_smfmac_f32_16x16x64_bf16 v[52:55], v[196:199], a[168:175], v10
    s_branch L_qt20_Sl
L_qf013_Sl:
    buffer_load_dwordx4 v[192:195], v13, s[4:7], s59 offen offset:0 sc1
    s_waitcnt vmcnt(2)
    v_max3_u32 v16, v196, v197, v198
    v_max_u32 v16, v16, v199
    v_cmp_eq_u32 vcc, -1, v16
L_qt130_Sl:
    s_nop 0
    s_cbranch_vccnz L_qf130_Sl
    v_smfmac_f32_16x16x64_bf16 v[32:35], v[196:199], a[8:15], v10
    v_smfmac_f32_16x16x64_bf16 v[36:39], v[196:199], a[40:47], v10
    v_smfmac_f32_16x16x64_bf16 v[40:43], v[196:199], a[72:79], v10
    v_smfmac_f32_16x16x64_bf16 v[44:47], v[196:199], a[104:111], v10
    s_waitcnt vmcnt(1)
    v_max3_u32 v16, v204, v205, v206
    v_smfmac_f32_16x16x64_bf16 v[48:51], v[196:199], a[136:143], v10
    v_max_u32 v16, v16, v207
    v_cmp_eq_u32 vcc, -1, v16
    v_smfmac_f32_16x16x64_bf16 v[52:55], v[196:199], a[168:175], v10
    s_branch L_qt30_Sl
L_qf10_Sl:
    buffer_load_dwordx4 v[196:199], v13, s[4:7], s59 offen offset:1024 sc1
    s_sub_u32 s39, s39, 1
    s_cbranch_scc1 L_chain_fail
    s_waitcnt vmcnt(1)
    v_max3_u32 v16, v192, v193, v194
    v_max_u32 v16, v16, v195
    v_cmp_eq_u32 vcc, -1, v16
    s_nop 0
    s_cbranch_vccnz L_qf01_Sl
    s_branch L_qt01_Sl
L_qf023_Sl:
    buffer_load_dwordx4 v[192:195], v13, s[4:7], s59 offen offset:0 sc1
    s_waitcnt vmcnt(2)
    v_max3_u32 v16, v200, v201, v202
    v_max_u32 v16, v16, v203
    v_cmp_eq_u32 vcc, -1, v16
    s_nop 0
    s_cbranch_vccnz L_qf230_Sl
    s_branch L_qt230_Sl
L_qf20_Sl:
    buffer_load_dwordx4 v[200:203], v13, s[4:7], s59 offen offset:2048 sc1
    s_sub_u32 s39, s39, 1
    s_cbranch_scc1 L_chain_fail
    s_waitcnt vmcnt(1)
    v_max3_u32 v16, v192, v193, v194
    v_max_u32 v16, v16, v195
    v_cmp_eq_u32 vcc, -1, v16
    s_nop 0
    s_cbranch_vccnz L_qf02_Sl
    s_branch L_qt02_Sl
L_qf21_Sl:
    buffer_load_dwordx4 v[200:203], v13, s[4:7], s59 offen offset:2048 sc1
    s_sub_u32 s39, s39, 1
    s_cbranch_scc1 L_chain_fail
    s_waitcnt vmcnt(1)
    v_max3_u32 v16, v196, v197, v198
    v_max_u32 v16, v16, v199
    v_cmp_eq_u32 vcc, -1, v16
    s_nop 0
    s_cbranch_vccnz L_qf12_Sl
    s_branch L_qt12_Sl
L_qf120_Sl:
    buffer_load_dwordx4 v[196:199], v13, s[4:7], s59 offen offset:1024 sc1
    s_waitcnt vmcnt(2)
    v_max3_u32 v16, v200, v201, v202
    v_max_u32 v16, v16, v203
    v_cmp_eq_u32 vcc, -1, v16
L_qt201_Sl:
    s_nop 0
    s_cbranch_vccnz L_qf201_Sl
    v_smfmac_f32_16x16x64_bf16 v[32:35], v[200:203], a[16:23], v10
    v_smfmac_f32_16x16x64_bf16 v[36:39], v[200:203], a[48:55], v10
    v_smfmac_f32_16x16x64_bf16 v[40:43], v[200:203], a[80:87], v10
    v_smfmac_f32_16x16x64_bf16 v[44:47], v[200:203], a[112:119], v10
    s_waitcnt vmcnt(1)
    v_max3_u32 v16, v192, v193, v194
    v_smfmac_f32_16x16x64_bf16 v[48:51], v[200:203], a[144:151], v10
    v_max_u32 v16, v16, v195
    v_cmp_eq_u32 vcc, -1, v16
    v_smfmac_f32_16x16x64_bf16 v[52:55], v[200:203], a[176:183], v10
    s_branch L_qt01_Sl
L_qf130_Sl:
    buffer_load_dwordx4 v[196:199], v13, s[4:7], s59 offen offset:1024 sc1
    s_waitcnt vmcnt(2)
    v_max3_u32 v16, v204, v205, v206
    v_max_u32 v16, v16, v207
    v_cmp_eq_u32 vcc, -1, v16
    s_nop 0
    s_cbranch_vccnz L_qf301_Sl
    s_branch L_qt301_Sl
L_qf201_Sl:
    buffer_load_dwordx4 v[200:203], v13, s[4:7], s59 offen offset:2048 sc1
    s_sub_u32 s39, s39, 1
    s_cbranch_scc1 L_chain_fail
    s_waitcnt vmcnt(2)
    v_max3_u32 v16, v192, v193, v194
    v_max_u32 v16, v16, v195
    v_cmp_eq_u32 vcc, -1, v16
    s_nop 0
    s_cbranch_vccnz L_qf012_Sl
    s_branch L_qt012_Sl
L_aslow_Sl:
    v_max3_u32 v17, v192, v193, v194
    v_max3_u32 v17, v17, v195, v196
    v_max3_u32 v17, v17, v197, v198
    v_max3_u32 v17, v17, v199, v200
    v_max3_u32 v17, v17, v201, v202
    v_max3_u32 v17, v17, v203, v204
    v_max3_u32 v17, v17, v205, v206
    v_max_u32 v17, v17, v207
    v_cmp_eq_u32 vcc, -1, v17
    s_nop 0
    s_cbranch_vccz L_aok_Sl
    s_mov_b64 exec, vcc
    s_sub_u32 s39, s39, 1
    s_cbranch_scc0 L_hopa_Sl
    s_branch L_chain_fail
L_cretry_Sl:
    buffer_load_dwordx4 v[192:195], v1, s[4:7], s55 offen offset:0 sc1
    buffer_load_dwordx4 v[196:199], v1, s[4:7], s55 offen offset:1024 sc1
    buffer_load_dwordx4 v[200:203], v1, s[4:7], s55 offen offset:2048 sc1
    buffer_load_dwordx4 v[204:207], v1, s[4:7], s55 offen offset:3072 sc1
    v_mov_b64 v[56:57], 0
    v_mov_b64 v[58:59], 0
    v_mov_b64 v[60:61], 0
    v_mov_b64 v[62:63], 0
    s_sub_u32 s39, s39, 1
    s_cbranch_scc0 L_hopc_Sl
    s_branch L_chain_fail
L_Hl:
    v_mov_b32 v56, 0
    v_mov_b32 v57, 0
    v_mov_b32 v58, 0
    v_mov_b32 v59, 0
    v_mov_b32 v60, 0
    v_mov_b32 v61, 0
    v_mov_b32 v62, 0
    v_mov_b32 v63, 0
    v_mov_b32 v224, 0
    v_mov_b32 v225, 0
    v_mov_b32 v226, 0
    v_mov_b32 v227, 0
    v_mov_b32 v228, 0
    v_mov_b32 v229, 0
    v_mov_b32 v230, 0
    v_mov_b32 v231, 0
    v_mov_b32 v232, 0
    v_mov_b32 v233, 0
    v_mov_b32 v234, 0
    v_mov_b32 v235, 0
    v_mov_b32 v236, 0
    v_mov_b32 v237, 0
    v_mov_b32 v238, 0
    v_mov_b32 v239, 0
    s_add_u32 s49, s37, 1
    s_lshl_b32 s88, s49, 18
    s_add_u32 s88, s88, s48
    s_add_u32 s89, s88, 0x20000
    s_and_b32 s49, s49, 1
    s_lshl_b32 s49, s49, 14
    s_add_u32 s92, s49, s65
    s_add_u32 s93, s92, 4096
    s_xor_b32 s94, s92, 0x4000
    s_add_u32 s94, s94, 32768
    s_add_u32 s95, s94, 4096
    s_add_u32 s49, s37, 2
    s_min_u32 s49, s49, 63
    s_lshl_b32 s90, s49, 18
    s_add_u32 s90, s90, s48
    s_add_u32 s90, s90, 0x1000000
    s_add_u32 s91, s90, 0x20000
L_loop_Hl:
    v_pk_add_f32 v[32:33], v[32:33], v[34:35]
    ds_write_b64 v3, v[32:33] offset:0
    v_pk_add_f32 v[36:37], v[36:37], v[38:39]
    ds_write_b64 v3, v[36:37] offset:776
    v_pk_add_f32 v[40:41], v[40:41], v[42:43]
    ds_write_b64 v3, v[40:41] offset:1552
    v_pk_add_f32 v[44:45], v[44:45], v[46:47]
    ds_write_b64 v3, v[44:45] offset:2328
    v_pk_add_f32 v[48:49], v[48:49], v[50:51]
    ds_write_b64 v3, v[48:49] offset:3104
    v_pk_add_f32 v[52:53], v[52:53], v[54:55]
    ds_write_b64 v3, v[52:53] offset:3880
L_loopw_Hl:
    s_waitcnt lgkmcnt(0)
    s_barrier
    ds_read2st64_b32 v[208:209], v4 offset0:0 offset1:19
    ds_read2st64_b32 v[210:211], v4 offset0:38 offset1:57
    ds_read2st64_b32 v[212:213], v5 offset0:0 offset1:19
    ds_read2st64_b32 v[214:215], v5 offset0:38 offset1:57
    ds_read2st64_b32 v[216:217], v7 offset0:0 offset1:19
    ds_read2st64_b32 v[218:219], v7 offset0:38 offset1:57
    ds_read2st64_b32 v[220:221], v12 offset0:0 offset1:19
    ds_read2st64_b32 v[222:223], v12 offset0:38 offset1:57
    s_waitcnt lgkmcnt(6)
    v_pk_add_f32 v[208:209], v[208:209], v[210:211]
    v_add_f32 v208, v208, v209
    s_waitcnt lgkmcnt(4)
    v_pk_add_f32 v[212:213], v[212:213], v[214:215]
    v_add_f32 v212, v212, v213
    v_cvt_pk_bf16_f32 v26, v208, v212
    buffer_store_dword v26, v2, s[4:7], s53 offen offset:0
    s_waitcnt lgkmcnt(2)
    v_pk_add_f32 v[216:217], v[216:217], v[218:219]
    v_add_f32 v216, v216, v217
    s_waitcnt lgkmcnt(0)
    v_pk_add_f32 v[220:221], v[220:221], v[222:223]
    v_add_f32 v220, v220, v221
    v_cvt_pk_bf16_f32 v27, v216, v220
    buffer_store_dword v27, v2, s[4:7], s54 offen offset:0
    s_lshl_b32 s58, s37, 17
    s_add_u32 s97, s58, s96
    s_add_u32 s58, s58, s47
    s_cmp_eq_u32 s37, 63
    s_cbranch_scc1 L_last_Hl
    ds_read_b128 v[208:211], v9 offset:0
    ds_read_b128 v[212:215], v9 offset:1024
    ds_read_b128 v[216:219], v9 offset:2048
    ds_read_b128 v[220:223], v9 offset:3072
    s_and_b32 s56, s37, 15
    s_lshl_b32 s56, s56, 19
    s_add_u32 s56, s56, s42
    s_and_b32 s52, s37, 4
    s_lshl_b32 s52, s52, 11
    s_xor_b32 s56, s56, s52
    s_and_b32 s59, s37, 3
    s_mul_i32 s59, s59, 131072
    s_add_u32 s59, s59, s45
    v_mov_b64 v[32:33], 0
    v_mov_b64 v[34:35], 0
    v_mov_b64 v[36:37], 0
    v_mov_b64 v[38:39], 0
    s_waitcnt lgkmcnt(3)
    v_mfma_f32_16x16x32_bf16 v[240:243], v[208:211], a[192:195], 0
    v_mov_b64 v[40:41], 0
    v_mfma_f32_16x16x32_bf16 v[244:247], v[208:211], a[224:227], 0
    v_mov_b64 v[42:43], 0
    v_mfma_f32_16x16x32_bf16 v[248:251], v[208:211], v[128:131], 0
    v_mov_b64 v[44:45], 0
    v_mfma_f32_16x16x32_bf16 v[252:255], v[208:211], v[160:163], 0
    v_mov_b64 v[46:47], 0
    s_waitcnt lgkmcnt(2)
    v_mfma_f32_16x16x32_bf16 v[240:243], v[212:215], a[196:199], v[240:243]
    v_mov_b64 v[48:49], 0
    v_mfma_f32_16x16x32_bf16 v[244:247], v[212:215], a[228:231], v[244:247]
    v_mov_b64 v[50:51], 0
    v_mfma_f32_16x16x32_bf16 v[248:251], v[212:215], v[132:135], v[248:251]
    v_mov_b64 v[52:53], 0
    v_mfma_f32_16x16x32_bf16 v[252:255], v[212:215], v[164:167], v[252:255]
    v_mov_b64 v[54:55], 0
    s_waitcnt lgkmcnt(1)
    buffer_load_dwordx4 v[192:195], v1, s[4:7], s55 offen offset:0 sc1
    buffer_load_dwordx4 v[196:199], v1, s[4:7], s55 offen offset:1024 sc1
    buffer_load_dwordx4 v[200:203], v1, s[4:7], s55 offen offset:2048 sc1
    buffer_load_dwordx4 v[204:207], v1, s[4:7], s55 offen offset:3072 sc1
    v_mfma_f32_16x16x32_bf16 v[240:243], v[216:219], a[200:203], v[240:243]
    v_mfma_f32_16x16x32_bf16 v[244:247], v[216:219], a[232:235], v[244:247]
    v_mfma_f32_16x16x32_bf16 v[248:251], v[216:219], v[136:139], v[248:251]
    v_mfma_f32_16x16x32_bf16 v[252:255], v[216:219], v[168:171], v[252:255]
    s_waitcnt lgkmcnt(0)
    v_mfma_f32_16x16x32_bf16 v[240:243], v[220:223], a[204:207], v[240:243]
    v_mfma_f32_16x16x32_bf16 v[244:247], v[220:223], a[236:239], v[244:247]
    v_mfma_f32_16x16x32_bf16 v[248:251], v[220:223], v[140:143], v[248:251]
    v_mfma_f32_16x16x32_bf16 v[252:255], v[220:223], v[172:175], v[252:255]
L_hopc_Hl:
    s_waitcnt vmcnt(2)
    v_max3_u32 v16, v192, v193, v194
    v_max3_u32 v16, v16, v195, v196
    v_max3_u32 v16, v16, v197, v198
    v_max_u32 v16, v16, v199
    s_waitcnt vmcnt(0)
    v_max3_u32 v16, v16, v200, v201
    v_max3_u32 v16, v16, v202, v203
    v_max3_u32 v16, v16, v204, v205
    v_max3_u32 v16, v16, v206, v207
    v_cmp_eq_u32 vcc, -1, v16
    s_nop 0
    s_cbranch_vccnz L_cretry_Hl
    ds_read_b128 v[208:211], v9 offset:4096
    ds_read_b128 v[212:215], v9 offset:5120
    ds_read_b128 v[216:219], v9 offset:6144
    ds_read_b128 v[220:223], v9 offset:7168
    s_mov_b32 m0, s92
    v_smfmac_f32_16x16x64_bf16 v[32:35], v[192:195], a[192:199], v10
    buffer_load_dwordx4 v1, s[4:7], s88 offen offset:0 sc1 lds
    v_smfmac_f32_16x16x64_bf16 v[36:39], v[192:195], a[224:231], v10
    buffer_load_dwordx4 v1, s[4:7], s88 offen offset:1024 sc1 lds
    v_smfmac_f32_16x16x64_bf16 v[40:43], v[192:195], v[128:135], v10
    buffer_load_dwordx4 v1, s[4:7], s88 offen offset:2048 sc1 lds
    v_smfmac_f32_16x16x64_bf16 v[44:47], v[192:195], v[160:167], v10
    buffer_load_dwordx4 v1, s[4:7], s88 offen offset:3072 sc1 lds
    s_mov_b32 m0, s93
    v_smfmac_f32_16x16x64_bf16 v[32:35], v[196:199], a[200:207], v10
    buffer_load_dwordx4 v1, s[4:7], s89 offen offset:0 sc1 lds
    v_smfmac_f32_16x16x64_bf16 v[36:39], v[196:199], a[232:239], v10
    buffer_load_dwordx4 v1, s[4:7], s89 offen offset:1024 sc1 lds
    v_smfmac_f32_16x16x64_bf16 v[40:43], v[196:199], v[136:143], v10
    buffer_load_dwordx4 v1, s[4:7], s89 offen offset:2048 sc1 lds
    v_smfmac_f32_16x16x64_bf16 v[44:47], v[196:199], v[168:175], v10
    buffer_load_dwordx4 v1, s[4:7], s89 offen offset:3072 sc1 lds
    s_mov_b32 m0, s94
    v_smfmac_f32_16x16x64_bf16 v[48:51], v[200:203], a[208:215], v10
    buffer_load_dwordx4 v1, s[4:7], s90 offen offset:0 sc1 lds
    v_smfmac_f32_16x16x64_bf16 v[52:55], v[200:203], a[240:247], v10
    buffer_load_dwordx4 v1, s[4:7], s90 offen offset:1024 sc1 lds
    v_smfmac_f32_16x16x64_bf16 v[56:59], v[200:203], v[144:151], v10
    buffer_load_dwordx4 v1, s[4:7], s90 offen offset:2048 sc1 lds
    v_smfmac_f32_16x16x64_bf16 v[60:63], v[200:203], v[176:183], v10
    buffer_load_dwordx4 v1, s[4:7], s90 offen offset:3072 sc1 lds
    s_mov_b32 m0, s95
    v_smfmac_f32_16x16x64_bf16 v[48:51], v[204:207], a[216:223], v10
    buffer_load_dwordx4 v1, s[4:7], s91 offen offset:0 sc1 lds
    v_cvt_pk_bf16_f32 v68, v32, v33
    v_cvt_pk_bf16_f32 v69, v34, v35
    v_smfmac_f32_16x16x64_bf16 v[52:55], v[204:207], a[248:255], v10
    buffer_load_dwordx4 v1, s[4:7], s91 offen offset:1024 sc1 lds
    v_cvt_pk_bf16_f32 v84, v36, v37
    v_cvt_pk_bf16_f32 v85, v38, v39
    v_smfmac_f32_16x16x64_bf16 v[56:59], v[204:207], v[152:159], v10
    buffer_load_dwordx4 v1, s[4:7], s91 offen offset:2048 sc1 lds
    v_cvt_pk_bf16_f32 v100, v40, v41
    v_cvt_pk_bf16_f32 v101, v42, v43
    v_smfmac_f32_16x16x64_bf16 v[60:63], v[204:207], v[184:191], v10
    buffer_load_dwordx4 v1, s[4:7], s91 offen offset:3072 sc1 lds
    v_cvt_pk_bf16_f32 v116, v44, v45
    v_cvt_pk_bf16_f32 v117, v46, v47
    v_cvt_pk_bf16_f32 v76, v48, v49
    v_cvt_pk_bf16_f32 v77, v50, v51
    v_cvt_pk_bf16_f32 v92, v52, v53
    v_cvt_pk_bf16_f32 v93, v54, v55
    v_cvt_pk_bf16_f32 v108, v56, v57
    v_cvt_pk_bf16_f32 v109, v58, v59
    v_cvt_pk_bf16_f32 v124, v60, v61
    v_cvt_pk_bf16_f32 v125, v62, v63
    s_barrier
    ds_read_b64_tr_b16 v[192:193], v6 offset:0
    ds_read_b64_tr_b16 v[194:195], v6 offset:16
    ds_read_b64_tr_b16 v[196:197], v6 offset:1024
    ds_read_b64_tr_b16 v[198:199], v6 offset:1040
    s_waitcnt lgkmcnt(2)
    v_smfmac_f32_16x16x64_bf16 v[224:227], v[192:195], v[64:71], v10
    v_smfmac_f32_16x16x64_bf16 v[228:231], v[192:195], v[80:87], v10
    v_smfmac_f32_16x16x64_bf16 v[232:235], v[192:195], v[96:103], v10
    v_smfmac_f32_16x16x64_bf16 v[236:239], v[192:195], v[112:119], v10
    s_waitcnt lgkmcnt(0)
    v_smfmac_f32_16x16x64_bf16 v[224:227], v[196:199], v[72:79], v10
    v_smfmac_f32_16x16x64_bf16 v[228:231], v[196:199], v[88:95], v10
    v_smfmac_f32_16x16x64_bf16 v[232:235], v[196:199], v[104:111], v10
    v_smfmac_f32_16x16x64_bf16 v[236:239], v[196:199], v[120:127], v10
    s_nop 4
    v_pk_add_f32 v[224:225], v[224:225], v[226:227]
    v_cvt_pk_bf16_f32 v18, v224, v225
    v_pk_add_f32 v[228:229], v[228:229], v[230:231]
    v_cvt_pk_bf16_f32 v19, v228, v229
    v_pk_add_f32 v[232:233], v[232:233], v[234:235]
    v_cvt_pk_bf16_f32 v20, v232, v233
    v_pk_add_f32 v[236:237], v[236:237], v[238:239]
    v_cvt_pk_bf16_f32 v21, v236, v237
    buffer_store_dwordx4 v[18:21], v1, s[4:7], s56 offen offset:0 sc1
    v_mfma_f32_16x16x32_bf16 v[32:35], v[208:211], a[192:195], 0
    v_cvt_pk_bf16_f32 v64, v240, v241
    s_and_b32 s51, s37, 3
    ds_read_b128 v[192:195], v9 offset:8192
    ds_read_b128 v[196:199], v9 offset:9216
    v_mfma_f32_16x16x32_bf16 v[36:39], v[208:211], a[224:227], 0
    v_cvt_pk_bf16_f32 v65, v242, v243
    s_xor_b32 s51, s51, 2
    v_mfma_f32_16x16x32_bf16 v[40:43], v[208:211], v[128:131], 0
    v_cvt_pk_bf16_f32 v80, v244, v245
    s_mul_i32 s51, s51, 196608
    v_mfma_f32_16x16x32_bf16 v[44:47], v[208:211], v[160:163], 0
    v_cvt_pk_bf16_f32 v81, v246, v247
    s_add_u32 s51, s51, s40
    v_mfma_f32_16x16x32_bf16 v[32:35], v[212:215], a[196:199], v[32:35]
    v_cvt_pk_bf16_f32 v96, v248, v249
    s_sub_u32 s50, s51, s40
    ds_read_b128 v[200:203], v9 offset:10240
    ds_read_b128 v[208:211], v9 offset:12288
    v_mfma_f32_16x16x32_bf16 v[36:39], v[212:215], a[228:231], v[36:39]
    v_cvt_pk_bf16_f32 v97, v250, v251
    s_add_u32 s50, s50, s41
    v_mfma_f32_16x16x32_bf16 v[40:43], v[212:215], v[132:135], v[40:43]
    v_cvt_pk_bf16_f32 v112, v252, v253
    s_add_u32 s56, s56, 0x100000
    v_mfma_f32_16x16x32_bf16 v[44:47], v[212:215], v[164:167], v[44:47]
    v_cvt_pk_bf16_f32 v113, v254, v255
    s_bitset0_b32 s56, 23
    v_mfma_f32_16x16x32_bf16 v[32:35], v[216:219], a[200:203], v[32:35]
    v_mov_b64 v[224:225], 0
    s_and_b32 s52, s37, 2
    ds_read_b128 v[204:207], v9 offset:11264
    ds_read_b128 v[212:215], v9 offset:13312
    v_mfma_f32_16x16x32_bf16 v[36:39], v[216:219], a[232:235], v[36:39]
    v_mov_b64 v[226:227], 0
    s_lshl_b32 s52, s52, 12
    v_mfma_f32_16x16x32_bf16 v[40:43], v[216:219], v[136:139], v[40:43]
    v_mov_b64 v[228:229], 0
    s_xor_b32 s56, s56, s52
    v_mfma_f32_16x16x32_bf16 v[44:47], v[216:219], v[168:171], v[44:47]
    v_mov_b64 v[230:231], 0
    s_add_u32 s37, s37, 1
    v_mfma_f32_16x16x32_bf16 v[32:35], v[220:223], a[204:207], v[32:35]
    v_mov_b64 v[232:233], 0
    s_add_u32 s57, s37, 2
    ds_read_b128 v[216:219], v9 offset:14336
    v_mfma_f32_16x16x32_bf16 v[36:39], v[220:223], a[236:239], v[36:39]
    v_mov_b64 v[234:235], 0
    s_min_u32 s57, s57, 63
    v_mfma_f32_16x16x32_bf16 v[40:43], v[220:223], v[140:143], v[40:43]
    v_mov_b64 v[236:237], 0
    s_and_b32 s57, s57, 60
    v_mfma_f32_16x16x32_bf16 v[44:47], v[220:223], v[172:175], v[44:47]
    v_mov_b64 v[238:239], 0
    s_cmp_lg_u32 s37, 53
    s_cselect_b32 s57, s57, 2
    s_waitcnt lgkmcnt(6)
    v_mfma_f32_16x16x32_bf16 v[48:51], v[192:195], a[208:211], 0
    s_lshl4_add_u32 s57, s57, s85
    ds_read_b128 v[220:223], v9 offset:15360
    v_mfma_f32_16x16x32_bf16 v[52:55], v[192:195], a[240:243], 0
    buffer_load_dword v17, off, s[4:7], s57 sc1
    v_mfma_f32_16x16x32_bf16 v[56:59], v[192:195], v[144:147], 0
    s_and_b32 s53, s37, 3
    v_mfma_f32_16x16x32_bf16 v[60:63], v[192:195], v[176:179], 0
    s_mul_i32 s53, s53, 196608
    s_waitcnt lgkmcnt(6)
    v_mfma_f32_16x16x32_bf16 v[48:51], v[196:199], a[212:215], v[48:51]
    v_cvt_pk_bf16_f32 v66, v32, v33
    s_add_u32 s53, s53, s40
    s_barrier
    v_mfma_f32_16x16x32_bf16 v[52:55], v[196:199], a[244:247], v[52:55]
    v_cvt_pk_bf16_f32 v67, v34, v35
    s_and_b32 s54, s37, 3
    v_mfma_f32_16x16x32_bf16 v[56:59], v[196:199], v[148:151], v[56:59]
    v_cvt_pk_bf16_f32 v82, v36, v37
    s_mul_i32 s54, s54, 196608
    v_mfma_f32_16x16x32_bf16 v[60:63], v[196:199], v[180:183], v[60:63]
    v_cvt_pk_bf16_f32 v83, v38, v39
    s_add_u32 s54, s54, s41
    s_waitcnt lgkmcnt(5)
    v_mfma_f32_16x16x32_bf16 v[48:51], v[200:203], a[216:219], v[48:51]
    v_cvt_pk_bf16_f32 v98, v40, v41
    s_and_b32 s55, s37, 3
    v_mfma_f32_16x16x32_bf16 v[52:55], v[200:203], a[248:251], v[52:55]
    v_cvt_pk_bf16_f32 v99, v42, v43
    s_mul_i32 s55, s55, 196608
    v_mfma_f32_16x16x32_bf16 v[56:59], v[200:203], v[152:155], v[56:59]
    v_cvt_pk_bf16_f32 v114, v44, v45
    s_add_u32 s55, s55, s46
    v_mfma_f32_16x16x32_bf16 v[60:63], v[200:203], v[184:187], v[60:63]
    v_cvt_pk_bf16_f32 v115, v46, v47
    s_add_u32 s49, s37, 1
    s_waitcnt lgkmcnt(3)
    v_mfma_f32_16x16x32_bf16 v[48:51], v[204:207], a[220:223], v[48:51]
    v_mov_b64 v[32:33], 0
    s_lshl_b32 s88, s49, 18
    v_mfma_f32_16x16x32_bf16 v[52:55], v[204:207], a[252:255], v[52:55]
    v_mov_b64 v[34:35], 0
    s_add_u32 s88, s88, s48
    v_mfma_f32_16x16x32_bf16 v[56:59], v[204:207], v[156:159], v[56:59]
    v_mov_b64 v[36:37], 0
    s_add_u32 s89, s88, 0x20000
    v_mfma_f32_16x16x32_bf16 v[60:63], v[204:207], v[188:191], v[60:63]
    v_mov_b64 v[38:39], 0
    s_and_b32 s49, s49, 1
    s_waitcnt lgkmcnt(4)
    v_mfma_f32_16x16x32_bf16 v[240:243], v[208:211], a[208:211], 0
    v_mov_b64 v[40:41], 0
    s_lshl_b32 s49, s49, 14
    v_mfma_f32_16x16x32_bf16 v[244:247], v[208:211], a[240:243], 0
    v_mov_b64 v[42:43], 0
    s_add_u32 s92, s49, s65
    v_mfma_f32_16x16x32_bf16 v[248:251], v[208:211], v[144:147], 0
    v_mov_b64 v[44:45], 0
    s_add_u32 s93, s92, 4096
    buffer_store_dword v26, v2, s[4:7], s97 offen offset:0 sc1
    v_mfma_f32_16x16x32_bf16 v[252:255], v[208:211], v[176:179], 0
    v_mov_b64 v[46:47], 0
    s_xor_b32 s94, s92, 0x4000
    s_waitcnt lgkmcnt(2)
    v_mfma_f32_16x16x32_bf16 v[240:243], v[212:215], a[212:215], v[240:243]
    v_cvt_pk_bf16_f32 v72, v48, v49
    s_add_u32 s94, s94, 32768
    buffer_store_dword v27, v2, s[4:7], s58 offen offset:2048 sc1
    v_mfma_f32_16x16x32_bf16 v[244:247], v[212:215], a[244:247], v[244:247]
    v_cvt_pk_bf16_f32 v73, v50, v51
    s_add_u32 s95, s94, 4096
    v_mfma_f32_16x16x32_bf16 v[248:251], v[212:215], v[148:151], v[248:251]
    v_cvt_pk_bf16_f32 v88, v52, v53
    s_add_u32 s49, s37, 2
    buffer_store_dwordx4 v[28:31], v1, s[4:7], s56 offen offset:0 sc1
    v_mfma_f32_16x16x32_bf16 v[252:255], v[212:215], v[180:183], v[252:255]
    v_cvt_pk_bf16_f32 v89, v54, v55
    s_min_u32 s49, s49, 63
    s_waitcnt lgkmcnt(1)
    v_mfma_f32_16x16x32_bf16 v[240:243], v[216:219], a[216:219], v[240:243]
    v_cvt_pk_bf16_f32 v104, v56, v57
    s_lshl_b32 s90, s49, 18
    buffer_store_dword v28, v2, s[4:7], s51 offen offset:0
    v_mfma_f32_16x16x32_bf16 v[244:247], v[216:219], a[248:251], v[244:247]
    v_cvt_pk_bf16_f32 v105, v58, v59
    s_add_u32 s90, s90, s48
    v_mfma_f32_16x16x32_bf16 v[248:251], v[216:219], v[152:155], v[248:251]
    v_cvt_pk_bf16_f32 v120, v60, v61
    s_add_u32 s90, s90, 0x1000000
    buffer_store_dword v28, v2, s[4:7], s50 offen offset:0
    v_mfma_f32_16x16x32_bf16 v[252:255], v[216:219], v[184:187], v[252:255]
    v_cvt_pk_bf16_f32 v121, v62, v63
    s_add_u32 s91, s90, 0x20000
    s_waitcnt lgkmcnt(0)
    v_mfma_f32_16x16x32_bf16 v[240:243], v[220:223], a[220:223], v[240:243]
    v_mfma_f32_16x16x32_bf16 v[244:247], v[220:223], a[252:255], v[244:247]
    v_mfma_f32_16x16x32_bf16 v[248:251], v[220:223], v[156:159], v[248:251]
    v_mfma_f32_16x16x32_bf16 v[252:255], v[220:223], v[188:191], v[252:255]
    v_mov_b64 v[48:49], 0
    v_mov_b64 v[50:51], 0
    v_mov_b64 v[52:53], 0
    v_mov_b64 v[54:55], 0
    v_mov_b64 v[56:57], 0
    v_mov_b64 v[58:59], 0
    v_mov_b64 v[60:61], 0
    v_mov_b64 v[62:63], 0
    v_xor_b32 v9, 0x4000, v9
    s_waitcnt vmcnt(5)
    v_cmp_ne_u32 vcc, 8, v17
    s_nop 0
    s_cbranch_vccnz L_kvs_Hl
L_kvo_Hl:
    v_cvt_pk_bf16_f32 v74, v240, v241
    v_cvt_pk_bf16_f32 v75, v242, v243
    v_cvt_pk_bf16_f32 v90, v244, v245
    v_cvt_pk_bf16_f32 v91, v246, v247
    v_cvt_pk_bf16_f32 v106, v248, v249
    v_cvt_pk_bf16_f32 v107, v250, v251
    v_cvt_pk_bf16_f32 v122, v252, v253
    v_cvt_pk_bf16_f32 v123, v254, v255
    s_barrier
    buffer_load_dwordx4 v[192:195], v13, s[4:7], s59 offen offset:0 sc1
    buffer_load_dwordx4 v[196:199], v13, s[4:7], s59 offen offset:1024 sc1
    buffer_load_dwordx4 v[200:203], v13, s[4:7], s59 offen offset:2048 sc1
    buffer_load_dwordx4 v[204:207], v13, s[4:7], s59 offen offset:3072 sc1
    s_waitcnt vmcnt(3)
    v_max3_u32 v16, v192, v193, v194
    v_max_u32 v16, v16, v195
    v_cmp_eq_u32 vcc, -1, v16
    s_nop 0
    s_cbranch_vccnz L_qf0123_Hl
    v_smfmac_f32_16x16x64_bf16 v[32:35], v[192:195], a[0:7], v10
    v_smfmac_f32_16x16x64_bf16 v[36:39], v[192:195], a[32:39], v10
    s_waitcnt vmcnt(2)
    v_max3_u32 v16, v196, v197, v198
    v_smfmac_f32_16x16x64_bf16 v[40:43], v[192:195], a[64:71], v10
    v_max_u32 v16, v16, v199
    v_cmp_eq_u32 vcc, -1, v16
    v_smfmac_f32_16x16x64_bf16 v[44:47], v[192:195], a[96:103], v10
    v_smfmac_f32_16x16x64_bf16 v[48:51], v[192:195], a[128:135], v10
    v_smfmac_f32_16x16x64_bf16 v[52:55], v[192:195], a[160:167], v10
    s_cbranch_vccnz L_qf123_Hl
    v_smfmac_f32_16x16x64_bf16 v[32:35], v[196:199], a[8:15], v10
    v_smfmac_f32_16x16x64_bf16 v[36:39], v[196:199], a[40:47], v10
    s_waitcnt vmcnt(1)
    v_max3_u32 v16, v200, v201, v202
    v_smfmac_f32_16x16x64_bf16 v[40:43], v[196:199], a[72:79], v10
    v_max_u32 v16, v16, v203
    v_cmp_eq_u32 vcc, -1, v16
    v_smfmac_f32_16x16x64_bf16 v[44:47], v[196:199], a[104:111], v10
    v_smfmac_f32_16x16x64_bf16 v[48:51], v[196:199], a[136:143], v10
    v_smfmac_f32_16x16x64_bf16 v[52:55], v[196:199], a[168:175], v10
    s_cbranch_vccnz L_qf23_Hl
    v_smfmac_f32_16x16x64_bf16 v[32:35], v[200:203], a[16:23], v10
    v_smfmac_f32_16x16x64_bf16 v[36:39], v[200:203], a[48:55], v10
    s_waitcnt vmcnt(0)
    v_max3_u32 v16, v204, v205, v206
    v_smfmac_f32_16x16x64_bf16 v[40:43], v[200:203], a[80:87], v10
    v_max_u32 v16, v16, v207
    v_cmp_eq_u32 vcc, -1, v16
    v_smfmac_f32_16x16x64_bf16 v[44:47], v[200:203], a[112:119], v10
    v_smfmac_f32_16x16x64_bf16 v[48:51], v[200:203], a[144:151], v10
    v_smfmac_f32_16x16x64_bf16 v[52:55], v[200:203], a[176:183], v10
    s_cbranch_vccnz L_qf3_Hl
    v_smfmac_f32_16x16x64_bf16 v[32:35], v[204:207], a[24:31], v10
    v_smfmac_f32_16x16x64_bf16 v[36:39], v[204:207], a[56:63], v10
    v_smfmac_f32_16x16x64_bf16 v[40:43], v[204:207], a[88:95], v10
    v_smfmac_f32_16x16x64_bf16 v[44:47], v[204:207], a[120:127], v10
    v_smfmac_f32_16x16x64_bf16 v[48:51], v[204:207], a[152:159], v10
    v_smfmac_f32_16x16x64_bf16 v[52:55], v[204:207], a[184:191], v10
    s_nop 2
    v_pk_add_f32 v[32:33], v[32:33], v[34:35]
    ds_write_b64 v3, v[32:33] offset:0
    v_pk_add_f32 v[36:37], v[36:37], v[38:39]
    ds_write_b64 v3, v[36:37] offset:776
    v_pk_add_f32 v[40:41], v[40:41], v[42:43]
    ds_write_b64 v3, v[40:41] offset:1552
    v_pk_add_f32 v[44:45], v[44:45], v[46:47]
    ds_write_b64 v3, v[44:45] offset:2328
    v_pk_add_f32 v[48:49], v[48:49], v[50:51]
    ds_write_b64 v3, v[48:49] offset:3104
    v_pk_add_f32 v[52:53], v[52:53], v[54:55]
    ds_write_b64 v3, v[52:53] offset:3880
    s_branch L_loopw_Hl
L_qf0123_Hl:
    buffer_load_dwordx4 v[192:195], v13, s[4:7], s59 offen offset:0 sc1
    s_waitcnt vmcnt(3)
    v_max3_u32 v16, v196, v197, v198
    v_max_u32 v16, v16, v199
    v_cmp_eq_u32 vcc, -1, v16
L_qt1230_Hl:
    s_nop 0
    s_cbranch_vccnz L_qf1230_Hl
    v_smfmac_f32_16x16x64_bf16 v[32:35], v[196:199], a[8:15], v10
    v_smfmac_f32_16x16x64_bf16 v[36:39], v[196:199], a[40:47], v10
    v_smfmac_f32_16x16x64_bf16 v[40:43], v[196:199], a[72:79], v10
    v_smfmac_f32_16x16x64_bf16 v[44:47], v[196:199], a[104:111], v10
    s_waitcnt vmcnt(2)
    v_max3_u32 v16, v200, v201, v202
    v_smfmac_f32_16x16x64_bf16 v[48:51], v[196:199], a[136:143], v10
    v_max_u32 v16, v16, v203
    v_cmp_eq_u32 vcc, -1, v16
    v_smfmac_f32_16x16x64_bf16 v[52:55], v[196:199], a[168:175], v10
L_qt230_Hl:
    s_cbranch_vccnz L_qf230_Hl
    v_smfmac_f32_16x16x64_bf16 v[32:35], v[200:203], a[16:23], v10
    v_smfmac_f32_16x16x64_bf16 v[36:39], v[200:203], a[48:55], v10
    v_smfmac_f32_16x16x64_bf16 v[40:43], v[200:203], a[80:87], v10
    v_smfmac_f32_16x16x64_bf16 v[44:47], v[200:203], a[112:119], v10
    s_waitcnt vmcnt(1)
    v_max3_u32 v16, v204, v205, v206
    v_smfmac_f32_16x16x64_bf16 v[48:51], v[200:203], a[144:151], v10
    v_max_u32 v16, v16, v207
    v_cmp_eq_u32 vcc, -1, v16
    v_smfmac_f32_16x16x64_bf16 v[52:55], v[200:203], a[176:183], v10
L_qt30_Hl:
    s_cbranch_vccnz L_qf30_Hl
    v_smfmac_f32_16x16x64_bf16 v[32:35], v[204:207], a[24:31], v10
    v_smfmac_f32_16x16x64_bf16 v[36:39], v[204:207], a[56:63], v10
    v_smfmac_f32_16x16x64_bf16 v[40:43], v[204:207], a[88:95], v10
    v_smfmac_f32_16x16x64_bf16 v[44:47], v[204:207], a[120:127], v10
    s_waitcnt vmcnt(0)
    v_max3_u32 v16, v192, v193, v194
    v_smfmac_f32_16x16x64_bf16 v[48:51], v[204:207], a[152:159], v10
    v_max_u32 v16, v16, v195
    v_cmp_eq_u32 vcc, -1, v16
    v_smfmac_f32_16x16x64_bf16 v[52:55], v[204:207], a[184:191], v10
L_qt0_Hl:
    s_cbranch_vccnz L_qf0_Hl
    v_smfmac_f32_16x16x64_bf16 v[32:35], v[192:195], a[0:7], v10
    v_smfmac_f32_16x16x64_bf16 v[36:39], v[192:195], a[32:39], v10
    v_smfmac_f32_16x16x64_bf16 v[40:43], v[192:195], a[64:71], v10
    v_smfmac_f32_16x16x64_bf16 v[44:47], v[192:195], a[96:103], v10
    v_smfmac_f32_16x16x64_bf16 v[48:51], v[192:195], a[128:135], v10
    v_smfmac_f32_16x16x64_bf16 v[52:55], v[192:195], a[160:167], v10
    s_nop 2
    v_pk_add_f32 v[32:33], v[32:33], v[34:35]
    ds_write_b64 v3, v[32:33] offset:0
    v_pk_add_f32 v[36:37], v[36:37], v[38:39]
    ds_write_b64 v3, v[36:37] offset:776
    v_pk_add_f32 v[40:41], v[40:41], v[42:43]
    ds_write_b64 v3, v[40:41] offset:1552
    v_pk_add_f32 v[44:45], v[44:45], v[46:47]
    ds_write_b64 v3, v[44:45] offset:2328
    v_pk_add_f32 v[48:49], v[48:49], v[50:51]
    ds_write_b64 v3, v[48:49] offset:3104
    v_pk_add_f32 v[52:53], v[52:53], v[54:55]
    ds_write_b64 v3, v[52:53] offset:3880
    s_branch L_loopw_Hl
L_qf123_Hl:
    buffer_load_dwordx4 v[196:199], v13, s[4:7], s59 offen offset:1024 sc1
    s_waitcnt vmcnt(2)
    v_max3_u32 v16, v200, v201, v202
    v_max_u32 v16, v16, v203
    v_cmp_eq_u32 vcc, -1, v16
L_qt231_Hl:
    s_nop 0
    s_cbranch_vccnz L_qf231_Hl
    v_smfmac_f32_16x16x64_bf16 v[32:35], v[200:203], a[16:23], v10
    v_smfmac_f32_16x16x64_bf16 v[36:39], v[200:203], a[48:55], v10
    v_smfmac_f32_16x16x64_bf16 v[40:43], v[200:203], a[80:87], v10
    v_smfmac_f32_16x16x64_bf16 v[44:47], v[200:203], a[112:119], v10
    s_waitcnt vmcnt(1)
    v_max3_u32 v16, v204, v205, v206
    v_smfmac_f32_16x16x64_bf16 v[48:51], v[200:203], a[144:151], v10
    v_max_u32 v16, v16, v207
    v_cmp_eq_u32 vcc, -1, v16
    v_smfmac_f32_16x16x64_bf16 v[52:55], v[200:203], a[176:183], v10
L_qt31_Hl:
    s_cbranch_vccnz L_qf31_Hl
    v_smfmac_f32_16x16x64_bf16 v[32:35], v[204:207], a[24:31], v10
    v_smfmac_f32_16x16x64_bf16 v[36:39], v[204:207], a[56:63], v10
    v_smfmac_f32_16x16x64_bf16 v[40:43], v[204:207], a[88:95], v10
    v_smfmac_f32_16x16x64_bf16 v[44:47], v[204:207], a[120:127], v10
    s_waitcnt vmcnt(0)
    v_max3_u32 v16, v196, v197, v198
    v_smfmac_f32_16x16x64_bf16 v[48:51], v[204:207], a[152:159], v10
    v_max_u32 v16, v16, v199
    v_cmp_eq_u32 vcc, -1, v16
    v_smfmac_f32_16x16x64_bf16 v[52:55], v[204:207], a[184:191], v10
L_qt1_Hl:
    s_cbranch_vccnz L_qf1_Hl
    v_smfmac_f32_16x16x64_bf16 v[32:35], v[196:199], a[8:15], v10
    v_smfmac_f32_16x16x64_bf16 v[36:39], v[196:199], a[40:47], v10
    v_smfmac_f32_16x16x64_bf16 v[40:43], v[196:199], a[72:79], v10
    v_smfmac_f32_16x16x64_bf16 v[44:47], v[196:199], a[104:111], v10
    v_smfmac_f32_16x16x64_bf16 v[48:51], v[196:199], a[136:143], v10
    v_smfmac_f32_16x16x64_bf16 v[52:55], v[196:199], a[168:175], v10
    s_nop 2
    v_pk_add_f32 v[32:33], v[32:33], v[34:35]
    ds_write_b64 v3, v[32:33] offset:0
    v_pk_add_f32 v[36:37], v[36:37], v[38:39]
    ds_write_b64 v3, v[36:37] offset:776
    v_pk_add_f32 v[40:41], v[40:41], v[42:43]
    ds_write_b64 v3, v[40:41] offset:1552
    v_pk_add_f32 v[44:45], v[44:45], v[46:47]
    ds_write_b64 v3, v[44:45] offset:2328
    v_pk_add_f32 v[48:49], v[48:49], v[50:51]
    ds_write_b64 v3, v[48:49] offset:3104
    v_pk_add_f32 v[52:53], v[52:53], v[54:55]
    ds_write_b64 v3, v[52:53] offset:3880
    s_branch L_loopw_Hl
L_qf23_Hl:
    buffer_load_dwordx4 v[200:203], v13, s[4:7], s59 offen offset:2048 sc1
    s_waitcnt vmcnt(1)
    v_max3_u32 v16, v204, v205, v206
    v_max_u32 v16, v16, v207
    v_cmp_eq_u32 vcc, -1, v16
L_qt32_Hl:
    s_nop 0
    s_cbranch_vccnz L_qf32_Hl
    v_smfmac_f32_16x16x64_bf16 v[32:35], v[204:207], a[24:31], v10
    v_smfmac_f32_16x16x64_bf16 v[36:39], v[204:207], a[56:63], v10
    v_smfmac_f32_16x16x64_bf16 v[40:43], v[204:207], a[88:95], v10
    v_smfmac_f32_16x16x64_bf16 v[44:47], v[204:207], a[120:127], v10
    s_waitcnt vmcnt(0)
    v_max3_u32 v16, v200, v201, v202
    v_smfmac_f32_16x16x64_bf16 v[48:51], v[204:207], a[152:159], v10
    v_max_u32 v16, v16, v203
    v_cmp_eq_u32 vcc, -1, v16
    v_smfmac_f32_16x16x64_bf16 v[52:55], v[204:207], a[184:191], v10
L_qt2_Hl:
    s_cbranch_vccnz L_qf2_Hl
    v_smfmac_f32_16x16x64_bf16 v[32:35], v[200:203], a[16:23], v10
    v_smfmac_f32_16x16x64_bf16 v[36:39], v[200:203], a[48:55], v10
    v_smfmac_f32_16x16x64_bf16 v[40:43], v[200:203], a[80:87], v10
    v_smfmac_f32_16x16x64_bf16 v[44:47], v[200:203], a[112:119], v10
    v_smfmac_f32_16x16x64_bf16 v[48:51], v[200:203], a[144:151], v10
    v_smfmac_f32_16x16x64_bf16 v[52:55], v[200:203], a[176:183], v10
    s_nop 2
    v_pk_add_f32 v[32:33], v[32:33], v[34:35]
    ds_write_b64 v3, v[32:33] offset:0
    v_pk_add_f32 v[36:37], v[36:37], v[38:39]
    ds_write_b64 v3, v[36:37] offset:776
    v_pk_add_f32 v[40:41], v[40:41], v[42:43]
    ds_write_b64 v3, v[40:41] offset:1552
    v_pk_add_f32 v[44:45], v[44:45], v[46:47]
    ds_write_b64 v3, v[44:45] offset:2328
    v_pk_add_f32 v[48:49], v[48:49], v[50:51]
    ds_write_b64 v3, v[48:49] offset:3104
    v_pk_add_f32 v[52:53], v[52:53], v[54:55]
    ds_write_b64 v3, v[52:53] offset:3880
    s_branch L_loopw_Hl
L_qf3_Hl:
    buffer_load_dwordx4 v[204:207], v13, s[4:7], s59 offen offset:3072 sc1
    s_sub_u32 s39, s39, 1
    s_cbranch_scc1 L_chain_fail
    s_waitcnt vmcnt(0)
    v_max3_u32 v16, v204, v205, v206
    v_max_u32 v16, v16, v207
    v_cmp_eq_u32 vcc, -1, v16
L_qt3_Hl:
    s_nop 0
    s_cbranch_vccnz L_qf3_Hl
    v_smfmac_f32_16x16x64_bf16 v[32:35], v[204:207], a[24:31], v10
    v_smfmac_f32_16x16x64_bf16 v[36:39], v[204:207], a[56:63], v10
    v_smfmac_f32_16x16x64_bf16 v[40:43], v[204:207], a[88:95], v10
    v_smfmac_f32_16x16x64_bf16 v[44:47], v[204:207], a[120:127], v10
    v_smfmac_f32_16x16x64_bf16 v[48:51], v[204:207], a[152:159], v10
    v_smfmac_f32_16x16x64_bf16 v[52:55], v[204:207], a[184:191], v10
    s_nop 2
    v_pk_add_f32 v[32:33], v[32:33], v[34:35]
    ds_write_b64 v3, v[32:33] offset:0
    v_pk_add_f32 v[36:37], v[36:37], v[38:39]
    ds_write_b64 v3, v[36:37] offset:776
    v_pk_add_f32 v[40:41], v[40:41], v[42:43]
    ds_write_b64 v3, v[40:41] offset:1552
    v_pk_add_f32 v[44:45], v[44:45], v[46:47]
    ds_write_b64 v3, v[44:45] offset:2328
    v_pk_add_f32 v[48:49], v[48:49], v[50:51]
    ds_write_b64 v3, v[48:49] offset:3104
    v_pk_add_f32 v[52:53], v[52:53], v[54:55]
    ds_write_b64 v3, v[52:53] offset:3880
    s_branch L_loopw_Hl
L_qf1230_Hl:
    buffer_load_dwordx4 v[196:199], v13, s[4:7], s59 offen offset:1024 sc1
    s_waitcnt vmcnt(3)
    v_max3_u32 v16, v200, v201, v202
    v_max_u32 v16, v16, v203
    v_cmp_eq_u32 vcc, -1, v16
L_qt2301_Hl:
    s_nop 0
    s_cbranch_vccnz L_qf2301_Hl
    v_smfmac_f32_16x16x64_bf16 v[32:35], v[200:203], a[16:23], v10
    v_smfmac_f32_16x16x64_bf16 v[36:39], v[200:203], a[48:55], v10
    v_smfmac_f32_16x16x64_bf16 v[40:43], v[200:203], a[80:87], v10
    v_smfmac_f32_16x16x64_bf16 v[44:47], v[200:203], a[112:119], v10
    s_waitcnt vmcnt(2)
    v_max3_u32 v16, v204, v205, v206
    v_smfmac_f32_16x16x64_bf16 v[48:51], v[200:203], a[144:151], v10
    v_max_u32 v16, v16, v207
    v_cmp_eq_u32 vcc, -1, v16
    v_smfmac_f32_16x16x64_bf16 v[52:55], v[200:203], a[176:183], v10
L_qt301_Hl:
    s_cbranch_vccnz L_qf301_Hl
    v_smfmac_f32_16x16x64_bf16 v[32:35], v[204:207], a[24:31], v10
    v_smfmac_f32_16x16x64_bf16 v[36:39], v[204:207], a[56:63], v10
    v_smfmac_f32_16x16x64_bf16 v[40:43], v[204:207], a[88:95], v10
    v_smfmac_f32_16x16x64_bf16 v[44:47], v[204:207], a[120:127], v10
    s_waitcnt vmcnt(1)
    v_max3_u32 v16, v192, v193, v194
    v_smfmac_f32_16x16x64_bf16 v[48:51], v[204:207], a[152:159], v10
    v_max_u32 v16, v16, v195
    v_cmp_eq_u32 vcc, -1, v16
    v_smfmac_f32_16x16x64_bf16 v[52:55], v[204:207], a[184:191], v10
L_qt01_Hl:
    s_cbranch_vccnz L_qf01_Hl
    v_smfmac_f32_16x16x64_bf16 v[32:35], v[192:195], a[0:7], v10
    v_smfmac_f32_16x16x64_bf16 v[36:39], v[192:195], a[32:39], v10
    v_smfmac_f32_16x16x64_bf16 v[40:43], v[192:195], a[64:71], v10
    v_smfmac_f32_16x16x64_bf16 v[44:47], v[192:195], a[96:103], v10
    s_waitcnt vmcnt(0)
    v_max3_u32 v16, v196, v197, v198
    v_smfmac_f32_16x16x64_bf16 v[48:51], v[192:195], a[128:135], v10
    v_max_u32 v16, v16, v199
    v_cmp_eq_u32 vcc, -1, v16
    v_smfmac_f32_16x16x64_bf16 v[52:55], v[192:195], a[160:167], v10
    s_branch L_qt1_Hl
L_qf230_Hl:
    buffer_load_dwordx4 v[200:203], v13, s[4:7], s59 offen offset:2048 sc1
    s_waitcnt vmcnt(2)
    v_max3_u32 v16, v204, v205, v206
    v_max_u32 v16, v16, v207
    v_cmp_eq_u32 vcc, -1, v16
L_qt302_Hl:
    s_nop 0
    s_cbranch_vccnz L_qf302_Hl
    v_smfmac_f32_16x16x64_bf16 v[32:35], v[204:207], a[24:31], v10
    v_smfmac_f32_16x16x64_bf16 v[36:39], v[204:207], a[56:63], v10
    v_smfmac_f32_16x16x64_bf16 v[40:43], v[204:207], a[88:95], v10
    v_smfmac_f32_16x16x64_bf16 v[44:47], v[204:207], a[120:127], v10
    s_waitcnt vmcnt(1)
    v_max3_u32 v16, v192, v193, v194
    v_smfmac_f32_16x16x64_bf16 v[48:51], v[204:207], a[152:159], v10
    v_max_u32 v16, v16, v195
    v_cmp_eq_u32 vcc, -1, v16
    v_smfmac_f32_16x16x64_bf16 v[52:55], v[204:207], a[184:191], v10
L_qt02_Hl:
    s_cbranch_vccnz L_qf02_Hl
    v_smfmac_f32_16x16x64_bf16 v[32:35], v[192:195], a[0:7], v10
    v_smfmac_f32_16x16x64_bf16 v[36:39], v[192:195], a[32:39], v10
    v_smfmac_f32_16x16x64_bf16 v[40:43], v[192:195], a[64:71], v10
    v_smfmac_f32_16x16x64_bf16 v[44:47], v[192:195], a[96:103], v10
    s_waitcnt vmcnt(0)
    v_max3_u32 v16, v200, v201, v202
    v_smfmac_f32_16x16x64_bf16 v[48:51], v[192:195], a[128:135], v10
    v_max_u32 v16, v16, v203
    v_cmp_eq_u32 vcc, -1, v16
    v_smfmac_f32_16x16x64_bf16 v[52:55], v[192:195], a[160:167], v10
    s_branch L_qt2_Hl
L_qf30_Hl:
    buffer_load_dwordx4 v[204:207], v13, s[4:7], s59 offen offset:3072 sc1
    s_sub_u32 s39, s39, 1
    s_cbranch_scc1 L_chain_fail
    s_waitcnt vmcnt(1)
    v_max3_u32 v16, v192, v193, v194
    v_max_u32 v16, v16, v195
    v_cmp_eq_u32 vcc, -1, v16
L_qt03_Hl:
    s_nop 0
    s_cbranch_vccnz L_qf03_Hl
    v_smfmac_f32_16x16x64_bf16 v[32:35], v[192:195], a[0:7], v10
    v_smfmac_f32_16x16x64_bf16 v[36:39], v[192:195], a[32:39], v10
    v_smfmac_f32_16x16x64_bf16 v[40:43], v[192:195], a[64:71], v10
    v_smfmac_f32_16x16x64_bf16 v[44:47], v[192:195], a[96:103], v10
    s_waitcnt vmcnt(0)
    v_max3_u32 v16, v204, v205, v206
    v_smfmac_f32_16x16x64_bf16 v[48:51], v[192:195], a[128:135], v10
    v_max_u32 v16, v16, v207
    v_cmp_eq_u32 vcc, -1, v16
    v_smfmac_f32_16x16x64_bf16 v[52:55], v[192:195], a[160:167], v10
    s_branch L_qt3_Hl
L_qf0_Hl:
    buffer_load_dwordx4 v[192:195], v13, s[4:7], s59 offen offset:0 sc1
    s_sub_u32 s39, s39, 1
    s_cbranch_scc1 L_chain_fail
    s_waitcnt vmcnt(0)
    v_max3_u32 v16, v192, v193, v194
    v_max_u32 v16, v16, v195
    v_cmp_eq_u32 vcc, -1, v16
    s_nop 0
    s_cbranch_vccnz L_qf0_Hl
    s_branch L_qt0_Hl
L_qf231_Hl:
    buffer_load_dwordx4 v[200:203], v13, s[4:7], s59 offen offset:2048 sc1
    s_waitcnt vmcnt(2)
    v_max3_u32 v16, v204, v205, v206
    v_max_u32 v16, v16, v207
    v_cmp_eq_u32 vcc, -1, v16
L_qt312_Hl:
    s_nop 0
    s_cbranch_vccnz L_qf312_Hl
    v_smfmac_f32_16x16x64_bf16 v[32:35], v[204:207], a[24:31], v10
    v_smfmac_f32_16x16x64_bf16 v[36:39], v[204:207], a[56:63], v10
    v_smfmac_f32_16x16x64_bf16 v[40:43], v[204:207], a[88:95], v10
    v_smfmac_f32_16x16x64_bf16 v[44:47], v[204:207], a[120:127], v10
    s_waitcnt vmcnt(1)
    v_max3_u32 v16, v196, v197, v198
    v_smfmac_f32_16x16x64_bf16 v[48:51], v[204:207], a[152:159], v10
    v_max_u32 v16, v16, v199
    v_cmp_eq_u32 vcc, -1, v16
    v_smfmac_f32_16x16x64_bf16 v[52:55], v[204:207], a[184:191], v10
L_qt12_Hl:
    s_cbranch_vccnz L_qf12_Hl
    v_smfmac_f32_16x16x64_bf16 v[32:35], v[196:199], a[8:15], v10
    v_smfmac_f32_16x16x64_bf16 v[36:39], v[196:199], a[40:47], v10
    v_smfmac_f32_16x16x64_bf16 v[40:43], v[196:199], a[72:79], v10
    v_smfmac_f32_16x16x64_bf16 v[44:47], v[196:199], a[104:111], v10
    s_waitcnt vmcnt(0)
    v_max3_u32 v16, v200, v201, v202
    v_smfmac_f32_16x16x64_bf16 v[48:51], v[196:199], a[136:143], v10
    v_max_u32 v16, v16, v203
    v_cmp_eq_u32 vcc, -1, v16
    v_smfmac_f32_16x16x64_bf16 v[52:55], v[196:199], a[168:175], v10
    s_branch L_qt2_Hl
L_qf31_Hl:
    buffer_load_dwordx4 v[204:207], v13, s[4:7], s59 offen offset:3072 sc1
    s_sub_u32 s39, s39, 1
    s_cbranch_scc1 L_chain_fail
    s_waitcnt vmcnt(1)
    v_max3_u32 v16, v196, v197, v198
    v_max_u32 v16, v16, v199
    v_cmp_eq_u32 vcc, -1, v16
L_qt13_Hl:
    s_nop 0
    s_cbranch_vccnz L_qf13_Hl
    v_smfmac_f32_16x16x64_bf16 v[32:35], v[196:199], a[8:15], v10
    v_smfmac_f32_16x16x64_bf16 v[36:39], v[196:199], a[40:47], v10
    v_smfmac_f32_16x16x64_bf16 v[40:43], v[196:199], a[72:79], v10
    v_smfmac_f32_16x16x64_bf16 v[44:47], v[196:199], a[104:111], v10
    s_waitcnt vmcnt(0)
    v_max3_u32 v16, v204, v205, v206
    v_smfmac_f32_16x16x64_bf16 v[48:51], v[196:199], a[136:143], v10
    v_max_u32 v16, v16, v207
    v_cmp_eq_u32 vcc, -1, v16
    v_smfmac_f32_16x16x64_bf16 v[52:55], v[196:199], a[168:175], v10
    s_branch L_qt3_Hl
L_qf1_Hl:
    buffer_load_dwordx4 v[196:199], v13, s[4:7], s59 offen offset:1024 sc1
    s_sub_u32 s39, s39, 1
    s_cbranch_scc1 L_chain_fail
    s_waitcnt vmcnt(0)
    v_max3_u32 v16, v196, v197, v198
    v_max_u32 v16, v16, v199
    v_cmp_eq_u32 vcc, -1, v16
    s_nop 0
    s_cbranch_vccnz L_qf1_Hl
    s_branch L_qt1_Hl
L_qf32_Hl:
    buffer_load_dwordx4 v[204:207], v13, s[4:7], s59 offen offset:3072 sc1
    s_sub_u32 s39, s39, 1
    s_cbranch_scc1 L_chain_fail
    s_waitcnt vmcnt(1)
    v_max3_u32 v16, v200, v201, v202
    v_max_u32 v16, v16, v203
    v_cmp_eq_u32 vcc, -1, v16
L_qt23_Hl:
    s_nop 0
    s_cbranch_vccnz L_qf23_Hl
    v_smfmac_f32_16x16x64_bf16 v[32:35], v[200:203], a[16:23], v10
    v_smfmac_f32_16x16x64_bf16 v[36:39], v[200:203], a[48:55], v10
    v_smfmac_f32_16x16x64_bf16 v[40:43], v[200:203], a[80:87], v10
    v_smfmac_f32_16x16x64_bf16 v[44:47], v[200:203], a[112:119], v10
    s_waitcnt vmcnt(0)
    v_max3_u32 v16, v204, v205, v206
    v_smfmac_f32_16x16x64_bf16 v[48:51], v[200:203], a[144:151], v10
    v_max_u32 v16, v16, v207
    v_cmp_eq_u32 vcc, -1, v16
    v_smfmac_f32_16x16x64_bf16 v[52:55], v[200:203], a[176:183], v10
    s_branch L_qt3_Hl
L_qf2_Hl:
    buffer_load_dwordx4 v[200:203], v13, s[4:7], s59 offen offset:2048 sc1
    s_sub_u32 s39, s39, 1
    s_cbranch_scc1 L_chain_fail
    s_waitcnt vmcnt(0)
    v_max3_u32 v16, v200, v201, v202
    v_max_u32 v16, v16, v203
    v_cmp_eq_u32 vcc, -1, v16
    s_nop 0
    s_cbranch_vccnz L_qf2_Hl
    s_branch L_qt2_Hl
L_qf2301_Hl:
    buffer_load_dwordx4 v[200:203], v13, s[4:7], s59 offen offset:2048 sc1
    s_waitcnt vmcnt(3)
    v_max3_u32 v16, v204, v205, v206
    v_max_u32 v16, v16, v207
    v_cmp_eq_u32 vcc, -1, v16
L_qt3012_Hl:
    s_nop 0
    s_cbranch_vccnz L_qf3012_Hl
    v_smfmac_f32_16x16x64_bf16 v[32:35], v[204:207], a[24:31], v10
    v_smfmac_f32_16x16x64_bf16 v[36:39], v[204:207], a[56:63], v10
    v_smfmac_f32_16x16x64_bf16 v[40:43], v[204:207], a[88:95], v10
    v_smfmac_f32_16x16x64_bf16 v[44:47], v[204:207], a[120:127], v10
    s_waitcnt vmcnt(2)
    v_max3_u32 v16, v192, v193, v194
    v_smfmac_f32_16x16x64_bf16 v[48:51], v[204:207], a[152:159], v10
    v_max_u32 v16, v16, v195
    v_cmp_eq_u32 vcc, -1, v16
    v_smfmac_f32_16x16x64_bf16 v[52:55], v[204:207], a[184:191], v10
L_qt012_Hl:
    s_cbranch_vccnz L_qf012_Hl
    v_smfmac_f32_16x16x64_bf16 v[32:35], v[192:195], a[0:7], v10
    v_smfmac_f32_16x16x64_bf16 v[36:39], v[192:195], a[32:39], v10
    v_smfmac_f32_16x16x64_bf16 v[40:43], v[192:195], a[64:71], v10
    v_smfmac_f32_16x16x64_bf16 v[44:47], v[192:195], a[96:103], v10
    s_waitcnt vmcnt(1)
    v_max3_u32 v16, v196, v197, v198
    v_smfmac_f32_16x16x64_bf16 v[48:51], v[192:195], a[128:135], v10
    v_max_u32 v16, v16, v199
    v_cmp_eq_u32 vcc, -1, v16
    v_smfmac_f32_16x16x64_bf16 v[52:55], v[192:195], a[160:167], v10
    s_branch L_qt12_Hl
L_qf301_Hl:
    buffer_load_dwordx4 v[204:207], v13, s[4:7], s59 offen offset:3072 sc1
    s_sub_u32 s39, s39, 1
    s_cbranch_scc1 L_chain_fail
    s_waitcnt vmcnt(2)
    v_max3_u32 v16, v192, v193, v194
    v_max_u32 v16, v16, v195
    v_cmp_eq_u32 vcc, -1, v16
L_qt013_Hl:
    s_nop 0
    s_cbranch_vccnz L_qf013_Hl
    v_smfmac_f32_16x16x64_bf16 v[32:35], v[192:195], a[0:7], v10
    v_smfmac_f32_16x16x64_bf16 v[36:39], v[192:195], a[32:39], v10
    v_smfmac_f32_16x16x64_bf16 v[40:43], v[192:195], a[64:71], v10
    v_smfmac_f32_16x16x64_bf16 v[44:47], v[192:195], a[96:103], v10
    s_waitcnt vmcnt(1)
    v_max3_u32 v16, v196, v197, v198
    v_smfmac_f32_16x16x64_bf16 v[48:51], v[192:195], a[128:135], v10
    v_max_u32 v16, v16, v199
    v_cmp_eq_u32 vcc, -1, v16
    v_smfmac_f32_16x16x64_bf16 v[52:55], v[192:195], a[160:167], v10
    s_branch L_qt13_Hl
L_qf01_Hl:
    buffer_load_dwordx4 v[192:195], v13, s[4:7], s59 offen offset:0 sc1
    s_waitcnt vmcnt(1)
    v_max3_u32 v16, v196, v197, v198
    v_max_u32 v16, v16, v199
    v_cmp_eq_u32 vcc, -1, v16
L_qt10_Hl:
    s_nop 0
    s_cbranch_vccnz L_qf10_Hl
    v_smfmac_f32_16x16x64_bf16 v[32:35], v[196:199], a[8:15], v10
    v_smfmac_f32_16x16x64_bf16 v[36:39], v[196:199], a[40:47], v10
    v_smfmac_f32_16x16x64_bf16 v[40:43], v[196:199], a[72:79], v10
    v_smfmac_f32_16x16x64_bf16 v[44:47], v[196:199], a[104:111], v10
    s_waitcnt vmcnt(0)
    v_max3_u32 v16, v192, v193, v194
    v_smfmac_f32_16x16x64_bf16 v[48:51], v[196:199], a[136:143], v10
    v_max_u32 v16, v16, v195
    v_cmp_eq_u32 vcc, -1, v16
    v_smfmac_f32_16x16x64_bf16 v[52:55], v[196:199], a[168:175], v10
    s_branch L_qt0_Hl
L_qf302_Hl:
    buffer_load_dwordx4 v[204:207], v13, s[4:7], s59 offen offset:3072 sc1
    s_sub_u32 s39, s39, 1
    s_cbranch_scc1 L_chain_fail
    s_waitcnt vmcnt(2)
    v_max3_u32 v16, v192, v193, v194
    v_max_u32 v16, v16, v195
    v_cmp_eq_u32 vcc, -1, v16
L_qt023_Hl:
    s_nop 0
    s_cbranch_vccnz L_qf023_Hl
    v_smfmac_f32_16x16x64_bf16 v[32:35], v[192:195], a[0:7], v10
    v_smfmac_f32_16x16x64_bf16 v[36:39], v[192:195], a[32:39], v10
    v_smfmac_f32_16x16x64_bf16 v[40:43], v[192:195], a[64:71], v10
    v_smfmac_f32_16x16x64_bf16 v[44:47], v[192:195], a[96:103], v10
    s_waitcnt vmcnt(1)
    v_max3_u32 v16, v200, v201, v202
    v_smfmac_f32_16x16x64_bf16 v[48:51], v[192:195], a[128:135], v10
    v_max_u32 v16, v16, v203
    v_cmp_eq_u32 vcc, -1, v16
    v_smfmac_f32_16x16x64_bf16 v[52:55], v[192:195], a[160:167], v10
    s_branch L_qt23_Hl
L_qf02_Hl:
    buffer_load_dwordx4 v[192:195], v13, s[4:7], s59 offen offset:0 sc1
    s_waitcnt vmcnt(1)
    v_max3_u32 v16, v200, v201, v202
    v_max_u32 v16, v16, v203
    v_cmp_eq_u32 vcc, -1, v16
L_qt20_Hl:
    s_nop 0
    s_cbranch_vccnz L_qf20_Hl
    v_smfmac_f32_16x16x64_bf16 v[32:35], v[200:203], a[16:23], v10
    v_smfmac_f32_16x16x64_bf16 v[36:39], v[200:203], a[48:55], v10
    v_smfmac_f32_16x16x64_bf16 v[40:43], v[200:203], a[80:87], v10
    v_smfmac_f32_16x16x64_bf16 v[44:47], v[200:203], a[112:119], v10
    s_waitcnt vmcnt(0)
    v_max3_u32 v16, v192, v193, v194
    v_smfmac_f32_16x16x64_bf16 v[48:51], v[200:203], a[144:151], v10
    v_max_u32 v16, v16, v195
    v_cmp_eq_u32 vcc, -1, v16
    v_smfmac_f32_16x16x64_bf16 v[52:55], v[200:203], a[176:183], v10
    s_branch L_qt0_Hl
L_qf03_Hl:
    buffer_load_dwordx4 v[192:195], v13, s[4:7], s59 offen offset:0 sc1
    s_waitcnt vmcnt(1)
    v_max3_u32 v16, v204, v205, v206
    v_max_u32 v16, v16, v207
    v_cmp_eq_u32 vcc, -1, v16
    s_nop 0
    s_cbranch_vccnz L_qf30_Hl
    s_branch L_qt30_Hl
L_qf312_Hl:
    buffer_load_dwordx4 v[204:207], v13, s[4:7], s59 offen offset:3072 sc1
    s_sub_u32 s39, s39, 1
    s_cbranch_scc1 L_chain_fail
    s_waitcnt vmcnt(2)
    v_max3_u32 v16, v196, v197, v198
    v_max_u32 v16, v16, v199
    v_cmp_eq_u32 vcc, -1, v16
L_qt123_Hl:
    s_nop 0
    s_cbranch_vccnz L_qf123_Hl
    v_smfmac_f32_16x16x64_bf16 v[32:35], v[196:199], a[8:15], v10
    v_smfmac_f32_16x16x64_bf16 v[36:39], v[196:199], a[40:47], v10
    v_smfmac_f32_16x16x64_bf16 v[40:43], v[196:199], a[72:79], v10
    v_smfmac_f32_16x16x64_bf16 v[44:47], v[196:199], a[104:111], v10
    s_waitcnt vmcnt(1)
    v_max3_u32 v16, v200, v201, v202
    v_smfmac_f32_16x16x64_bf16 v[48:51], v[196:199], a[136:143], v10
    v_max_u32 v16, v16, v203
    v_cmp_eq_u32 vcc, -1, v16
    v_smfmac_f32_16x16x64_bf16 v[52:55], v[196:199], a[168:175], v10
    s_branch L_qt23_Hl
L_qf12_Hl:
    buffer_load_dwordx4 v[196:199], v13, s[4:7], s59 offen offset:1024 sc1
    s_waitcnt vmcnt(1)
    v_max3_u32 v16, v200, v201, v202
    v_max_u32 v16, v16, v203
    v_cmp_eq_u32 vcc, -1, v16
L_qt21_Hl:
    s_nop 0
    s_cbranch_vccnz L_qf21_Hl
    v_smfmac_f32_16x16x64_bf16 v[32:35], v[200:203], a[16:23], v10
    v_smfmac_f32_16x16x64_bf16 v[36:39], v[200:203], a[48:55], v10
    v_smfmac_f32_16x16x64_bf16 v[40:43], v[200:203], a[80:87], v10
    v_smfmac_f32_16x16x64_bf16 v[44:47], v[200:203], a[112:119], v10
    s_waitcnt vmcnt(0)
    v_max3_u32 v16, v196, v197, v198
    v_smfmac_f32_16x16x64_bf16 v[48:51], v[200:203], a[144:151], v10
    v_max_u32 v16, v16, v199
    v_cmp_eq_u32 vcc, -1, v16
    v_smfmac_f32_16x16x64_bf16 v[52:55], v[200:203], a[176:183], v10
    s_branch L_qt1_Hl
L_qf13_Hl:
    buffer_load_dwordx4 v[196:199], v13, s[4:7], s59 offen offset:1024 sc1
    s_waitcnt vmcnt(1)
    v_max3_u32 v16, v204, v205, v206
    v_max_u32 v16, v16, v207
    v_cmp_eq_u32 vcc, -1, v16
    s_nop 0
    s_cbranch_vccnz L_qf31_Hl
    s_branch L_qt31_Hl
L_qf3012_Hl:
    buffer_load_dwordx4 v[204:207], v13, s[4:7], s59 offen offset:3072 sc1
    s_sub_u32 s39, s39, 1
    s_cbranch_scc1 L_chain_fail
    s_waitcnt vmcnt(3)
    v_max3_u32 v16, v192, v193, v194
    v_max_u32 v16, v16, v195
    v_cmp_eq_u32 vcc, -1, v16
L_qt0123_Hl:
    s_nop 0
    s_cbranch_vccnz L_qf0123_Hl
    v_smfmac_f32_16x16x64_bf16 v[32:35], v[192:195], a[0:7], v10
    v_smfmac_f32_16x16x64_bf16 v[36:39], v[192:195], a[32:39], v10
    v_smfmac_f32_16x16x64_bf16 v[40:43], v[192:195], a[64:71], v10
    v_smfmac_f32_16x16x64_bf16 v[44:47], v[192:195], a[96:103], v10
    s_waitcnt vmcnt(2)
    v_max3_u32 v16, v196, v197, v198
    v_smfmac_f32_16x16x64_bf16 v[48:51], v[192:195], a[128:135], v10
    v_max_u32 v16, v16, v199
    v_cmp_eq_u32 vcc, -1, v16
    v_smfmac_f32_16x16x64_bf16 v[52:55], v[192:195], a[160:167], v10
    s_branch L_qt123_Hl
L_qf012_Hl:
    buffer_load_dwordx4 v[192:195], v13, s[4:7], s59 offen offset:0 sc1
    s_waitcnt vmcnt(2)
    v_max3_u32 v16, v196, v197, v198
    v_max_u32 v16, v16, v199
    v_cmp_eq_u32 vcc, -1, v16
L_qt120_Hl:
    s_nop 0
    s_cbranch_vccnz L_qf120_Hl
    v_smfmac_f32_16x16x64_bf16 v[32:35], v[196:199], a[8:15], v10
    v_smfmac_f32_16x16x64_bf16 v[36:39], v[196:199], a[40:47], v10
    v_smfmac_f32_16x16x64_bf16 v[40:43], v[196:199], a[72:79], v10
    v_smfmac_f32_16x16x64_bf16 v[44:47], v[196:199], a[104:111], v10
    s_waitcnt vmcnt(1)
    v_max3_u32 v16, v200, v201, v202
    v_smfmac_f32_16x16x64_bf16 v[48:51], v[196:199], a[136:143], v10
    v_max_u32 v16, v16, v203
    v_cmp_eq_u32 vcc, -1, v16
    v_smfmac_f32_16x16x64_bf16 v[52:55], v[196:199], a[168:175], v10
    s_branch L_qt20_Hl
L_qf013_Hl:
    buffer_load_dwordx4 v[192:195], v13, s[4:7], s59 offen offset:0 sc1
    s_waitcnt vmcnt(2)
    v_max3_u32 v16, v196, v197, v198
    v_max_u32 v16, v16, v199
    v_cmp_eq_u32 vcc, -1, v16
L_qt130_Hl:
    s_nop 0
    s_cbranch_vccnz L_qf130_Hl
    v_smfmac_f32_16x16x64_bf16 v[32:35], v[196:199], a[8:15], v10
    v_smfmac_f32_16x16x64_bf16 v[36:39], v[196:199], a[40:47], v10
    v_smfmac_f32_16x16x64_bf16 v[40:43], v[196:199], a[72:79], v10
    v_smfmac_f32_16x16x64_bf16 v[44:47], v[196:199], a[104:111], v10
    s_waitcnt vmcnt(1)
    v_max3_u32 v16, v204, v205, v206
    v_smfmac_f32_16x16x64_bf16 v[48:51], v[196:199], a[136:143], v10
    v_max_u32 v16, v16, v207
    v_cmp_eq_u32 vcc, -1, v16
    v_smfmac_f32_16x16x64_bf16 v[52:55], v[196:199], a[168:175], v10
    s_branch L_qt30_Hl
L_qf10_Hl:
    buffer_load_dwordx4 v[196:199], v13, s[4:7], s59 offen offset:1024 sc1
    s_sub_u32 s39, s39, 1
    s_cbranch_scc1 L_chain_fail
    s_waitcnt vmcnt(1)
    v_max3_u32 v16, v192, v193, v194
    v_max_u32 v16, v16, v195
    v_cmp_eq_u32 vcc, -1, v16
    s_nop 0
    s_cbranch_vccnz L_qf01_Hl
    s_branch L_qt01_Hl
L_qf023_Hl:
    buffer_load_dwordx4 v[192:195], v13, s[4:7], s59 offen offset:0 sc1
    s_waitcnt vmcnt(2)
    v_max3_u32 v16, v200, v201, v202
    v_max_u32 v16, v16, v203
    v_cmp_eq_u32 vcc, -1, v16
    s_nop 0
    s_cbranch_vccnz L_qf230_Hl
    s_branch L_qt230_Hl
L_qf20_Hl:
    buffer_load_dwordx4 v[200:203], v13, s[4:7], s59 offen offset:2048 sc1
    s_sub_u32 s39, s39, 1
    s_cbranch_scc1 L_chain_fail
    s_waitcnt vmcnt(1)
    v_max3_u32 v16, v192, v193, v194
    v_max_u32 v16, v16, v195
    v_cmp_eq_u32 vcc, -1, v16
    s_nop 0
    s_cbranch_vccnz L_qf02_Hl
    s_branch L_qt02_Hl
L_qf21_Hl:
    buffer_load_dwordx4 v[200:203], v13, s[4:7], s59 offen offset:2048 sc1
    s_sub_u32 s39, s39, 1
    s_cbranch_scc1 L_chain_fail
    s_waitcnt vmcnt(1)
    v_max3_u32 v16, v196, v197, v198
    v_max_u32 v16, v16, v199
    v_cmp_eq_u32 vcc, -1, v16
    s_nop 0
    s_cbranch_vccnz L_qf12_Hl
    s_branch L_qt12_Hl
L_qf120_Hl:
    buffer_load_dwordx4 v[196:199], v13, s[4:7], s59 offen offset:1024 sc1
    s_waitcnt vmcnt(2)
    v_max3_u32 v16, v200, v201, v202
    v_max_u32 v16, v16, v203
    v_cmp_eq_u32 vcc, -1, v16
L_qt201_Hl:
    s_nop 0
    s_cbranch_vccnz L_qf201_Hl
    v_smfmac_f32_16x16x64_bf16 v[32:35], v[200:203], a[16:23], v10
    v_smfmac_f32_16x16x64_bf16 v[36:39], v[200:203], a[48:55], v10
    v_smfmac_f32_16x16x64_bf16 v[40:43], v[200:203], a[80:87], v10
    v_smfmac_f32_16x16x64_bf16 v[44:47], v[200:203], a[112:119], v10
    s_waitcnt vmcnt(1)
    v_max3_u32 v16, v192, v193, v194
    v_smfmac_f32_16x16x64_bf16 v[48:51], v[200:203], a[144:151], v10
    v_max_u32 v16, v16, v195
    v_cmp_eq_u32 vcc, -1, v16
    v_smfmac_f32_16x16x64_bf16 v[52:55], v[200:203], a[176:183], v10
    s_branch L_qt01_Hl
L_qf130_Hl:
    buffer_load_dwordx4 v[196:199], v13, s[4:7], s59 offen offset:1024 sc1
    s_waitcnt vmcnt(2)
    v_max3_u32 v16, v204, v205, v206
    v_max_u32 v16, v16, v207
    v_cmp_eq_u32 vcc, -1, v16
    s_nop 0
    s_cbranch_vccnz L_qf301_Hl
    s_branch L_qt301_Hl
L_qf201_Hl:
    buffer_load_dwordx4 v[200:203], v13, s[4:7], s59 offen offset:2048 sc1
    s_sub_u32 s39, s39, 1
    s_cbranch_scc1 L_chain_fail
    s_waitcnt vmcnt(2)
    v_max3_u32 v16, v192, v193, v194
    v_max_u32 v16, v16, v195
    v_cmp_eq_u32 vcc, -1, v16
    s_nop 0
    s_cbranch_vccnz L_qf012_Hl
    s_branch L_qt012_Hl
L_cretry_Hl:
    buffer_load_dwordx4 v[192:195], v1, s[4:7], s55 offen offset:0 sc1
    buffer_load_dwordx4 v[196:199], v1, s[4:7], s55 offen offset:1024 sc1
    buffer_load_dwordx4 v[200:203], v1, s[4:7], s55 offen offset:2048 sc1
    buffer_load_dwordx4 v[204:207], v1, s[4:7], s55 offen offset:3072 sc1
    s_sub_u32 s39, s39, 1
    s_cbranch_scc0 L_hopc_Hl
    s_branch L_chain_fail
L_kvs_Hl:
Lkv_32:
    buffer_load_dword v16, off, s[4:7], s57 sc1
    s_waitcnt vmcnt(0)
    v_readfirstlane_b32 s50, v16
    s_nop 0
    s_cmp_eq_u32 s50, 8
    s_cbranch_scc1 Lkv_33
    s_sleep 4
    s_sub_u32 s39, s39, 1
    s_cbranch_scc0 Lkv_32
    s_branch L_chain_fail
Lkv_33:
    s_branch L_kvo_Hl
L_last_Hl:
    buffer_store_dword v27, v2, s[4:7], s58 offen offset:2048 sc1
    s_branch L_lastk
L_remote:
    s_cmp_ge_u32 s32, 2
    s_cbranch_scc1 L_Hr
    v_mov_b32 v56, 0
    v_mov_b32 v57, 0
    v_mov_b32 v58, 0
    v_mov_b32 v59, 0
    v_mov_b32 v60, 0
    v_mov_b32 v61, 0
    v_mov_b32 v62, 0
    v_mov_b32 v63, 0
L_loop_Sr:
    v_pk_add_f32 v[32:33], v[32:33], v[34:35]
    ds_write_b64 v3, v[32:33] offset:0
    v_pk_add_f32 v[36:37], v[36:37], v[38:39]
    ds_write_b64 v3, v[36:37] offset:776
    v_pk_add_f32 v[40:41], v[40:41], v[42:43]
    ds_write_b64 v3, v[40:41] offset:1552
    v_pk_add_f32 v[44:45], v[44:45], v[46:47]
    ds_write_b64 v3, v[44:45] offset:2328
    v_pk_add_f32 v[48:49], v[48:49], v[50:51]
    ds_write_b64 v3, v[48:49] offset:3104
    v_pk_add_f32 v[52:53], v[52:53], v[54:55]
    ds_write_b64 v3, v[52:53] offset:3880
L_loopw_Sr:
    s_waitcnt lgkmcnt(0)
    s_barrier
    ds_read2st64_b32 v[208:209], v4 offset0:0 offset1:19
    ds_read2st64_b32 v[210:211], v4 offset0:38 offset1:57
    ds_read2st64_b32 v[212:213], v5 offset0:0 offset1:19
    ds_read2st64_b32 v[214:215], v5 offset0:38 offset1:57
    s_waitcnt lgkmcnt(2)
    v_pk_add_f32 v[208:209], v[208:209], v[210:211]
    v_add_f32 v208, v208, v209
    s_waitcnt lgkmcnt(0)
    v_pk_add_f32 v[212:213], v[212:213], v[214:215]
    v_add_f32 v212, v212, v213
    v_cvt_pk_bf16_f32 v26, v208, v212
    buffer_store_dword v26, v2, s[4:7], s53 offen offset:0 sc1
    s_lshl_b32 s97, s37, 17
    s_add_u32 s97, s97, s96
    s_cmp_eq_u32 s37, 63
    s_cbranch_scc1 L_lastk
    ds_read_b128 v[64:67], v8 offset:0
    ds_read_b128 v[68:71], v8 offset:1024
    ds_read_b128 v[72:75], v8 offset:2048
    ds_read_b128 v[76:79], v8 offset:3072
    ds_read_b128 v[80:83], v8 offset:4096
    ds_read_b128 v[84:87], v8 offset:5120
    ds_read_b128 v[88:91], v8 offset:6144
    ds_read_b128 v[92:95], v8 offset:7168
    s_min_u32 s51, s37, 60
    s_lshl_b32 s51, s51, 18
    s_add_u32 s51, s51, s84
    s_and_b32 s56, s37, 15
    s_lshl_b32 s56, s56, 19
    s_add_u32 s56, s56, s43
    s_and_b32 s52, s37, 4
    s_lshl_b32 s52, s52, 11
    s_xor_b32 s56, s56, s52
    s_and_b32 s57, s37, 3
    s_mul_i32 s57, s57, 131072
    s_add_u32 s57, s57, s44
    s_and_b32 s59, s37, 3
    s_mul_i32 s59, s59, 131072
    s_add_u32 s59, s59, s45
    s_and_b32 s54, s37, 3
    s_xor_b32 s54, s54, 2
    s_mul_i32 s54, s54, 196608
    s_add_u32 s54, s54, s40
    s_and_b32 s58, s37, 3
    s_xor_b32 s58, s58, 2
    s_mul_i32 s58, s58, 131072
    s_add_u32 s58, s58, s44
    v_mov_b64 v[32:33], 0
    v_mov_b64 v[34:35], 0
    v_mov_b64 v[36:37], 0
    buffer_load_dwordx4 v[192:195], v1, s[4:7], s55 offen offset:0 sc1
    buffer_load_dwordx4 v[196:199], v1, s[4:7], s55 offen offset:1024 sc1
    buffer_load_dwordx4 v[200:203], v1, s[4:7], s55 offen offset:2048 sc1
    buffer_load_dwordx4 v[204:207], v1, s[4:7], s55 offen offset:3072 sc1
    v_mov_b64 v[38:39], 0
    v_mov_b64 v[40:41], 0
    v_mov_b64 v[42:43], 0
    v_mov_b64 v[44:45], 0
    v_mov_b64 v[46:47], 0
    v_mov_b64 v[48:49], 0
    v_mov_b64 v[50:51], 0
    v_mov_b64 v[52:53], 0
    v_mov_b64 v[54:55], 0
    s_waitcnt lgkmcnt(0)
L_hopc_Sr:
    s_waitcnt vmcnt(3)
    v_smfmac_f32_16x16x64_bf16 v[56:59], v[192:195], v[64:71], v10
    v_max3_u32 v16, v192, v192, v193
    v_smfmac_f32_16x16x64_bf16 v[60:63], v[192:195], v[80:87], v10
    v_max3_u32 v16, v16, v194, v195
    s_waitcnt vmcnt(2)
    v_smfmac_f32_16x16x64_bf16 v[56:59], v[196:199], v[72:79], v10
    v_max3_u32 v16, v16, v196, v197
    v_smfmac_f32_16x16x64_bf16 v[60:63], v[196:199], v[88:95], v10
    v_max3_u32 v16, v16, v198, v199
    s_waitcnt vmcnt(1)
    v_mfma_f32_16x16x32_bf16 v[228:231], v[192:195], v[200:203], 0
    v_max3_u32 v16, v16, v200, v201
    v_max3_u32 v16, v16, v202, v203
    s_waitcnt vmcnt(0)
    v_mfma_f32_16x16x32_bf16 v[228:231], v[196:199], v[204:207], v[228:231]
    v_max3_u32 v16, v16, v204, v205
    v_max3_u32 v16, v16, v206, v207
    v_cmp_eq_u32 vcc, -1, v16
    v_pk_add_f32 v[18:19], v[56:57], v[58:59]
    v_pk_add_f32 v[20:21], v[60:61], v[62:63]
    s_cbranch_vccnz L_cretry_Sr
    s_nop 1
    v_cndmask_b32 v22, v228, v230, s[60:61]
    v_cndmask_b32 v23, v229, v231, s[60:61]
    s_nop 0
    v_add_f32_dpp v22, v22, v22 quad_perm:[2,3,0,1] row_mask:0xf bank_mask:0xf
    v_add_f32_dpp v23, v23, v23 quad_perm:[2,3,0,1] row_mask:0xf bank_mask:0xf
    v_max3_f32 v24, v18, v20, v22
    v_max3_f32 v25, v19, v21, v23
    s_nop 0
    v_max_f32_dpp v24, v24, v24 row_ror:8 row_mask:0xf bank_mask:0xf
    v_max_f32_dpp v25, v25, v25 row_ror:8 row_mask:0xf bank_mask:0xf
    s_nop 0
    v_max_f32_dpp v24, v24, v24 row_ror:4 row_mask:0xf bank_mask:0xf
    v_max_f32_dpp v25, v25, v25 row_ror:4 row_mask:0xf bank_mask:0xf
    s_nop 0
    v_max_f32_dpp v24, v24, v24 row_ror:2 row_mask:0xf bank_mask:0xf
    v_max_f32_dpp v25, v25, v25 row_ror:2 row_mask:0xf bank_mask:0xf
    s_nop 0
    v_max_f32_dpp v24, v24, v24 row_ror:1 row_mask:0xf bank_mask:0xf
    v_max_f32_dpp v25, v25, v25 row_ror:1 row_mask:0xf bank_mask:0xf
    v_pk_mul_f32 v[24:25], v[24:25], s[66:67]
    v_pk_fma_f32 v[18:19], v[18:19], s[66:67], v[24:25] neg_lo:[0,0,1] neg_hi:[0,0,1]
    v_pk_fma_f32 v[20:21], v[20:21], s[66:67], v[24:25] neg_lo:[0,0,1] neg_hi:[0,0,1]
    v_pk_fma_f32 v[22:23], v[22:23], s[66:67], v[24:25] neg_lo:[0,0,1] neg_hi:[0,0,1]
    v_exp_f32 v18, v18
    v_exp_f32 v19, v19
    v_exp_f32 v20, v20
    v_exp_f32 v21, v21
    v_exp_f32 v22, v22
    v_exp_f32 v23, v23
    v_pk_add_f32 v[24:25], v[18:19], v[20:21]
    v_fma_f32 v24, v22, 0.5, v24
    v_fma_f32 v25, v23, 0.5, v25
    s_nop 0
    v_add_f32_dpp v24, v24, v24 row_ror:8 row_mask:0xf bank_mask:0xf
    v_add_f32_dpp v25, v25, v25 row_ror:8 row_mask:0xf bank_mask:0xf
    s_nop 0
    v_add_f32_dpp v24, v24, v24 row_ror:4 row_mask:0xf bank_mask:0xf
    v_add_f32_dpp v25, v25, v25 row_ror:4 row_mask:0xf bank_mask:0xf
    s_nop 0
    v_add_f32_dpp v24, v24, v24 row_ror:2 row_mask:0xf bank_mask:0xf
    v_add_f32_dpp v25, v25, v25 row_ror:2 row_mask:0xf bank_mask:0xf
    s_nop 0
    v_add_f32_dpp v24, v24, v24 row_ror:1 row_mask:0xf bank_mask:0xf
    v_add_f32_dpp v25, v25, v25 row_ror:1 row_mask:0xf bank_mask:0xf
    v_rcp_f32 v24, v24
    v_rcp_f32 v25, v25
    s_nop 0
    v_pk_mul_f32 v[18:19], v[18:19], v[24:25]
    v_pk_mul_f32 v[20:21], v[20:21], v[24:25]
    v_pk_mul_f32 v[22:23], v[22:23], v[24:25]
    v_cvt_pk_bf16_f32 v228, v18, v19
    v_cvt_pk_bf16_f32 v229, v20, v21
    v_cvt_pk_bf16_f32 v230, v22, v23
    ds_write2_b32 v6, v228, v229 offset0:0 offset1:64
    ds_write_b32 v7, v230 offset:512
    s_waitcnt lgkmcnt(0)
    s_barrier
    s_add_u32 s37, s37, 1
    s_and_b32 s53, s37, 3
    s_mul_i32 s53, s53, 196608
    s_add_u32 s53, s53, s40
    s_and_b32 s55, s37, 3
    s_mul_i32 s55, s55, 196608
    s_add_u32 s55, s55, s46
    v_mov_b64 v[56:57], 0
    v_mov_b64 v[58:59], 0
    v_mov_b64 v[60:61], 0
    v_mov_b64 v[62:63], 0
    v_xor_b32 v8, 0x4000, v8
    s_cmp_lt_u32 s37, 55
    s_cbranch_scc1 Lls_34
    s_cmp_eq_u32 s37, 55
    s_cbranch_scc0 Lls_35
    s_lshl_b32 s22, s20, 15
    s_lshl_b32 s23, s32, 13
    s_add_u32 s22, s22, s23
    v_mov_b32 v188, s22
    v_bfe_u32 v190, v0, 0, 6
    v_lshl_add_u32 v188, v190, 4, v188
    v_subrev_u32 v189, 8, v188
    buffer_load_dwordx2 v[96:97], v189, s[12:15], 0 offen offset:0
    buffer_load_dwordx4 v[98:101], v188, s[12:15], 0 offen offset:0
Lls_35:
    s_cmp_eq_u32 s37, 56
    s_cbranch_scc0 Lls_36
    buffer_load_dwordx2 v[102:103], v188, s[12:15], 0 offen offset:1016
    buffer_load_dwordx4 v[104:107], v188, s[12:15], 0 offen offset:1024
Lls_36:
    s_cmp_eq_u32 s37, 57
    s_cbranch_scc0 Lls_37
    v_add_u32 v188, 4096, v188
    v_subrev_u32 v189, 8, v188
    buffer_load_dwordx2 v[120:121], v189, s[12:15], 0 offen offset:0
    buffer_load_dwordx4 v[122:125], v188, s[12:15], 0 offen offset:0
Lls_37:
    s_cmp_eq_u32 s37, 58
    s_cbranch_scc0 Lls_38
    buffer_load_dwordx2 v[126:127], v188, s[12:15], 0 offen offset:1016
    buffer_load_dwordx4 v[128:131], v188, s[12:15], 0 offen offset:1024
Lls_38:
    s_cmp_eq_u32 s37, 59
    s_cbranch_scc0 Lls_39
    s_lshl_b32 s23, s20, 15
    s_lshl_b32 s22, s32, 10
    s_add_u32 s23, s23, s22
    s_add_u32 s23, s23, 0x9200000
    s_cmp_lt_u32 s32, 2
    s_cselect_b32 s23, s23, 0x10000000
    v_lshlrev_b32 v189, 4, v0
    buffer_load_dwordx4 v[144:147], v189, s[4:7], s23 offen sc1
    s_add_u32 s23, s23, 4096
    buffer_load_dwordx4 v[148:151], v189, s[4:7], s23 offen sc1
Lls_39:
    s_cmp_eq_u32 s37, 60
    s_cbranch_scc0 Lls_40
    s_add_u32 s23, s23, 4096
    buffer_load_dwordx4 v[152:155], v189, s[4:7], s23 offen sc1
    s_add_u32 s23, s23, 4096
    buffer_load_dwordx4 v[156:159], v189, s[4:7], s23 offen sc1
Lls_40:
    s_cmp_eq_u32 s37, 61
    s_cbranch_scc0 Lls_41
    s_add_u32 s23, s23, 4096
    buffer_load_dwordx4 v[160:163], v189, s[4:7], s23 offen sc1
    s_add_u32 s23, s23, 4096
    buffer_load_dwordx4 v[164:167], v189, s[4:7], s23 offen sc1
Lls_41:
    s_cmp_eq_u32 s37, 62
    s_cbranch_scc0 Lls_42
    s_add_u32 s23, s23, 4096
    buffer_load_dwordx4 v[168:171], v189, s[4:7], s23 offen sc1
    s_add_u32 s23, s23, 4096
    buffer_load_dwordx4 v[172:175], v189, s[4:7], s23 offen sc1
    s_add_u32 s23, s23, 4096
Lls_42:
Lls_34:
    s_mov_b64 exec, 0xffff
    buffer_load_dword v27, v11, s[4:7], s51 offen sc1
    s_mov_b64 exec, -1
    buffer_store_dword v26, v2, s[4:7], s97 offen offset:0 sc1
    buffer_store_dword v28, v2, s[4:7], s54 offen offset:0 sc1
    buffer_store_dword v28, v14, s[4:7], s58 offen offset:0 sc1
    s_barrier
L_hopa_Sr:
    buffer_load_dwordx4 v[192:195], v12, s[4:7], s56 offen offset:0 sc1
    buffer_load_dwordx4 v[196:199], v12, s[4:7], s56 offen offset:1024 sc1
    buffer_load_dwordx4 v[200:203], v12, s[4:7], s56 offen offset:2048 sc1
    buffer_load_dwordx4 v[204:207], v12, s[4:7], s56 offen offset:3072 sc1
    s_mov_b64 exec, -1
    s_waitcnt vmcnt(3)
    v_mfma_f32_16x16x32_bf16 v[232:235], v[192:195], v[240:243], 0
    s_waitcnt vmcnt(2)
    v_mfma_f32_16x16x32_bf16 v[232:235], v[196:199], v[240:243], v[232:235]
    s_waitcnt vmcnt(1)
    v_mfma_f32_16x16x32_bf16 v[232:235], v[200:203], v[240:243], v[232:235]
    s_waitcnt vmcnt(0)
    v_mfma_f32_16x16x32_bf16 v[232:235], v[204:207], v[240:243], v[232:235]
    s_nop 7
    v_pk_add_f32 v[16:17], v[232:233], v[234:235]
    v_cvt_pk_bf16_f32 v232, v232, v233
    v_cvt_pk_bf16_f32 v233, v234, v235
    v_cmp_u_f32 vcc, v16, v17
    v_cndmask_b32 v232, v233, v232, s[86:87]
    s_cbranch_vccnz L_aslow_Sr
L_aok_Sr:
    buffer_store_dword v232, v14, s[4:7], s57 offen offset:0 sc1
L_askip_Sr:
    s_barrier
    buffer_load_dwordx4 v[192:195], v13, s[4:7], s59 offen offset:0 sc1
    buffer_load_dwordx4 v[196:199], v13, s[4:7], s59 offen offset:1024 sc1
    buffer_load_dwordx4 v[200:203], v13, s[4:7], s59 offen offset:2048 sc1
    buffer_load_dwordx4 v[204:207], v13, s[4:7], s59 offen offset:3072 sc1
    s_waitcnt vmcnt(3)
    v_max3_u32 v16, v192, v193, v194
    v_max_u32 v16, v16, v195
    v_cmp_eq_u32 vcc, -1, v16
    s_nop 0
    s_cbranch_vccnz L_qf0123_Sr
    v_smfmac_f32_16x16x64_bf16 v[32:35], v[192:195], a[0:7], v10
    v_smfmac_f32_16x16x64_bf16 v[36:39], v[192:195], a[32:39], v10
    s_waitcnt vmcnt(2)
    v_max3_u32 v16, v196, v197, v198
    v_smfmac_f32_16x16x64_bf16 v[40:43], v[192:195], a[64:71], v10
    v_max_u32 v16, v16, v199
    v_cmp_eq_u32 vcc, -1, v16
    v_smfmac_f32_16x16x64_bf16 v[44:47], v[192:195], a[96:103], v10
    v_smfmac_f32_16x16x64_bf16 v[48:51], v[192:195], a[128:135], v10
    v_smfmac_f32_16x16x64_bf16 v[52:55], v[192:195], a[160:167], v10
    s_cbranch_vccnz L_qf123_Sr
    v_smfmac_f32_16x16x64_bf16 v[32:35], v[196:199], a[8:15], v10
    v_smfmac_f32_16x16x64_bf16 v[36:39], v[196:199], a[40:47], v10
    s_waitcnt vmcnt(1)
    v_max3_u32 v16, v200, v201, v202
    v_smfmac_f32_16x16x64_bf16 v[40:43], v[196:199], a[72:79], v10
    v_max_u32 v16, v16, v203
    v_cmp_eq_u32 vcc, -1, v16
    v_smfmac_f32_16x16x64_bf16 v[44:47], v[196:199], a[104:111], v10
    v_smfmac_f32_16x16x64_bf16 v[48:51], v[196:199], a[136:143], v10
    v_smfmac_f32_16x16x64_bf16 v[52:55], v[196:199], a[168:175], v10
    s_cbranch_vccnz L_qf23_Sr
    v_smfmac_f32_16x16x64_bf16 v[32:35], v[200:203], a[16:23], v10
    v_smfmac_f32_16x16x64_bf16 v[36:39], v[200:203], a[48:55], v10
    s_waitcnt vmcnt(0)
    v_max3_u32 v16, v204, v205, v206
    v_smfmac_f32_16x16x64_bf16 v[40:43], v[200:203], a[80:87], v10
    v_max_u32 v16, v16, v207
    v_cmp_eq_u32 vcc, -1, v16
    v_smfmac_f32_16x16x64_bf16 v[44:47], v[200:203], a[112:119], v10
    v_smfmac_f32_16x16x64_bf16 v[48:51], v[200:203], a[144:151], v10
    v_smfmac_f32_16x16x64_bf16 v[52:55], v[200:203], a[176:183], v10
    s_cbranch_vccnz L_qf3_Sr
    v_smfmac_f32_16x16x64_bf16 v[32:35], v[204:207], a[24:31], v10
    v_smfmac_f32_16x16x64_bf16 v[36:39], v[204:207], a[56:63], v10
    v_smfmac_f32_16x16x64_bf16 v[40:43], v[204:207], a[88:95], v10
    v_smfmac_f32_16x16x64_bf16 v[44:47], v[204:207], a[120:127], v10
    v_smfmac_f32_16x16x64_bf16 v[48:51], v[204:207], a[152:159], v10
    v_smfmac_f32_16x16x64_bf16 v[52:55], v[204:207], a[184:191], v10
    s_nop 2
    v_pk_add_f32 v[32:33], v[32:33], v[34:35]
    ds_write_b64 v3, v[32:33] offset:0
    v_pk_add_f32 v[36:37], v[36:37], v[38:39]
    ds_write_b64 v3, v[36:37] offset:776
    v_pk_add_f32 v[40:41], v[40:41], v[42:43]
    ds_write_b64 v3, v[40:41] offset:1552
    v_pk_add_f32 v[44:45], v[44:45], v[46:47]
    ds_write_b64 v3, v[44:45] offset:2328
    v_pk_add_f32 v[48:49], v[48:49], v[50:51]
    ds_write_b64 v3, v[48:49] offset:3104
    v_pk_add_f32 v[52:53], v[52:53], v[54:55]
    ds_write_b64 v3, v[52:53] offset:3880
    s_branch L_loopw_Sr
L_qf0123_Sr:
    buffer_load_dwordx4 v[192:195], v13, s[4:7], s59 offen offset:0 sc1
    s_waitcnt vmcnt(3)
    v_max3_u32 v16, v196, v197, v198
    v_max_u32 v16, v16, v199
    v_cmp_eq_u32 vcc, -1, v16
L_qt1230_Sr:
    s_nop 0
    s_cbranch_vccnz L_qf1230_Sr
    v_smfmac_f32_16x16x64_bf16 v[32:35], v[196:199], a[8:15], v10
    v_smfmac_f32_16x16x64_bf16 v[36:39], v[196:199], a[40:47], v10
    v_smfmac_f32_16x16x64_bf16 v[40:43], v[196:199], a[72:79], v10
    v_smfmac_f32_16x16x64_bf16 v[44:47], v[196:199], a[104:111], v10
    s_waitcnt vmcnt(2)
    v_max3_u32 v16, v200, v201, v202
    v_smfmac_f32_16x16x64_bf16 v[48:51], v[196:199], a[136:143], v10
    v_max_u32 v16, v16, v203
    v_cmp_eq_u32 vcc, -1, v16
    v_smfmac_f32_16x16x64_bf16 v[52:55], v[196:199], a[168:175], v10
L_qt230_Sr:
    s_cbranch_vccnz L_qf230_Sr
    v_smfmac_f32_16x16x64_bf16 v[32:35], v[200:203], a[16:23], v10
    v_smfmac_f32_16x16x64_bf16 v[36:39], v[200:203], a[48:55], v10
    v_smfmac_f32_16x16x64_bf16 v[40:43], v[200:203], a[80:87], v10
    v_smfmac_f32_16x16x64_bf16 v[44:47], v[200:203], a[112:119], v10
    s_waitcnt vmcnt(1)
    v_max3_u32 v16, v204, v205, v206
    v_smfmac_f32_16x16x64_bf16 v[48:51], v[200:203], a[144:151], v10
    v_max_u32 v16, v16, v207
    v_cmp_eq_u32 vcc, -1, v16
    v_smfmac_f32_16x16x64_bf16 v[52:55], v[200:203], a[176:183], v10
L_qt30_Sr:
    s_cbranch_vccnz L_qf30_Sr
    v_smfmac_f32_16x16x64_bf16 v[32:35], v[204:207], a[24:31], v10
    v_smfmac_f32_16x16x64_bf16 v[36:39], v[204:207], a[56:63], v10
    v_smfmac_f32_16x16x64_bf16 v[40:43], v[204:207], a[88:95], v10
    v_smfmac_f32_16x16x64_bf16 v[44:47], v[204:207], a[120:127], v10
    s_waitcnt vmcnt(0)
    v_max3_u32 v16, v192, v193, v194
    v_smfmac_f32_16x16x64_bf16 v[48:51], v[204:207], a[152:159], v10
    v_max_u32 v16, v16, v195
    v_cmp_eq_u32 vcc, -1, v16
    v_smfmac_f32_16x16x64_bf16 v[52:55], v[204:207], a[184:191], v10
L_qt0_Sr:
    s_cbranch_vccnz L_qf0_Sr
    v_smfmac_f32_16x16x64_bf16 v[32:35], v[192:195], a[0:7], v10
    v_smfmac_f32_16x16x64_bf16 v[36:39], v[192:195], a[32:39], v10
    v_smfmac_f32_16x16x64_bf16 v[40:43], v[192:195], a[64:71], v10
    v_smfmac_f32_16x16x64_bf16 v[44:47], v[192:195], a[96:103], v10
    v_smfmac_f32_16x16x64_bf16 v[48:51], v[192:195], a[128:135], v10
    v_smfmac_f32_16x16x64_bf16 v[52:55], v[192:195], a[160:167], v10
    s_nop 2
    v_pk_add_f32 v[32:33], v[32:33], v[34:35]
    ds_write_b64 v3, v[32:33] offset:0
    v_pk_add_f32 v[36:37], v[36:37], v[38:39]
    ds_write_b64 v3, v[36:37] offset:776
    v_pk_add_f32 v[40:41], v[40:41], v[42:43]
    ds_write_b64 v3, v[40:41] offset:1552
    v_pk_add_f32 v[44:45], v[44:45], v[46:47]
    ds_write_b64 v3, v[44:45] offset:2328
    v_pk_add_f32 v[48:49], v[48:49], v[50:51]
    ds_write_b64 v3, v[48:49] offset:3104
    v_pk_add_f32 v[52:53], v[52:53], v[54:55]
    ds_write_b64 v3, v[52:53] offset:3880
    s_branch L_loopw_Sr
L_qf123_Sr:
    buffer_load_dwordx4 v[196:199], v13, s[4:7], s59 offen offset:1024 sc1
    s_waitcnt vmcnt(2)
    v_max3_u32 v16, v200, v201, v202
    v_max_u32 v16, v16, v203
    v_cmp_eq_u32 vcc, -1, v16
L_qt231_Sr:
    s_nop 0
    s_cbranch_vccnz L_qf231_Sr
    v_smfmac_f32_16x16x64_bf16 v[32:35], v[200:203], a[16:23], v10
    v_smfmac_f32_16x16x64_bf16 v[36:39], v[200:203], a[48:55], v10
    v_smfmac_f32_16x16x64_bf16 v[40:43], v[200:203], a[80:87], v10
    v_smfmac_f32_16x16x64_bf16 v[44:47], v[200:203], a[112:119], v10
    s_waitcnt vmcnt(1)
    v_max3_u32 v16, v204, v205, v206
    v_smfmac_f32_16x16x64_bf16 v[48:51], v[200:203], a[144:151], v10
    v_max_u32 v16, v16, v207
    v_cmp_eq_u32 vcc, -1, v16
    v_smfmac_f32_16x16x64_bf16 v[52:55], v[200:203], a[176:183], v10
L_qt31_Sr:
    s_cbranch_vccnz L_qf31_Sr
    v_smfmac_f32_16x16x64_bf16 v[32:35], v[204:207], a[24:31], v10
    v_smfmac_f32_16x16x64_bf16 v[36:39], v[204:207], a[56:63], v10
    v_smfmac_f32_16x16x64_bf16 v[40:43], v[204:207], a[88:95], v10
    v_smfmac_f32_16x16x64_bf16 v[44:47], v[204:207], a[120:127], v10
    s_waitcnt vmcnt(0)
    v_max3_u32 v16, v196, v197, v198
    v_smfmac_f32_16x16x64_bf16 v[48:51], v[204:207], a[152:159], v10
    v_max_u32 v16, v16, v199
    v_cmp_eq_u32 vcc, -1, v16
    v_smfmac_f32_16x16x64_bf16 v[52:55], v[204:207], a[184:191], v10
L_qt1_Sr:
    s_cbranch_vccnz L_qf1_Sr
    v_smfmac_f32_16x16x64_bf16 v[32:35], v[196:199], a[8:15], v10
    v_smfmac_f32_16x16x64_bf16 v[36:39], v[196:199], a[40:47], v10
    v_smfmac_f32_16x16x64_bf16 v[40:43], v[196:199], a[72:79], v10
    v_smfmac_f32_16x16x64_bf16 v[44:47], v[196:199], a[104:111], v10
    v_smfmac_f32_16x16x64_bf16 v[48:51], v[196:199], a[136:143], v10
    v_smfmac_f32_16x16x64_bf16 v[52:55], v[196:199], a[168:175], v10
    s_nop 2
    v_pk_add_f32 v[32:33], v[32:33], v[34:35]
    ds_write_b64 v3, v[32:33] offset:0
    v_pk_add_f32 v[36:37], v[36:37], v[38:39]
    ds_write_b64 v3, v[36:37] offset:776
    v_pk_add_f32 v[40:41], v[40:41], v[42:43]
    ds_write_b64 v3, v[40:41] offset:1552
    v_pk_add_f32 v[44:45], v[44:45], v[46:47]
    ds_write_b64 v3, v[44:45] offset:2328
    v_pk_add_f32 v[48:49], v[48:49], v[50:51]
    ds_write_b64 v3, v[48:49] offset:3104
    v_pk_add_f32 v[52:53], v[52:53], v[54:55]
    ds_write_b64 v3, v[52:53] offset:3880
    s_branch L_loopw_Sr
L_qf23_Sr:
    buffer_load_dwordx4 v[200:203], v13, s[4:7], s59 offen offset:2048 sc1
    s_waitcnt vmcnt(1)
    v_max3_u32 v16, v204, v205, v206
    v_max_u32 v16, v16, v207
    v_cmp_eq_u32 vcc, -1, v16
L_qt32_Sr:
    s_nop 0
    s_cbranch_vccnz L_qf32_Sr
    v_smfmac_f32_16x16x64_bf16 v[32:35], v[204:207], a[24:31], v10
    v_smfmac_f32_16x16x64_bf16 v[36:39], v[204:207], a[56:63], v10
    v_smfmac_f32_16x16x64_bf16 v[40:43], v[204:207], a[88:95], v10
    v_smfmac_f32_16x16x64_bf16 v[44:47], v[204:207], a[120:127], v10
    s_waitcnt vmcnt(0)
    v_max3_u32 v16, v200, v201, v202
    v_smfmac_f32_16x16x64_bf16 v[48:51], v[204:207], a[152:159], v10
    v_max_u32 v16, v16, v203
    v_cmp_eq_u32 vcc, -1, v16
    v_smfmac_f32_16x16x64_bf16 v[52:55], v[204:207], a[184:191], v10
L_qt2_Sr:
    s_cbranch_vccnz L_qf2_Sr
    v_smfmac_f32_16x16x64_bf16 v[32:35], v[200:203], a[16:23], v10
    v_smfmac_f32_16x16x64_bf16 v[36:39], v[200:203], a[48:55], v10
    v_smfmac_f32_16x16x64_bf16 v[40:43], v[200:203], a[80:87], v10
    v_smfmac_f32_16x16x64_bf16 v[44:47], v[200:203], a[112:119], v10
    v_smfmac_f32_16x16x64_bf16 v[48:51], v[200:203], a[144:151], v10
    v_smfmac_f32_16x16x64_bf16 v[52:55], v[200:203], a[176:183], v10
    s_nop 2
    v_pk_add_f32 v[32:33], v[32:33], v[34:35]
    ds_write_b64 v3, v[32:33] offset:0
    v_pk_add_f32 v[36:37], v[36:37], v[38:39]
    ds_write_b64 v3, v[36:37] offset:776
    v_pk_add_f32 v[40:41], v[40:41], v[42:43]
    ds_write_b64 v3, v[40:41] offset:1552
    v_pk_add_f32 v[44:45], v[44:45], v[46:47]
    ds_write_b64 v3, v[44:45] offset:2328
    v_pk_add_f32 v[48:49], v[48:49], v[50:51]
    ds_write_b64 v3, v[48:49] offset:3104
    v_pk_add_f32 v[52:53], v[52:53], v[54:55]
    ds_write_b64 v3, v[52:53] offset:3880
    s_branch L_loopw_Sr
L_qf3_Sr:
    buffer_load_dwordx4 v[204:207], v13, s[4:7], s59 offen offset:3072 sc1
    s_sub_u32 s39, s39, 1
    s_cbranch_scc1 L_chain_fail
    s_waitcnt vmcnt(0)
    v_max3_u32 v16, v204, v205, v206
    v_max_u32 v16, v16, v207
    v_cmp_eq_u32 vcc, -1, v16
L_qt3_Sr:
    s_nop 0
    s_cbranch_vccnz L_qf3_Sr
    v_smfmac_f32_16x16x64_bf16 v[32:35], v[204:207], a[24:31], v10
    v_smfmac_f32_16x16x64_bf16 v[36:39], v[204:207], a[56:63], v10
    v_smfmac_f32_16x16x64_bf16 v[40:43], v[204:207], a[88:95], v10
    v_smfmac_f32_16x16x64_bf16 v[44:47], v[204:207], a[120:127], v10
    v_smfmac_f32_16x16x64_bf16 v[48:51], v[204:207], a[152:159], v10
    v_smfmac_f32_16x16x64_bf16 v[52:55], v[204:207], a[184:191], v10
    s_nop 2
    v_pk_add_f32 v[32:33], v[32:33], v[34:35]
    ds_write_b64 v3, v[32:33] offset:0
    v_pk_add_f32 v[36:37], v[36:37], v[38:39]
    ds_write_b64 v3, v[36:37] offset:776
    v_pk_add_f32 v[40:41], v[40:41], v[42:43]
    ds_write_b64 v3, v[40:41] offset:1552
    v_pk_add_f32 v[44:45], v[44:45], v[46:47]
    ds_write_b64 v3, v[44:45] offset:2328
    v_pk_add_f32 v[48:49], v[48:49], v[50:51]
    ds_write_b64 v3, v[48:49] offset:3104
    v_pk_add_f32 v[52:53], v[52:53], v[54:55]
    ds_write_b64 v3, v[52:53] offset:3880
    s_branch L_loopw_Sr
L_qf1230_Sr:
    buffer_load_dwordx4 v[196:199], v13, s[4:7], s59 offen offset:1024 sc1
    s_waitcnt vmcnt(3)
    v_max3_u32 v16, v200, v201, v202
    v_max_u32 v16, v16, v203
    v_cmp_eq_u32 vcc, -1, v16
L_qt2301_Sr:
    s_nop 0
    s_cbranch_vccnz L_qf2301_Sr
    v_smfmac_f32_16x16x64_bf16 v[32:35], v[200:203], a[16:23], v10
    v_smfmac_f32_16x16x64_bf16 v[36:39], v[200:203], a[48:55], v10
    v_smfmac_f32_16x16x64_bf16 v[40:43], v[200:203], a[80:87], v10
    v_smfmac_f32_16x16x64_bf16 v[44:47], v[200:203], a[112:119], v10
    s_waitcnt vmcnt(2)
    v_max3_u32 v16, v204, v205, v206
    v_smfmac_f32_16x16x64_bf16 v[48:51], v[200:203], a[144:151], v10
    v_max_u32 v16, v16, v207
    v_cmp_eq_u32 vcc, -1, v16
    v_smfmac_f32_16x16x64_bf16 v[52:55], v[200:203], a[176:183], v10
L_qt301_Sr:
    s_cbranch_vccnz L_qf301_Sr
    v_smfmac_f32_16x16x64_bf16 v[32:35], v[204:207], a[24:31], v10
    v_smfmac_f32_16x16x64_bf16 v[36:39], v[204:207], a[56:63], v10
    v_smfmac_f32_16x16x64_bf16 v[40:43], v[204:207], a[88:95], v10
    v_smfmac_f32_16x16x64_bf16 v[44:47], v[204:207], a[120:127], v10
    s_waitcnt vmcnt(1)
    v_max3_u32 v16, v192, v193, v194
    v_smfmac_f32_16x16x64_bf16 v[48:51], v[204:207], a[152:159], v10
    v_max_u32 v16, v16, v195
    v_cmp_eq_u32 vcc, -1, v16
    v_smfmac_f32_16x16x64_bf16 v[52:55], v[204:207], a[184:191], v10
L_qt01_Sr:
    s_cbranch_vccnz L_qf01_Sr
    v_smfmac_f32_16x16x64_bf16 v[32:35], v[192:195], a[0:7], v10
    v_smfmac_f32_16x16x64_bf16 v[36:39], v[192:195], a[32:39], v10
    v_smfmac_f32_16x16x64_bf16 v[40:43], v[192:195], a[64:71], v10
    v_smfmac_f32_16x16x64_bf16 v[44:47], v[192:195], a[96:103], v10
    s_waitcnt vmcnt(0)
    v_max3_u32 v16, v196, v197, v198
    v_smfmac_f32_16x16x64_bf16 v[48:51], v[192:195], a[128:135], v10
    v_max_u32 v16, v16, v199
    v_cmp_eq_u32 vcc, -1, v16
    v_smfmac_f32_16x16x64_bf16 v[52:55], v[192:195], a[160:167], v10
    s_branch L_qt1_Sr
L_qf230_Sr:
    buffer_load_dwordx4 v[200:203], v13, s[4:7], s59 offen offset:2048 sc1
    s_waitcnt vmcnt(2)
    v_max3_u32 v16, v204, v205, v206
    v_max_u32 v16, v16, v207
    v_cmp_eq_u32 vcc, -1, v16
L_qt302_Sr:
    s_nop 0
    s_cbranch_vccnz L_qf302_Sr
    v_smfmac_f32_16x16x64_bf16 v[32:35], v[204:207], a[24:31], v10
    v_smfmac_f32_16x16x64_bf16 v[36:39], v[204:207], a[56:63], v10
    v_smfmac_f32_16x16x64_bf16 v[40:43], v[204:207], a[88:95], v10
    v_smfmac_f32_16x16x64_bf16 v[44:47], v[204:207], a[120:127], v10
    s_waitcnt vmcnt(1)
    v_max3_u32 v16, v192, v193, v194
    v_smfmac_f32_16x16x64_bf16 v[48:51], v[204:207], a[152:159], v10
    v_max_u32 v16, v16, v195
    v_cmp_eq_u32 vcc, -1, v16
    v_smfmac_f32_16x16x64_bf16 v[52:55], v[204:207], a[184:191], v10
L_qt02_Sr:
    s_cbranch_vccnz L_qf02_Sr
    v_smfmac_f32_16x16x64_bf16 v[32:35], v[192:195], a[0:7], v10
    v_smfmac_f32_16x16x64_bf16 v[36:39], v[192:195], a[32:39], v10
    v_smfmac_f32_16x16x64_bf16 v[40:43], v[192:195], a[64:71], v10
    v_smfmac_f32_16x16x64_bf16 v[44:47], v[192:195], a[96:103], v10
    s_waitcnt vmcnt(0)
    v_max3_u32 v16, v200, v201, v202
    v_smfmac_f32_16x16x64_bf16 v[48:51], v[192:195], a[128:135], v10
    v_max_u32 v16, v16, v203
    v_cmp_eq_u32 vcc, -1, v16
    v_smfmac_f32_16x16x64_bf16 v[52:55], v[192:195], a[160:167], v10
    s_branch L_qt2_Sr
L_qf30_Sr:
    buffer_load_dwordx4 v[204:207], v13, s[4:7], s59 offen offset:3072 sc1
    s_sub_u32 s39, s39, 1
    s_cbranch_scc1 L_chain_fail
    s_waitcnt vmcnt(1)
    v_max3_u32 v16, v192, v193, v194
    v_max_u32 v16, v16, v195
    v_cmp_eq_u32 vcc, -1, v16
L_qt03_Sr:
    s_nop 0
    s_cbranch_vccnz L_qf03_Sr
    v_smfmac_f32_16x16x64_bf16 v[32:35], v[192:195], a[0:7], v10
    v_smfmac_f32_16x16x64_bf16 v[36:39], v[192:195], a[32:39], v10
    v_smfmac_f32_16x16x64_bf16 v[40:43], v[192:195], a[64:71], v10
    v_smfmac_f32_16x16x64_bf16 v[44:47], v[192:195], a[96:103], v10
    s_waitcnt vmcnt(0)
    v_max3_u32 v16, v204, v205, v206
    v_smfmac_f32_16x16x64_bf16 v[48:51], v[192:195], a[128:135], v10
    v_max_u32 v16, v16, v207
    v_cmp_eq_u32 vcc, -1, v16
    v_smfmac_f32_16x16x64_bf16 v[52:55], v[192:195], a[160:167], v10
    s_branch L_qt3_Sr
L_qf0_Sr:
    buffer_load_dwordx4 v[192:195], v13, s[4:7], s59 offen offset:0 sc1
    s_sub_u32 s39, s39, 1
    s_cbranch_scc1 L_chain_fail
    s_waitcnt vmcnt(0)
    v_max3_u32 v16, v192, v193, v194
    v_max_u32 v16, v16, v195
    v_cmp_eq_u32 vcc, -1, v16
    s_nop 0
    s_cbranch_vccnz L_qf0_Sr
    s_branch L_qt0_Sr
L_qf231_Sr:
    buffer_load_dwordx4 v[200:203], v13, s[4:7], s59 offen offset:2048 sc1
    s_waitcnt vmcnt(2)
    v_max3_u32 v16, v204, v205, v206
    v_max_u32 v16, v16, v207
    v_cmp_eq_u32 vcc, -1, v16
L_qt312_Sr:
    s_nop 0
    s_cbranch_vccnz L_qf312_Sr
    v_smfmac_f32_16x16x64_bf16 v[32:35], v[204:207], a[24:31], v10
    v_smfmac_f32_16x16x64_bf16 v[36:39], v[204:207], a[56:63], v10
    v_smfmac_f32_16x16x64_bf16 v[40:43], v[204:207], a[88:95], v10
    v_smfmac_f32_16x16x64_bf16 v[44:47], v[204:207], a[120:127], v10
    s_waitcnt vmcnt(1)
    v_max3_u32 v16, v196, v197, v198
    v_smfmac_f32_16x16x64_bf16 v[48:51], v[204:207], a[152:159], v10
    v_max_u32 v16, v16, v199
    v_cmp_eq_u32 vcc, -1, v16
    v_smfmac_f32_16x16x64_bf16 v[52:55], v[204:207], a[184:191], v10
L_qt12_Sr:
    s_cbranch_vccnz L_qf12_Sr
    v_smfmac_f32_16x16x64_bf16 v[32:35], v[196:199], a[8:15], v10
    v_smfmac_f32_16x16x64_bf16 v[36:39], v[196:199], a[40:47], v10
    v_smfmac_f32_16x16x64_bf16 v[40:43], v[196:199], a[72:79], v10
    v_smfmac_f32_16x16x64_bf16 v[44:47], v[196:199], a[104:111], v10
    s_waitcnt vmcnt(0)
    v_max3_u32 v16, v200, v201, v202
    v_smfmac_f32_16x16x64_bf16 v[48:51], v[196:199], a[136:143], v10
    v_max_u32 v16, v16, v203
    v_cmp_eq_u32 vcc, -1, v16
    v_smfmac_f32_16x16x64_bf16 v[52:55], v[196:199], a[168:175], v10
    s_branch L_qt2_Sr
L_qf31_Sr:
    buffer_load_dwordx4 v[204:207], v13, s[4:7], s59 offen offset:3072 sc1
    s_sub_u32 s39, s39, 1
    s_cbranch_scc1 L_chain_fail
    s_waitcnt vmcnt(1)
    v_max3_u32 v16, v196, v197, v198
    v_max_u32 v16, v16, v199
    v_cmp_eq_u32 vcc, -1, v16
L_qt13_Sr:
    s_nop 0
    s_cbranch_vccnz L_qf13_Sr
    v_smfmac_f32_16x16x64_bf16 v[32:35], v[196:199], a[8:15], v10
    v_smfmac_f32_16x16x64_bf16 v[36:39], v[196:199], a[40:47], v10
    v_smfmac_f32_16x16x64_bf16 v[40:43], v[196:199], a[72:79], v10
    v_smfmac_f32_16x16x64_bf16 v[44:47], v[196:199], a[104:111], v10
    s_waitcnt vmcnt(0)
    v_max3_u32 v16, v204, v205, v206
    v_smfmac_f32_16x16x64_bf16 v[48:51], v[196:199], a[136:143], v10
    v_max_u32 v16, v16, v207
    v_cmp_eq_u32 vcc, -1, v16
    v_smfmac_f32_16x16x64_bf16 v[52:55], v[196:199], a[168:175], v10
    s_branch L_qt3_Sr
L_qf1_Sr:
    buffer_load_dwordx4 v[196:199], v13, s[4:7], s59 offen offset:1024 sc1
    s_sub_u32 s39, s39, 1
    s_cbranch_scc1 L_chain_fail
    s_waitcnt vmcnt(0)
    v_max3_u32 v16, v196, v197, v198
    v_max_u32 v16, v16, v199
    v_cmp_eq_u32 vcc, -1, v16
    s_nop 0
    s_cbranch_vccnz L_qf1_Sr
    s_branch L_qt1_Sr
L_qf32_Sr:
    buffer_load_dwordx4 v[204:207], v13, s[4:7], s59 offen offset:3072 sc1
    s_sub_u32 s39, s39, 1
    s_cbranch_scc1 L_chain_fail
    s_waitcnt vmcnt(1)
    v_max3_u32 v16, v200, v201, v202
    v_max_u32 v16, v16, v203
    v_cmp_eq_u32 vcc, -1, v16
L_qt23_Sr:
    s_nop 0
    s_cbranch_vccnz L_qf23_Sr
    v_smfmac_f32_16x16x64_bf16 v[32:35], v[200:203], a[16:23], v10
    v_smfmac_f32_16x16x64_bf16 v[36:39], v[200:203], a[48:55], v10
    v_smfmac_f32_16x16x64_bf16 v[40:43], v[200:203], a[80:87], v10
    v_smfmac_f32_16x16x64_bf16 v[44:47], v[200:203], a[112:119], v10
    s_waitcnt vmcnt(0)
    v_max3_u32 v16, v204, v205, v206
    v_smfmac_f32_16x16x64_bf16 v[48:51], v[200:203], a[144:151], v10
    v_max_u32 v16, v16, v207
    v_cmp_eq_u32 vcc, -1, v16
    v_smfmac_f32_16x16x64_bf16 v[52:55], v[200:203], a[176:183], v10
    s_branch L_qt3_Sr
L_qf2_Sr:
    buffer_load_dwordx4 v[200:203], v13, s[4:7], s59 offen offset:2048 sc1
    s_sub_u32 s39, s39, 1
    s_cbranch_scc1 L_chain_fail
    s_waitcnt vmcnt(0)
    v_max3_u32 v16, v200, v201, v202
    v_max_u32 v16, v16, v203
    v_cmp_eq_u32 vcc, -1, v16
    s_nop 0
    s_cbranch_vccnz L_qf2_Sr
    s_branch L_qt2_Sr
L_qf2301_Sr:
    buffer_load_dwordx4 v[200:203], v13, s[4:7], s59 offen offset:2048 sc1
    s_waitcnt vmcnt(3)
    v_max3_u32 v16, v204, v205, v206
    v_max_u32 v16, v16, v207
    v_cmp_eq_u32 vcc, -1, v16
L_qt3012_Sr:
    s_nop 0
    s_cbranch_vccnz L_qf3012_Sr
    v_smfmac_f32_16x16x64_bf16 v[32:35], v[204:207], a[24:31], v10
    v_smfmac_f32_16x16x64_bf16 v[36:39], v[204:207], a[56:63], v10
    v_smfmac_f32_16x16x64_bf16 v[40:43], v[204:207], a[88:95], v10
    v_smfmac_f32_16x16x64_bf16 v[44:47], v[204:207], a[120:127], v10
    s_waitcnt vmcnt(2)
    v_max3_u32 v16, v192, v193, v194
    v_smfmac_f32_16x16x64_bf16 v[48:51], v[204:207], a[152:159], v10
    v_max_u32 v16, v16, v195
    v_cmp_eq_u32 vcc, -1, v16
    v_smfmac_f32_16x16x64_bf16 v[52:55], v[204:207], a[184:191], v10
L_qt012_Sr:
    s_cbranch_vccnz L_qf012_Sr
    v_smfmac_f32_16x16x64_bf16 v[32:35], v[192:195], a[0:7], v10
    v_smfmac_f32_16x16x64_bf16 v[36:39], v[192:195], a[32:39], v10
    v_smfmac_f32_16x16x64_bf16 v[40:43], v[192:195], a[64:71], v10
    v_smfmac_f32_16x16x64_bf16 v[44:47], v[192:195], a[96:103], v10
    s_waitcnt vmcnt(1)
    v_max3_u32 v16, v196, v197, v198
    v_smfmac_f32_16x16x64_bf16 v[48:51], v[192:195], a[128:135], v10
    v_max_u32 v16, v16, v199
    v_cmp_eq_u32 vcc, -1, v16
    v_smfmac_f32_16x16x64_bf16 v[52:55], v[192:195], a[160:167], v10
    s_branch L_qt12_Sr
L_qf301_Sr:
    buffer_load_dwordx4 v[204:207], v13, s[4:7], s59 offen offset:3072 sc1
    s_sub_u32 s39, s39, 1
    s_cbranch_scc1 L_chain_fail
    s_waitcnt vmcnt(2)
    v_max3_u32 v16, v192, v193, v194
    v_max_u32 v16, v16, v195
    v_cmp_eq_u32 vcc, -1, v16
L_qt013_Sr:
    s_nop 0
    s_cbranch_vccnz L_qf013_Sr
    v_smfmac_f32_16x16x64_bf16 v[32:35], v[192:195], a[0:7], v10
    v_smfmac_f32_16x16x64_bf16 v[36:39], v[192:195], a[32:39], v10
    v_smfmac_f32_16x16x64_bf16 v[40:43], v[192:195], a[64:71], v10
    v_smfmac_f32_16x16x64_bf16 v[44:47], v[192:195], a[96:103], v10
    s_waitcnt vmcnt(1)
    v_max3_u32 v16, v196, v197, v198
    v_smfmac_f32_16x16x64_bf16 v[48:51], v[192:195], a[128:135], v10
    v_max_u32 v16, v16, v199
    v_cmp_eq_u32 vcc, -1, v16
    v_smfmac_f32_16x16x64_bf16 v[52:55], v[192:195], a[160:167], v10
    s_branch L_qt13_Sr
L_qf01_Sr:
    buffer_load_dwordx4 v[192:195], v13, s[4:7], s59 offen offset:0 sc1
    s_waitcnt vmcnt(1)
    v_max3_u32 v16, v196, v197, v198
    v_max_u32 v16, v16, v199
    v_cmp_eq_u32 vcc, -1, v16
L_qt10_Sr:
    s_nop 0
    s_cbranch_vccnz L_qf10_Sr
    v_smfmac_f32_16x16x64_bf16 v[32:35], v[196:199], a[8:15], v10
    v_smfmac_f32_16x16x64_bf16 v[36:39], v[196:199], a[40:47], v10
    v_smfmac_f32_16x16x64_bf16 v[40:43], v[196:199], a[72:79], v10
    v_smfmac_f32_16x16x64_bf16 v[44:47], v[196:199], a[104:111], v10
    s_waitcnt vmcnt(0)
    v_max3_u32 v16, v192, v193, v194
    v_smfmac_f32_16x16x64_bf16 v[48:51], v[196:199], a[136:143], v10
    v_max_u32 v16, v16, v195
    v_cmp_eq_u32 vcc, -1, v16
    v_smfmac_f32_16x16x64_bf16 v[52:55], v[196:199], a[168:175], v10
    s_branch L_qt0_Sr
L_qf302_Sr:
    buffer_load_dwordx4 v[204:207], v13, s[4:7], s59 offen offset:3072 sc1
    s_sub_u32 s39, s39, 1
    s_cbranch_scc1 L_chain_fail
    s_waitcnt vmcnt(2)
    v_max3_u32 v16, v192, v193, v194
    v_max_u32 v16, v16, v195
    v_cmp_eq_u32 vcc, -1, v16
L_qt023_Sr:
    s_nop 0
    s_cbranch_vccnz L_qf023_Sr
    v_smfmac_f32_16x16x64_bf16 v[32:35], v[192:195], a[0:7], v10
    v_smfmac_f32_16x16x64_bf16 v[36:39], v[192:195], a[32:39], v10
    v_smfmac_f32_16x16x64_bf16 v[40:43], v[192:195], a[64:71], v10
    v_smfmac_f32_16x16x64_bf16 v[44:47], v[192:195], a[96:103], v10
    s_waitcnt vmcnt(1)
    v_max3_u32 v16, v200, v201, v202
    v_smfmac_f32_16x16x64_bf16 v[48:51], v[192:195], a[128:135], v10
    v_max_u32 v16, v16, v203
    v_cmp_eq_u32 vcc, -1, v16
    v_smfmac_f32_16x16x64_bf16 v[52:55], v[192:195], a[160:167], v10
    s_branch L_qt23_Sr
L_qf02_Sr:
    buffer_load_dwordx4 v[192:195], v13, s[4:7], s59 offen offset:0 sc1
    s_waitcnt vmcnt(1)
    v_max3_u32 v16, v200, v201, v202
    v_max_u32 v16, v16, v203
    v_cmp_eq_u32 vcc, -1, v16
L_qt20_Sr:
    s_nop 0
    s_cbranch_vccnz L_qf20_Sr
    v_smfmac_f32_16x16x64_bf16 v[32:35], v[200:203], a[16:23], v10
    v_smfmac_f32_16x16x64_bf16 v[36:39], v[200:203], a[48:55], v10
    v_smfmac_f32_16x16x64_bf16 v[40:43], v[200:203], a[80:87], v10
    v_smfmac_f32_16x16x64_bf16 v[44:47], v[200:203], a[112:119], v10
    s_waitcnt vmcnt(0)
    v_max3_u32 v16, v192, v193, v194
    v_smfmac_f32_16x16x64_bf16 v[48:51], v[200:203], a[144:151], v10
    v_max_u32 v16, v16, v195
    v_cmp_eq_u32 vcc, -1, v16
    v_smfmac_f32_16x16x64_bf16 v[52:55], v[200:203], a[176:183], v10
    s_branch L_qt0_Sr
L_qf03_Sr:
    buffer_load_dwordx4 v[192:195], v13, s[4:7], s59 offen offset:0 sc1
    s_waitcnt vmcnt(1)
    v_max3_u32 v16, v204, v205, v206
    v_max_u32 v16, v16, v207
    v_cmp_eq_u32 vcc, -1, v16
    s_nop 0
    s_cbranch_vccnz L_qf30_Sr
    s_branch L_qt30_Sr
L_qf312_Sr:
    buffer_load_dwordx4 v[204:207], v13, s[4:7], s59 offen offset:3072 sc1
    s_sub_u32 s39, s39, 1
    s_cbranch_scc1 L_chain_fail
    s_waitcnt vmcnt(2)
    v_max3_u32 v16, v196, v197, v198
    v_max_u32 v16, v16, v199
    v_cmp_eq_u32 vcc, -1, v16
L_qt123_Sr:
    s_nop 0
    s_cbranch_vccnz L_qf123_Sr
    v_smfmac_f32_16x16x64_bf16 v[32:35], v[196:199], a[8:15], v10
    v_smfmac_f32_16x16x64_bf16 v[36:39], v[196:199], a[40:47], v10
    v_smfmac_f32_16x16x64_bf16 v[40:43], v[196:199], a[72:79], v10
    v_smfmac_f32_16x16x64_bf16 v[44:47], v[196:199], a[104:111], v10
    s_waitcnt vmcnt(1)
    v_max3_u32 v16, v200, v201, v202
    v_smfmac_f32_16x16x64_bf16 v[48:51], v[196:199], a[136:143], v10
    v_max_u32 v16, v16, v203
    v_cmp_eq_u32 vcc, -1, v16
    v_smfmac_f32_16x16x64_bf16 v[52:55], v[196:199], a[168:175], v10
    s_branch L_qt23_Sr
L_qf12_Sr:
    buffer_load_dwordx4 v[196:199], v13, s[4:7], s59 offen offset:1024 sc1
    s_waitcnt vmcnt(1)
    v_max3_u32 v16, v200, v201, v202
    v_max_u32 v16, v16, v203
    v_cmp_eq_u32 vcc, -1, v16
L_qt21_Sr:
    s_nop 0
    s_cbranch_vccnz L_qf21_Sr
    v_smfmac_f32_16x16x64_bf16 v[32:35], v[200:203], a[16:23], v10
    v_smfmac_f32_16x16x64_bf16 v[36:39], v[200:203], a[48:55], v10
    v_smfmac_f32_16x16x64_bf16 v[40:43], v[200:203], a[80:87], v10
    v_smfmac_f32_16x16x64_bf16 v[44:47], v[200:203], a[112:119], v10
    s_waitcnt vmcnt(0)
    v_max3_u32 v16, v196, v197, v198
    v_smfmac_f32_16x16x64_bf16 v[48:51], v[200:203], a[144:151], v10
    v_max_u32 v16, v16, v199
    v_cmp_eq_u32 vcc, -1, v16
    v_smfmac_f32_16x16x64_bf16 v[52:55], v[200:203], a[176:183], v10
    s_branch L_qt1_Sr
L_qf13_Sr:
    buffer_load_dwordx4 v[196:199], v13, s[4:7], s59 offen offset:1024 sc1
    s_waitcnt vmcnt(1)
    v_max3_u32 v16, v204, v205, v206
    v_max_u32 v16, v16, v207
    v_cmp_eq_u32 vcc, -1, v16
    s_nop 0
    s_cbranch_vccnz L_qf31_Sr
    s_branch L_qt31_Sr
L_qf3012_Sr:
    buffer_load_dwordx4 v[204:207], v13, s[4:7], s59 offen offset:3072 sc1
    s_sub_u32 s39, s39, 1
    s_cbranch_scc1 L_chain_fail
    s_waitcnt vmcnt(3)
    v_max3_u32 v16, v192, v193, v194
    v_max_u32 v16, v16, v195
    v_cmp_eq_u32 vcc, -1, v16
L_qt0123_Sr:
    s_nop 0
    s_cbranch_vccnz L_qf0123_Sr
    v_smfmac_f32_16x16x64_bf16 v[32:35], v[192:195], a[0:7], v10
    v_smfmac_f32_16x16x64_bf16 v[36:39], v[192:195], a[32:39], v10
    v_smfmac_f32_16x16x64_bf16 v[40:43], v[192:195], a[64:71], v10
    v_smfmac_f32_16x16x64_bf16 v[44:47], v[192:195], a[96:103], v10
    s_waitcnt vmcnt(2)
    v_max3_u32 v16, v196, v197, v198
    v_smfmac_f32_16x16x64_bf16 v[48:51], v[192:195], a[128:135], v10
    v_max_u32 v16, v16, v199
    v_cmp_eq_u32 vcc, -1, v16
    v_smfmac_f32_16x16x64_bf16 v[52:55], v[192:195], a[160:167], v10
    s_branch L_qt123_Sr
L_qf012_Sr:
    buffer_load_dwordx4 v[192:195], v13, s[4:7], s59 offen offset:0 sc1
    s_waitcnt vmcnt(2)
    v_max3_u32 v16, v196, v197, v198
    v_max_u32 v16, v16, v199
    v_cmp_eq_u32 vcc, -1, v16
L_qt120_Sr:
    s_nop 0
    s_cbranch_vccnz L_qf120_Sr
    v_smfmac_f32_16x16x64_bf16 v[32:35], v[196:199], a[8:15], v10
    v_smfmac_f32_16x16x64_bf16 v[36:39], v[196:199], a[40:47], v10
    v_smfmac_f32_16x16x64_bf16 v[40:43], v[196:199], a[72:79], v10
    v_smfmac_f32_16x16x64_bf16 v[44:47], v[196:199], a[104:111], v10
    s_waitcnt vmcnt(1)
    v_max3_u32 v16, v200, v201, v202
    v_smfmac_f32_16x16x64_bf16 v[48:51], v[196:199], a[136:143], v10
    v_max_u32 v16, v16, v203
    v_cmp_eq_u32 vcc, -1, v16
    v_smfmac_f32_16x16x64_bf16 v[52:55], v[196:199], a[168:175], v10
    s_branch L_qt20_Sr
L_qf013_Sr:
    buffer_load_dwordx4 v[192:195], v13, s[4:7], s59 offen offset:0 sc1
    s_waitcnt vmcnt(2)
    v_max3_u32 v16, v196, v197, v198
    v_max_u32 v16, v16, v199
    v_cmp_eq_u32 vcc, -1, v16
L_qt130_Sr:
    s_nop 0
    s_cbranch_vccnz L_qf130_Sr
    v_smfmac_f32_16x16x64_bf16 v[32:35], v[196:199], a[8:15], v10
    v_smfmac_f32_16x16x64_bf16 v[36:39], v[196:199], a[40:47], v10
    v_smfmac_f32_16x16x64_bf16 v[40:43], v[196:199], a[72:79], v10
    v_smfmac_f32_16x16x64_bf16 v[44:47], v[196:199], a[104:111], v10
    s_waitcnt vmcnt(1)
    v_max3_u32 v16, v204, v205, v206
    v_smfmac_f32_16x16x64_bf16 v[48:51], v[196:199], a[136:143], v10
    v_max_u32 v16, v16, v207
    v_cmp_eq_u32 vcc, -1, v16
    v_smfmac_f32_16x16x64_bf16 v[52:55], v[196:199], a[168:175], v10
    s_branch L_qt30_Sr
L_qf10_Sr:
    buffer_load_dwordx4 v[196:199], v13, s[4:7], s59 offen offset:1024 sc1
    s_sub_u32 s39, s39, 1
    s_cbranch_scc1 L_chain_fail
    s_waitcnt vmcnt(1)
    v_max3_u32 v16, v192, v193, v194
    v_max_u32 v16, v16, v195
    v_cmp_eq_u32 vcc, -1, v16
    s_nop 0
    s_cbranch_vccnz L_qf01_Sr
    s_branch L_qt01_Sr
L_qf023_Sr:
    buffer_load_dwordx4 v[192:195], v13, s[4:7], s59 offen offset:0 sc1
    s_waitcnt vmcnt(2)
    v_max3_u32 v16, v200, v201, v202
    v_max_u32 v16, v16, v203
    v_cmp_eq_u32 vcc, -1, v16
    s_nop 0
    s_cbranch_vccnz L_qf230_Sr
    s_branch L_qt230_Sr
L_qf20_Sr:
    buffer_load_dwordx4 v[200:203], v13, s[4:7], s59 offen offset:2048 sc1
    s_sub_u32 s39, s39, 1
    s_cbranch_scc1 L_chain_fail
    s_waitcnt vmcnt(1)
    v_max3_u32 v16, v192, v193, v194
    v_max_u32 v16, v16, v195
    v_cmp_eq_u32 vcc, -1, v16
    s_nop 0
    s_cbranch_vccnz L_qf02_Sr
    s_branch L_qt02_Sr
L_qf21_Sr:
    buffer_load_dwordx4 v[200:203], v13, s[4:7], s59 offen offset:2048 sc1
    s_sub_u32 s39, s39, 1
    s_cbranch_scc1 L_chain_fail
    s_waitcnt vmcnt(1)
    v_max3_u32 v16, v196, v197, v198
    v_max_u32 v16, v16, v199
    v_cmp_eq_u32 vcc, -1, v16
    s_nop 0
    s_cbranch_vccnz L_qf12_Sr
    s_branch L_qt12_Sr
L_qf120_Sr:
    buffer_load_dwordx4 v[196:199], v13, s[4:7], s59 offen offset:1024 sc1
    s_waitcnt vmcnt(2)
    v_max3_u32 v16, v200, v201, v202
    v_max_u32 v16, v16, v203
    v_cmp_eq_u32 vcc, -1, v16
L_qt201_Sr:
    s_nop 0
    s_cbranch_vccnz L_qf201_Sr
    v_smfmac_f32_16x16x64_bf16 v[32:35], v[200:203], a[16:23], v10
    v_smfmac_f32_16x16x64_bf16 v[36:39], v[200:203], a[48:55], v10
    v_smfmac_f32_16x16x64_bf16 v[40:43], v[200:203], a[80:87], v10
    v_smfmac_f32_16x16x64_bf16 v[44:47], v[200:203], a[112:119], v10
    s_waitcnt vmcnt(1)
    v_max3_u32 v16, v192, v193, v194
    v_smfmac_f32_16x16x64_bf16 v[48:51], v[200:203], a[144:151], v10
    v_max_u32 v16, v16, v195
    v_cmp_eq_u32 vcc, -1, v16
    v_smfmac_f32_16x16x64_bf16 v[52:55], v[200:203], a[176:183], v10
    s_branch L_qt01_Sr
L_qf130_Sr:
    buffer_load_dwordx4 v[196:199], v13, s[4:7], s59 offen offset:1024 sc1
    s_waitcnt vmcnt(2)
    v_max3_u32 v16, v204, v205, v206
    v_max_u32 v16, v16, v207
    v_cmp_eq_u32 vcc, -1, v16
    s_nop 0
    s_cbranch_vccnz L_qf301_Sr
    s_branch L_qt301_Sr
L_qf201_Sr:
    buffer_load_dwordx4 v[200:203], v13, s[4:7], s59 offen offset:2048 sc1
    s_sub_u32 s39, s39, 1
    s_cbranch_scc1 L_chain_fail
    s_waitcnt vmcnt(2)
    v_max3_u32 v16, v192, v193, v194
    v_max_u32 v16, v16, v195
    v_cmp_eq_u32 vcc, -1, v16
    s_nop 0
    s_cbranch_vccnz L_qf012_Sr
    s_branch L_qt012_Sr
L_aslow_Sr:
    v_max3_u32 v17, v192, v193, v194
    v_max3_u32 v17, v17, v195, v196
    v_max3_u32 v17, v17, v197, v198
    v_max3_u32 v17, v17, v199, v200
    v_max3_u32 v17, v17, v201, v202
    v_max3_u32 v17, v17, v203, v204
    v_max3_u32 v17, v17, v205, v206
    v_max_u32 v17, v17, v207
    v_cmp_eq_u32 vcc, -1, v17
    s_nop 0
    s_cbranch_vccz L_aok_Sr
    s_mov_b64 exec, vcc
    s_sub_u32 s39, s39, 1
    s_cbranch_scc0 L_hopa_Sr
    s_branch L_chain_fail
L_cretry_Sr:
    buffer_load_dwordx4 v[192:195], v1, s[4:7], s55 offen offset:0 sc1
    buffer_load_dwordx4 v[196:199], v1, s[4:7], s55 offen offset:1024 sc1
    buffer_load_dwordx4 v[200:203], v1, s[4:7], s55 offen offset:2048 sc1
    buffer_load_dwordx4 v[204:207], v1, s[4:7], s55 offen offset:3072 sc1
    v_mov_b64 v[56:57], 0
    v_mov_b64 v[58:59], 0
    v_mov_b64 v[60:61], 0
    v_mov_b64 v[62:63], 0
    s_sub_u32 s39, s39, 1
    s_cbranch_scc0 L_hopc_Sr
    s_branch L_chain_fail
L_Hr:
    v_mov_b32 v56, 0
    v_mov_b32 v57, 0
    v_mov_b32 v58, 0
    v_mov_b32 v59, 0
    v_mov_b32 v60, 0
    v_mov_b32 v61, 0
    v_mov_b32 v62, 0
    v_mov_b32 v63, 0
    v_mov_b32 v224, 0
    v_mov_b32 v225, 0
    v_mov_b32 v226, 0
    v_mov_b32 v227, 0
    v_mov_b32 v228, 0
    v_mov_b32 v229, 0
    v_mov_b32 v230, 0
    v_mov_b32 v231, 0
    v_mov_b32 v232, 0
    v_mov_b32 v233, 0
    v_mov_b32 v234, 0
    v_mov_b32 v235, 0
    v_mov_b32 v236, 0
    v_mov_b32 v237, 0
    v_mov_b32 v238, 0
    v_mov_b32 v239, 0
    s_add_u32 s49, s37, 1
    s_lshl_b32 s88, s49, 18
    s_add_u32 s88, s88, s48
    s_add_u32 s89, s88, 0x20000
    s_and_b32 s49, s49, 1
    s_lshl_b32 s49, s49, 14
    s_add_u32 s92, s49, s65
    s_add_u32 s93, s92, 4096
    s_xor_b32 s94, s92, 0x4000
    s_add_u32 s94, s94, 32768
    s_add_u32 s95, s94, 4096
    s_add_u32 s49, s37, 2
    s_min_u32 s49, s49, 63
    s_lshl_b32 s90, s49, 18
    s_add_u32 s90, s90, s48
    s_add_u32 s90, s90, 0x1000000
    s_add_u32 s91, s90, 0x20000
L_loop_Hr:
    v_pk_add_f32 v[32:33], v[32:33], v[34:35]
    ds_write_b64 v3, v[32:33] offset:0
    v_pk_add_f32 v[36:37], v[36:37], v[38:39]
    ds_write_b64 v3, v[36:37] offset:776
    v_pk_add_f32 v[40:41], v[40:41], v[42:43]
    ds_write_b64 v3, v[40:41] offset:1552
    v_pk_add_f32 v[44:45], v[44:45], v[46:47]
    ds_write_b64 v3, v[44:45] offset:2328
    v_pk_add_f32 v[48:49], v[48:49], v[50:51]
    ds_write_b64 v3, v[48:49] offset:3104
    v_pk_add_f32 v[52:53], v[52:53], v[54:55]
    ds_write_b64 v3, v[52:53] offset:3880
L_loopw_Hr:
    s_waitcnt lgkmcnt(0)
    s_barrier
    ds_read2st64_b32 v[208:209], v4 offset0:0 offset1:19
    ds_read2st64_b32 v[210:211], v4 offset0:38 offset1:57
    ds_read2st64_b32 v[212:213], v5 offset0:0 offset1:19
    ds_read2st64_b32 v[214:215], v5 offset0:38 offset1:57
    ds_read2st64_b32 v[216:217], v7 offset0:0 offset1:19
    ds_read2st64_b32 v[218:219], v7 offset0:38 offset1:57
    ds_read2st64_b32 v[220:221], v12 offset0:0 offset1:19
    ds_read2st64_b32 v[222:223], v12 offset0:38 offset1:57
    s_waitcnt lgkmcnt(6)
    v_pk_add_f32 v[208:209], v[208:209], v[210:211]
    v_add_f32 v208, v208, v209
    s_waitcnt lgkmcnt(4)
    v_pk_add_f32 v[212:213], v[212:213], v[214:215]
    v_add_f32 v212, v212, v213
    v_cvt_pk_bf16_f32 v26, v208, v212
    buffer_store_dword v26, v2, s[4:7], s53 offen offset:0 sc1
    s_waitcnt lgkmcnt(2)
    v_pk_add_f32 v[216:217], v[216:217], v[218:219]
    v_add_f32 v216, v216, v217
    s_waitcnt lgkmcnt(0)
    v_pk_add_f32 v[220:221], v[220:221], v[222:223]
    v_add_f32 v220, v220, v221
    v_cvt_pk_bf16_f32 v27, v216, v220
    buffer_store_dword v27, v2, s[4:7], s54 offen offset:0 sc1
    s_lshl_b32 s58, s37, 17
    s_add_u32 s97, s58, s96
    s_add_u32 s58, s58, s47
    s_cmp_eq_u32 s37, 63
    s_cbranch_scc1 L_last_Hr
    ds_read_b128 v[208:211], v9 offset:0
    ds_read_b128 v[212:215], v9 offset:1024
    ds_read_b128 v[216:219], v9 offset:2048
    ds_read_b128 v[220:223], v9 offset:3072
    s_and_b32 s56, s37, 15
    s_lshl_b32 s56, s56, 19
    s_add_u32 s56, s56, s42
    s_and_b32 s52, s37, 4
    s_lshl_b32 s52, s52, 11
    s_xor_b32 s56, s56, s52
    s_and_b32 s59, s37, 3
    s_mul_i32 s59, s59, 131072
    s_add_u32 s59, s59, s45
    v_mov_b64 v[32:33], 0
    v_mov_b64 v[34:35], 0
    v_mov_b64 v[36:37], 0
    v_mov_b64 v[38:39], 0
    s_waitcnt lgkmcnt(3)
    v_mfma_f32_16x16x32_bf16 v[240:243], v[208:211], a[192:195], 0
    v_mov_b64 v[40:41], 0
    v_mfma_f32_16x16x32_bf16 v[244:247], v[208:211], a[224:227], 0
    v_mov_b64 v[42:43], 0
    v_mfma_f32_16x16x32_bf16 v[248:251], v[208:211], v[128:131], 0
    v_mov_b64 v[44:45], 0
    v_mfma_f32_16x16x32_bf16 v[252:255], v[208:211], v[160:163], 0
    v_mov_b64 v[46:47], 0
    s_waitcnt lgkmcnt(2)
    v_mfma_f32_16x16x32_bf16 v[240:243], v[212:215], a[196:199], v[240:243]
    v_mov_b64 v[48:49], 0
    v_mfma_f32_16x16x32_bf16 v[244:247], v[212:215], a[228:231], v[244:247]
    v_mov_b64 v[50:51], 0
    v_mfma_f32_16x16x32_bf16 v[248:251], v[212:215], v[132:135], v[248:251]
    v_mov_b64 v[52:53], 0
    v_mfma_f32_16x16x32_bf16 v[252:255], v[212:215], v[164:167], v[252:255]
    v_mov_b64 v[54:55], 0
    s_waitcnt lgkmcnt(1)
    buffer_load_dwordx4 v[192:195], v1, s[4:7], s55 offen offset:0 sc1
    buffer_load_dwordx4 v[196:199], v1, s[4:7], s55 offen offset:1024 sc1
    buffer_load_dwordx4 v[200:203], v1, s[4:7], s55 offen offset:2048 sc1
    buffer_load_dwordx4 v[204:207], v1, s[4:7], s55 offen offset:3072 sc1
    v_mfma_f32_16x16x32_bf16 v[240:243], v[216:219], a[200:203], v[240:243]
    v_mfma_f32_16x16x32_bf16 v[244:247], v[216:219], a[232:235], v[244:247]
    v_mfma_f32_16x16x32_bf16 v[248:251], v[216:219], v[136:139], v[248:251]
    v_mfma_f32_16x16x32_bf16 v[252:255], v[216:219], v[168:171], v[252:255]
    s_waitcnt lgkmcnt(0)
    v_mfma_f32_16x16x32_bf16 v[240:243], v[220:223], a[204:207], v[240:243]
    v_mfma_f32_16x16x32_bf16 v[244:247], v[220:223], a[236:239], v[244:247]
    v_mfma_f32_16x16x32_bf16 v[248:251], v[220:223], v[140:143], v[248:251]
    v_mfma_f32_16x16x32_bf16 v[252:255], v[220:223], v[172:175], v[252:255]
L_hopc_Hr:
    s_waitcnt vmcnt(2)
    v_max3_u32 v16, v192, v193, v194
    v_max3_u32 v16, v16, v195, v196
    v_max3_u32 v16, v16, v197, v198
    v_max_u32 v16, v16, v199
    s_waitcnt vmcnt(0)
    v_max3_u32 v16, v16, v200, v201
    v_max3_u32 v16, v16, v202, v203
    v_max3_u32 v16, v16, v204, v205
    v_max3_u32 v16, v16, v206, v207
    v_cmp_eq_u32 vcc, -1, v16
    s_nop 0
    s_cbranch_vccnz L_cretry_Hr
    ds_read_b128 v[208:211], v9 offset:4096
    ds_read_b128 v[212:215], v9 offset:5120
    ds_read_b128 v[216:219], v9 offset:6144
    ds_read_b128 v[220:223], v9 offset:7168
    s_mov_b32 m0, s92
    v_smfmac_f32_16x16x64_bf16 v[32:35], v[192:195], a[192:199], v10
    buffer_load_dwordx4 v1, s[4:7], s88 offen offset:0 sc1 lds
    v_smfmac_f32_16x16x64_bf16 v[36:39], v[192:195], a[224:231], v10
    buffer_load_dwordx4 v1, s[4:7], s88 offen offset:1024 sc1 lds
    v_smfmac_f32_16x16x64_bf16 v[40:43], v[192:195], v[128:135], v10
    buffer_load_dwordx4 v1, s[4:7], s88 offen offset:2048 sc1 lds
    v_smfmac_f32_16x16x64_bf16 v[44:47], v[192:195], v[160:167], v10
    buffer_load_dwordx4 v1, s[4:7], s88 offen offset:3072 sc1 lds
    s_mov_b32 m0, s93
    v_smfmac_f32_16x16x64_bf16 v[32:35], v[196:199], a[200:207], v10
    buffer_load_dwordx4 v1, s[4:7], s89 offen offset:0 sc1 lds
    v_smfmac_f32_16x16x64_bf16 v[36:39], v[196:199], a[232:239], v10
    buffer_load_dwordx4 v1, s[4:7], s89 offen offset:1024 sc1 lds
    v_smfmac_f32_16x16x64_bf16 v[40:43], v[196:199], v[136:143], v10
    buffer_load_dwordx4 v1, s[4:7], s89 offen offset:2048 sc1 lds
    v_smfmac_f32_16x16x64_bf16 v[44:47], v[196:199], v[168:175], v10
    buffer_load_dwordx4 v1, s[4:7], s89 offen offset:3072 sc1 lds
    s_mov_b32 m0, s94
    v_smfmac_f32_16x16x64_bf16 v[48:51], v[200:203], a[208:215], v10
    buffer_load_dwordx4 v1, s[4:7], s90 offen offset:0 sc1 lds
    v_smfmac_f32_16x16x64_bf16 v[52:55], v[200:203], a[240:247], v10
    buffer_load_dwordx4 v1, s[4:7], s90 offen offset:1024 sc1 lds
    v_smfmac_f32_16x16x64_bf16 v[56:59], v[200:203], v[144:151], v10
    buffer_load_dwordx4 v1, s[4:7], s90 offen offset:2048 sc1 lds
    v_smfmac_f32_16x16x64_bf16 v[60:63], v[200:203], v[176:183], v10
    buffer_load_dwordx4 v1, s[4:7], s90 offen offset:3072 sc1 lds
    s_mov_b32 m0, s95
    v_smfmac_f32_16x16x64_bf16 v[48:51], v[204:207], a[216:223], v10
    buffer_load_dwordx4 v1, s[4:7], s91 offen offset:0 sc1 lds
    v_cvt_pk_bf16_f32 v68, v32, v33
    v_cvt_pk_bf16_f32 v69, v34, v35
    v_smfmac_f32_16x16x64_bf16 v[52:55], v[204:207], a[248:255], v10
    buffer_load_dwordx4 v1, s[4:7], s91 offen offset:1024 sc1 lds
    v_cvt_pk_bf16_f32 v84, v36, v37
    v_cvt_pk_bf16_f32 v85, v38, v39
    v_smfmac_f32_16x16x64_bf16 v[56:59], v[204:207], v[152:159], v10
    buffer_load_dwordx4 v1, s[4:7], s91 offen offset:2048 sc1 lds
    v_cvt_pk_bf16_f32 v100, v40, v41
    v_cvt_pk_bf16_f32 v101, v42, v43
    v_smfmac_f32_16x16x64_bf16 v[60:63], v[204:207], v[184:191], v10
    buffer_load_dwordx4 v1, s[4:7], s91 offen offset:3072 sc1 lds
    v_cvt_pk_bf16_f32 v116, v44, v45
    v_cvt_pk_bf16_f32 v117, v46, v47
    v_cvt_pk_bf16_f32 v76, v48, v49
    v_cvt_pk_bf16_f32 v77, v50, v51
    v_cvt_pk_bf16_f32 v92, v52, v53
    v_cvt_pk_bf16_f32 v93, v54, v55
    v_cvt_pk_bf16_f32 v108, v56, v57
    v_cvt_pk_bf16_f32 v109, v58, v59
    v_cvt_pk_bf16_f32 v124, v60, v61
    v_cvt_pk_bf16_f32 v125, v62, v63
    s_barrier
    ds_read_b64_tr_b16 v[192:193], v6 offset:0
    ds_read_b64_tr_b16 v[194:195], v6 offset:16
    ds_read_b64_tr_b16 v[196:197], v6 offset:1024
    ds_read_b64_tr_b16 v[198:199], v6 offset:1040
    s_waitcnt lgkmcnt(2)
    v_smfmac_f32_16x16x64_bf16 v[224:227], v[192:195], v[64:71], v10
    v_smfmac_f32_16x16x64_bf16 v[228:231], v[192:195], v[80:87], v10
    v_smfmac_f32_16x16x64_bf16 v[232:235], v[192:195], v[96:103], v10
    v_smfmac_f32_16x16x64_bf16 v[236:239], v[192:195], v[112:119], v10
    s_waitcnt lgkmcnt(0)
    v_smfmac_f32_16x16x64_bf16 v[224:227], v[196:199], v[72:79], v10
    v_smfmac_f32_16x16x64_bf16 v[228:231], v[196:199], v[88:95], v10
    v_smfmac_f32_16x16x64_bf16 v[232:235], v[196:199], v[104:111], v10
    v_smfmac_f32_16x16x64_bf16 v[236:239], v[196:199], v[120:127], v10
    s_nop 4
    v_pk_add_f32 v[224:225], v[224:225], v[226:227]
    v_cvt_pk_bf16_f32 v18, v224, v225
    v_pk_add_f32 v[228:229], v[228:229], v[230:231]
    v_cvt_pk_bf16_f32 v19, v228, v229
    v_pk_add_f32 v[232:233], v[232:233], v[234:235]
    v_cvt_pk_bf16_f32 v20, v232, v233
    v_pk_add_f32 v[236:237], v[236:237], v[238:239]
    v_cvt_pk_bf16_f32 v21, v236, v237
    buffer_store_dwordx4 v[18:21], v1, s[4:7], s56 offen offset:0 sc1
    v_mfma_f32_16x16x32_bf16 v[32:35], v[208:211], a[192:195], 0
    v_cvt_pk_bf16_f32 v64, v240, v241
    s_and_b32 s51, s37, 3
    ds_read_b128 v[192:195], v9 offset:8192
    ds_read_b128 v[196:199], v9 offset:9216
    v_mfma_f32_16x16x32_bf16 v[36:39], v[208:211], a[224:227], 0
    v_cvt_pk_bf16_f32 v65, v242, v243
    s_xor_b32 s51, s51, 2
    v_mfma_f32_16x16x32_bf16 v[40:43], v[208:211], v[128:131], 0
    v_cvt_pk_bf16_f32 v80, v244, v245
    s_mul_i32 s51, s51, 196608
    v_mfma_f32_16x16x32_bf16 v[44:47], v[208:211], v[160:163], 0
    v_cvt_pk_bf16_f32 v81, v246, v247
    s_add_u32 s51, s51, s40
    v_mfma_f32_16x16x32_bf16 v[32:35], v[212:215], a[196:199], v[32:35]
    v_cvt_pk_bf16_f32 v96, v248, v249
    s_sub_u32 s50, s51, s40
    ds_read_b128 v[200:203], v9 offset:10240
    ds_read_b128 v[208:211], v9 offset:12288
    v_mfma_f32_16x16x32_bf16 v[36:39], v[212:215], a[228:231], v[36:39]
    v_cvt_pk_bf16_f32 v97, v250, v251
    s_add_u32 s50, s50, s41
    v_mfma_f32_16x16x32_bf16 v[40:43], v[212:215], v[132:135], v[40:43]
    v_cvt_pk_bf16_f32 v112, v252, v253
    s_add_u32 s56, s56, 0x100000
    v_mfma_f32_16x16x32_bf16 v[44:47], v[212:215], v[164:167], v[44:47]
    v_cvt_pk_bf16_f32 v113, v254, v255
    s_bitset0_b32 s56, 23
    v_mfma_f32_16x16x32_bf16 v[32:35], v[216:219], a[200:203], v[32:35]
    v_mov_b64 v[224:225], 0
    s_and_b32 s52, s37, 2
    ds_read_b128 v[204:207], v9 offset:11264
    ds_read_b128 v[212:215], v9 offset:13312
    v_mfma_f32_16x16x32_bf16 v[36:39], v[216:219], a[232:235], v[36:39]
    v_mov_b64 v[226:227], 0
    s_lshl_b32 s52, s52, 12
    v_mfma_f32_16x16x32_bf16 v[40:43], v[216:219], v[136:139], v[40:43]
    v_mov_b64 v[228:229], 0
    s_xor_b32 s56, s56, s52
    v_mfma_f32_16x16x32_bf16 v[44:47], v[216:219], v[168:171], v[44:47]
    v_mov_b64 v[230:231], 0
    s_add_u32 s37, s37, 1
    v_mfma_f32_16x16x32_bf16 v[32:35], v[220:223], a[204:207], v[32:35]
    v_mov_b64 v[232:233], 0
    s_add_u32 s57, s37, 2
    ds_read_b128 v[216:219], v9 offset:14336
    v_mfma_f32_16x16x32_bf16 v[36:39], v[220:223], a[236:239], v[36:39]
    v_mov_b64 v[234:235], 0
    s_min_u32 s57, s57, 63
    v_mfma_f32_16x16x32_bf16 v[40:43], v[220:223], v[140:143], v[40:43]
    v_mov_b64 v[236:237], 0
    s_and_b32 s57, s57, 60
    v_mfma_f32_16x16x32_bf16 v[44:47], v[220:223], v[172:175], v[44:47]
    v_mov_b64 v[238:239], 0
    s_cmp_lg_u32 s37, 53
    s_cselect_b32 s57, s57, 2
    s_waitcnt lgkmcnt(6)
    v_mfma_f32_16x16x32_bf16 v[48:51], v[192:195], a[208:211], 0
    s_lshl4_add_u32 s57, s57, s85
    ds_read_b128 v[220:223], v9 offset:15360
    v_mfma_f32_16x16x32_bf16 v[52:55], v[192:195], a[240:243], 0
    buffer_load_dword v17, off, s[4:7], s57 sc1
    v_mfma_f32_16x16x32_bf16 v[56:59], v[192:195], v[144:147], 0
    s_and_b32 s53, s37, 3
    v_mfma_f32_16x16x32_bf16 v[60:63], v[192:195], v[176:179], 0
    s_mul_i32 s53, s53, 196608
    s_waitcnt lgkmcnt(6)
    v_mfma_f32_16x16x32_bf16 v[48:51], v[196:199], a[212:215], v[48:51]
    v_cvt_pk_bf16_f32 v66, v32, v33
    s_add_u32 s53, s53, s40
    s_barrier
    v_mfma_f32_16x16x32_bf16 v[52:55], v[196:199], a[244:247], v[52:55]
    v_cvt_pk_bf16_f32 v67, v34, v35
    s_and_b32 s54, s37, 3
    v_mfma_f32_16x16x32_bf16 v[56:59], v[196:199], v[148:151], v[56:59]
    v_cvt_pk_bf16_f32 v82, v36, v37
    s_mul_i32 s54, s54, 196608
    v_mfma_f32_16x16x32_bf16 v[60:63], v[196:199], v[180:183], v[60:63]
    v_cvt_pk_bf16_f32 v83, v38, v39
    s_add_u32 s54, s54, s41
    s_waitcnt lgkmcnt(5)
    v_mfma_f32_16x16x32_bf16 v[48:51], v[200:203], a[216:219], v[48:51]
    v_cvt_pk_bf16_f32 v98, v40, v41
    s_and_b32 s55, s37, 3
    v_mfma_f32_16x16x32_bf16 v[52:55], v[200:203], a[248:251], v[52:55]
    v_cvt_pk_bf16_f32 v99, v42, v43
    s_mul_i32 s55, s55, 196608
    v_mfma_f32_16x16x32_bf16 v[56:59], v[200:203], v[152:155], v[56:59]
    v_cvt_pk_bf16_f32 v114, v44, v45
    s_add_u32 s55, s55, s46
    v_mfma_f32_16x16x32_bf16 v[60:63], v[200:203], v[184:187], v[60:63]
    v_cvt_pk_bf16_f32 v115, v46, v47
    s_add_u32 s49, s37, 1
    s_waitcnt lgkmcnt(3)
    v_mfma_f32_16x16x32_bf16 v[48:51], v[204:207], a[220:223], v[48:51]
    v_mov_b64 v[32:33], 0
    s_lshl_b32 s88, s49, 18
    v_mfma_f32_16x16x32_bf16 v[52:55], v[204:207], a[252:255], v[52:55]
    v_mov_b64 v[34:35], 0
    s_add_u32 s88, s88, s48
    v_mfma_f32_16x16x32_bf16 v[56:59], v[204:207], v[156:159], v[56:59]
    v_mov_b64 v[36:37], 0
    s_add_u32 s89, s88, 0x20000
    v_mfma_f32_16x16x32_bf16 v[60:63], v[204:207], v[188:191], v[60:63]
    v_mov_b64 v[38:39], 0
    s_and_b32 s49, s49, 1
    s_waitcnt lgkmcnt(4)
    v_mfma_f32_16x16x32_bf16 v[240:243], v[208:211], a[208:211], 0
    v_mov_b64 v[40:41], 0
    s_lshl_b32 s49, s49, 14
    v_mfma_f32_16x16x32_bf16 v[244:247], v[208:211], a[240:243], 0
    v_mov_b64 v[42:43], 0
    s_add_u32 s92, s49, s65
    v_mfma_f32_16x16x32_bf16 v[248:251], v[208:211], v[144:147], 0
    v_mov_b64 v[44:45], 0
    s_add_u32 s93, s92, 4096
    buffer_store_dword v26, v2, s[4:7], s97 offen offset:0 sc1
    v_mfma_f32_16x16x32_bf16 v[252:255], v[208:211], v[176:179], 0
    v_mov_b64 v[46:47], 0
    s_xor_b32 s94, s92, 0x4000
    s_waitcnt lgkmcnt(2)
    v_mfma_f32_16x16x32_bf16 v[240:243], v[212:215], a[212:215], v[240:243]
    v_cvt_pk_bf16_f32 v72, v48, v49
    s_add_u32 s94, s94, 32768
    buffer_store_dword v27, v2, s[4:7], s58 offen offset:2048 sc1
    v_mfma_f32_16x16x32_bf16 v[244:247], v[212:215], a[244:247], v[244:247]
    v_cvt_pk_bf16_f32 v73, v50, v51
    s_add_u32 s95, s94, 4096
    v_mfma_f32_16x16x32_bf16 v[248:251], v[212:215], v[148:151], v[248:251]
    v_cvt_pk_bf16_f32 v88, v52, v53
    s_add_u32 s49, s37, 2
    buffer_store_dwordx4 v[28:31], v1, s[4:7], s56 offen offset:0 sc1
    v_mfma_f32_16x16x32_bf16 v[252:255], v[212:215], v[180:183], v[252:255]
    v_cvt_pk_bf16_f32 v89, v54, v55
    s_min_u32 s49, s49, 63
    s_waitcnt lgkmcnt(1)
    v_mfma_f32_16x16x32_bf16 v[240:243], v[216:219], a[216:219], v[240:243]
    v_cvt_pk_bf16_f32 v104, v56, v57
    s_lshl_b32 s90, s49, 18
    buffer_store_dword v28, v2, s[4:7], s51 offen offset:0 sc1
    v_mfma_f32_16x16x32_bf16 v[244:247], v[216:219], a[248:251], v[244:247]
    v_cvt_pk_bf16_f32 v105, v58, v59
    s_add_u32 s90, s90, s48
    v_mfma_f32_16x16x32_bf16 v[248:251], v[216:219], v[152:155], v[248:251]
    v_cvt_pk_bf16_f32 v120, v60, v61
    s_add_u32 s90, s90, 0x1000000
    buffer_store_dword v28, v2, s[4:7], s50 offen offset:0 sc1
    v_mfma_f32_16x16x32_bf16 v[252:255], v[216:219], v[184:187], v[252:255]
    v_cvt_pk_bf16_f32 v121, v62, v63
    s_add_u32 s91, s90, 0x20000
    s_waitcnt lgkmcnt(0)
    v_mfma_f32_16x16x32_bf16 v[240:243], v[220:223], a[220:223], v[240:243]
    v_mfma_f32_16x16x32_bf16 v[244:247], v[220:223], a[252:255], v[244:247]
    v_mfma_f32_16x16x32_bf16 v[248:251], v[220:223], v[156:159], v[248:251]
    v_mfma_f32_16x16x32_bf16 v[252:255], v[220:223], v[188:191], v[252:255]
    v_mov_b64 v[48:49], 0
    v_mov_b64 v[50:51], 0
    v_mov_b64 v[52:53], 0
    v_mov_b64 v[54:55], 0
    v_mov_b64 v[56:57], 0
    v_mov_b64 v[58:59], 0
    v_mov_b64 v[60:61], 0
    v_mov_b64 v[62:63], 0
    v_xor_b32 v9, 0x4000, v9
    s_waitcnt vmcnt(5)
    v_cmp_ne_u32 vcc, 8, v17
    s_nop 0
    s_cbranch_vccnz L_kvs_Hr
L_kvo_Hr:
    v_cvt_pk_bf16_f32 v74, v240, v241
    v_cvt_pk_bf16_f32 v75, v242, v243
    v_cvt_pk_bf16_f32 v90, v244, v245
    v_cvt_pk_bf16_f32 v91, v246, v247
    v_cvt_pk_bf16_f32 v106, v248, v249
    v_cvt_pk_bf16_f32 v107, v250, v251
    v_cvt_pk_bf16_f32 v122, v252, v253
    v_cvt_pk_bf16_f32 v123, v254, v255
    s_barrier
    buffer_load_dwordx4 v[192:195], v13, s[4:7], s59 offen offset:0 sc1
    buffer_load_dwordx4 v[196:199], v13, s[4:7], s59 offen offset:1024 sc1
    buffer_load_dwordx4 v[200:203], v13, s[4:7], s59 offen offset:2048 sc1
    buffer_load_dwordx4 v[204:207], v13, s[4:7], s59 offen offset:3072 sc1
    s_waitcnt vmcnt(3)
    v_max3_u32 v16, v192, v193, v194
    v_max_u32 v16, v16, v195
    v_cmp_eq_u32 vcc, -1, v16
    s_nop 0
    s_cbranch_vccnz L_qf0123_Hr
    v_smfmac_f32_16x16x64_bf16 v[32:35], v[192:195], a[0:7], v10
    v_smfmac_f32_16x16x64_bf16 v[36:39], v[192:195], a[32:39], v10
    s_waitcnt vmcnt(2)
    v_max3_u32 v16, v196, v197, v198
    v_smfmac_f32_16x16x64_bf16 v[40:43], v[192:195], a[64:71], v10
    v_max_u32 v16, v16, v199
    v_cmp_eq_u32 vcc, -1, v16
    v_smfmac_f32_16x16x64_bf16 v[44:47], v[192:195], a[96:103], v10
    v_smfmac_f32_16x16x64_bf16 v[48:51], v[192:195], a[128:135], v10
    v_smfmac_f32_16x16x64_bf16 v[52:55], v[192:195], a[160:167], v10
    s_cbranch_vccnz L_qf123_Hr
    v_smfmac_f32_16x16x64_bf16 v[32:35], v[196:199], a[8:15], v10
    v_smfmac_f32_16x16x64_bf16 v[36:39], v[196:199], a[40:47], v10
    s_waitcnt vmcnt(1)
    v_max3_u32 v16, v200, v201, v202
    v_smfmac_f32_16x16x64_bf16 v[40:43], v[196:199], a[72:79], v10
    v_max_u32 v16, v16, v203
    v_cmp_eq_u32 vcc, -1, v16
    v_smfmac_f32_16x16x64_bf16 v[44:47], v[196:199], a[104:111], v10
    v_smfmac_f32_16x16x64_bf16 v[48:51], v[196:199], a[136:143], v10
    v_smfmac_f32_16x16x64_bf16 v[52:55], v[196:199], a[168:175], v10
    s_cbranch_vccnz L_qf23_Hr
    v_smfmac_f32_16x16x64_bf16 v[32:35], v[200:203], a[16:23], v10
    v_smfmac_f32_16x16x64_bf16 v[36:39], v[200:203], a[48:55], v10
    s_waitcnt vmcnt(0)
    v_max3_u32 v16, v204, v205, v206
    v_smfmac_f32_16x16x64_bf16 v[40:43], v[200:203], a[80:87], v10
    v_max_u32 v16, v16, v207
    v_cmp_eq_u32 vcc, -1, v16
    v_smfmac_f32_16x16x64_bf16 v[44:47], v[200:203], a[112:119], v10
    v_smfmac_f32_16x16x64_bf16 v[48:51], v[200:203], a[144:151], v10
    v_smfmac_f32_16x16x64_bf16 v[52:55], v[200:203], a[176:183], v10
    s_cbranch_vccnz L_qf3_Hr
    v_smfmac_f32_16x16x64_bf16 v[32:35], v[204:207], a[24:31], v10
    v_smfmac_f32_16x16x64_bf16 v[36:39], v[204:207], a[56:63], v10
    v_smfmac_f32_16x16x64_bf16 v[40:43], v[204:207], a[88:95], v10
    v_smfmac_f32_16x16x64_bf16 v[44:47], v[204:207], a[120:127], v10
    v_smfmac_f32_16x16x64_bf16 v[48:51], v[204:207], a[152:159], v10
    v_smfmac_f32_16x16x64_bf16 v[52:55], v[204:207], a[184:191], v10
    s_nop 2
    v_pk_add_f32 v[32:33], v[32:33], v[34:35]
    ds_write_b64 v3, v[32:33] offset:0
    v_pk_add_f32 v[36:37], v[36:37], v[38:39]
    ds_write_b64 v3, v[36:37] offset:776
    v_pk_add_f32 v[40:41], v[40:41], v[42:43]
    ds_write_b64 v3, v[40:41] offset:1552
    v_pk_add_f32 v[44:45], v[44:45], v[46:47]
    ds_write_b64 v3, v[44:45] offset:2328
    v_pk_add_f32 v[48:49], v[48:49], v[50:51]
    ds_write_b64 v3, v[48:49] offset:3104
    v_pk_add_f32 v[52:53], v[52:53], v[54:55]
    ds_write_b64 v3, v[52:53] offset:3880
    s_branch L_loopw_Hr
L_qf0123_Hr:
    buffer_load_dwordx4 v[192:195], v13, s[4:7], s59 offen offset:0 sc1
    s_waitcnt vmcnt(3)
    v_max3_u32 v16, v196, v197, v198
    v_max_u32 v16, v16, v199
    v_cmp_eq_u32 vcc, -1, v16
L_qt1230_Hr:
    s_nop 0
    s_cbranch_vccnz L_qf1230_Hr
    v_smfmac_f32_16x16x64_bf16 v[32:35], v[196:199], a[8:15], v10
    v_smfmac_f32_16x16x64_bf16 v[36:39], v[196:199], a[40:47], v10
    v_smfmac_f32_16x16x64_bf16 v[40:43], v[196:199], a[72:79], v10
    v_smfmac_f32_16x16x64_bf16 v[44:47], v[196:199], a[104:111], v10
    s_waitcnt vmcnt(2)
    v_max3_u32 v16, v200, v201, v202
    v_smfmac_f32_16x16x64_bf16 v[48:51], v[196:199], a[136:143], v10
    v_max_u32 v16, v16, v203
    v_cmp_eq_u32 vcc, -1, v16
    v_smfmac_f32_16x16x64_bf16 v[52:55], v[196:199], a[168:175], v10
L_qt230_Hr:
    s_cbranch_vccnz L_qf230_Hr
    v_smfmac_f32_16x16x64_bf16 v[32:35], v[200:203], a[16:23], v10
    v_smfmac_f32_16x16x64_bf16 v[36:39], v[200:203], a[48:55], v10
    v_smfmac_f32_16x16x64_bf16 v[40:43], v[200:203], a[80:87], v10
    v_smfmac_f32_16x16x64_bf16 v[44:47], v[200:203], a[112:119], v10
    s_waitcnt vmcnt(1)
    v_max3_u32 v16, v204, v205, v206
    v_smfmac_f32_16x16x64_bf16 v[48:51], v[200:203], a[144:151], v10
    v_max_u32 v16, v16, v207
    v_cmp_eq_u32 vcc, -1, v16
    v_smfmac_f32_16x16x64_bf16 v[52:55], v[200:203], a[176:183], v10
L_qt30_Hr:
    s_cbranch_vccnz L_qf30_Hr
    v_smfmac_f32_16x16x64_bf16 v[32:35], v[204:207], a[24:31], v10
    v_smfmac_f32_16x16x64_bf16 v[36:39], v[204:207], a[56:63], v10
    v_smfmac_f32_16x16x64_bf16 v[40:43], v[204:207], a[88:95], v10
    v_smfmac_f32_16x16x64_bf16 v[44:47], v[204:207], a[120:127], v10
    s_waitcnt vmcnt(0)
    v_max3_u32 v16, v192, v193, v194
    v_smfmac_f32_16x16x64_bf16 v[48:51], v[204:207], a[152:159], v10
    v_max_u32 v16, v16, v195
    v_cmp_eq_u32 vcc, -1, v16
    v_smfmac_f32_16x16x64_bf16 v[52:55], v[204:207], a[184:191], v10
L_qt0_Hr:
    s_cbranch_vccnz L_qf0_Hr
    v_smfmac_f32_16x16x64_bf16 v[32:35], v[192:195], a[0:7], v10
    v_smfmac_f32_16x16x64_bf16 v[36:39], v[192:195], a[32:39], v10
    v_smfmac_f32_16x16x64_bf16 v[40:43], v[192:195], a[64:71], v10
    v_smfmac_f32_16x16x64_bf16 v[44:47], v[192:195], a[96:103], v10
    v_smfmac_f32_16x16x64_bf16 v[48:51], v[192:195], a[128:135], v10
    v_smfmac_f32_16x16x64_bf16 v[52:55], v[192:195], a[160:167], v10
    s_nop 2
    v_pk_add_f32 v[32:33], v[32:33], v[34:35]
    ds_write_b64 v3, v[32:33] offset:0
    v_pk_add_f32 v[36:37], v[36:37], v[38:39]
    ds_write_b64 v3, v[36:37] offset:776
    v_pk_add_f32 v[40:41], v[40:41], v[42:43]
    ds_write_b64 v3, v[40:41] offset:1552
    v_pk_add_f32 v[44:45], v[44:45], v[46:47]
    ds_write_b64 v3, v[44:45] offset:2328
    v_pk_add_f32 v[48:49], v[48:49], v[50:51]
    ds_write_b64 v3, v[48:49] offset:3104
    v_pk_add_f32 v[52:53], v[52:53], v[54:55]
    ds_write_b64 v3, v[52:53] offset:3880
    s_branch L_loopw_Hr
L_qf123_Hr:
    buffer_load_dwordx4 v[196:199], v13, s[4:7], s59 offen offset:1024 sc1
    s_waitcnt vmcnt(2)
    v_max3_u32 v16, v200, v201, v202
    v_max_u32 v16, v16, v203
    v_cmp_eq_u32 vcc, -1, v16
L_qt231_Hr:
    s_nop 0
    s_cbranch_vccnz L_qf231_Hr
    v_smfmac_f32_16x16x64_bf16 v[32:35], v[200:203], a[16:23], v10
    v_smfmac_f32_16x16x64_bf16 v[36:39], v[200:203], a[48:55], v10
    v_smfmac_f32_16x16x64_bf16 v[40:43], v[200:203], a[80:87], v10
    v_smfmac_f32_16x16x64_bf16 v[44:47], v[200:203], a[112:119], v10
    s_waitcnt vmcnt(1)
    v_max3_u32 v16, v204, v205, v206
    v_smfmac_f32_16x16x64_bf16 v[48:51], v[200:203], a[144:151], v10
    v_max_u32 v16, v16, v207
    v_cmp_eq_u32 vcc, -1, v16
    v_smfmac_f32_16x16x64_bf16 v[52:55], v[200:203], a[176:183], v10
L_qt31_Hr:
    s_cbranch_vccnz L_qf31_Hr
    v_smfmac_f32_16x16x64_bf16 v[32:35], v[204:207], a[24:31], v10
    v_smfmac_f32_16x16x64_bf16 v[36:39], v[204:207], a[56:63], v10
    v_smfmac_f32_16x16x64_bf16 v[40:43], v[204:207], a[88:95], v10
    v_smfmac_f32_16x16x64_bf16 v[44:47], v[204:207], a[120:127], v10
    s_waitcnt vmcnt(0)
    v_max3_u32 v16, v196, v197, v198
    v_smfmac_f32_16x16x64_bf16 v[48:51], v[204:207], a[152:159], v10
    v_max_u32 v16, v16, v199
    v_cmp_eq_u32 vcc, -1, v16
    v_smfmac_f32_16x16x64_bf16 v[52:55], v[204:207], a[184:191], v10
L_qt1_Hr:
    s_cbranch_vccnz L_qf1_Hr
    v_smfmac_f32_16x16x64_bf16 v[32:35], v[196:199], a[8:15], v10
    v_smfmac_f32_16x16x64_bf16 v[36:39], v[196:199], a[40:47], v10
    v_smfmac_f32_16x16x64_bf16 v[40:43], v[196:199], a[72:79], v10
    v_smfmac_f32_16x16x64_bf16 v[44:47], v[196:199], a[104:111], v10
    v_smfmac_f32_16x16x64_bf16 v[48:51], v[196:199], a[136:143], v10
    v_smfmac_f32_16x16x64_bf16 v[52:55], v[196:199], a[168:175], v10
    s_nop 2
    v_pk_add_f32 v[32:33], v[32:33], v[34:35]
    ds_write_b64 v3, v[32:33] offset:0
    v_pk_add_f32 v[36:37], v[36:37], v[38:39]
    ds_write_b64 v3, v[36:37] offset:776
    v_pk_add_f32 v[40:41], v[40:41], v[42:43]
    ds_write_b64 v3, v[40:41] offset:1552
    v_pk_add_f32 v[44:45], v[44:45], v[46:47]
    ds_write_b64 v3, v[44:45] offset:2328
    v_pk_add_f32 v[48:49], v[48:49], v[50:51]
    ds_write_b64 v3, v[48:49] offset:3104
    v_pk_add_f32 v[52:53], v[52:53], v[54:55]
    ds_write_b64 v3, v[52:53] offset:3880
    s_branch L_loopw_Hr
L_qf23_Hr:
    buffer_load_dwordx4 v[200:203], v13, s[4:7], s59 offen offset:2048 sc1
    s_waitcnt vmcnt(1)
    v_max3_u32 v16, v204, v205, v206
    v_max_u32 v16, v16, v207
    v_cmp_eq_u32 vcc, -1, v16
L_qt32_Hr:
    s_nop 0
    s_cbranch_vccnz L_qf32_Hr
    v_smfmac_f32_16x16x64_bf16 v[32:35], v[204:207], a[24:31], v10
    v_smfmac_f32_16x16x64_bf16 v[36:39], v[204:207], a[56:63], v10
    v_smfmac_f32_16x16x64_bf16 v[40:43], v[204:207], a[88:95], v10
    v_smfmac_f32_16x16x64_bf16 v[44:47], v[204:207], a[120:127], v10
    s_waitcnt vmcnt(0)
    v_max3_u32 v16, v200, v201, v202
    v_smfmac_f32_16x16x64_bf16 v[48:51], v[204:207], a[152:159], v10
    v_max_u32 v16, v16, v203
    v_cmp_eq_u32 vcc, -1, v16
    v_smfmac_f32_16x16x64_bf16 v[52:55], v[204:207], a[184:191], v10
L_qt2_Hr:
    s_cbranch_vccnz L_qf2_Hr
    v_smfmac_f32_16x16x64_bf16 v[32:35], v[200:203], a[16:23], v10
    v_smfmac_f32_16x16x64_bf16 v[36:39], v[200:203], a[48:55], v10
    v_smfmac_f32_16x16x64_bf16 v[40:43], v[200:203], a[80:87], v10
    v_smfmac_f32_16x16x64_bf16 v[44:47], v[200:203], a[112:119], v10
    v_smfmac_f32_16x16x64_bf16 v[48:51], v[200:203], a[144:151], v10
    v_smfmac_f32_16x16x64_bf16 v[52:55], v[200:203], a[176:183], v10
    s_nop 2
    v_pk_add_f32 v[32:33], v[32:33], v[34:35]
    ds_write_b64 v3, v[32:33] offset:0
    v_pk_add_f32 v[36:37], v[36:37], v[38:39]
    ds_write_b64 v3, v[36:37] offset:776
    v_pk_add_f32 v[40:41], v[40:41], v[42:43]
    ds_write_b64 v3, v[40:41] offset:1552
    v_pk_add_f32 v[44:45], v[44:45], v[46:47]
    ds_write_b64 v3, v[44:45] offset:2328
    v_pk_add_f32 v[48:49], v[48:49], v[50:51]
    ds_write_b64 v3, v[48:49] offset:3104
    v_pk_add_f32 v[52:53], v[52:53], v[54:55]
    ds_write_b64 v3, v[52:53] offset:3880
    s_branch L_loopw_Hr
L_qf3_Hr:
    buffer_load_dwordx4 v[204:207], v13, s[4:7], s59 offen offset:3072 sc1
    s_sub_u32 s39, s39, 1
    s_cbranch_scc1 L_chain_fail
    s_waitcnt vmcnt(0)
    v_max3_u32 v16, v204, v205, v206
    v_max_u32 v16, v16, v207
    v_cmp_eq_u32 vcc, -1, v16
L_qt3_Hr:
    s_nop 0
    s_cbranch_vccnz L_qf3_Hr
    v_smfmac_f32_16x16x64_bf16 v[32:35], v[204:207], a[24:31], v10
    v_smfmac_f32_16x16x64_bf16 v[36:39], v[204:207], a[56:63], v10
    v_smfmac_f32_16x16x64_bf16 v[40:43], v[204:207], a[88:95], v10
    v_smfmac_f32_16x16x64_bf16 v[44:47], v[204:207], a[120:127], v10
    v_smfmac_f32_16x16x64_bf16 v[48:51], v[204:207], a[152:159], v10
    v_smfmac_f32_16x16x64_bf16 v[52:55], v[204:207], a[184:191], v10
    s_nop 2
    v_pk_add_f32 v[32:33], v[32:33], v[34:35]
    ds_write_b64 v3, v[32:33] offset:0
    v_pk_add_f32 v[36:37], v[36:37], v[38:39]
    ds_write_b64 v3, v[36:37] offset:776
    v_pk_add_f32 v[40:41], v[40:41], v[42:43]
    ds_write_b64 v3, v[40:41] offset:1552
    v_pk_add_f32 v[44:45], v[44:45], v[46:47]
    ds_write_b64 v3, v[44:45] offset:2328
    v_pk_add_f32 v[48:49], v[48:49], v[50:51]
    ds_write_b64 v3, v[48:49] offset:3104
    v_pk_add_f32 v[52:53], v[52:53], v[54:55]
    ds_write_b64 v3, v[52:53] offset:3880
    s_branch L_loopw_Hr
L_qf1230_Hr:
    buffer_load_dwordx4 v[196:199], v13, s[4:7], s59 offen offset:1024 sc1
    s_waitcnt vmcnt(3)
    v_max3_u32 v16, v200, v201, v202
    v_max_u32 v16, v16, v203
    v_cmp_eq_u32 vcc, -1, v16
L_qt2301_Hr:
    s_nop 0
    s_cbranch_vccnz L_qf2301_Hr
    v_smfmac_f32_16x16x64_bf16 v[32:35], v[200:203], a[16:23], v10
    v_smfmac_f32_16x16x64_bf16 v[36:39], v[200:203], a[48:55], v10
    v_smfmac_f32_16x16x64_bf16 v[40:43], v[200:203], a[80:87], v10
    v_smfmac_f32_16x16x64_bf16 v[44:47], v[200:203], a[112:119], v10
    s_waitcnt vmcnt(2)
    v_max3_u32 v16, v204, v205, v206
    v_smfmac_f32_16x16x64_bf16 v[48:51], v[200:203], a[144:151], v10
    v_max_u32 v16, v16, v207
    v_cmp_eq_u32 vcc, -1, v16
    v_smfmac_f32_16x16x64_bf16 v[52:55], v[200:203], a[176:183], v10
L_qt301_Hr:
    s_cbranch_vccnz L_qf301_Hr
    v_smfmac_f32_16x16x64_bf16 v[32:35], v[204:207], a[24:31], v10
    v_smfmac_f32_16x16x64_bf16 v[36:39], v[204:207], a[56:63], v10
    v_smfmac_f32_16x16x64_bf16 v[40:43], v[204:207], a[88:95], v10
    v_smfmac_f32_16x16x64_bf16 v[44:47], v[204:207], a[120:127], v10
    s_waitcnt vmcnt(1)
    v_max3_u32 v16, v192, v193, v194
    v_smfmac_f32_16x16x64_bf16 v[48:51], v[204:207], a[152:159], v10
    v_max_u32 v16, v16, v195
    v_cmp_eq_u32 vcc, -1, v16
    v_smfmac_f32_16x16x64_bf16 v[52:55], v[204:207], a[184:191], v10
L_qt01_Hr:
    s_cbranch_vccnz L_qf01_Hr
    v_smfmac_f32_16x16x64_bf16 v[32:35], v[192:195], a[0:7], v10
    v_smfmac_f32_16x16x64_bf16 v[36:39], v[192:195], a[32:39], v10
    v_smfmac_f32_16x16x64_bf16 v[40:43], v[192:195], a[64:71], v10
    v_smfmac_f32_16x16x64_bf16 v[44:47], v[192:195], a[96:103], v10
    s_waitcnt vmcnt(0)
    v_max3_u32 v16, v196, v197, v198
    v_smfmac_f32_16x16x64_bf16 v[48:51], v[192:195], a[128:135], v10
    v_max_u32 v16, v16, v199
    v_cmp_eq_u32 vcc, -1, v16
    v_smfmac_f32_16x16x64_bf16 v[52:55], v[192:195], a[160:167], v10
    s_branch L_qt1_Hr
L_qf230_Hr:
    buffer_load_dwordx4 v[200:203], v13, s[4:7], s59 offen offset:2048 sc1
    s_waitcnt vmcnt(2)
    v_max3_u32 v16, v204, v205, v206
    v_max_u32 v16, v16, v207
    v_cmp_eq_u32 vcc, -1, v16
L_qt302_Hr:
    s_nop 0
    s_cbranch_vccnz L_qf302_Hr
    v_smfmac_f32_16x16x64_bf16 v[32:35], v[204:207], a[24:31], v10
    v_smfmac_f32_16x16x64_bf16 v[36:39], v[204:207], a[56:63], v10
    v_smfmac_f32_16x16x64_bf16 v[40:43], v[204:207], a[88:95], v10
    v_smfmac_f32_16x16x64_bf16 v[44:47], v[204:207], a[120:127], v10
    s_waitcnt vmcnt(1)
    v_max3_u32 v16, v192, v193, v194
    v_smfmac_f32_16x16x64_bf16 v[48:51], v[204:207], a[152:159], v10
    v_max_u32 v16, v16, v195
    v_cmp_eq_u32 vcc, -1, v16
    v_smfmac_f32_16x16x64_bf16 v[52:55], v[204:207], a[184:191], v10
L_qt02_Hr:
    s_cbranch_vccnz L_qf02_Hr
    v_smfmac_f32_16x16x64_bf16 v[32:35], v[192:195], a[0:7], v10
    v_smfmac_f32_16x16x64_bf16 v[36:39], v[192:195], a[32:39], v10
    v_smfmac_f32_16x16x64_bf16 v[40:43], v[192:195], a[64:71], v10
    v_smfmac_f32_16x16x64_bf16 v[44:47], v[192:195], a[96:103], v10
    s_waitcnt vmcnt(0)
    v_max3_u32 v16, v200, v201, v202
    v_smfmac_f32_16x16x64_bf16 v[48:51], v[192:195], a[128:135], v10
    v_max_u32 v16, v16, v203
    v_cmp_eq_u32 vcc, -1, v16
    v_smfmac_f32_16x16x64_bf16 v[52:55], v[192:195], a[160:167], v10
    s_branch L_qt2_Hr
L_qf30_Hr:
    buffer_load_dwordx4 v[204:207], v13, s[4:7], s59 offen offset:3072 sc1
    s_sub_u32 s39, s39, 1
    s_cbranch_scc1 L_chain_fail
    s_waitcnt vmcnt(1)
    v_max3_u32 v16, v192, v193, v194
    v_max_u32 v16, v16, v195
    v_cmp_eq_u32 vcc, -1, v16
L_qt03_Hr:
    s_nop 0
    s_cbranch_vccnz L_qf03_Hr
    v_smfmac_f32_16x16x64_bf16 v[32:35], v[192:195], a[0:7], v10
    v_smfmac_f32_16x16x64_bf16 v[36:39], v[192:195], a[32:39], v10
    v_smfmac_f32_16x16x64_bf16 v[40:43], v[192:195], a[64:71], v10
    v_smfmac_f32_16x16x64_bf16 v[44:47], v[192:195], a[96:103], v10
    s_waitcnt vmcnt(0)
    v_max3_u32 v16, v204, v205, v206
    v_smfmac_f32_16x16x64_bf16 v[48:51], v[192:195], a[128:135], v10
    v_max_u32 v16, v16, v207
    v_cmp_eq_u32 vcc, -1, v16
    v_smfmac_f32_16x16x64_bf16 v[52:55], v[192:195], a[160:167], v10
    s_branch L_qt3_Hr
L_qf0_Hr:
    buffer_load_dwordx4 v[192:195], v13, s[4:7], s59 offen offset:0 sc1
    s_sub_u32 s39, s39, 1
    s_cbranch_scc1 L_chain_fail
    s_waitcnt vmcnt(0)
    v_max3_u32 v16, v192, v193, v194
    v_max_u32 v16, v16, v195
    v_cmp_eq_u32 vcc, -1, v16
    s_nop 0
    s_cbranch_vccnz L_qf0_Hr
    s_branch L_qt0_Hr
L_qf231_Hr:
    buffer_load_dwordx4 v[200:203], v13, s[4:7], s59 offen offset:2048 sc1
    s_waitcnt vmcnt(2)
    v_max3_u32 v16, v204, v205, v206
    v_max_u32 v16, v16, v207
    v_cmp_eq_u32 vcc, -1, v16
L_qt312_Hr:
    s_nop 0
    s_cbranch_vccnz L_qf312_Hr
    v_smfmac_f32_16x16x64_bf16 v[32:35], v[204:207], a[24:31], v10
    v_smfmac_f32_16x16x64_bf16 v[36:39], v[204:207], a[56:63], v10
    v_smfmac_f32_16x16x64_bf16 v[40:43], v[204:207], a[88:95], v10
    v_smfmac_f32_16x16x64_bf16 v[44:47], v[204:207], a[120:127], v10
    s_waitcnt vmcnt(1)
    v_max3_u32 v16, v196, v197, v198
    v_smfmac_f32_16x16x64_bf16 v[48:51], v[204:207], a[152:159], v10
    v_max_u32 v16, v16, v199
    v_cmp_eq_u32 vcc, -1, v16
    v_smfmac_f32_16x16x64_bf16 v[52:55], v[204:207], a[184:191], v10
L_qt12_Hr:
    s_cbranch_vccnz L_qf12_Hr
    v_smfmac_f32_16x16x64_bf16 v[32:35], v[196:199], a[8:15], v10
    v_smfmac_f32_16x16x64_bf16 v[36:39], v[196:199], a[40:47], v10
    v_smfmac_f32_16x16x64_bf16 v[40:43], v[196:199], a[72:79], v10
    v_smfmac_f32_16x16x64_bf16 v[44:47], v[196:199], a[104:111], v10
    s_waitcnt vmcnt(0)
    v_max3_u32 v16, v200, v201, v202
    v_smfmac_f32_16x16x64_bf16 v[48:51], v[196:199], a[136:143], v10
    v_max_u32 v16, v16, v203
    v_cmp_eq_u32 vcc, -1, v16
    v_smfmac_f32_16x16x64_bf16 v[52:55], v[196:199], a[168:175], v10
    s_branch L_qt2_Hr
L_qf31_Hr:
    buffer_load_dwordx4 v[204:207], v13, s[4:7], s59 offen offset:3072 sc1
    s_sub_u32 s39, s39, 1
    s_cbranch_scc1 L_chain_fail
    s_waitcnt vmcnt(1)
    v_max3_u32 v16, v196, v197, v198
    v_max_u32 v16, v16, v199
    v_cmp_eq_u32 vcc, -1, v16
L_qt13_Hr:
    s_nop 0
    s_cbranch_vccnz L_qf13_Hr
    v_smfmac_f32_16x16x64_bf16 v[32:35], v[196:199], a[8:15], v10
    v_smfmac_f32_16x16x64_bf16 v[36:39], v[196:199], a[40:47], v10
    v_smfmac_f32_16x16x64_bf16 v[40:43], v[196:199], a[72:79], v10
    v_smfmac_f32_16x16x64_bf16 v[44:47], v[196:199], a[104:111], v10
    s_waitcnt vmcnt(0)
    v_max3_u32 v16, v204, v205, v206
    v_smfmac_f32_16x16x64_bf16 v[48:51], v[196:199], a[136:143], v10
    v_max_u32 v16, v16, v207
    v_cmp_eq_u32 vcc, -1, v16
    v_smfmac_f32_16x16x64_bf16 v[52:55], v[196:199], a[168:175], v10
    s_branch L_qt3_Hr
L_qf1_Hr:
    buffer_load_dwordx4 v[196:199], v13, s[4:7], s59 offen offset:1024 sc1
    s_sub_u32 s39, s39, 1
    s_cbranch_scc1 L_chain_fail
    s_waitcnt vmcnt(0)
    v_max3_u32 v16, v196, v197, v198
    v_max_u32 v16, v16, v199
    v_cmp_eq_u32 vcc, -1, v16
    s_nop 0
    s_cbranch_vccnz L_qf1_Hr
    s_branch L_qt1_Hr
L_qf32_Hr:
    buffer_load_dwordx4 v[204:207], v13, s[4:7], s59 offen offset:3072 sc1
    s_sub_u32 s39, s39, 1
    s_cbranch_scc1 L_chain_fail
    s_waitcnt vmcnt(1)
    v_max3_u32 v16, v200, v201, v202
    v_max_u32 v16, v16, v203
    v_cmp_eq_u32 vcc, -1, v16
L_qt23_Hr:
    s_nop 0
    s_cbranch_vccnz L_qf23_Hr
    v_smfmac_f32_16x16x64_bf16 v[32:35], v[200:203], a[16:23], v10
    v_smfmac_f32_16x16x64_bf16 v[36:39], v[200:203], a[48:55], v10
    v_smfmac_f32_16x16x64_bf16 v[40:43], v[200:203], a[80:87], v10
    v_smfmac_f32_16x16x64_bf16 v[44:47], v[200:203], a[112:119], v10
    s_waitcnt vmcnt(0)
    v_max3_u32 v16, v204, v205, v206
    v_smfmac_f32_16x16x64_bf16 v[48:51], v[200:203], a[144:151], v10
    v_max_u32 v16, v16, v207
    v_cmp_eq_u32 vcc, -1, v16
    v_smfmac_f32_16x16x64_bf16 v[52:55], v[200:203], a[176:183], v10
    s_branch L_qt3_Hr
L_qf2_Hr:
    buffer_load_dwordx4 v[200:203], v13, s[4:7], s59 offen offset:2048 sc1
    s_sub_u32 s39, s39, 1
    s_cbranch_scc1 L_chain_fail
    s_waitcnt vmcnt(0)
    v_max3_u32 v16, v200, v201, v202
    v_max_u32 v16, v16, v203
    v_cmp_eq_u32 vcc, -1, v16
    s_nop 0
    s_cbranch_vccnz L_qf2_Hr
    s_branch L_qt2_Hr
L_qf2301_Hr:
    buffer_load_dwordx4 v[200:203], v13, s[4:7], s59 offen offset:2048 sc1
    s_waitcnt vmcnt(3)
    v_max3_u32 v16, v204, v205, v206
    v_max_u32 v16, v16, v207
    v_cmp_eq_u32 vcc, -1, v16
L_qt3012_Hr:
    s_nop 0
    s_cbranch_vccnz L_qf3012_Hr
    v_smfmac_f32_16x16x64_bf16 v[32:35], v[204:207], a[24:31], v10
    v_smfmac_f32_16x16x64_bf16 v[36:39], v[204:207], a[56:63], v10
    v_smfmac_f32_16x16x64_bf16 v[40:43], v[204:207], a[88:95], v10
    v_smfmac_f32_16x16x64_bf16 v[44:47], v[204:207], a[120:127], v10
    s_waitcnt vmcnt(2)
    v_max3_u32 v16, v192, v193, v194
    v_smfmac_f32_16x16x64_bf16 v[48:51], v[204:207], a[152:159], v10
    v_max_u32 v16, v16, v195
    v_cmp_eq_u32 vcc, -1, v16
    v_smfmac_f32_16x16x64_bf16 v[52:55], v[204:207], a[184:191], v10
L_qt012_Hr:
    s_cbranch_vccnz L_qf012_Hr
    v_smfmac_f32_16x16x64_bf16 v[32:35], v[192:195], a[0:7], v10
    v_smfmac_f32_16x16x64_bf16 v[36:39], v[192:195], a[32:39], v10
    v_smfmac_f32_16x16x64_bf16 v[40:43], v[192:195], a[64:71], v10
    v_smfmac_f32_16x16x64_bf16 v[44:47], v[192:195], a[96:103], v10
    s_waitcnt vmcnt(1)
    v_max3_u32 v16, v196, v197, v198
    v_smfmac_f32_16x16x64_bf16 v[48:51], v[192:195], a[128:135], v10
    v_max_u32 v16, v16, v199
    v_cmp_eq_u32 vcc, -1, v16
    v_smfmac_f32_16x16x64_bf16 v[52:55], v[192:195], a[160:167], v10
    s_branch L_qt12_Hr
L_qf301_Hr:
    buffer_load_dwordx4 v[204:207], v13, s[4:7], s59 offen offset:3072 sc1
    s_sub_u32 s39, s39, 1
    s_cbranch_scc1 L_chain_fail
    s_waitcnt vmcnt(2)
    v_max3_u32 v16, v192, v193, v194
    v_max_u32 v16, v16, v195
    v_cmp_eq_u32 vcc, -1, v16
L_qt013_Hr:
    s_nop 0
    s_cbranch_vccnz L_qf013_Hr
    v_smfmac_f32_16x16x64_bf16 v[32:35], v[192:195], a[0:7], v10
    v_smfmac_f32_16x16x64_bf16 v[36:39], v[192:195], a[32:39], v10
    v_smfmac_f32_16x16x64_bf16 v[40:43], v[192:195], a[64:71], v10
    v_smfmac_f32_16x16x64_bf16 v[44:47], v[192:195], a[96:103], v10
    s_waitcnt vmcnt(1)
    v_max3_u32 v16, v196, v197, v198
    v_smfmac_f32_16x16x64_bf16 v[48:51], v[192:195], a[128:135], v10
    v_max_u32 v16, v16, v199
    v_cmp_eq_u32 vcc, -1, v16
    v_smfmac_f32_16x16x64_bf16 v[52:55], v[192:195], a[160:167], v10
    s_branch L_qt13_Hr
L_qf01_Hr:
    buffer_load_dwordx4 v[192:195], v13, s[4:7], s59 offen offset:0 sc1
    s_waitcnt vmcnt(1)
    v_max3_u32 v16, v196, v197, v198
    v_max_u32 v16, v16, v199
    v_cmp_eq_u32 vcc, -1, v16
L_qt10_Hr:
    s_nop 0
    s_cbranch_vccnz L_qf10_Hr
    v_smfmac_f32_16x16x64_bf16 v[32:35], v[196:199], a[8:15], v10
    v_smfmac_f32_16x16x64_bf16 v[36:39], v[196:199], a[40:47], v10
    v_smfmac_f32_16x16x64_bf16 v[40:43], v[196:199], a[72:79], v10
    v_smfmac_f32_16x16x64_bf16 v[44:47], v[196:199], a[104:111], v10
    s_waitcnt vmcnt(0)
    v_max3_u32 v16, v192, v193, v194
    v_smfmac_f32_16x16x64_bf16 v[48:51], v[196:199], a[136:143], v10
    v_max_u32 v16, v16, v195
    v_cmp_eq_u32 vcc, -1, v16
    v_smfmac_f32_16x16x64_bf16 v[52:55], v[196:199], a[168:175], v10
    s_branch L_qt0_Hr
L_qf302_Hr:
    buffer_load_dwordx4 v[204:207], v13, s[4:7], s59 offen offset:3072 sc1
    s_sub_u32 s39, s39, 1
    s_cbranch_scc1 L_chain_fail
    s_waitcnt vmcnt(2)
    v_max3_u32 v16, v192, v193, v194
    v_max_u32 v16, v16, v195
    v_cmp_eq_u32 vcc, -1, v16
L_qt023_Hr:
    s_nop 0
    s_cbranch_vccnz L_qf023_Hr
    v_smfmac_f32_16x16x64_bf16 v[32:35], v[192:195], a[0:7], v10
    v_smfmac_f32_16x16x64_bf16 v[36:39], v[192:195], a[32:39], v10
    v_smfmac_f32_16x16x64_bf16 v[40:43], v[192:195], a[64:71], v10
    v_smfmac_f32_16x16x64_bf16 v[44:47], v[192:195], a[96:103], v10
    s_waitcnt vmcnt(1)
    v_max3_u32 v16, v200, v201, v202
    v_smfmac_f32_16x16x64_bf16 v[48:51], v[192:195], a[128:135], v10
    v_max_u32 v16, v16, v203
    v_cmp_eq_u32 vcc, -1, v16
    v_smfmac_f32_16x16x64_bf16 v[52:55], v[192:195], a[160:167], v10
    s_branch L_qt23_Hr
L_qf02_Hr:
    buffer_load_dwordx4 v[192:195], v13, s[4:7], s59 offen offset:0 sc1
    s_waitcnt vmcnt(1)
    v_max3_u32 v16, v200, v201, v202
    v_max_u32 v16, v16, v203
    v_cmp_eq_u32 vcc, -1, v16
L_qt20_Hr:
    s_nop 0
    s_cbranch_vccnz L_qf20_Hr
    v_smfmac_f32_16x16x64_bf16 v[32:35], v[200:203], a[16:23], v10
    v_smfmac_f32_16x16x64_bf16 v[36:39], v[200:203], a[48:55], v10
    v_smfmac_f32_16x16x64_bf16 v[40:43], v[200:203], a[80:87], v10
    v_smfmac_f32_16x16x64_bf16 v[44:47], v[200:203], a[112:119], v10
    s_waitcnt vmcnt(0)
    v_max3_u32 v16, v192, v193, v194
    v_smfmac_f32_16x16x64_bf16 v[48:51], v[200:203], a[144:151], v10
    v_max_u32 v16, v16, v195
    v_cmp_eq_u32 vcc, -1, v16
    v_smfmac_f32_16x16x64_bf16 v[52:55], v[200:203], a[176:183], v10
    s_branch L_qt0_Hr
L_qf03_Hr:
    buffer_load_dwordx4 v[192:195], v13, s[4:7], s59 offen offset:0 sc1
    s_waitcnt vmcnt(1)
    v_max3_u32 v16, v204, v205, v206
    v_max_u32 v16, v16, v207
    v_cmp_eq_u32 vcc, -1, v16
    s_nop 0
    s_cbranch_vccnz L_qf30_Hr
    s_branch L_qt30_Hr
L_qf312_Hr:
    buffer_load_dwordx4 v[204:207], v13, s[4:7], s59 offen offset:3072 sc1
    s_sub_u32 s39, s39, 1
    s_cbranch_scc1 L_chain_fail
    s_waitcnt vmcnt(2)
    v_max3_u32 v16, v196, v197, v198
    v_max_u32 v16, v16, v199
    v_cmp_eq_u32 vcc, -1, v16
L_qt123_Hr:
    s_nop 0
    s_cbranch_vccnz L_qf123_Hr
    v_smfmac_f32_16x16x64_bf16 v[32:35], v[196:199], a[8:15], v10
    v_smfmac_f32_16x16x64_bf16 v[36:39], v[196:199], a[40:47], v10
    v_smfmac_f32_16x16x64_bf16 v[40:43], v[196:199], a[72:79], v10
    v_smfmac_f32_16x16x64_bf16 v[44:47], v[196:199], a[104:111], v10
    s_waitcnt vmcnt(1)
    v_max3_u32 v16, v200, v201, v202
    v_smfmac_f32_16x16x64_bf16 v[48:51], v[196:199], a[136:143], v10
    v_max_u32 v16, v16, v203
    v_cmp_eq_u32 vcc, -1, v16
    v_smfmac_f32_16x16x64_bf16 v[52:55], v[196:199], a[168:175], v10
    s_branch L_qt23_Hr
L_qf12_Hr:
    buffer_load_dwordx4 v[196:199], v13, s[4:7], s59 offen offset:1024 sc1
    s_waitcnt vmcnt(1)
    v_max3_u32 v16, v200, v201, v202
    v_max_u32 v16, v16, v203
    v_cmp_eq_u32 vcc, -1, v16
L_qt21_Hr:
    s_nop 0
    s_cbranch_vccnz L_qf21_Hr
    v_smfmac_f32_16x16x64_bf16 v[32:35], v[200:203], a[16:23], v10
    v_smfmac_f32_16x16x64_bf16 v[36:39], v[200:203], a[48:55], v10
    v_smfmac_f32_16x16x64_bf16 v[40:43], v[200:203], a[80:87], v10
    v_smfmac_f32_16x16x64_bf16 v[44:47], v[200:203], a[112:119], v10
    s_waitcnt vmcnt(0)
    v_max3_u32 v16, v196, v197, v198
    v_smfmac_f32_16x16x64_bf16 v[48:51], v[200:203], a[144:151], v10
    v_max_u32 v16, v16, v199
    v_cmp_eq_u32 vcc, -1, v16
    v_smfmac_f32_16x16x64_bf16 v[52:55], v[200:203], a[176:183], v10
    s_branch L_qt1_Hr
L_qf13_Hr:
    buffer_load_dwordx4 v[196:199], v13, s[4:7], s59 offen offset:1024 sc1
    s_waitcnt vmcnt(1)
    v_max3_u32 v16, v204, v205, v206
    v_max_u32 v16, v16, v207
    v_cmp_eq_u32 vcc, -1, v16
    s_nop 0
    s_cbranch_vccnz L_qf31_Hr
    s_branch L_qt31_Hr
L_qf3012_Hr:
    buffer_load_dwordx4 v[204:207], v13, s[4:7], s59 offen offset:3072 sc1
    s_sub_u32 s39, s39, 1
    s_cbranch_scc1 L_chain_fail
    s_waitcnt vmcnt(3)
    v_max3_u32 v16, v192, v193, v194
    v_max_u32 v16, v16, v195
    v_cmp_eq_u32 vcc, -1, v16
L_qt0123_Hr:
    s_nop 0
    s_cbranch_vccnz L_qf0123_Hr
    v_smfmac_f32_16x16x64_bf16 v[32:35], v[192:195], a[0:7], v10
    v_smfmac_f32_16x16x64_bf16 v[36:39], v[192:195], a[32:39], v10
    v_smfmac_f32_16x16x64_bf16 v[40:43], v[192:195], a[64:71], v10
    v_smfmac_f32_16x16x64_bf16 v[44:47], v[192:195], a[96:103], v10
    s_waitcnt vmcnt(2)
    v_max3_u32 v16, v196, v197, v198
    v_smfmac_f32_16x16x64_bf16 v[48:51], v[192:195], a[128:135], v10
    v_max_u32 v16, v16, v199
    v_cmp_eq_u32 vcc, -1, v16
    v_smfmac_f32_16x16x64_bf16 v[52:55], v[192:195], a[160:167], v10
    s_branch L_qt123_Hr
L_qf012_Hr:
    buffer_load_dwordx4 v[192:195], v13, s[4:7], s59 offen offset:0 sc1
    s_waitcnt vmcnt(2)
    v_max3_u32 v16, v196, v197, v198
    v_max_u32 v16, v16, v199
    v_cmp_eq_u32 vcc, -1, v16
L_qt120_Hr:
    s_nop 0
    s_cbranch_vccnz L_qf120_Hr
    v_smfmac_f32_16x16x64_bf16 v[32:35], v[196:199], a[8:15], v10
    v_smfmac_f32_16x16x64_bf16 v[36:39], v[196:199], a[40:47], v10
    v_smfmac_f32_16x16x64_bf16 v[40:43], v[196:199], a[72:79], v10
    v_smfmac_f32_16x16x64_bf16 v[44:47], v[196:199], a[104:111], v10
    s_waitcnt vmcnt(1)
    v_max3_u32 v16, v200, v201, v202
    v_smfmac_f32_16x16x64_bf16 v[48:51], v[196:199], a[136:143], v10
    v_max_u32 v16, v16, v203
    v_cmp_eq_u32 vcc, -1, v16
    v_smfmac_f32_16x16x64_bf16 v[52:55], v[196:199], a[168:175], v10
    s_branch L_qt20_Hr
L_qf013_Hr:
    buffer_load_dwordx4 v[192:195], v13, s[4:7], s59 offen offset:0 sc1
    s_waitcnt vmcnt(2)
    v_max3_u32 v16, v196, v197, v198
    v_max_u32 v16, v16, v199
    v_cmp_eq_u32 vcc, -1, v16
L_qt130_Hr:
    s_nop 0
    s_cbranch_vccnz L_qf130_Hr
    v_smfmac_f32_16x16x64_bf16 v[32:35], v[196:199], a[8:15], v10
    v_smfmac_f32_16x16x64_bf16 v[36:39], v[196:199], a[40:47], v10
    v_smfmac_f32_16x16x64_bf16 v[40:43], v[196:199], a[72:79], v10
    v_smfmac_f32_16x16x64_bf16 v[44:47], v[196:199], a[104:111], v10
    s_waitcnt vmcnt(1)
    v_max3_u32 v16, v204, v205, v206
    v_smfmac_f32_16x16x64_bf16 v[48:51], v[196:199], a[136:143], v10
    v_max_u32 v16, v16, v207
    v_cmp_eq_u32 vcc, -1, v16
    v_smfmac_f32_16x16x64_bf16 v[52:55], v[196:199], a[168:175], v10
    s_branch L_qt30_Hr
L_qf10_Hr:
    buffer_load_dwordx4 v[196:199], v13, s[4:7], s59 offen offset:1024 sc1
    s_sub_u32 s39, s39, 1
    s_cbranch_scc1 L_chain_fail
    s_waitcnt vmcnt(1)
    v_max3_u32 v16, v192, v193, v194
    v_max_u32 v16, v16, v195
    v_cmp_eq_u32 vcc, -1, v16
    s_nop 0
    s_cbranch_vccnz L_qf01_Hr
    s_branch L_qt01_Hr
L_qf023_Hr:
    buffer_load_dwordx4 v[192:195], v13, s[4:7], s59 offen offset:0 sc1
    s_waitcnt vmcnt(2)
    v_max3_u32 v16, v200, v201, v202
    v_max_u32 v16, v16, v203
    v_cmp_eq_u32 vcc, -1, v16
    s_nop 0
    s_cbranch_vccnz L_qf230_Hr
    s_branch L_qt230_Hr
L_qf20_Hr:
    buffer_load_dwordx4 v[200:203], v13, s[4:7], s59 offen offset:2048 sc1
    s_sub_u32 s39, s39, 1
    s_cbranch_scc1 L_chain_fail
    s_waitcnt vmcnt(1)
    v_max3_u32 v16, v192, v193, v194
    v_max_u32 v16, v16, v195
    v_cmp_eq_u32 vcc, -1, v16
    s_nop 0
    s_cbranch_vccnz L_qf02_Hr
    s_branch L_qt02_Hr
L_qf21_Hr:
    buffer_load_dwordx4 v[200:203], v13, s[4:7], s59 offen offset:2048 sc1
    s_sub_u32 s39, s39, 1
    s_cbranch_scc1 L_chain_fail
    s_waitcnt vmcnt(1)
    v_max3_u32 v16, v196, v197, v198
    v_max_u32 v16, v16, v199
    v_cmp_eq_u32 vcc, -1, v16
    s_nop 0
    s_cbranch_vccnz L_qf12_Hr
    s_branch L_qt12_Hr
L_qf120_Hr:
    buffer_load_dwordx4 v[196:199], v13, s[4:7], s59 offen offset:1024 sc1
    s_waitcnt vmcnt(2)
    v_max3_u32 v16, v200, v201, v202
    v_max_u32 v16, v16, v203
    v_cmp_eq_u32 vcc, -1, v16
L_qt201_Hr:
    s_nop 0
    s_cbranch_vccnz L_qf201_Hr
    v_smfmac_f32_16x16x64_bf16 v[32:35], v[200:203], a[16:23], v10
    v_smfmac_f32_16x16x64_bf16 v[36:39], v[200:203], a[48:55], v10
    v_smfmac_f32_16x16x64_bf16 v[40:43], v[200:203], a[80:87], v10
    v_smfmac_f32_16x16x64_bf16 v[44:47], v[200:203], a[112:119], v10
    s_waitcnt vmcnt(1)
    v_max3_u32 v16, v192, v193, v194
    v_smfmac_f32_16x16x64_bf16 v[48:51], v[200:203], a[144:151], v10
    v_max_u32 v16, v16, v195
    v_cmp_eq_u32 vcc, -1, v16
    v_smfmac_f32_16x16x64_bf16 v[52:55], v[200:203], a[176:183], v10
    s_branch L_qt01_Hr
L_qf130_Hr:
    buffer_load_dwordx4 v[196:199], v13, s[4:7], s59 offen offset:1024 sc1
    s_waitcnt vmcnt(2)
    v_max3_u32 v16, v204, v205, v206
    v_max_u32 v16, v16, v207
    v_cmp_eq_u32 vcc, -1, v16
    s_nop 0
    s_cbranch_vccnz L_qf301_Hr
    s_branch L_qt301_Hr
L_qf201_Hr:
    buffer_load_dwordx4 v[200:203], v13, s[4:7], s59 offen offset:2048 sc1
    s_sub_u32 s39, s39, 1
    s_cbranch_scc1 L_chain_fail
    s_waitcnt vmcnt(2)
    v_max3_u32 v16, v192, v193, v194
    v_max_u32 v16, v16, v195
    v_cmp_eq_u32 vcc, -1, v16
    s_nop 0
    s_cbranch_vccnz L_qf012_Hr
    s_branch L_qt012_Hr
L_cretry_Hr:
    buffer_load_dwordx4 v[192:195], v1, s[4:7], s55 offen offset:0 sc1
    buffer_load_dwordx4 v[196:199], v1, s[4:7], s55 offen offset:1024 sc1
    buffer_load_dwordx4 v[200:203], v1, s[4:7], s55 offen offset:2048 sc1
    buffer_load_dwordx4 v[204:207], v1, s[4:7], s55 offen offset:3072 sc1
    s_sub_u32 s39, s39, 1
    s_cbranch_scc0 L_hopc_Hr
    s_branch L_chain_fail
L_kvs_Hr:
Lkv_43:
    buffer_load_dword v16, off, s[4:7], s57 sc1
    s_waitcnt vmcnt(0)
    v_readfirstlane_b32 s50, v16
    s_nop 0
    s_cmp_eq_u32 s50, 8
    s_cbranch_scc1 Lkv_44
    s_sleep 4
    s_sub_u32 s39, s39, 1
    s_cbranch_scc0 Lkv_43
    s_branch L_chain_fail
Lkv_44:
    s_branch L_kvo_Hr
L_last_Hr:
    buffer_store_dword v27, v2, s[4:7], s58 offen offset:2048 sc1
    s_branch L_lastk
L_lastk:
    buffer_store_dword v26, v2, s[4:7], s97 offen offset:0 sc1
    s_branch L_chain_done
L_chain_fail:
    s_mov_b64 exec, -1
    v_mov_b32 v16, 1
    buffer_atomic_add v16, off, s[28:31], 0 offset:4 sc1
L_chain_done:
    s_mov_b32 s40, s100
    s_cmp_lt_u32 s100, 2
    s_cbranch_scc1 Lhh_45
    s_lshl_b32 s22, s20, 15
    s_lshl_b32 s23, s32, 13
    s_add_u32 s22, s22, s23
    v_mov_b32 v188, s22
    v_bfe_u32 v190, v0, 0, 6
    v_lshl_add_u32 v188, v190, 4, v188
    v_subrev_u32 v189, 8, v188
    buffer_load_dwordx2 v[96:97], v189, s[12:15], 0 offen offset:0
    buffer_load_dwordx4 v[98:101], v188, s[12:15], 0 offen offset:0
    buffer_load_dwordx2 v[102:103], v188, s[12:15], 0 offen offset:1016
    buffer_load_dwordx4 v[104:107], v188, s[12:15], 0 offen offset:1024
    v_add_u32 v188, 4096, v188
    v_subrev_u32 v189, 8, v188
    buffer_load_dwordx2 v[120:121], v189, s[12:15], 0 offen offset:0
    buffer_load_dwordx4 v[122:125], v188, s[12:15], 0 offen offset:0
    buffer_load_dwordx2 v[126:127], v188, s[12:15], 0 offen offset:1016
    buffer_load_dwordx4 v[128:131], v188, s[12:15], 0 offen offset:1024
Lhh_45:
    s_mov_b32 s45, s20
    s_lshl_b32 s42, s45, 4
    s_lshl_b32 s41, s40, 19
    s_add_u32 s41, s41, s42
    v_mov_b32 v1, s41
    v_bfe_u32 v31, v0, 0, 6
    v_lshl_add_u32 v1, v31, 13, v1
    s_barrier
    v_mov_b32 v14, 0
    v_mov_b32 v15, 0
    v_mov_b32 v16, 0
    v_mov_b32 v17, 0
    s_lshl_b32 s41, s40, 10
    v_mov_b32 v10, s41
    v_bfe_u32 v31, v0, 0, 6
    v_lshl_add_u32 v10, v31, 4, v10
    v_cmp_gt_u32 vcc, 2480, v10
    s_nop 0
    s_and_saveexec_b64 s[72:73], vcc
    ds_write_b128 v10, v[14:17] offset:0
    ds_write_b128 v10, v[14:17] offset:7600
    ds_write_b128 v10, v[14:17] offset:15200
    ds_write_b128 v10, v[14:17] offset:22800
    ds_write_b128 v10, v[14:17] offset:30400
    ds_write_b128 v10, v[14:17] offset:38000
    ds_write_b128 v10, v[14:17] offset:45600
    ds_write_b128 v10, v[14:17] offset:53200
    s_mov_b64 exec, 0xffff
    s_mul_i32 s43, s40, 16640
    s_add_u32 s43, s43, 60800
    s_add_u32 s41, s43, 4096
    v_mov_b32 v10, s41
    v_bfe_u32 v31, v0, 2, 2
    v_lshl_add_u32 v10, v31, 12, v10
    v_bfe_u32 v31, v0, 2, 2
    v_lshl_add_u32 v10, v31, 6, v10
    v_bfe_u32 v31, v0, 0, 2
    v_lshl_add_u32 v10, v31, 4, v10
    ds_write_b128 v10, v[14:17]
    s_mov_b64 exec, -1
    s_mul_i32 s41, s40, 1280
    s_add_u32 s41, s41, 2480
    v_mov_b32 v2, s41
    v_bfe_u32 v31, v0, 2, 4
    v_lshl_add_u32 v2, v31, 6, v2
    v_bfe_u32 v31, v0, 2, 4
    v_lshl_add_u32 v2, v31, 4, v2
    v_bfe_u32 v31, v0, 0, 2
    v_lshl_add_u32 v2, v31, 4, v2
    s_mul_i32 s41, s40, 640
    s_add_u32 s41, s41, 2480
    v_mov_b32 v8, s41
    v_bfe_u32 v31, v0, 3, 3
    v_lshl_add_u32 v8, v31, 6, v8
    v_bfe_u32 v31, v0, 3, 3
    v_lshl_add_u32 v8, v31, 4, v8
    v_bfe_u32 v31, v0, 0, 3
    v_lshl_add_u32 v8, v31, 3, v8
    v_and_b32 v10, 31, v0
    v_sub_u32 v10, 31, v10
    v_and_b32 v11, 3, v10
    v_and_b32 v10, 28, v10
    v_mul_u32_u24 v11, 4160, v11
    v_lshl_add_u32 v10, v10, 1, v11
    v_mov_b32 v3, s43
    v_bfe_u32 v31, v0, 5, 1
    v_lshl_add_u32 v3, v31, 4, v3
    v_add_u32 v3, v3, v10
    v_sub_u32 v10, 63, v0
    v_lshlrev_b32 v10, 4, v10
    v_add_u32 v7, s43, v10
    s_mul_i32 s42, s40, 15200
    v_mov_b32 v4, s42
    v_bfe_u32 v31, v0, 0, 5
    v_lshl_add_u32 v4, v31, 6, v4
    v_bfe_u32 v31, v0, 0, 5
    v_lshl_add_u32 v4, v31, 4, v4
    v_bfe_u32 v31, v0, 5, 1
    v_lshl_add_u32 v4, v31, 4, v4
    s_add_u32 s42, s42, 2480
    v_mov_b32 v5, s42
    v_bfe_u32 v31, v0, 0, 5
    v_lshl_add_u32 v5, v31, 6, v5
    v_bfe_u32 v31, v0, 0, 5
    v_lshl_add_u32 v5, v31, 4, v5
    v_bfe_u32 v31, v0, 5, 1
    v_lshl_add_u32 v5, v31, 3, v5
    s_mov_b32 s72, 0xffff
    s_waitcnt vmcnt(63) lgkmcnt(0)
    ds_write_b128 v2, v[144:147] offset:0
    ds_write_b128 v2, v[148:151] offset:7600
    ds_write_b128 v2, v[152:155] offset:15200
    ds_write_b128 v2, v[156:159] offset:22800
    ds_write_b128 v2, v[160:163] offset:30400
    ds_write_b128 v2, v[164:167] offset:38000
    ds_write_b128 v2, v[168:171] offset:45600
    ds_write_b128 v2, v[172:175] offset:53200
    v_lshlrev_b32 v32, 16, s68
    s_and_b32 s41, s68, 0xffff0000
    v_mov_b32 v33, s41
    v_lshlrev_b32 v34, 16, s69
    s_and_b32 s41, s69, 0xffff0000
    v_mov_b32 v35, s41
    v_lshlrev_b32 v36, 16, s70
    s_and_b32 s41, s70, 0xffff0000
    v_mov_b32 v37, s41
    v_lshlrev_b32 v38, 16, s71
    s_and_b32 s41, s71, 0xffff0000
    v_mov_b32 v39, s41
    s_waitcnt lgkmcnt(0)
    s_barrier
    s_waitcnt vmcnt(0)
    ds_read_b64 v[144:145], v8 offset:0
    ds_read_b64 v[146:147], v8 offset:7600
    ds_read_b64 v[148:149], v8 offset:15200
    ds_read_b64 v[150:151], v8 offset:22800
    ds_read_b64 v[152:153], v8 offset:30400
    ds_read_b64 v[154:155], v8 offset:38000
    ds_read_b64 v[156:157], v8 offset:45600
    ds_read_b64 v[158:159], v8 offset:53200
    s_mov_b32 s56, 0
L_cv2l:
    v_cmp_ne_u32 vcc, 0, v0
    s_nop 1
    v_cndmask_b32 v96, 0, v96, vcc
    v_cndmask_b32 v97, 0, v97, vcc
    v_alignbit_b32 v192, v101, v101, 16
    v_alignbit_b32 v193, v100, v100, 16
    v_alignbit_b32 v194, v99, v99, 16
    v_alignbit_b32 v195, v98, v98, 16
    ds_write_b128 v7, v[192:195] offset:3072
    v_bfi_b32 v196, s72, v101, v100
    v_bfi_b32 v197, s72, v100, v99
    v_bfi_b32 v198, s72, v99, v98
    v_bfi_b32 v199, s72, v98, v97
    ds_write_b128 v7, v[196:199] offset:7232
    v_alignbit_b32 v200, v100, v100, 16
    v_alignbit_b32 v201, v99, v99, 16
    v_alignbit_b32 v202, v98, v98, 16
    v_alignbit_b32 v203, v97, v97, 16
    ds_write_b128 v7, v[200:203] offset:11392
    v_bfi_b32 v204, s72, v100, v99
    v_bfi_b32 v205, s72, v99, v98
    v_bfi_b32 v206, s72, v98, v97
    v_bfi_b32 v207, s72, v97, v96
    ds_write_b128 v7, v[204:207] offset:15552
    s_waitcnt lgkmcnt(4)
    v_alignbit_b32 v208, v107, v107, 16
    v_alignbit_b32 v209, v106, v106, 16
    v_alignbit_b32 v210, v105, v105, 16
    v_alignbit_b32 v211, v104, v104, 16
    ds_write_b128 v7, v[208:211] offset:2048
    v_bfi_b32 v212, s72, v107, v106
    v_bfi_b32 v213, s72, v106, v105
    v_bfi_b32 v214, s72, v105, v104
    v_bfi_b32 v215, s72, v104, v103
    ds_write_b128 v7, v[212:215] offset:6208
    v_alignbit_b32 v216, v106, v106, 16
    v_alignbit_b32 v217, v105, v105, 16
    v_alignbit_b32 v218, v104, v104, 16
    v_alignbit_b32 v219, v103, v103, 16
    ds_write_b128 v7, v[216:219] offset:10368
    v_bfi_b32 v220, s72, v106, v105
    v_bfi_b32 v221, s72, v105, v104
    v_bfi_b32 v222, s72, v104, v103
    v_bfi_b32 v223, s72, v103, v102
    ds_write_b128 v7, v[220:223] offset:14528
    s_waitcnt lgkmcnt(4)
    s_waitcnt lgkmcnt(0)
    s_barrier
    ds_read_b64 v[192:193], v3 offset:4032
    ds_read_b64 v[194:195], v3 offset:4040
    ds_read_b128 v[196:199], v4 offset:2480
    ds_read_b64 v[200:201], v3 offset:4064
    ds_read_b64 v[202:203], v3 offset:4072
    ds_read_b128 v[204:207], v4 offset:2512
    ds_read_b64 v[208:209], v3 offset:3968
    ds_read_b64 v[210:211], v3 offset:3976
    ds_read_b128 v[212:215], v4 offset:2400
    ds_read_b64 v[216:217], v3 offset:4000
    ds_read_b64 v[218:219], v3 offset:4008
    ds_read_b128 v[220:223], v4 offset:2432
    s_waitcnt lgkmcnt(9)
    v_mfma_f32_32x32x16_bf16 v[56:71], v[192:195], v[196:199], 0
    ds_read_b64 v[224:225], v3 offset:3904
    ds_read_b64 v[226:227], v3 offset:3912
    ds_read_b128 v[228:231], v4 offset:2320
    v_mov_b32 v96, v120
    s_waitcnt lgkmcnt(9)
    v_mfma_f32_32x32x16_bf16 v[56:71], v[200:203], v[204:207], v[56:71]
    ds_read_b64 v[232:233], v3 offset:3936
    ds_read_b64 v[234:235], v3 offset:3944
    ds_read_b128 v[236:239], v4 offset:2352
    v_mov_b32 v97, v121
    s_waitcnt lgkmcnt(9)
    v_mfma_f32_32x32x16_bf16 v[56:71], v[208:211], v[212:215], v[56:71]
    ds_read_b64 v[192:193], v3 offset:3840
    ds_read_b64 v[194:195], v3 offset:3848
    ds_read_b128 v[196:199], v4 offset:2240
    v_mov_b32 v98, v122
    s_cmp_eq_u32 s56, 1
    s_cbranch_scc1 Lq_46
    buffer_load_dwordx4 v[40:43], v1, s[8:11], 0 offen
    v_add_u32 v1, 2048, v1
Lq_46:
    s_waitcnt lgkmcnt(9)
    v_mfma_f32_32x32x16_bf16 v[56:71], v[216:219], v[220:223], v[56:71]
    ds_read_b64 v[200:201], v3 offset:3872
    ds_read_b64 v[202:203], v3 offset:3880
    ds_read_b128 v[204:207], v4 offset:2272
    v_mov_b32 v99, v123
    s_waitcnt lgkmcnt(9)
    v_mfma_f32_32x32x16_bf16 v[56:71], v[224:227], v[228:231], v[56:71]
    ds_read_b64 v[208:209], v3 offset:3776
    ds_read_b64 v[210:211], v3 offset:3784
    ds_read_b128 v[212:215], v4 offset:2160
    v_mov_b32 v100, v124
    s_waitcnt lgkmcnt(9)
    v_mfma_f32_32x32x16_bf16 v[56:71], v[232:235], v[236:239], v[56:71]
    ds_read_b64 v[216:217], v3 offset:3808
    ds_read_b64 v[218:219], v3 offset:3816
    ds_read_b128 v[220:223], v4 offset:2192
    v_mov_b32 v101, v125
    s_waitcnt lgkmcnt(9)
    v_mfma_f32_32x32x16_bf16 v[56:71], v[192:195], v[196:199], v[56:71]
    ds_read_b64 v[224:225], v3 offset:3712
    ds_read_b64 v[226:227], v3 offset:3720
    ds_read_b128 v[228:231], v4 offset:2080
    v_mov_b32 v102, v126
    s_waitcnt lgkmcnt(9)
    v_mfma_f32_32x32x16_bf16 v[56:71], v[200:203], v[204:207], v[56:71]
    ds_read_b64 v[232:233], v3 offset:3744
    ds_read_b64 v[234:235], v3 offset:3752
    ds_read_b128 v[236:239], v4 offset:2112
    v_mov_b32 v103, v127
    s_waitcnt lgkmcnt(9)
    v_mfma_f32_32x32x16_bf16 v[56:71], v[208:211], v[212:215], v[56:71]
    ds_read_b64 v[192:193], v3 offset:3648
    ds_read_b64 v[194:195], v3 offset:3656
    ds_read_b128 v[196:199], v4 offset:2000
    v_mov_b32 v104, v128
    s_waitcnt lgkmcnt(9)
    v_mfma_f32_32x32x16_bf16 v[56:71], v[216:219], v[220:223], v[56:71]
    ds_read_b64 v[200:201], v3 offset:3680
    ds_read_b64 v[202:203], v3 offset:3688
    ds_read_b128 v[204:207], v4 offset:2032
    v_mov_b32 v105, v129
    s_waitcnt lgkmcnt(9)
    v_mfma_f32_32x32x16_bf16 v[56:71], v[224:227], v[228:231], v[56:71]
    ds_read_b64 v[208:209], v3 offset:3584
    ds_read_b64 v[210:211], v3 offset:3592
    ds_read_b128 v[212:215], v4 offset:1920
    v_mov_b32 v106, v130
    s_cmp_eq_u32 s56, 1
    s_cbranch_scc1 Lq_47
    buffer_load_dwordx4 v[44:47], v1, s[8:11], 0 offen
    v_add_u32 v1, 2048, v1
Lq_47:
    s_waitcnt lgkmcnt(9)
    v_mfma_f32_32x32x16_bf16 v[56:71], v[232:235], v[236:239], v[56:71]
    ds_read_b64 v[216:217], v3 offset:3616
    ds_read_b64 v[218:219], v3 offset:3624
    ds_read_b128 v[220:223], v4 offset:1952
    v_mov_b32 v107, v131
    s_waitcnt lgkmcnt(9)
    v_mfma_f32_32x32x16_bf16 v[56:71], v[192:195], v[196:199], v[56:71]
    ds_read_b64 v[224:225], v3 offset:3520
    ds_read_b64 v[226:227], v3 offset:3528
    ds_read_b128 v[228:231], v4 offset:1840
    s_waitcnt lgkmcnt(9)
    v_mfma_f32_32x32x16_bf16 v[56:71], v[200:203], v[204:207], v[56:71]
    ds_read_b64 v[232:233], v3 offset:3552
    ds_read_b64 v[234:235], v3 offset:3560
    ds_read_b128 v[236:239], v4 offset:1872
    s_waitcnt lgkmcnt(9)
    v_mfma_f32_32x32x16_bf16 v[56:71], v[208:211], v[212:215], v[56:71]
    ds_read_b64 v[192:193], v3 offset:3456
    ds_read_b64 v[194:195], v3 offset:3464
    ds_read_b128 v[196:199], v4 offset:1760
    s_waitcnt lgkmcnt(9)
    v_mfma_f32_32x32x16_bf16 v[56:71], v[216:219], v[220:223], v[56:71]
    ds_read_b64 v[200:201], v3 offset:3488
    ds_read_b64 v[202:203], v3 offset:3496
    ds_read_b128 v[204:207], v4 offset:1792
    s_waitcnt lgkmcnt(9)
    v_mfma_f32_32x32x16_bf16 v[56:71], v[224:227], v[228:231], v[56:71]
    ds_read_b64 v[208:209], v3 offset:3392
    ds_read_b64 v[210:211], v3 offset:3400
    ds_read_b128 v[212:215], v4 offset:1680
    s_waitcnt lgkmcnt(9)
    v_mfma_f32_32x32x16_bf16 v[56:71], v[232:235], v[236:239], v[56:71]
    ds_read_b64 v[216:217], v3 offset:3424
    ds_read_b64 v[218:219], v3 offset:3432
    ds_read_b128 v[220:223], v4 offset:1712
    s_waitcnt lgkmcnt(9)
    v_mfma_f32_32x32x16_bf16 v[56:71], v[192:195], v[196:199], v[56:71]
    ds_read_b64 v[224:225], v3 offset:3328
    ds_read_b64 v[226:227], v3 offset:3336
    ds_read_b128 v[228:231], v4 offset:1600
    s_cmp_eq_u32 s56, 1
    s_cbranch_scc1 Lq_48
    buffer_load_dwordx4 v[48:51], v1, s[8:11], 0 offen
    v_add_u32 v1, 2048, v1
Lq_48:
    s_waitcnt lgkmcnt(9)
    v_mfma_f32_32x32x16_bf16 v[56:71], v[200:203], v[204:207], v[56:71]
    ds_read_b64 v[232:233], v3 offset:3360
    ds_read_b64 v[234:235], v3 offset:3368
    ds_read_b128 v[236:239], v4 offset:1632
    s_waitcnt lgkmcnt(9)
    v_mfma_f32_32x32x16_bf16 v[56:71], v[208:211], v[212:215], v[56:71]
    ds_read_b64 v[192:193], v3 offset:3264
    ds_read_b64 v[194:195], v3 offset:3272
    ds_read_b128 v[196:199], v4 offset:1520
    s_waitcnt lgkmcnt(9)
    v_mfma_f32_32x32x16_bf16 v[56:71], v[216:219], v[220:223], v[56:71]
    ds_read_b64 v[200:201], v3 offset:3296
    ds_read_b64 v[202:203], v3 offset:3304
    ds_read_b128 v[204:207], v4 offset:1552
    s_waitcnt lgkmcnt(9)
    v_mfma_f32_32x32x16_bf16 v[56:71], v[224:227], v[228:231], v[56:71]
    ds_read_b64 v[208:209], v3 offset:3200
    ds_read_b64 v[210:211], v3 offset:3208
    ds_read_b128 v[212:215], v4 offset:1440
    s_waitcnt lgkmcnt(9)
    v_mfma_f32_32x32x16_bf16 v[56:71], v[232:235], v[236:239], v[56:71]
    ds_read_b64 v[216:217], v3 offset:3232
    ds_read_b64 v[218:219], v3 offset:3240
    ds_read_b128 v[220:223], v4 offset:1472
    s_waitcnt lgkmcnt(9)
    v_mfma_f32_32x32x16_bf16 v[56:71], v[192:195], v[196:199], v[56:71]
    ds_read_b64 v[224:225], v3 offset:3136
    ds_read_b64 v[226:227], v3 offset:3144
    ds_read_b128 v[228:231], v4 offset:1360
    s_waitcnt lgkmcnt(9)
    v_mfma_f32_32x32x16_bf16 v[56:71], v[200:203], v[204:207], v[56:71]
    ds_read_b64 v[232:233], v3 offset:3168
    ds_read_b64 v[234:235], v3 offset:3176
    ds_read_b128 v[236:239], v4 offset:1392
    s_waitcnt lgkmcnt(9)
    v_mfma_f32_32x32x16_bf16 v[56:71], v[208:211], v[212:215], v[56:71]
    ds_read_b64 v[192:193], v3 offset:3072
    ds_read_b64 v[194:195], v3 offset:3080
    ds_read_b128 v[196:199], v4 offset:1280
    s_cmp_eq_u32 s56, 1
    s_cbranch_scc1 Lq_49
    buffer_load_dwordx4 v[52:55], v1, s[8:11], 0 offen
    v_add_u32 v1, 2048, v1
Lq_49:
    s_waitcnt lgkmcnt(9)
    v_mfma_f32_32x32x16_bf16 v[56:71], v[216:219], v[220:223], v[56:71]
    ds_read_b64 v[200:201], v3 offset:3104
    ds_read_b64 v[202:203], v3 offset:3112
    ds_read_b128 v[204:207], v4 offset:1312
    s_waitcnt lgkmcnt(9)
    v_mfma_f32_32x32x16_bf16 v[56:71], v[224:227], v[228:231], v[56:71]
    ds_read_b64 v[208:209], v3 offset:3008
    ds_read_b64 v[210:211], v3 offset:3016
    ds_read_b128 v[212:215], v4 offset:1200
    s_waitcnt lgkmcnt(9)
    v_mfma_f32_32x32x16_bf16 v[56:71], v[232:235], v[236:239], v[56:71]
    ds_read_b64 v[216:217], v3 offset:3040
    ds_read_b64 v[218:219], v3 offset:3048
    ds_read_b128 v[220:223], v4 offset:1232
    s_waitcnt lgkmcnt(9)
    v_mfma_f32_32x32x16_bf16 v[56:71], v[192:195], v[196:199], v[56:71]
    ds_read_b64 v[224:225], v3 offset:2944
    ds_read_b64 v[226:227], v3 offset:2952
    ds_read_b128 v[228:231], v4 offset:1120
    s_waitcnt lgkmcnt(9)
    v_mfma_f32_32x32x16_bf16 v[56:71], v[200:203], v[204:207], v[56:71]
    ds_read_b64 v[232:233], v3 offset:2976
    ds_read_b64 v[234:235], v3 offset:2984
    ds_read_b128 v[236:239], v4 offset:1152
    s_waitcnt lgkmcnt(9)
    v_mfma_f32_32x32x16_bf16 v[56:71], v[208:211], v[212:215], v[56:71]
    ds_read_b64 v[192:193], v3 offset:2880
    ds_read_b64 v[194:195], v3 offset:2888
    ds_read_b128 v[196:199], v4 offset:1040
    s_waitcnt lgkmcnt(9)
    v_mfma_f32_32x32x16_bf16 v[56:71], v[216:219], v[220:223], v[56:71]
    ds_read_b64 v[200:201], v3 offset:2912
    ds_read_b64 v[202:203], v3 offset:2920
    ds_read_b128 v[204:207], v4 offset:1072
    s_waitcnt lgkmcnt(9)
    v_mfma_f32_32x32x16_bf16 v[56:71], v[224:227], v[228:231], v[56:71]
    ds_read_b64 v[208:209], v3 offset:2816
    ds_read_b64 v[210:211], v3 offset:2824
    ds_read_b128 v[212:215], v4 offset:960
    s_waitcnt lgkmcnt(9)
    v_mfma_f32_32x32x16_bf16 v[56:71], v[232:235], v[236:239], v[56:71]
    ds_read_b64 v[216:217], v3 offset:2848
    ds_read_b64 v[218:219], v3 offset:2856
    ds_read_b128 v[220:223], v4 offset:992
    s_waitcnt lgkmcnt(9)
    v_mfma_f32_32x32x16_bf16 v[56:71], v[192:195], v[196:199], v[56:71]
    ds_read_b64 v[224:225], v3 offset:2752
    ds_read_b64 v[226:227], v3 offset:2760
    ds_read_b128 v[228:231], v4 offset:880
    s_waitcnt lgkmcnt(9)
    v_mfma_f32_32x32x16_bf16 v[56:71], v[200:203], v[204:207], v[56:71]
    ds_read_b64 v[232:233], v3 offset:2784
    ds_read_b64 v[234:235], v3 offset:2792
    ds_read_b128 v[236:239], v4 offset:912
    s_waitcnt lgkmcnt(9)
    v_mfma_f32_32x32x16_bf16 v[56:71], v[208:211], v[212:215], v[56:71]
    ds_read_b64 v[192:193], v3 offset:2688
    ds_read_b64 v[194:195], v3 offset:2696
    ds_read_b128 v[196:199], v4 offset:800
    s_waitcnt lgkmcnt(9)
    v_mfma_f32_32x32x16_bf16 v[56:71], v[216:219], v[220:223], v[56:71]
    ds_read_b64 v[200:201], v3 offset:2720
    ds_read_b64 v[202:203], v3 offset:2728
    ds_read_b128 v[204:207], v4 offset:832
    s_waitcnt lgkmcnt(9)
    v_mfma_f32_32x32x16_bf16 v[56:71], v[224:227], v[228:231], v[56:71]
    ds_read_b64 v[208:209], v3 offset:2624
    ds_read_b64 v[210:211], v3 offset:2632
    ds_read_b128 v[212:215], v4 offset:720
    s_waitcnt lgkmcnt(9)
    v_mfma_f32_32x32x16_bf16 v[56:71], v[232:235], v[236:239], v[56:71]
    ds_read_b64 v[216:217], v3 offset:2656
    ds_read_b64 v[218:219], v3 offset:2664
    ds_read_b128 v[220:223], v4 offset:752
    s_waitcnt lgkmcnt(9)
    v_mfma_f32_32x32x16_bf16 v[56:71], v[192:195], v[196:199], v[56:71]
    ds_read_b64 v[224:225], v3 offset:2560
    ds_read_b64 v[226:227], v3 offset:2568
    ds_read_b128 v[228:231], v4 offset:640
    s_waitcnt lgkmcnt(9)
    v_mfma_f32_32x32x16_bf16 v[56:71], v[200:203], v[204:207], v[56:71]
    ds_read_b64 v[232:233], v3 offset:2592
    ds_read_b64 v[234:235], v3 offset:2600
    ds_read_b128 v[236:239], v4 offset:672
    s_waitcnt lgkmcnt(9)
    v_mfma_f32_32x32x16_bf16 v[56:71], v[208:211], v[212:215], v[56:71]
    ds_read_b64 v[192:193], v3 offset:2496
    ds_read_b64 v[194:195], v3 offset:2504
    ds_read_b128 v[196:199], v4 offset:560
    s_waitcnt lgkmcnt(9)
    v_mfma_f32_32x32x16_bf16 v[56:71], v[216:219], v[220:223], v[56:71]
    ds_read_b64 v[200:201], v3 offset:2528
    ds_read_b64 v[202:203], v3 offset:2536
    ds_read_b128 v[204:207], v4 offset:592
    s_waitcnt lgkmcnt(9)
    v_mfma_f32_32x32x16_bf16 v[56:71], v[224:227], v[228:231], v[56:71]
    ds_read_b64 v[208:209], v3 offset:2432
    ds_read_b64 v[210:211], v3 offset:2440
    ds_read_b128 v[212:215], v4 offset:480
    s_waitcnt lgkmcnt(9)
    v_mfma_f32_32x32x16_bf16 v[56:71], v[232:235], v[236:239], v[56:71]
    ds_read_b64 v[216:217], v3 offset:2464
    ds_read_b64 v[218:219], v3 offset:2472
    ds_read_b128 v[220:223], v4 offset:512
    s_waitcnt lgkmcnt(9)
    v_mfma_f32_32x32x16_bf16 v[56:71], v[192:195], v[196:199], v[56:71]
    ds_read_b64 v[224:225], v3 offset:2368
    ds_read_b64 v[226:227], v3 offset:2376
    ds_read_b128 v[228:231], v4 offset:400
    s_waitcnt lgkmcnt(9)
    v_mfma_f32_32x32x16_bf16 v[56:71], v[200:203], v[204:207], v[56:71]
    ds_read_b64 v[232:233], v3 offset:2400
    ds_read_b64 v[234:235], v3 offset:2408
    ds_read_b128 v[236:239], v4 offset:432
    s_waitcnt lgkmcnt(9)
    v_mfma_f32_32x32x16_bf16 v[56:71], v[208:211], v[212:215], v[56:71]
    ds_read_b64 v[192:193], v3 offset:2304
    ds_read_b64 v[194:195], v3 offset:2312
    ds_read_b128 v[196:199], v4 offset:320
    s_waitcnt lgkmcnt(9)
    v_mfma_f32_32x32x16_bf16 v[56:71], v[216:219], v[220:223], v[56:71]
    ds_read_b64 v[200:201], v3 offset:2336
    ds_read_b64 v[202:203], v3 offset:2344
    ds_read_b128 v[204:207], v4 offset:352
    s_waitcnt lgkmcnt(9)
    v_mfma_f32_32x32x16_bf16 v[56:71], v[224:227], v[228:231], v[56:71]
    ds_read_b64 v[208:209], v3 offset:2240
    ds_read_b64 v[210:211], v3 offset:2248
    ds_read_b128 v[212:215], v4 offset:240
    s_waitcnt lgkmcnt(9)
    v_mfma_f32_32x32x16_bf16 v[56:71], v[232:235], v[236:239], v[56:71]
    ds_read_b64 v[216:217], v3 offset:2272
    ds_read_b64 v[218:219], v3 offset:2280
    ds_read_b128 v[220:223], v4 offset:272
    s_waitcnt lgkmcnt(9)
    v_mfma_f32_32x32x16_bf16 v[56:71], v[192:195], v[196:199], v[56:71]
    ds_read_b64 v[224:225], v3 offset:2176
    ds_read_b64 v[226:227], v3 offset:2184
    ds_read_b128 v[228:231], v4 offset:160
    s_waitcnt lgkmcnt(9)
    v_mfma_f32_32x32x16_bf16 v[56:71], v[200:203], v[204:207], v[56:71]
    ds_read_b64 v[232:233], v3 offset:2208
    ds_read_b64 v[234:235], v3 offset:2216
    ds_read_b128 v[236:239], v4 offset:192
    s_waitcnt lgkmcnt(9)
    v_mfma_f32_32x32x16_bf16 v[56:71], v[208:211], v[212:215], v[56:71]
    ds_read_b64 v[192:193], v3 offset:2112
    ds_read_b64 v[194:195], v3 offset:2120
    ds_read_b128 v[196:199], v4 offset:80
    s_waitcnt lgkmcnt(9)
    v_mfma_f32_32x32x16_bf16 v[56:71], v[216:219], v[220:223], v[56:71]
    ds_read_b64 v[200:201], v3 offset:2144
    ds_read_b64 v[202:203], v3 offset:2152
    ds_read_b128 v[204:207], v4 offset:112
    s_waitcnt lgkmcnt(9)
    v_mfma_f32_32x32x16_bf16 v[56:71], v[224:227], v[228:231], v[56:71]
    ds_read_b64 v[208:209], v3 offset:2048
    ds_read_b64 v[210:211], v3 offset:2056
    ds_read_b128 v[212:215], v4 offset:0
    s_waitcnt lgkmcnt(9)
    v_mfma_f32_32x32x16_bf16 v[56:71], v[232:235], v[236:239], v[56:71]
    ds_read_b64 v[216:217], v3 offset:2080
    ds_read_b64 v[218:219], v3 offset:2088
    ds_read_b128 v[220:223], v4 offset:32
    s_waitcnt lgkmcnt(9)
    v_mfma_f32_32x32x16_bf16 v[56:71], v[192:195], v[196:199], v[56:71]
    s_waitcnt lgkmcnt(6)
    v_mfma_f32_32x32x16_bf16 v[56:71], v[200:203], v[204:207], v[56:71]
    s_waitcnt lgkmcnt(3)
    v_mfma_f32_32x32x16_bf16 v[56:71], v[208:211], v[212:215], v[56:71]
    s_waitcnt lgkmcnt(0)
    v_mfma_f32_32x32x16_bf16 v[56:71], v[216:219], v[220:223], v[56:71]
    s_nop 11
    v_cvt_pk_bf16_f32 v56, v56, v57
    v_cvt_pk_bf16_f32 v57, v58, v59
    ds_write_b64 v5, v[56:57] offset:0
    v_cvt_pk_bf16_f32 v60, v60, v61
    v_cvt_pk_bf16_f32 v61, v62, v63
    ds_write_b64 v5, v[60:61] offset:16
    v_cvt_pk_bf16_f32 v64, v64, v65
    v_cvt_pk_bf16_f32 v65, v66, v67
    ds_write_b64 v5, v[64:65] offset:32
    v_cvt_pk_bf16_f32 v68, v68, v69
    v_cvt_pk_bf16_f32 v69, v70, v71
    ds_write_b64 v5, v[68:69] offset:48
    v_add_u32 v4, 7600, v4
    v_add_u32 v5, 7600, v5
    s_add_u32 s56, s56, 1
    s_cmp_lt_u32 s56, 2
    s_cbranch_scc1 L_cv2l
    s_waitcnt lgkmcnt(0)
    s_barrier
    ds_read_b64 v[56:57], v8 offset:0
    ds_read_b64 v[58:59], v8 offset:7600
    ds_read_b64 v[60:61], v8 offset:15200
    ds_read_b64 v[62:63], v8 offset:22800
    ds_read_b64 v[64:65], v8 offset:30400
    ds_read_b64 v[66:67], v8 offset:38000
    ds_read_b64 v[68:69], v8 offset:45600
    ds_read_b64 v[70:71], v8 offset:53200
    s_lshl_b32 s41, s40, 20
    s_lshl_b32 s42, s45, 4
    s_add_u32 s41, s41, s42
    v_bfe_u32 v31, v0, 0, 6
    v_lshlrev_b32 v1, 14, v31
    s_waitcnt vmcnt(0) lgkmcnt(0)
    v_lshlrev_b32 v192, 16, v56
    v_and_b32 v193, 0xffff0000, v56
    v_lshlrev_b32 v194, 16, v144
    v_and_b32 v195, 0xffff0000, v144
    v_fma_f32 v192, v194, v32, v192
    v_fma_f32 v193, v195, v32, v193
    v_lshlrev_b32 v196, 16, v58
    v_and_b32 v197, 0xffff0000, v58
    v_lshlrev_b32 v198, 16, v146
    v_and_b32 v199, 0xffff0000, v146
    v_fma_f32 v196, v198, v33, v196
    v_fma_f32 v197, v199, v33, v197
    v_lshlrev_b32 v200, 16, v40
    v_and_b32 v201, 0xffff0000, v40
    v_mul_f32 v200, v200, v192
    v_mul_f32 v201, v201, v196
    v_cvt_pk_bf16_f32 v40, v200, v201
    v_lshlrev_b32 v200, 16, v44
    v_and_b32 v201, 0xffff0000, v44
    v_mul_f32 v200, v200, v193
    v_mul_f32 v201, v201, v197
    v_cvt_pk_bf16_f32 v44, v200, v201
    v_lshlrev_b32 v204, 16, v60
    v_and_b32 v205, 0xffff0000, v60
    v_lshlrev_b32 v206, 16, v148
    v_and_b32 v207, 0xffff0000, v148
    v_fma_f32 v204, v206, v34, v204
    v_fma_f32 v205, v207, v34, v205
    v_lshlrev_b32 v208, 16, v62
    v_and_b32 v209, 0xffff0000, v62
    v_lshlrev_b32 v210, 16, v150
    v_and_b32 v211, 0xffff0000, v150
    v_fma_f32 v208, v210, v35, v208
    v_fma_f32 v209, v211, v35, v209
    v_lshlrev_b32 v212, 16, v41
    v_and_b32 v213, 0xffff0000, v41
    v_mul_f32 v212, v212, v204
    v_mul_f32 v213, v213, v208
    v_cvt_pk_bf16_f32 v41, v212, v213
    v_lshlrev_b32 v212, 16, v45
    v_and_b32 v213, 0xffff0000, v45
    v_mul_f32 v212, v212, v205
    v_mul_f32 v213, v213, v209
    v_cvt_pk_bf16_f32 v45, v212, v213
    v_lshlrev_b32 v192, 16, v64
    v_and_b32 v193, 0xffff0000, v64
    v_lshlrev_b32 v194, 16, v152
    v_and_b32 v195, 0xffff0000, v152
    v_fma_f32 v192, v194, v36, v192
    v_fma_f32 v193, v195, v36, v193
    v_lshlrev_b32 v196, 16, v66
    v_and_b32 v197, 0xffff0000, v66
    v_lshlrev_b32 v198, 16, v154
    v_and_b32 v199, 0xffff0000, v154
    v_fma_f32 v196, v198, v37, v196
    v_fma_f32 v197, v199, v37, v197
    v_lshlrev_b32 v200, 16, v42
    v_and_b32 v201, 0xffff0000, v42
    v_mul_f32 v200, v200, v192
    v_mul_f32 v201, v201, v196
    v_cvt_pk_bf16_f32 v42, v200, v201
    v_lshlrev_b32 v200, 16, v46
    v_and_b32 v201, 0xffff0000, v46
    v_mul_f32 v200, v200, v193
    v_mul_f32 v201, v201, v197
    v_cvt_pk_bf16_f32 v46, v200, v201
    v_lshlrev_b32 v204, 16, v68
    v_and_b32 v205, 0xffff0000, v68
    v_lshlrev_b32 v206, 16, v156
    v_and_b32 v207, 0xffff0000, v156
    v_fma_f32 v204, v206, v38, v204
    v_fma_f32 v205, v207, v38, v205
    v_lshlrev_b32 v208, 16, v70
    v_and_b32 v209, 0xffff0000, v70
    v_lshlrev_b32 v210, 16, v158
    v_and_b32 v211, 0xffff0000, v158
    v_fma_f32 v208, v210, v39, v208
    v_fma_f32 v209, v211, v39, v209
    v_lshlrev_b32 v212, 16, v43
    v_and_b32 v213, 0xffff0000, v43
    v_mul_f32 v212, v212, v204
    v_mul_f32 v213, v213, v208
    v_cvt_pk_bf16_f32 v43, v212, v213
    v_lshlrev_b32 v212, 16, v47
    v_and_b32 v213, 0xffff0000, v47
    v_mul_f32 v212, v212, v205
    v_mul_f32 v213, v213, v209
    v_cvt_pk_bf16_f32 v47, v212, v213
    buffer_store_dwordx4 v[40:43], v1, s[80:83], s41 offen
    s_add_u32 s41, s41, 4096
    buffer_store_dwordx4 v[44:47], v1, s[80:83], s41 offen
    s_add_u32 s41, s41, 4096
    v_lshlrev_b32 v192, 16, v57
    v_and_b32 v193, 0xffff0000, v57
    v_lshlrev_b32 v194, 16, v145
    v_and_b32 v195, 0xffff0000, v145
    v_fma_f32 v192, v194, v32, v192
    v_fma_f32 v193, v195, v32, v193
    v_lshlrev_b32 v196, 16, v59
    v_and_b32 v197, 0xffff0000, v59
    v_lshlrev_b32 v198, 16, v147
    v_and_b32 v199, 0xffff0000, v147
    v_fma_f32 v196, v198, v33, v196
    v_fma_f32 v197, v199, v33, v197
    v_lshlrev_b32 v200, 16, v48
    v_and_b32 v201, 0xffff0000, v48
    v_mul_f32 v200, v200, v192
    v_mul_f32 v201, v201, v196
    v_cvt_pk_bf16_f32 v48, v200, v201
    v_lshlrev_b32 v200, 16, v52
    v_and_b32 v201, 0xffff0000, v52
    v_mul_f32 v200, v200, v193
    v_mul_f32 v201, v201, v197
    v_cvt_pk_bf16_f32 v52, v200, v201
    v_lshlrev_b32 v204, 16, v61
    v_and_b32 v205, 0xffff0000, v61
    v_lshlrev_b32 v206, 16, v149
    v_and_b32 v207, 0xffff0000, v149
    v_fma_f32 v204, v206, v34, v204
    v_fma_f32 v205, v207, v34, v205
    v_lshlrev_b32 v208, 16, v63
    v_and_b32 v209, 0xffff0000, v63
    v_lshlrev_b32 v210, 16, v151
    v_and_b32 v211, 0xffff0000, v151
    v_fma_f32 v208, v210, v35, v208
    v_fma_f32 v209, v211, v35, v209
    v_lshlrev_b32 v212, 16, v49
    v_and_b32 v213, 0xffff0000, v49
    v_mul_f32 v212, v212, v204
    v_mul_f32 v213, v213, v208
    v_cvt_pk_bf16_f32 v49, v212, v213
    v_lshlrev_b32 v212, 16, v53
    v_and_b32 v213, 0xffff0000, v53
    v_mul_f32 v212, v212, v205
    v_mul_f32 v213, v213, v209
    v_cvt_pk_bf16_f32 v53, v212, v213
    v_lshlrev_b32 v192, 16, v65
    v_and_b32 v193, 0xffff0000, v65
    v_lshlrev_b32 v194, 16, v153
    v_and_b32 v195, 0xffff0000, v153
    v_fma_f32 v192, v194, v36, v192
    v_fma_f32 v193, v195, v36, v193
    v_lshlrev_b32 v196, 16, v67
    v_and_b32 v197, 0xffff0000, v67
    v_lshlrev_b32 v198, 16, v155
    v_and_b32 v199, 0xffff0000, v155
    v_fma_f32 v196, v198, v37, v196
    v_fma_f32 v197, v199, v37, v197
    v_lshlrev_b32 v200, 16, v50
    v_and_b32 v201, 0xffff0000, v50
    v_mul_f32 v200, v200, v192
    v_mul_f32 v201, v201, v196
    v_cvt_pk_bf16_f32 v50, v200, v201
    v_lshlrev_b32 v200, 16, v54
    v_and_b32 v201, 0xffff0000, v54
    v_mul_f32 v200, v200, v193
    v_mul_f32 v201, v201, v197
    v_cvt_pk_bf16_f32 v54, v200, v201
    v_lshlrev_b32 v204, 16, v69
    v_and_b32 v205, 0xffff0000, v69
    v_lshlrev_b32 v206, 16, v157
    v_and_b32 v207, 0xffff0000, v157
    v_fma_f32 v204, v206, v38, v204
    v_fma_f32 v205, v207, v38, v205
    v_lshlrev_b32 v208, 16, v71
    v_and_b32 v209, 0xffff0000, v71
    v_lshlrev_b32 v210, 16, v159
    v_and_b32 v211, 0xffff0000, v159
    v_fma_f32 v208, v210, v39, v208
    v_fma_f32 v209, v211, v39, v209
    v_lshlrev_b32 v212, 16, v51
    v_and_b32 v213, 0xffff0000, v51
    v_mul_f32 v212, v212, v204
    v_mul_f32 v213, v213, v208
    v_cvt_pk_bf16_f32 v51, v212, v213
    v_lshlrev_b32 v212, 16, v55
    v_and_b32 v213, 0xffff0000, v55
    v_mul_f32 v212, v212, v205
    v_mul_f32 v213, v213, v209
    v_cvt_pk_bf16_f32 v55, v212, v213
    buffer_store_dwordx4 v[48:51], v1, s[80:83], s41 offen
    s_add_u32 s41, s41, 4096
    buffer_store_dwordx4 v[52:55], v1, s[80:83], s41 offen
    s_add_u32 s41, s41, 4096
    s_endpgm
L_side:
    s_sub_u32 s53, s3, 4
    s_lshr_b32 s54, s2, 3
    s_mov_b32 s55, 400000
    s_mov_b32 s40, s100
    s_lshr_b32 s62, s54, 1
    s_lshl_b32 s41, s53, 4
    s_add_u32 s62, s62, s41
    s_bfe_u32 s63, s62, 0x40001
    s_lshl_b32 s63, s63, 10
    s_add_u32 s63, s63, 0x4dc0000
    v_lshrrev_b32 v20, 3, v0
    v_xor_b32 v8, v0, v20
    v_and_b32 v8, 7, v8
    v_lshlrev_b32 v8, 4, v8
    v_lshl_add_u32 v8, v20, 11, v8
    s_mul_i32 s41, s40, 65536
    v_add_u32 v8, s41, v8
    v_add_u32 v9, 0x4000, v8
    v_add_u32 v10, 0x8000, v8
    v_add_u32 v11, 0xc000, v8
    s_mul_i32 s49, s40, 4096
    v_lshrrev_b32 v20, 4, v0
    s_and_b32 s41, s40, 1
    s_lshl_b32 s42, s41, 2
    v_or_b32 v21, s42, v20
    v_lshlrev_b32 v21, 1, v21
    v_xor_b32 v16, v0, v21
    v_and_b32 v16, 15, v16
    v_lshlrev_b32 v16, 4, v16
    v_lshl_add_u32 v16, v20, 13, v16
    s_lshl_b32 s41, s41, 3
    s_lshr_b32 s42, s40, 1
    s_lshl_b32 s42, s42, 2
    s_add_u32 s41, s41, s42
    s_lshl_b32 s42, s41, 13
    v_add_u32 v16, s42, v16
    v_add_u32 v17, 0x20000, v16
    v_add_u32 v18, 0x40000, v16
    v_add_u32 v19, 0x60000, v16
    s_lshl_b32 s50, s41, 8
    s_add_u32 s50, s50, 16384
    v_lshrrev_b32 v20, 4, v0
    v_xor_b32 v1, v0, v20
    v_and_b32 v1, 7, v1
    v_lshlrev_b32 v1, 4, v1
    v_and_b32 v20, 15, v0
    v_lshl_add_u32 v1, v20, 7, v1
    s_and_b32 s41, s40, 1
    s_mul_i32 s41, s41, 8192
    v_add_u32 v1, s41, v1
    v_xor_b32 v2, 64, v1
    v_bfe_u32 v21, v0, 2, 3
    v_lshlrev_b32 v20, 0, v21
    s_lshr_b32 s41, s40, 1
    s_lshl_b32 s41, s41, 2
    v_xor_b32 v20, s41, v20
    v_mov_b32 v22, 16384
    v_bfe_u32 v21, v0, 4, 2
    v_lshl_add_u32 v22, v21, 11, v22
    v_bfe_u32 v21, v0, 2, 2
    v_lshl_add_u32 v22, v21, 8, v22
    v_bfe_u32 v21, v0, 0, 2
    v_lshl_add_u32 v22, v21, 3, v22
    v_xor_b32 v23, 0, v20
    v_lshl_add_u32 v4, v23, 5, v22
    v_xor_b32 v23, 1, v20
    v_lshl_add_u32 v5, v23, 5, v22
    v_xor_b32 v23, 2, v20
    v_lshl_add_u32 v6, v23, 5, v22
    v_xor_b32 v23, 3, v20
    v_lshl_add_u32 v7, v23, 5, v22
    v_lshlrev_b32 v3, 4, v0
    s_mov_b32 s79, 0x10000000
    s_mov_b32 s14, 0x4000000
    s_and_b32 s41, s40, 1
    s_mul_i32 s41, s41, 8192
    v_subrev_u32 v1, s41, v1
    v_subrev_u32 v2, s41, v2
    s_sub_u32 s50, s50, 16384
    v_bfe_u32 v21, v0, 2, 3
    v_lshlrev_b32 v20, 0, v21
    s_lshl_b32 s41, s40, 1
    v_xor_b32 v20, s41, v20
    v_bfe_u32 v21, v0, 4, 2
    v_lshlrev_b32 v22, 11, v21
    v_bfe_u32 v21, v0, 2, 2
    v_lshl_add_u32 v22, v21, 8, v22
    v_bfe_u32 v21, v0, 0, 2
    v_lshl_add_u32 v22, v21, 3, v22
    v_xor_b32 v23, 0, v20
    v_lshl_add_u32 v4, v23, 5, v22
    v_add_u32 v6, 0x10000, v4
    v_xor_b32 v23, 1, v20
    v_lshl_add_u32 v5, v23, 5, v22
    v_add_u32 v7, 0x10000, v5
    v_add_u32 v1, 0x20000, v1
    v_add_u32 v2, 0x20000, v2
    v_mov_b32 v24, -1
    v_mov_b32 v25, -1
    v_mov_b32 v26, -1
    v_mov_b32 v27, -1
    s_cmp_ge_u32 s62, 32
    s_cselect_b64 s[36:37], s[16:17], s[12:13]
    s_and_b32 s41, s62, 31
    s_lshl_b32 s46, s41, 8
    s_lshl_b32 s41, s41, 12
    s_lshr_b32 s42, s62, 5
    s_lshl_b32 s60, s42, 24
    s_add_u32 s60, s60, s41
    s_lshl_b32 s42, s42, 11
    s_add_u32 s61, s41, s42
    s_lshl_b32 s41, s40, 10
    s_add_u32 s60, s60, s41
    s_and_b32 s41, s41, 1024
    s_add_u32 s61, s61, s41
    s_lshr_b32 s41, s40, 1
    s_lshl_b32 s41, s41, 17
    s_add_u32 s61, s61, s41
    s_add_u32 s61, s61, 0x4000000
    s_and_b32 s57, s54, 1
    s_mov_b32 s58, 2
    s_mov_b32 s56, 0
    s_mov_b32 s71, 0x10000000
    s_lshl_b32 s45, s57, 17
    s_lshr_b32 s41, s40, 1
    s_lshl_b32 s41, s41, 22
    s_add_u32 s45, s45, s41
    s_add_u32 s70, s45, 0x40000
    s_lshl_b32 s48, s57, 19
    s_add_u32 s48, s48, s60
    s_lshl_b32 s72, s57, 18
    s_add_u32 s72, s72, s61
    s_add_u32 s57, s57, 2
    s_lshl_b32 s74, s57, 18
    s_lshl_b32 s68, s57, 20
    s_add_u32 s68, s68, s60
    s_lshl_b32 s73, s57, 19
    s_add_u32 s73, s73, s61
    s_lshl_b32 s69, s57, 6
    s_add_u32 s69, s69, s63
    s_add_u32 s57, s57, s58
    s_mov_b32 s51, s74
    s_branch L_phase0
L_phase:
    s_lshl_b32 s74, s57, 18
    s_lshl_b32 s68, s57, 20
    s_add_u32 s68, s68, s60
    s_lshl_b32 s73, s57, 19
    s_add_u32 s73, s73, s61
    s_lshl_b32 s69, s57, 6
    s_add_u32 s69, s69, s63
    s_add_u32 s57, s57, s58
    s_mov_b32 s45, s74
L_phase0:
    s_barrier
    s_add_u32 m0, s50, 0
    s_nop 0
    buffer_load_dwordx4 v16, s[36:39], s46 offen lds
    s_add_u32 m0, s50, 4096
    s_nop 0
    buffer_load_dwordx4 v17, s[36:39], s46 offen lds
    s_add_u32 m0, s50, 8192
    s_nop 0
    buffer_load_dwordx4 v18, s[36:39], s46 offen lds
    s_add_u32 m0, s50, 12288
    s_nop 0
    buffer_load_dwordx4 v19, s[36:39], s46 offen lds
    s_add_u32 s46, s46, 0x80000
    s_add_u32 m0, s50, 16384
    s_nop 0
    buffer_load_dwordx4 v16, s[36:39], s46 offen lds
    s_add_u32 m0, s50, 20480
    s_nop 0
    buffer_load_dwordx4 v17, s[36:39], s46 offen lds
    s_add_u32 m0, s50, 24576
    s_nop 0
    buffer_load_dwordx4 v18, s[36:39], s46 offen lds
    s_add_u32 m0, s50, 28672
    s_nop 0
    buffer_load_dwordx4 v19, s[36:39], s46 offen lds
    s_add_u32 s46, s46, 0x80000
    s_add_u32 m0, s50, 32768
    s_nop 0
    buffer_load_dwordx4 v16, s[36:39], s46 offen lds
    s_add_u32 m0, s50, 36864
    s_nop 0
    buffer_load_dwordx4 v17, s[36:39], s46 offen lds
    s_add_u32 m0, s50, 40960
    s_nop 0
    buffer_load_dwordx4 v18, s[36:39], s46 offen lds
    s_add_u32 m0, s50, 45056
    s_nop 0
    buffer_load_dwordx4 v19, s[36:39], s46 offen lds
    s_add_u32 s46, s46, 0x80000
    s_add_u32 m0, s50, 49152
    s_nop 0
    buffer_load_dwordx4 v16, s[36:39], s46 offen lds
    s_add_u32 m0, s50, 53248
    s_nop 0
    buffer_load_dwordx4 v17, s[36:39], s46 offen lds
    s_add_u32 m0, s50, 57344
    s_nop 0
    buffer_load_dwordx4 v18, s[36:39], s46 offen lds
    s_add_u32 m0, s50, 61440
    s_nop 0
    buffer_load_dwordx4 v19, s[36:39], s46 offen lds
    s_add_u32 s46, s46, 0x80000
    s_or_b32 s3, s100, s101
    s_cbranch_scc1 Lcl_50
    s_lshr_b32 s41, s2, 3
    s_lshl_b32 s41, 1, s41
    s_and_b32 s42, s2, 7
    s_lshl_b32 s42, s42, 2
    v_mov_b32 v15, s41
    s_mov_b64 exec, 1
    buffer_atomic_or v15, off, s[28:31], s42 offset:192 sc0 sc1
    s_mov_b64 exec, -1
Lcl_50:
    s_add_u32 m0, s50, 65536
    s_nop 0
    buffer_load_dwordx4 v16, s[36:39], s46 offen lds
    s_add_u32 m0, s50, 69632
    s_nop 0
    buffer_load_dwordx4 v17, s[36:39], s46 offen lds
    s_add_u32 m0, s50, 73728
    s_nop 0
    buffer_load_dwordx4 v18, s[36:39], s46 offen lds
    s_add_u32 m0, s50, 77824
    s_nop 0
    buffer_load_dwordx4 v19, s[36:39], s46 offen lds
    s_add_u32 s46, s46, 0x80000
    s_add_u32 m0, s50, 81920
    s_nop 0
    buffer_load_dwordx4 v16, s[36:39], s46 offen lds
    s_add_u32 m0, s50, 86016
    s_nop 0
    buffer_load_dwordx4 v17, s[36:39], s46 offen lds
    s_add_u32 m0, s50, 90112
    s_nop 0
    buffer_load_dwordx4 v18, s[36:39], s46 offen lds
    s_add_u32 m0, s50, 94208
    s_nop 0
    buffer_load_dwordx4 v19, s[36:39], s46 offen lds
    s_add_u32 s46, s46, 0x80000
    s_add_u32 m0, s50, 98304
    s_nop 0
    buffer_load_dwordx4 v16, s[36:39], s46 offen lds
    s_add_u32 m0, s50, 102400
    s_nop 0
    buffer_load_dwordx4 v17, s[36:39], s46 offen lds
    s_add_u32 m0, s50, 106496
    s_nop 0
    buffer_load_dwordx4 v18, s[36:39], s46 offen lds
    s_add_u32 m0, s50, 110592
    s_nop 0
    buffer_load_dwordx4 v19, s[36:39], s46 offen lds
    s_add_u32 s46, s46, 0x80000
    s_add_u32 m0, s50, 114688
    s_nop 0
    buffer_load_dwordx4 v16, s[36:39], s46 offen lds
    s_add_u32 m0, s50, 118784
    s_nop 0
    buffer_load_dwordx4 v17, s[36:39], s46 offen lds
    s_add_u32 m0, s50, 122880
    s_nop 0
    buffer_load_dwordx4 v18, s[36:39], s46 offen lds
    s_add_u32 m0, s50, 126976
    s_nop 0
    buffer_load_dwordx4 v19, s[36:39], s46 offen lds
    s_add_u32 s46, s46, 0x80000
    v_mov_b32 v28, 0
    s_and_b32 s41, s54, 15
    s_lshl_b32 s41, s41, 2
    s_add_u32 s41, s41, s53
    s_lshl_b32 s41, s41, 11
    s_add_u32 s41, s41, 0x4d80000
    v_lshlrev_b32 v29, 5, v0
    buffer_store_dword v28, v29, s[4:7], s41 offen sc1
    s_lshl2_add_u32 s41, s54, s40
    s_lshl_b32 s41, s41, 12
    s_lshl_b32 s42, s56, 22
    s_add_u32 s41, s41, s42
    v_lshlrev_b32 v29, 6, v0
    buffer_load_dword v23, v29, s[32:35], s41 offen
    s_cmp_eq_u32 s56, 0
    s_cbranch_scc1 Lp1_51
    s_waitcnt vmcnt(34)
    s_lshl_b32 s41, s40, 13
    s_add_u32 s41, s41, 131072
    v_lshrrev_b32 v22, 3, v0
    v_xor_b32 v22, v0, v22
    v_and_b32 v22, 7, v22
    v_lshlrev_b32 v22, 4, v22
    v_add_u32 v22, s41, v22
    v_and_b32 v20, 7, v0
    v_lshl_add_u32 v20, v20, 7, v22
    v_lshrrev_b32 v31, 3, v0
    v_lshl_add_u32 v22, v31, 7, v22
    v_lshlrev_b32 v140, 16, v48
    v_and_b32 v148, 0xffff0000, v48
    v_lshlrev_b32 v156, 16, v49
    v_and_b32 v164, 0xffff0000, v49
    v_lshlrev_b32 v141, 16, v50
    v_and_b32 v149, 0xffff0000, v50
    v_lshlrev_b32 v157, 16, v51
    v_and_b32 v165, 0xffff0000, v51
    v_lshlrev_b32 v142, 16, v52
    v_and_b32 v150, 0xffff0000, v52
    v_lshlrev_b32 v158, 16, v53
    v_and_b32 v166, 0xffff0000, v53
    v_lshlrev_b32 v143, 16, v54
    v_and_b32 v151, 0xffff0000, v54
    v_lshlrev_b32 v159, 16, v55
    v_and_b32 v167, 0xffff0000, v55
    v_lshlrev_b32 v144, 16, v56
    v_and_b32 v152, 0xffff0000, v56
    v_lshlrev_b32 v160, 16, v57
    v_and_b32 v168, 0xffff0000, v57
    v_lshlrev_b32 v145, 16, v58
    v_and_b32 v153, 0xffff0000, v58
    v_lshlrev_b32 v161, 16, v59
    v_and_b32 v169, 0xffff0000, v59
    v_lshlrev_b32 v146, 16, v60
    v_and_b32 v154, 0xffff0000, v60
    v_lshlrev_b32 v162, 16, v61
    v_and_b32 v170, 0xffff0000, v61
    v_lshlrev_b32 v147, 16, v62
    v_and_b32 v155, 0xffff0000, v62
    v_lshlrev_b32 v163, 16, v63
    v_and_b32 v171, 0xffff0000, v63
    v_lshlrev_b32 v172, 16, v64
    v_and_b32 v173, 0xffff0000, v64
    v_lshlrev_b32 v174, 16, v68
    v_and_b32 v175, 0xffff0000, v68
    v_lshlrev_b32 v176, 16, v72
    v_and_b32 v177, 0xffff0000, v72
    v_lshlrev_b32 v178, 16, v76
    v_and_b32 v179, 0xffff0000, v76
    v_lshlrev_b32 v180, 16, v80
    v_and_b32 v181, 0xffff0000, v80
    v_lshlrev_b32 v182, 16, v84
    v_and_b32 v183, 0xffff0000, v84
    v_lshlrev_b32 v184, 16, v88
    v_and_b32 v185, 0xffff0000, v88
    v_lshlrev_b32 v186, 16, v92
    v_and_b32 v187, 0xffff0000, v92
    v_lshlrev_b32 v188, 16, v96
    v_and_b32 v189, 0xffff0000, v96
    v_lshlrev_b32 v190, 16, v100
    v_and_b32 v191, 0xffff0000, v100
    v_lshlrev_b32 v192, 16, v104
    v_and_b32 v193, 0xffff0000, v104
    v_pk_mul_f32 v[194:195], v[172:173], v[164:165]
    v_pk_mul_f32 v[196:197], v[174:175], v[164:165]
    v_pk_mul_f32 v[198:199], v[176:177], v[164:165]
    v_pk_mul_f32 v[200:201], v[178:179], v[164:165]
    v_pk_mul_f32 v[202:203], v[180:181], v[164:165]
    v_pk_mul_f32 v[204:205], v[182:183], v[164:165]
    v_pk_mul_f32 v[206:207], v[184:185], v[164:165]
    v_pk_mul_f32 v[208:209], v[186:187], v[164:165]
    v_pk_fma_f32 v[194:195], v[174:175], v[156:157], v[194:195]
    v_pk_fma_f32 v[196:197], v[176:177], v[156:157], v[196:197]
    v_pk_fma_f32 v[198:199], v[178:179], v[156:157], v[198:199]
    v_pk_fma_f32 v[200:201], v[180:181], v[156:157], v[200:201]
    v_pk_fma_f32 v[202:203], v[182:183], v[156:157], v[202:203]
    v_pk_fma_f32 v[204:205], v[184:185], v[156:157], v[204:205]
    v_pk_fma_f32 v[206:207], v[186:187], v[156:157], v[206:207]
    v_pk_fma_f32 v[208:209], v[188:189], v[156:157], v[208:209]
    v_pk_fma_f32 v[194:195], v[176:177], v[148:149], v[194:195]
    v_pk_fma_f32 v[196:197], v[178:179], v[148:149], v[196:197]
    v_pk_fma_f32 v[198:199], v[180:181], v[148:149], v[198:199]
    v_pk_fma_f32 v[200:201], v[182:183], v[148:149], v[200:201]
    v_pk_fma_f32 v[202:203], v[184:185], v[148:149], v[202:203]
    v_pk_fma_f32 v[204:205], v[186:187], v[148:149], v[204:205]
    v_pk_fma_f32 v[206:207], v[188:189], v[148:149], v[206:207]
    v_pk_fma_f32 v[208:209], v[190:191], v[148:149], v[208:209]
    v_pk_fma_f32 v[194:195], v[178:179], v[140:141], v[194:195]
    v_pk_fma_f32 v[196:197], v[180:181], v[140:141], v[196:197]
    v_pk_fma_f32 v[198:199], v[182:183], v[140:141], v[198:199]
    v_pk_fma_f32 v[200:201], v[184:185], v[140:141], v[200:201]
    v_pk_fma_f32 v[202:203], v[186:187], v[140:141], v[202:203]
    v_pk_fma_f32 v[204:205], v[188:189], v[140:141], v[204:205]
    v_pk_fma_f32 v[206:207], v[190:191], v[140:141], v[206:207]
    v_pk_fma_f32 v[208:209], v[192:193], v[140:141], v[208:209]
    v_lshlrev_b32 v210, 16, v108
    v_and_b32 v211, 0xffff0000, v108
    v_pk_mul_f32 v[194:195], v[194:195], v[210:211]
    v_lshlrev_b32 v212, 16, v112
    v_and_b32 v213, 0xffff0000, v112
    v_pk_mul_f32 v[196:197], v[196:197], v[212:213]
    v_lshlrev_b32 v214, 16, v116
    v_and_b32 v215, 0xffff0000, v116
    v_pk_mul_f32 v[198:199], v[198:199], v[214:215]
    v_lshlrev_b32 v216, 16, v120
    v_and_b32 v217, 0xffff0000, v120
    v_pk_mul_f32 v[200:201], v[200:201], v[216:217]
    v_lshlrev_b32 v210, 16, v124
    v_and_b32 v211, 0xffff0000, v124
    v_pk_mul_f32 v[202:203], v[202:203], v[210:211]
    v_lshlrev_b32 v212, 16, v128
    v_and_b32 v213, 0xffff0000, v128
    v_pk_mul_f32 v[204:205], v[204:205], v[212:213]
    v_lshlrev_b32 v214, 16, v132
    v_and_b32 v215, 0xffff0000, v132
    v_pk_mul_f32 v[206:207], v[206:207], v[214:215]
    v_lshlrev_b32 v216, 16, v136
    v_and_b32 v217, 0xffff0000, v136
    v_pk_mul_f32 v[208:209], v[208:209], v[216:217]
    v_cvt_pk_bf16_f32 v220, v194, v196
    v_cvt_pk_bf16_f32 v221, v198, v200
    v_cvt_pk_bf16_f32 v222, v202, v204
    v_cvt_pk_bf16_f32 v223, v206, v208
    ds_write_b128 v20, v[220:223] offset:0
    v_cvt_pk_bf16_f32 v224, v195, v197
    v_cvt_pk_bf16_f32 v225, v199, v201
    v_cvt_pk_bf16_f32 v226, v203, v205
    v_cvt_pk_bf16_f32 v227, v207, v209
    ds_write_b128 v20, v[224:227] offset:1024
    v_lshlrev_b32 v172, 16, v65
    v_and_b32 v173, 0xffff0000, v65
    v_lshlrev_b32 v174, 16, v69
    v_and_b32 v175, 0xffff0000, v69
    v_lshlrev_b32 v176, 16, v73
    v_and_b32 v177, 0xffff0000, v73
    v_lshlrev_b32 v178, 16, v77
    v_and_b32 v179, 0xffff0000, v77
    v_lshlrev_b32 v180, 16, v81
    v_and_b32 v181, 0xffff0000, v81
    v_lshlrev_b32 v182, 16, v85
    v_and_b32 v183, 0xffff0000, v85
    v_lshlrev_b32 v184, 16, v89
    v_and_b32 v185, 0xffff0000, v89
    v_lshlrev_b32 v186, 16, v93
    v_and_b32 v187, 0xffff0000, v93
    v_lshlrev_b32 v188, 16, v97
    v_and_b32 v189, 0xffff0000, v97
    v_lshlrev_b32 v190, 16, v101
    v_and_b32 v191, 0xffff0000, v101
    v_lshlrev_b32 v192, 16, v105
    v_and_b32 v193, 0xffff0000, v105
    v_pk_mul_f32 v[194:195], v[172:173], v[166:167]
    v_pk_mul_f32 v[196:197], v[174:175], v[166:167]
    v_pk_mul_f32 v[198:199], v[176:177], v[166:167]
    v_pk_mul_f32 v[200:201], v[178:179], v[166:167]
    v_pk_mul_f32 v[202:203], v[180:181], v[166:167]
    v_pk_mul_f32 v[204:205], v[182:183], v[166:167]
    v_pk_mul_f32 v[206:207], v[184:185], v[166:167]
    v_pk_mul_f32 v[208:209], v[186:187], v[166:167]
    v_pk_fma_f32 v[194:195], v[174:175], v[158:159], v[194:195]
    v_pk_fma_f32 v[196:197], v[176:177], v[158:159], v[196:197]
    v_pk_fma_f32 v[198:199], v[178:179], v[158:159], v[198:199]
    v_pk_fma_f32 v[200:201], v[180:181], v[158:159], v[200:201]
    v_pk_fma_f32 v[202:203], v[182:183], v[158:159], v[202:203]
    v_pk_fma_f32 v[204:205], v[184:185], v[158:159], v[204:205]
    v_pk_fma_f32 v[206:207], v[186:187], v[158:159], v[206:207]
    v_pk_fma_f32 v[208:209], v[188:189], v[158:159], v[208:209]
    v_pk_fma_f32 v[194:195], v[176:177], v[150:151], v[194:195]
    v_pk_fma_f32 v[196:197], v[178:179], v[150:151], v[196:197]
    v_pk_fma_f32 v[198:199], v[180:181], v[150:151], v[198:199]
    v_pk_fma_f32 v[200:201], v[182:183], v[150:151], v[200:201]
    v_pk_fma_f32 v[202:203], v[184:185], v[150:151], v[202:203]
    v_pk_fma_f32 v[204:205], v[186:187], v[150:151], v[204:205]
    v_pk_fma_f32 v[206:207], v[188:189], v[150:151], v[206:207]
    v_pk_fma_f32 v[208:209], v[190:191], v[150:151], v[208:209]
    v_pk_fma_f32 v[194:195], v[178:179], v[142:143], v[194:195]
    v_pk_fma_f32 v[196:197], v[180:181], v[142:143], v[196:197]
    v_pk_fma_f32 v[198:199], v[182:183], v[142:143], v[198:199]
    v_pk_fma_f32 v[200:201], v[184:185], v[142:143], v[200:201]
    v_pk_fma_f32 v[202:203], v[186:187], v[142:143], v[202:203]
    v_pk_fma_f32 v[204:205], v[188:189], v[142:143], v[204:205]
    v_pk_fma_f32 v[206:207], v[190:191], v[142:143], v[206:207]
    v_pk_fma_f32 v[208:209], v[192:193], v[142:143], v[208:209]
    v_lshlrev_b32 v210, 16, v109
    v_and_b32 v211, 0xffff0000, v109
    v_pk_mul_f32 v[194:195], v[194:195], v[210:211]
    v_lshlrev_b32 v212, 16, v113
    v_and_b32 v213, 0xffff0000, v113
    v_pk_mul_f32 v[196:197], v[196:197], v[212:213]
    v_lshlrev_b32 v214, 16, v117
    v_and_b32 v215, 0xffff0000, v117
    v_pk_mul_f32 v[198:199], v[198:199], v[214:215]
    v_lshlrev_b32 v216, 16, v121
    v_and_b32 v217, 0xffff0000, v121
    v_pk_mul_f32 v[200:201], v[200:201], v[216:217]
    v_lshlrev_b32 v210, 16, v125
    v_and_b32 v211, 0xffff0000, v125
    v_pk_mul_f32 v[202:203], v[202:203], v[210:211]
    v_lshlrev_b32 v212, 16, v129
    v_and_b32 v213, 0xffff0000, v129
    v_pk_mul_f32 v[204:205], v[204:205], v[212:213]
    v_lshlrev_b32 v214, 16, v133
    v_and_b32 v215, 0xffff0000, v133
    v_pk_mul_f32 v[206:207], v[206:207], v[214:215]
    v_lshlrev_b32 v216, 16, v137
    v_and_b32 v217, 0xffff0000, v137
    v_pk_mul_f32 v[208:209], v[208:209], v[216:217]
    v_cvt_pk_bf16_f32 v228, v194, v196
    v_cvt_pk_bf16_f32 v229, v198, v200
    v_cvt_pk_bf16_f32 v230, v202, v204
    v_cvt_pk_bf16_f32 v231, v206, v208
    ds_write_b128 v20, v[228:231] offset:2048
    v_cvt_pk_bf16_f32 v232, v195, v197
    v_cvt_pk_bf16_f32 v233, v199, v201
    v_cvt_pk_bf16_f32 v234, v203, v205
    v_cvt_pk_bf16_f32 v235, v207, v209
    ds_write_b128 v20, v[232:235] offset:3072
    v_lshlrev_b32 v172, 16, v66
    v_and_b32 v173, 0xffff0000, v66
    v_lshlrev_b32 v174, 16, v70
    v_and_b32 v175, 0xffff0000, v70
    v_lshlrev_b32 v176, 16, v74
    v_and_b32 v177, 0xffff0000, v74
    v_lshlrev_b32 v178, 16, v78
    v_and_b32 v179, 0xffff0000, v78
    v_lshlrev_b32 v180, 16, v82
    v_and_b32 v181, 0xffff0000, v82
    v_lshlrev_b32 v182, 16, v86
    v_and_b32 v183, 0xffff0000, v86
    v_lshlrev_b32 v184, 16, v90
    v_and_b32 v185, 0xffff0000, v90
    v_lshlrev_b32 v186, 16, v94
    v_and_b32 v187, 0xffff0000, v94
    v_lshlrev_b32 v188, 16, v98
    v_and_b32 v189, 0xffff0000, v98
    v_lshlrev_b32 v190, 16, v102
    v_and_b32 v191, 0xffff0000, v102
    v_lshlrev_b32 v192, 16, v106
    v_and_b32 v193, 0xffff0000, v106
    v_pk_mul_f32 v[194:195], v[172:173], v[168:169]
    v_pk_mul_f32 v[196:197], v[174:175], v[168:169]
    v_pk_mul_f32 v[198:199], v[176:177], v[168:169]
    v_pk_mul_f32 v[200:201], v[178:179], v[168:169]
    v_pk_mul_f32 v[202:203], v[180:181], v[168:169]
    v_pk_mul_f32 v[204:205], v[182:183], v[168:169]
    v_pk_mul_f32 v[206:207], v[184:185], v[168:169]
    v_pk_mul_f32 v[208:209], v[186:187], v[168:169]
    v_pk_fma_f32 v[194:195], v[174:175], v[160:161], v[194:195]
    v_pk_fma_f32 v[196:197], v[176:177], v[160:161], v[196:197]
    v_pk_fma_f32 v[198:199], v[178:179], v[160:161], v[198:199]
    v_pk_fma_f32 v[200:201], v[180:181], v[160:161], v[200:201]
    v_pk_fma_f32 v[202:203], v[182:183], v[160:161], v[202:203]
    v_pk_fma_f32 v[204:205], v[184:185], v[160:161], v[204:205]
    v_pk_fma_f32 v[206:207], v[186:187], v[160:161], v[206:207]
    v_pk_fma_f32 v[208:209], v[188:189], v[160:161], v[208:209]
    v_pk_fma_f32 v[194:195], v[176:177], v[152:153], v[194:195]
    v_pk_fma_f32 v[196:197], v[178:179], v[152:153], v[196:197]
    v_pk_fma_f32 v[198:199], v[180:181], v[152:153], v[198:199]
    v_pk_fma_f32 v[200:201], v[182:183], v[152:153], v[200:201]
    v_pk_fma_f32 v[202:203], v[184:185], v[152:153], v[202:203]
    v_pk_fma_f32 v[204:205], v[186:187], v[152:153], v[204:205]
    v_pk_fma_f32 v[206:207], v[188:189], v[152:153], v[206:207]
    v_pk_fma_f32 v[208:209], v[190:191], v[152:153], v[208:209]
    v_pk_fma_f32 v[194:195], v[178:179], v[144:145], v[194:195]
    v_pk_fma_f32 v[196:197], v[180:181], v[144:145], v[196:197]
    v_pk_fma_f32 v[198:199], v[182:183], v[144:145], v[198:199]
    v_pk_fma_f32 v[200:201], v[184:185], v[144:145], v[200:201]
    v_pk_fma_f32 v[202:203], v[186:187], v[144:145], v[202:203]
    v_pk_fma_f32 v[204:205], v[188:189], v[144:145], v[204:205]
    v_pk_fma_f32 v[206:207], v[190:191], v[144:145], v[206:207]
    v_pk_fma_f32 v[208:209], v[192:193], v[144:145], v[208:209]
    v_lshlrev_b32 v210, 16, v110
    v_and_b32 v211, 0xffff0000, v110
    v_pk_mul_f32 v[194:195], v[194:195], v[210:211]
    v_lshlrev_b32 v212, 16, v114
    v_and_b32 v213, 0xffff0000, v114
    v_pk_mul_f32 v[196:197], v[196:197], v[212:213]
    v_lshlrev_b32 v214, 16, v118
    v_and_b32 v215, 0xffff0000, v118
    v_pk_mul_f32 v[198:199], v[198:199], v[214:215]
    v_lshlrev_b32 v216, 16, v122
    v_and_b32 v217, 0xffff0000, v122
    v_pk_mul_f32 v[200:201], v[200:201], v[216:217]
    v_lshlrev_b32 v210, 16, v126
    v_and_b32 v211, 0xffff0000, v126
    v_pk_mul_f32 v[202:203], v[202:203], v[210:211]
    v_lshlrev_b32 v212, 16, v130
    v_and_b32 v213, 0xffff0000, v130
    v_pk_mul_f32 v[204:205], v[204:205], v[212:213]
    v_lshlrev_b32 v214, 16, v134
    v_and_b32 v215, 0xffff0000, v134
    v_pk_mul_f32 v[206:207], v[206:207], v[214:215]
    v_lshlrev_b32 v216, 16, v138
    v_and_b32 v217, 0xffff0000, v138
    v_pk_mul_f32 v[208:209], v[208:209], v[216:217]
    v_cvt_pk_bf16_f32 v236, v194, v196
    v_cvt_pk_bf16_f32 v237, v198, v200
    v_cvt_pk_bf16_f32 v238, v202, v204
    v_cvt_pk_bf16_f32 v239, v206, v208
    ds_write_b128 v20, v[236:239] offset:4096
    v_cvt_pk_bf16_f32 v240, v195, v197
    v_cvt_pk_bf16_f32 v241, v199, v201
    v_cvt_pk_bf16_f32 v242, v203, v205
    v_cvt_pk_bf16_f32 v243, v207, v209
    ds_write_b128 v20, v[240:243] offset:5120
    v_lshlrev_b32 v172, 16, v67
    v_and_b32 v173, 0xffff0000, v67
    v_lshlrev_b32 v174, 16, v71
    v_and_b32 v175, 0xffff0000, v71
    v_lshlrev_b32 v176, 16, v75
    v_and_b32 v177, 0xffff0000, v75
    v_lshlrev_b32 v178, 16, v79
    v_and_b32 v179, 0xffff0000, v79
    v_lshlrev_b32 v180, 16, v83
    v_and_b32 v181, 0xffff0000, v83
    v_lshlrev_b32 v182, 16, v87
    v_and_b32 v183, 0xffff0000, v87
    v_lshlrev_b32 v184, 16, v91
    v_and_b32 v185, 0xffff0000, v91
    v_lshlrev_b32 v186, 16, v95
    v_and_b32 v187, 0xffff0000, v95
    v_lshlrev_b32 v188, 16, v99
    v_and_b32 v189, 0xffff0000, v99
    v_lshlrev_b32 v190, 16, v103
    v_and_b32 v191, 0xffff0000, v103
    v_lshlrev_b32 v192, 16, v107
    v_and_b32 v193, 0xffff0000, v107
    v_pk_mul_f32 v[194:195], v[172:173], v[170:171]
    v_pk_mul_f32 v[196:197], v[174:175], v[170:171]
    v_pk_mul_f32 v[198:199], v[176:177], v[170:171]
    v_pk_mul_f32 v[200:201], v[178:179], v[170:171]
    v_pk_mul_f32 v[202:203], v[180:181], v[170:171]
    v_pk_mul_f32 v[204:205], v[182:183], v[170:171]
    v_pk_mul_f32 v[206:207], v[184:185], v[170:171]
    v_pk_mul_f32 v[208:209], v[186:187], v[170:171]
    v_pk_fma_f32 v[194:195], v[174:175], v[162:163], v[194:195]
    v_pk_fma_f32 v[196:197], v[176:177], v[162:163], v[196:197]
    v_pk_fma_f32 v[198:199], v[178:179], v[162:163], v[198:199]
    v_pk_fma_f32 v[200:201], v[180:181], v[162:163], v[200:201]
    v_pk_fma_f32 v[202:203], v[182:183], v[162:163], v[202:203]
    v_pk_fma_f32 v[204:205], v[184:185], v[162:163], v[204:205]
    v_pk_fma_f32 v[206:207], v[186:187], v[162:163], v[206:207]
    v_pk_fma_f32 v[208:209], v[188:189], v[162:163], v[208:209]
    v_pk_fma_f32 v[194:195], v[176:177], v[154:155], v[194:195]
    v_pk_fma_f32 v[196:197], v[178:179], v[154:155], v[196:197]
    v_pk_fma_f32 v[198:199], v[180:181], v[154:155], v[198:199]
    v_pk_fma_f32 v[200:201], v[182:183], v[154:155], v[200:201]
    v_pk_fma_f32 v[202:203], v[184:185], v[154:155], v[202:203]
    v_pk_fma_f32 v[204:205], v[186:187], v[154:155], v[204:205]
    v_pk_fma_f32 v[206:207], v[188:189], v[154:155], v[206:207]
    v_pk_fma_f32 v[208:209], v[190:191], v[154:155], v[208:209]
    v_pk_fma_f32 v[194:195], v[178:179], v[146:147], v[194:195]
    v_pk_fma_f32 v[196:197], v[180:181], v[146:147], v[196:197]
    v_pk_fma_f32 v[198:199], v[182:183], v[146:147], v[198:199]
    v_pk_fma_f32 v[200:201], v[184:185], v[146:147], v[200:201]
    v_pk_fma_f32 v[202:203], v[186:187], v[146:147], v[202:203]
    v_pk_fma_f32 v[204:205], v[188:189], v[146:147], v[204:205]
    v_pk_fma_f32 v[206:207], v[190:191], v[146:147], v[206:207]
    v_pk_fma_f32 v[208:209], v[192:193], v[146:147], v[208:209]
    v_lshlrev_b32 v210, 16, v111
    v_and_b32 v211, 0xffff0000, v111
    v_pk_mul_f32 v[194:195], v[194:195], v[210:211]
    v_lshlrev_b32 v212, 16, v115
    v_and_b32 v213, 0xffff0000, v115
    v_pk_mul_f32 v[196:197], v[196:197], v[212:213]
    v_lshlrev_b32 v214, 16, v119
    v_and_b32 v215, 0xffff0000, v119
    v_pk_mul_f32 v[198:199], v[198:199], v[214:215]
    v_lshlrev_b32 v216, 16, v123
    v_and_b32 v217, 0xffff0000, v123
    v_pk_mul_f32 v[200:201], v[200:201], v[216:217]
    v_lshlrev_b32 v210, 16, v127
    v_and_b32 v211, 0xffff0000, v127
    v_pk_mul_f32 v[202:203], v[202:203], v[210:211]
    v_lshlrev_b32 v212, 16, v131
    v_and_b32 v213, 0xffff0000, v131
    v_pk_mul_f32 v[204:205], v[204:205], v[212:213]
    v_lshlrev_b32 v214, 16, v135
    v_and_b32 v215, 0xffff0000, v135
    v_pk_mul_f32 v[206:207], v[206:207], v[214:215]
    v_lshlrev_b32 v216, 16, v139
    v_and_b32 v217, 0xffff0000, v139
    v_pk_mul_f32 v[208:209], v[208:209], v[216:217]
    v_cvt_pk_bf16_f32 v244, v194, v196
    v_cvt_pk_bf16_f32 v245, v198, v200
    v_cvt_pk_bf16_f32 v246, v202, v204
    v_cvt_pk_bf16_f32 v247, v206, v208
    ds_write_b128 v20, v[244:247] offset:6144
    v_cvt_pk_bf16_f32 v248, v195, v197
    v_cvt_pk_bf16_f32 v249, v199, v201
    v_cvt_pk_bf16_f32 v250, v203, v205
    v_cvt_pk_bf16_f32 v251, v207, v209
    ds_write_b128 v20, v[248:251] offset:7168
    s_waitcnt lgkmcnt(0)
    ds_read_b128 v[220:223], v22 offset:0
    ds_read_b128 v[224:227], v22 offset:1024
    ds_read_b128 v[228:231], v22 offset:2048
    ds_read_b128 v[232:235], v22 offset:3072
    ds_read_b128 v[236:239], v22 offset:4096
    ds_read_b128 v[240:243], v22 offset:5120
    ds_read_b128 v[244:247], v22 offset:6144
    ds_read_b128 v[248:251], v22 offset:7168
    s_waitcnt lgkmcnt(7)
    buffer_store_dwordx4 v[220:223], v21, s[4:7], s59 offen sc1
    s_add_u32 s59, s59, 4096
    s_waitcnt lgkmcnt(6)
    buffer_store_dwordx4 v[224:227], v21, s[4:7], s59 offen sc1
    s_add_u32 s59, s59, 4096
    s_waitcnt lgkmcnt(5)
    buffer_store_dwordx4 v[228:231], v21, s[4:7], s59 offen sc1
    s_add_u32 s59, s59, 4096
    s_waitcnt lgkmcnt(4)
    buffer_store_dwordx4 v[232:235], v21, s[4:7], s59 offen sc1
    s_add_u32 s59, s59, 4096
    s_waitcnt lgkmcnt(3)
    buffer_store_dwordx4 v[236:239], v21, s[4:7], s59 offen sc1
    s_add_u32 s59, s59, 4096
    s_waitcnt lgkmcnt(2)
    buffer_store_dwordx4 v[240:243], v21, s[4:7], s59 offen sc1
    s_add_u32 s59, s59, 4096
    s_waitcnt lgkmcnt(1)
    buffer_store_dwordx4 v[244:247], v21, s[4:7], s59 offen sc1
    s_add_u32 s59, s59, 4096
    s_waitcnt lgkmcnt(0)
    buffer_store_dwordx4 v[248:251], v21, s[4:7], s59 offen sc1
    s_add_u32 s59, s59, 4096
Lp1_51:
    s_waitcnt vmcnt(18)
    s_cmp_lg_u32 s101, 0
    s_cbranch_scc1 Lvr_55
    v_mov_b32 v28, 163824
    s_cmp_eq_u32 s100, 0
    s_cbranch_scc0 Lvr_54
    s_mov_b32 s3, s2
    s_mov_b32 vcc_hi, 600
Lvr_52:
    v_readfirstlane_b32 s42, v15
    s_lshr_b32 s41, s2, 3
    s_bitcmp1_b32 s42, s41
    s_cbranch_scc0 Lvr_53
    s_cmp_eq_u32 s42, -1
    s_cselect_b32 s41, 1, 8
    s_add_u32 s2, s2, s41
    s_and_b32 s2, s2, 255
    s_lshr_b32 s41, s2, 3
    s_lshl_b32 s41, 1, s41
    s_and_b32 s42, s2, 7
    s_lshl_b32 s42, s42, 2
    v_mov_b32 v15, s41
    s_mov_b64 exec, 1
    buffer_atomic_or v15, off, s[28:31], s42 offset:192 sc0 sc1
    s_mov_b64 exec, -1
    s_waitcnt vmcnt(0)
    s_sub_u32 vcc_hi, vcc_hi, 1
    s_cbranch_scc0 Lvr_52
    s_mov_b32 s2, 256
Lvr_53:
    v_mov_b32 v29, s2
    s_mov_b32 s2, s3
    ds_write_b32 v28, v29
    s_waitcnt lgkmcnt(0)
Lvr_54:
    s_barrier
    ds_read_b32 v29, v28
    s_mov_b32 s101, 1
    s_waitcnt lgkmcnt(0)
    v_readfirstlane_b32 s41, v29
    s_nop 0
    s_cmp_eq_u32 s41, s2
    s_cbranch_scc1 Lvr_55
    s_cmp_ge_u32 s41, 256
    s_cbranch_scc1 L_exit
    s_and_b32 s2, s41, 255
    s_waitcnt vmcnt(0)
    s_barrier
    s_branch L_restart
Lvr_55:
    s_barrier
    ds_read_b64_tr_b16 a[0:1], v4 offset:0
    ds_read_b64_tr_b16 a[2:3], v4 offset:1024
    ds_read_b64_tr_b16 a[4:5], v5 offset:0
    ds_read_b64_tr_b16 a[6:7], v5 offset:1024
    s_waitcnt lgkmcnt(8)
    ds_read_b64_tr_b16 a[8:9], v4 offset:8192
    ds_read_b64_tr_b16 a[10:11], v4 offset:9216
    ds_read_b64_tr_b16 a[12:13], v5 offset:8192
    ds_read_b64_tr_b16 a[14:15], v5 offset:9216
    s_waitcnt lgkmcnt(8)
    ds_read_b64_tr_b16 a[16:17], v4 offset:16384
    ds_read_b64_tr_b16 a[18:19], v4 offset:17408
    ds_read_b64_tr_b16 a[20:21], v5 offset:16384
    ds_read_b64_tr_b16 a[22:23], v5 offset:17408
    s_waitcnt lgkmcnt(8)
    ds_read_b64_tr_b16 a[24:25], v4 offset:24576
    ds_read_b64_tr_b16 a[26:27], v4 offset:25600
    ds_read_b64_tr_b16 a[28:29], v5 offset:24576
    ds_read_b64_tr_b16 a[30:31], v5 offset:25600
    s_waitcnt lgkmcnt(8)
    ds_read_b64_tr_b16 a[32:33], v4 offset:32768
    ds_read_b64_tr_b16 a[34:35], v4 offset:33792
    ds_read_b64_tr_b16 a[36:37], v5 offset:32768
    ds_read_b64_tr_b16 a[38:39], v5 offset:33792
    s_waitcnt lgkmcnt(8)
    ds_read_b64_tr_b16 a[40:41], v4 offset:40960
    ds_read_b64_tr_b16 a[42:43], v4 offset:41984
    ds_read_b64_tr_b16 a[44:45], v5 offset:40960
    ds_read_b64_tr_b16 a[46:47], v5 offset:41984
    s_waitcnt lgkmcnt(8)
    ds_read_b64_tr_b16 a[48:49], v4 offset:49152
    ds_read_b64_tr_b16 a[50:51], v4 offset:50176
    ds_read_b64_tr_b16 a[52:53], v5 offset:49152
    ds_read_b64_tr_b16 a[54:55], v5 offset:50176
    s_waitcnt lgkmcnt(8)
    ds_read_b64_tr_b16 a[56:57], v4 offset:57344
    ds_read_b64_tr_b16 a[58:59], v4 offset:58368
    ds_read_b64_tr_b16 a[60:61], v5 offset:57344
    ds_read_b64_tr_b16 a[62:63], v5 offset:58368
    s_waitcnt lgkmcnt(8)
    s_waitcnt lgkmcnt(0)
    s_barrier
    s_add_u32 m0, s50, 0
    s_nop 0
    buffer_load_dwordx4 v16, s[36:39], s46 offen lds
    s_add_u32 m0, s50, 4096
    s_nop 0
    buffer_load_dwordx4 v17, s[36:39], s46 offen lds
    s_add_u32 m0, s50, 8192
    s_nop 0
    buffer_load_dwordx4 v18, s[36:39], s46 offen lds
    s_add_u32 m0, s50, 12288
    s_nop 0
    buffer_load_dwordx4 v19, s[36:39], s46 offen lds
    s_add_u32 s46, s46, 0x80000
    s_add_u32 m0, s50, 16384
    s_nop 0
    buffer_load_dwordx4 v16, s[36:39], s46 offen lds
    s_add_u32 m0, s50, 20480
    s_nop 0
    buffer_load_dwordx4 v17, s[36:39], s46 offen lds
    s_add_u32 m0, s50, 24576
    s_nop 0
    buffer_load_dwordx4 v18, s[36:39], s46 offen lds
    s_add_u32 m0, s50, 28672
    s_nop 0
    buffer_load_dwordx4 v19, s[36:39], s46 offen lds
    s_add_u32 s46, s46, 0x80000
    s_add_u32 m0, s50, 32768
    s_nop 0
    buffer_load_dwordx4 v16, s[36:39], s46 offen lds
    s_add_u32 m0, s50, 36864
    s_nop 0
    buffer_load_dwordx4 v17, s[36:39], s46 offen lds
    s_add_u32 m0, s50, 40960
    s_nop 0
    buffer_load_dwordx4 v18, s[36:39], s46 offen lds
    s_add_u32 m0, s50, 45056
    s_nop 0
    buffer_load_dwordx4 v19, s[36:39], s46 offen lds
    s_add_u32 s46, s46, 0x80000
    s_add_u32 m0, s50, 49152
    s_nop 0
    buffer_load_dwordx4 v16, s[36:39], s46 offen lds
    s_add_u32 m0, s50, 53248
    s_nop 0
    buffer_load_dwordx4 v17, s[36:39], s46 offen lds
    s_add_u32 m0, s50, 57344
    s_nop 0
    buffer_load_dwordx4 v18, s[36:39], s46 offen lds
    s_add_u32 m0, s50, 61440
    s_nop 0
    buffer_load_dwordx4 v19, s[36:39], s46 offen lds
    s_add_u32 s46, s46, 0x80000
    s_add_u32 s65, s49, 131072
    s_add_u32 m0, s65, 0
    s_nop 0
    buffer_load_dwordx4 v8, s[32:35], s45 offen lds
    s_add_u32 m0, s65, 1024
    s_nop 0
    buffer_load_dwordx4 v9, s[32:35], s45 offen lds
    s_add_u32 m0, s65, 2048
    s_nop 0
    buffer_load_dwordx4 v10, s[32:35], s45 offen lds
    s_add_u32 m0, s65, 3072
    s_nop 0
    buffer_load_dwordx4 v11, s[32:35], s45 offen lds
    s_add_u32 s45, s45, 128
    s_add_u32 s65, s49, 147456
    s_add_u32 m0, s65, 0
    s_nop 0
    buffer_load_dwordx4 v8, s[32:35], s45 offen lds
    s_add_u32 m0, s65, 1024
    s_nop 0
    buffer_load_dwordx4 v9, s[32:35], s45 offen lds
    s_add_u32 m0, s65, 2048
    s_nop 0
    buffer_load_dwordx4 v10, s[32:35], s45 offen lds
    s_add_u32 m0, s65, 3072
    s_nop 0
    buffer_load_dwordx4 v11, s[32:35], s45 offen lds
    s_add_u32 s45, s45, 128
    s_waitcnt vmcnt(24)
    s_barrier
    ds_read_b64_tr_b16 a[64:65], v6 offset:0
    ds_read_b64_tr_b16 a[66:67], v6 offset:1024
    ds_read_b64_tr_b16 a[68:69], v7 offset:0
    ds_read_b64_tr_b16 a[70:71], v7 offset:1024
    s_waitcnt lgkmcnt(8)
    ds_read_b64_tr_b16 a[72:73], v6 offset:8192
    ds_read_b64_tr_b16 a[74:75], v6 offset:9216
    ds_read_b64_tr_b16 a[76:77], v7 offset:8192
    ds_read_b64_tr_b16 a[78:79], v7 offset:9216
    s_waitcnt lgkmcnt(8)
    ds_read_b64_tr_b16 a[80:81], v6 offset:16384
    ds_read_b64_tr_b16 a[82:83], v6 offset:17408
    ds_read_b64_tr_b16 a[84:85], v7 offset:16384
    ds_read_b64_tr_b16 a[86:87], v7 offset:17408
    s_waitcnt lgkmcnt(8)
    ds_read_b64_tr_b16 a[88:89], v6 offset:24576
    ds_read_b64_tr_b16 a[90:91], v6 offset:25600
    ds_read_b64_tr_b16 a[92:93], v7 offset:24576
    ds_read_b64_tr_b16 a[94:95], v7 offset:25600
    s_waitcnt lgkmcnt(8)
    ds_read_b64_tr_b16 a[96:97], v6 offset:32768
    ds_read_b64_tr_b16 a[98:99], v6 offset:33792
    ds_read_b64_tr_b16 a[100:101], v7 offset:32768
    ds_read_b64_tr_b16 a[102:103], v7 offset:33792
    s_waitcnt lgkmcnt(8)
    ds_read_b64_tr_b16 a[104:105], v6 offset:40960
    ds_read_b64_tr_b16 a[106:107], v6 offset:41984
    ds_read_b64_tr_b16 a[108:109], v7 offset:40960
    ds_read_b64_tr_b16 a[110:111], v7 offset:41984
    s_waitcnt lgkmcnt(8)
    ds_read_b64_tr_b16 a[112:113], v6 offset:49152
    ds_read_b64_tr_b16 a[114:115], v6 offset:50176
    ds_read_b64_tr_b16 a[116:117], v7 offset:49152
    ds_read_b64_tr_b16 a[118:119], v7 offset:50176
    s_waitcnt lgkmcnt(8)
    ds_read_b64_tr_b16 a[120:121], v6 offset:57344
    ds_read_b64_tr_b16 a[122:123], v6 offset:58368
    ds_read_b64_tr_b16 a[124:125], v7 offset:57344
    ds_read_b64_tr_b16 a[126:127], v7 offset:58368
    s_waitcnt lgkmcnt(8)
    s_waitcnt lgkmcnt(0)
    s_barrier
    s_add_u32 m0, s50, 65536
    s_nop 0
    buffer_load_dwordx4 v16, s[36:39], s46 offen lds
    s_add_u32 m0, s50, 69632
    s_nop 0
    buffer_load_dwordx4 v17, s[36:39], s46 offen lds
    s_add_u32 m0, s50, 73728
    s_nop 0
    buffer_load_dwordx4 v18, s[36:39], s46 offen lds
    s_add_u32 m0, s50, 77824
    s_nop 0
    buffer_load_dwordx4 v19, s[36:39], s46 offen lds
    s_add_u32 s46, s46, 0x80000
    s_add_u32 m0, s50, 81920
    s_nop 0
    buffer_load_dwordx4 v16, s[36:39], s46 offen lds
    s_add_u32 m0, s50, 86016
    s_nop 0
    buffer_load_dwordx4 v17, s[36:39], s46 offen lds
    s_add_u32 m0, s50, 90112
    s_nop 0
    buffer_load_dwordx4 v18, s[36:39], s46 offen lds
    s_add_u32 m0, s50, 94208
    s_nop 0
    buffer_load_dwordx4 v19, s[36:39], s46 offen lds
    s_add_u32 s46, s46, 0x80000
    s_add_u32 m0, s50, 98304
    s_nop 0
    buffer_load_dwordx4 v16, s[36:39], s46 offen lds
    s_add_u32 m0, s50, 102400
    s_nop 0
    buffer_load_dwordx4 v17, s[36:39], s46 offen lds
    s_add_u32 m0, s50, 106496
    s_nop 0
    buffer_load_dwordx4 v18, s[36:39], s46 offen lds
    s_add_u32 m0, s50, 110592
    s_nop 0
    buffer_load_dwordx4 v19, s[36:39], s46 offen lds
    s_add_u32 s46, s46, 0x80000
    s_add_u32 m0, s50, 114688
    s_nop 0
    buffer_load_dwordx4 v16, s[36:39], s46 offen lds
    s_add_u32 m0, s50, 118784
    s_nop 0
    buffer_load_dwordx4 v17, s[36:39], s46 offen lds
    s_add_u32 m0, s50, 122880
    s_nop 0
    buffer_load_dwordx4 v18, s[36:39], s46 offen lds
    s_add_u32 m0, s50, 126976
    s_nop 0
    buffer_load_dwordx4 v19, s[36:39], s46 offen lds
    s_add_u32 s46, s46, 0x80000
    s_waitcnt vmcnt(24)
    s_barrier
    ds_read_b64_tr_b16 a[128:129], v4 offset:0
    ds_read_b64_tr_b16 a[130:131], v4 offset:1024
    ds_read_b64_tr_b16 a[132:133], v5 offset:0
    ds_read_b64_tr_b16 a[134:135], v5 offset:1024
    s_waitcnt lgkmcnt(8)
    ds_read_b64_tr_b16 a[136:137], v4 offset:8192
    ds_read_b64_tr_b16 a[138:139], v4 offset:9216
    ds_read_b64_tr_b16 a[140:141], v5 offset:8192
    ds_read_b64_tr_b16 a[142:143], v5 offset:9216
    s_waitcnt lgkmcnt(8)
    ds_read_b64_tr_b16 a[144:145], v4 offset:16384
    ds_read_b64_tr_b16 a[146:147], v4 offset:17408
    ds_read_b64_tr_b16 a[148:149], v5 offset:16384
    ds_read_b64_tr_b16 a[150:151], v5 offset:17408
    s_waitcnt lgkmcnt(8)
    ds_read_b64_tr_b16 a[152:153], v4 offset:24576
    ds_read_b64_tr_b16 a[154:155], v4 offset:25600
    ds_read_b64_tr_b16 a[156:157], v5 offset:24576
    ds_read_b64_tr_b16 a[158:159], v5 offset:25600
    s_waitcnt lgkmcnt(8)
    ds_read_b64_tr_b16 a[160:161], v4 offset:32768
    ds_read_b64_tr_b16 a[162:163], v4 offset:33792
    ds_read_b64_tr_b16 a[164:165], v5 offset:32768
    ds_read_b64_tr_b16 a[166:167], v5 offset:33792
    s_waitcnt lgkmcnt(8)
    ds_read_b64_tr_b16 a[168:169], v4 offset:40960
    ds_read_b64_tr_b16 a[170:171], v4 offset:41984
    ds_read_b64_tr_b16 a[172:173], v5 offset:40960
    ds_read_b64_tr_b16 a[174:175], v5 offset:41984
    s_waitcnt lgkmcnt(8)
    ds_read_b64_tr_b16 a[176:177], v4 offset:49152
    ds_read_b64_tr_b16 a[178:179], v4 offset:50176
    ds_read_b64_tr_b16 a[180:181], v5 offset:49152
    ds_read_b64_tr_b16 a[182:183], v5 offset:50176
    s_waitcnt lgkmcnt(8)
    ds_read_b64_tr_b16 a[184:185], v4 offset:57344
    ds_read_b64_tr_b16 a[186:187], v4 offset:58368
    ds_read_b64_tr_b16 a[188:189], v5 offset:57344
    ds_read_b64_tr_b16 a[190:191], v5 offset:58368
    s_waitcnt lgkmcnt(8)
    s_waitcnt lgkmcnt(0)
    s_barrier
    s_waitcnt vmcnt(0)
    s_barrier
    ds_read_b64_tr_b16 a[192:193], v6 offset:0
    ds_read_b64_tr_b16 a[194:195], v6 offset:1024
    ds_read_b64_tr_b16 a[196:197], v7 offset:0
    ds_read_b64_tr_b16 a[198:199], v7 offset:1024
    s_waitcnt lgkmcnt(8)
    ds_read_b64_tr_b16 a[200:201], v6 offset:8192
    ds_read_b64_tr_b16 a[202:203], v6 offset:9216
    ds_read_b64_tr_b16 a[204:205], v7 offset:8192
    ds_read_b64_tr_b16 a[206:207], v7 offset:9216
    s_waitcnt lgkmcnt(8)
    ds_read_b64_tr_b16 a[208:209], v6 offset:16384
    ds_read_b64_tr_b16 a[210:211], v6 offset:17408
    ds_read_b64_tr_b16 a[212:213], v7 offset:16384
    ds_read_b64_tr_b16 a[214:215], v7 offset:17408
    s_waitcnt lgkmcnt(8)
    ds_read_b64_tr_b16 a[216:217], v6 offset:24576
    ds_read_b64_tr_b16 a[218:219], v6 offset:25600
    ds_read_b64_tr_b16 a[220:221], v7 offset:24576
    ds_read_b64_tr_b16 a[222:223], v7 offset:25600
    s_waitcnt lgkmcnt(8)
    ds_read_b64_tr_b16 a[224:225], v6 offset:32768
    ds_read_b64_tr_b16 a[226:227], v6 offset:33792
    ds_read_b64_tr_b16 a[228:229], v7 offset:32768
    ds_read_b64_tr_b16 a[230:231], v7 offset:33792
    s_waitcnt lgkmcnt(8)
    ds_read_b64_tr_b16 a[232:233], v6 offset:40960
    ds_read_b64_tr_b16 a[234:235], v6 offset:41984
    ds_read_b64_tr_b16 a[236:237], v7 offset:40960
    ds_read_b64_tr_b16 a[238:239], v7 offset:41984
    s_waitcnt lgkmcnt(8)
    ds_read_b64_tr_b16 a[240:241], v6 offset:49152
    ds_read_b64_tr_b16 a[242:243], v6 offset:50176
    ds_read_b64_tr_b16 a[244:245], v7 offset:49152
    ds_read_b64_tr_b16 a[246:247], v7 offset:50176
    s_waitcnt lgkmcnt(8)
    ds_read_b64_tr_b16 a[248:249], v6 offset:57344
    ds_read_b64_tr_b16 a[250:251], v6 offset:58368
    ds_read_b64_tr_b16 a[252:253], v7 offset:57344
    ds_read_b64_tr_b16 a[254:255], v7 offset:58368
    s_waitcnt lgkmcnt(8)
    s_waitcnt lgkmcnt(0)
    s_barrier
    s_add_u32 s65, s49, 98304
    s_add_u32 m0, s65, 0
    s_nop 0
    buffer_load_dwordx4 v8, s[32:35], s45 offen lds
    s_add_u32 m0, s65, 1024
    s_nop 0
    buffer_load_dwordx4 v9, s[32:35], s45 offen lds
    s_add_u32 m0, s65, 2048
    s_nop 0
    buffer_load_dwordx4 v10, s[32:35], s45 offen lds
    s_add_u32 m0, s65, 3072
    s_nop 0
    buffer_load_dwordx4 v11, s[32:35], s45 offen lds
    s_add_u32 s45, s45, 128
    s_cmp_eq_u32 s40, 0
    s_cbranch_scc0 Lone_56
    v_mov_b32 v20, 2
    s_mov_b64 exec, 1
    buffer_atomic_add v20, off, s[4:7], s71 offset:0 sc1
    s_mov_b64 exec, -1
Lone_56:
    s_lshl_b32 s42, s53, 2
    s_lshr_b32 s41, s54, 3
    s_add_u32 s42, s42, s41
    s_lshl_b32 s42, s42, 10
    s_add_u32 s42, s42, 0x4dc0020
    s_cmp_eq_u32 s56, 0
    s_cselect_b32 s42, 0x10000000, s42
    s_cmp_eq_u32 s40, 0
    s_cbranch_scc0 Lone_57
    v_mov_b32 v20, 1
    s_mov_b64 exec, 1
    buffer_atomic_add v20, off, s[4:7], s42 offset:0 sc1
    s_mov_b64 exec, -1
Lone_57:
    s_cmp_eq_u32 s56, 1
    s_cbranch_scc1 L_noshort
    s_mov_b32 s71, s63
    ds_read_b128 v[32:35], v1 offset:0
    ds_read_b128 v[36:39], v1 offset:2048
    ds_read_b128 v[40:43], v1 offset:4096
    ds_read_b128 v[44:47], v1 offset:6144
    ds_read_b128 v[48:51], v1 offset:8192
    ds_read_b128 v[52:55], v1 offset:10240
    ds_read_b128 v[56:59], v1 offset:12288
    ds_read_b128 v[60:63], v1 offset:14336
L_g3s:
    buffer_store_dwordx4 v[24:27], v3, s[4:7], s72 offen sc1
    s_mov_b32 s74, s70
    s_mov_b32 s70, s51
    s_waitcnt lgkmcnt(0)
    v_mfma_f32_16x16x32_bf16 v[128:131], a[0:3], v[32:35], 0
    ds_read_b128 v[64:67], v2 offset:0
    ds_read_b128 v[68:71], v2 offset:2048
    v_mfma_f32_16x16x32_bf16 v[132:135], a[4:7], v[32:35], 0
    ds_read_b128 v[72:75], v2 offset:4096
    ds_read_b128 v[76:79], v2 offset:6144
    v_mfma_f32_16x16x32_bf16 v[136:139], a[0:3], v[36:39], 0
    s_add_u32 s65, s49, 114688
    s_add_u32 m0, s65, 0
    v_mfma_f32_16x16x32_bf16 v[140:143], a[4:7], v[36:39], 0
    buffer_load_dwordx4 v8, s[32:35], s45 offen lds
    s_add_u32 m0, s65, 1024
    v_mfma_f32_16x16x32_bf16 v[144:147], a[0:3], v[40:43], 0
    buffer_load_dwordx4 v9, s[32:35], s45 offen lds
    s_add_u32 m0, s65, 2048
    v_mfma_f32_16x16x32_bf16 v[148:151], a[4:7], v[40:43], 0
    buffer_load_dwordx4 v10, s[32:35], s45 offen lds
    s_add_u32 m0, s65, 3072
    v_mfma_f32_16x16x32_bf16 v[152:155], a[0:3], v[44:47], 0
    buffer_load_dwordx4 v11, s[32:35], s45 offen lds
    s_add_u32 s45, s45, 128
    v_mfma_f32_16x16x32_bf16 v[156:159], a[4:7], v[44:47], 0
    v_add_u32 v1, 0x4000, v1
    v_add_u32 v2, 0x4000, v2
    s_waitcnt vmcnt(8) lgkmcnt(0)
    s_barrier
    v_mfma_f32_16x16x32_bf16 v[128:131], a[8:11], v[64:67], v[128:131]
    ds_read_b128 v[32:35], v1 offset:0
    v_mfma_f32_16x16x32_bf16 v[132:135], a[12:15], v[64:67], v[132:135]
    ds_read_b128 v[36:39], v1 offset:2048
    v_mfma_f32_16x16x32_bf16 v[136:139], a[8:11], v[68:71], v[136:139]
    ds_read_b128 v[40:43], v1 offset:4096
    v_mfma_f32_16x16x32_bf16 v[140:143], a[12:15], v[68:71], v[140:143]
    ds_read_b128 v[44:47], v1 offset:6144
    v_mfma_f32_16x16x32_bf16 v[144:147], a[8:11], v[72:75], v[144:147]
    v_mfma_f32_16x16x32_bf16 v[148:151], a[12:15], v[72:75], v[148:151]
    v_mfma_f32_16x16x32_bf16 v[152:155], a[8:11], v[76:79], v[152:155]
    v_mfma_f32_16x16x32_bf16 v[156:159], a[12:15], v[76:79], v[156:159]
    s_waitcnt lgkmcnt(0)
    v_mfma_f32_16x16x32_bf16 v[128:131], a[16:19], v[32:35], v[128:131]
    ds_read_b128 v[64:67], v2 offset:0
    ds_read_b128 v[68:71], v2 offset:2048
    v_mfma_f32_16x16x32_bf16 v[132:135], a[20:23], v[32:35], v[132:135]
    ds_read_b128 v[72:75], v2 offset:4096
    ds_read_b128 v[76:79], v2 offset:6144
    v_mfma_f32_16x16x32_bf16 v[136:139], a[16:19], v[36:39], v[136:139]
    s_add_u32 s65, s49, 131072
    s_add_u32 m0, s65, 0
    v_mfma_f32_16x16x32_bf16 v[140:143], a[20:23], v[36:39], v[140:143]
    buffer_load_dwordx4 v8, s[32:35], s45 offen lds
    s_add_u32 m0, s65, 1024
    v_mfma_f32_16x16x32_bf16 v[144:147], a[16:19], v[40:43], v[144:147]
    buffer_load_dwordx4 v9, s[32:35], s45 offen lds
    s_add_u32 m0, s65, 2048
    v_mfma_f32_16x16x32_bf16 v[148:151], a[20:23], v[40:43], v[148:151]
    buffer_load_dwordx4 v10, s[32:35], s45 offen lds
    s_add_u32 m0, s65, 3072
    v_mfma_f32_16x16x32_bf16 v[152:155], a[16:19], v[44:47], v[152:155]
    buffer_load_dwordx4 v11, s[32:35], s45 offen lds
    s_add_u32 s45, s45, 128
    v_mfma_f32_16x16x32_bf16 v[156:159], a[20:23], v[44:47], v[156:159]
    v_add_u32 v1, 0xffff4000, v1
    v_add_u32 v2, 0xffff4000, v2
    s_waitcnt vmcnt(8) lgkmcnt(0)
    s_barrier
    v_mfma_f32_16x16x32_bf16 v[128:131], a[24:27], v[64:67], v[128:131]
    ds_read_b128 v[32:35], v1 offset:0
    v_mfma_f32_16x16x32_bf16 v[132:135], a[28:31], v[64:67], v[132:135]
    ds_read_b128 v[36:39], v1 offset:2048
    v_mfma_f32_16x16x32_bf16 v[136:139], a[24:27], v[68:71], v[136:139]
    ds_read_b128 v[40:43], v1 offset:4096
    v_mfma_f32_16x16x32_bf16 v[140:143], a[28:31], v[68:71], v[140:143]
    ds_read_b128 v[44:47], v1 offset:6144
    v_mfma_f32_16x16x32_bf16 v[144:147], a[24:27], v[72:75], v[144:147]
    v_mfma_f32_16x16x32_bf16 v[148:151], a[28:31], v[72:75], v[148:151]
    v_mfma_f32_16x16x32_bf16 v[152:155], a[24:27], v[76:79], v[152:155]
    v_mfma_f32_16x16x32_bf16 v[156:159], a[28:31], v[76:79], v[156:159]
    s_waitcnt lgkmcnt(0)
    v_mfma_f32_16x16x32_bf16 v[128:131], a[32:35], v[32:35], v[128:131]
    ds_read_b128 v[64:67], v2 offset:0
    ds_read_b128 v[68:71], v2 offset:2048
    v_mfma_f32_16x16x32_bf16 v[132:135], a[36:39], v[32:35], v[132:135]
    ds_read_b128 v[72:75], v2 offset:4096
    ds_read_b128 v[76:79], v2 offset:6144
    v_mfma_f32_16x16x32_bf16 v[136:139], a[32:35], v[36:39], v[136:139]
    s_add_u32 s65, s49, 147456
    s_add_u32 m0, s65, 0
    v_mfma_f32_16x16x32_bf16 v[140:143], a[36:39], v[36:39], v[140:143]
    buffer_load_dwordx4 v8, s[32:35], s45 offen lds
    s_add_u32 m0, s65, 1024
    v_mfma_f32_16x16x32_bf16 v[144:147], a[32:35], v[40:43], v[144:147]
    buffer_load_dwordx4 v9, s[32:35], s45 offen lds
    s_add_u32 m0, s65, 2048
    v_mfma_f32_16x16x32_bf16 v[148:151], a[36:39], v[40:43], v[148:151]
    buffer_load_dwordx4 v10, s[32:35], s45 offen lds
    s_add_u32 m0, s65, 3072
    v_mfma_f32_16x16x32_bf16 v[152:155], a[32:35], v[44:47], v[152:155]
    buffer_load_dwordx4 v11, s[32:35], s45 offen lds
    s_add_u32 s45, s45, 128
    v_mfma_f32_16x16x32_bf16 v[156:159], a[36:39], v[44:47], v[156:159]
    v_add_u32 v1, 0x4000, v1
    v_add_u32 v2, 0x4000, v2
    s_waitcnt vmcnt(8) lgkmcnt(0)
    s_barrier
    v_mfma_f32_16x16x32_bf16 v[128:131], a[40:43], v[64:67], v[128:131]
    ds_read_b128 v[32:35], v1 offset:0
    v_mfma_f32_16x16x32_bf16 v[132:135], a[44:47], v[64:67], v[132:135]
    ds_read_b128 v[36:39], v1 offset:2048
    v_mfma_f32_16x16x32_bf16 v[136:139], a[40:43], v[68:71], v[136:139]
    ds_read_b128 v[40:43], v1 offset:4096
    v_mfma_f32_16x16x32_bf16 v[140:143], a[44:47], v[68:71], v[140:143]
    ds_read_b128 v[44:47], v1 offset:6144
    v_mfma_f32_16x16x32_bf16 v[144:147], a[40:43], v[72:75], v[144:147]
    v_mfma_f32_16x16x32_bf16 v[148:151], a[44:47], v[72:75], v[148:151]
    v_mfma_f32_16x16x32_bf16 v[152:155], a[40:43], v[76:79], v[152:155]
    v_mfma_f32_16x16x32_bf16 v[156:159], a[44:47], v[76:79], v[156:159]
    s_waitcnt lgkmcnt(0)
    v_mfma_f32_16x16x32_bf16 v[128:131], a[48:51], v[32:35], v[128:131]
    ds_read_b128 v[64:67], v2 offset:0
    ds_read_b128 v[68:71], v2 offset:2048
    v_mfma_f32_16x16x32_bf16 v[132:135], a[52:55], v[32:35], v[132:135]
    ds_read_b128 v[72:75], v2 offset:4096
    ds_read_b128 v[76:79], v2 offset:6144
    v_mfma_f32_16x16x32_bf16 v[136:139], a[48:51], v[36:39], v[136:139]
    s_add_u32 s65, s49, 98304
    s_add_u32 m0, s65, 0
    v_mfma_f32_16x16x32_bf16 v[140:143], a[52:55], v[36:39], v[140:143]
    buffer_load_dwordx4 v8, s[32:35], s45 offen lds
    s_add_u32 m0, s65, 1024
    v_mfma_f32_16x16x32_bf16 v[144:147], a[48:51], v[40:43], v[144:147]
    buffer_load_dwordx4 v9, s[32:35], s45 offen lds
    s_add_u32 m0, s65, 2048
    v_mfma_f32_16x16x32_bf16 v[148:151], a[52:55], v[40:43], v[148:151]
    buffer_load_dwordx4 v10, s[32:35], s45 offen lds
    s_add_u32 m0, s65, 3072
    v_mfma_f32_16x16x32_bf16 v[152:155], a[48:51], v[44:47], v[152:155]
    buffer_load_dwordx4 v11, s[32:35], s45 offen lds
    s_add_u32 s45, s45, 128
    v_mfma_f32_16x16x32_bf16 v[156:159], a[52:55], v[44:47], v[156:159]
    v_add_u32 v1, 0x4000, v1
    v_add_u32 v2, 0x4000, v2
    s_waitcnt vmcnt(8) lgkmcnt(0)
    s_barrier
    v_mfma_f32_16x16x32_bf16 v[128:131], a[56:59], v[64:67], v[128:131]
    ds_read_b128 v[32:35], v1 offset:0
    v_mfma_f32_16x16x32_bf16 v[132:135], a[60:63], v[64:67], v[132:135]
    ds_read_b128 v[36:39], v1 offset:2048
    v_mfma_f32_16x16x32_bf16 v[136:139], a[56:59], v[68:71], v[136:139]
    ds_read_b128 v[40:43], v1 offset:4096
    v_mfma_f32_16x16x32_bf16 v[140:143], a[60:63], v[68:71], v[140:143]
    ds_read_b128 v[44:47], v1 offset:6144
    v_mfma_f32_16x16x32_bf16 v[144:147], a[56:59], v[72:75], v[144:147]
    v_mfma_f32_16x16x32_bf16 v[148:151], a[60:63], v[72:75], v[148:151]
    v_mfma_f32_16x16x32_bf16 v[152:155], a[56:59], v[76:79], v[152:155]
    v_mfma_f32_16x16x32_bf16 v[156:159], a[60:63], v[76:79], v[156:159]
    s_waitcnt lgkmcnt(0)
    v_mfma_f32_16x16x32_bf16 v[128:131], a[64:67], v[32:35], v[128:131]
    ds_read_b128 v[64:67], v2 offset:0
    ds_read_b128 v[68:71], v2 offset:2048
    v_mfma_f32_16x16x32_bf16 v[132:135], a[68:71], v[32:35], v[132:135]
    ds_read_b128 v[72:75], v2 offset:4096
    ds_read_b128 v[76:79], v2 offset:6144
    v_mfma_f32_16x16x32_bf16 v[136:139], a[64:67], v[36:39], v[136:139]
    s_add_u32 s65, s49, 114688
    s_add_u32 m0, s65, 0
    v_mfma_f32_16x16x32_bf16 v[140:143], a[68:71], v[36:39], v[140:143]
    buffer_load_dwordx4 v8, s[32:35], s45 offen lds
    s_add_u32 m0, s65, 1024
    v_mfma_f32_16x16x32_bf16 v[144:147], a[64:67], v[40:43], v[144:147]
    buffer_load_dwordx4 v9, s[32:35], s45 offen lds
    s_add_u32 m0, s65, 2048
    v_mfma_f32_16x16x32_bf16 v[148:151], a[68:71], v[40:43], v[148:151]
    buffer_load_dwordx4 v10, s[32:35], s45 offen lds
    s_add_u32 m0, s65, 3072
    v_mfma_f32_16x16x32_bf16 v[152:155], a[64:67], v[44:47], v[152:155]
    buffer_load_dwordx4 v11, s[32:35], s45 offen lds
    s_add_u32 s45, s45, 128
    v_mfma_f32_16x16x32_bf16 v[156:159], a[68:71], v[44:47], v[156:159]
    v_add_u32 v1, 0x4000, v1
    v_add_u32 v2, 0x4000, v2
    s_waitcnt vmcnt(8) lgkmcnt(0)
    s_barrier
    v_mfma_f32_16x16x32_bf16 v[128:131], a[72:75], v[64:67], v[128:131]
    ds_read_b128 v[32:35], v1 offset:0
    v_mfma_f32_16x16x32_bf16 v[132:135], a[76:79], v[64:67], v[132:135]
    ds_read_b128 v[36:39], v1 offset:2048
    v_mfma_f32_16x16x32_bf16 v[136:139], a[72:75], v[68:71], v[136:139]
    ds_read_b128 v[40:43], v1 offset:4096
    v_mfma_f32_16x16x32_bf16 v[140:143], a[76:79], v[68:71], v[140:143]
    ds_read_b128 v[44:47], v1 offset:6144
    v_mfma_f32_16x16x32_bf16 v[144:147], a[72:75], v[72:75], v[144:147]
    v_mfma_f32_16x16x32_bf16 v[148:151], a[76:79], v[72:75], v[148:151]
    v_mfma_f32_16x16x32_bf16 v[152:155], a[72:75], v[76:79], v[152:155]
    v_mfma_f32_16x16x32_bf16 v[156:159], a[76:79], v[76:79], v[156:159]
    s_waitcnt lgkmcnt(0)
    v_mfma_f32_16x16x32_bf16 v[128:131], a[80:83], v[32:35], v[128:131]
    ds_read_b128 v[64:67], v2 offset:0
    ds_read_b128 v[68:71], v2 offset:2048
    v_mfma_f32_16x16x32_bf16 v[132:135], a[84:87], v[32:35], v[132:135]
    ds_read_b128 v[72:75], v2 offset:4096
    ds_read_b128 v[76:79], v2 offset:6144
    v_mfma_f32_16x16x32_bf16 v[136:139], a[80:83], v[36:39], v[136:139]
    s_add_u32 s65, s49, 131072
    s_add_u32 m0, s65, 0
    v_mfma_f32_16x16x32_bf16 v[140:143], a[84:87], v[36:39], v[140:143]
    buffer_load_dwordx4 v8, s[32:35], s45 offen lds
    s_add_u32 m0, s65, 1024
    v_mfma_f32_16x16x32_bf16 v[144:147], a[80:83], v[40:43], v[144:147]
    buffer_load_dwordx4 v9, s[32:35], s45 offen lds
    s_add_u32 m0, s65, 2048
    v_mfma_f32_16x16x32_bf16 v[148:151], a[84:87], v[40:43], v[148:151]
    buffer_load_dwordx4 v10, s[32:35], s45 offen lds
    s_add_u32 m0, s65, 3072
    v_mfma_f32_16x16x32_bf16 v[152:155], a[80:83], v[44:47], v[152:155]
    buffer_load_dwordx4 v11, s[32:35], s45 offen lds
    s_add_u32 s45, s45, 128
    v_mfma_f32_16x16x32_bf16 v[156:159], a[84:87], v[44:47], v[156:159]
    v_add_u32 v1, 0xffff4000, v1
    v_add_u32 v2, 0xffff4000, v2
    s_waitcnt vmcnt(8) lgkmcnt(0)
    s_barrier
    v_mfma_f32_16x16x32_bf16 v[128:131], a[88:91], v[64:67], v[128:131]
    ds_read_b128 v[32:35], v1 offset:0
    v_mfma_f32_16x16x32_bf16 v[132:135], a[92:95], v[64:67], v[132:135]
    ds_read_b128 v[36:39], v1 offset:2048
    v_mfma_f32_16x16x32_bf16 v[136:139], a[88:91], v[68:71], v[136:139]
    ds_read_b128 v[40:43], v1 offset:4096
    v_mfma_f32_16x16x32_bf16 v[140:143], a[92:95], v[68:71], v[140:143]
    ds_read_b128 v[44:47], v1 offset:6144
    v_mfma_f32_16x16x32_bf16 v[144:147], a[88:91], v[72:75], v[144:147]
    v_mfma_f32_16x16x32_bf16 v[148:151], a[92:95], v[72:75], v[148:151]
    v_mfma_f32_16x16x32_bf16 v[152:155], a[88:91], v[76:79], v[152:155]
    v_mfma_f32_16x16x32_bf16 v[156:159], a[92:95], v[76:79], v[156:159]
    s_waitcnt lgkmcnt(0)
    v_mfma_f32_16x16x32_bf16 v[128:131], a[96:99], v[32:35], v[128:131]
    ds_read_b128 v[64:67], v2 offset:0
    ds_read_b128 v[68:71], v2 offset:2048
    v_mfma_f32_16x16x32_bf16 v[132:135], a[100:103], v[32:35], v[132:135]
    ds_read_b128 v[72:75], v2 offset:4096
    ds_read_b128 v[76:79], v2 offset:6144
    v_mfma_f32_16x16x32_bf16 v[136:139], a[96:99], v[36:39], v[136:139]
    s_add_u32 s65, s49, 147456
    s_add_u32 m0, s65, 0
    v_mfma_f32_16x16x32_bf16 v[140:143], a[100:103], v[36:39], v[140:143]
    buffer_load_dwordx4 v8, s[32:35], s45 offen lds
    s_add_u32 m0, s65, 1024
    v_mfma_f32_16x16x32_bf16 v[144:147], a[96:99], v[40:43], v[144:147]
    buffer_load_dwordx4 v9, s[32:35], s45 offen lds
    s_add_u32 m0, s65, 2048
    v_mfma_f32_16x16x32_bf16 v[148:151], a[100:103], v[40:43], v[148:151]
    buffer_load_dwordx4 v10, s[32:35], s45 offen lds
    s_add_u32 m0, s65, 3072
    v_mfma_f32_16x16x32_bf16 v[152:155], a[96:99], v[44:47], v[152:155]
    buffer_load_dwordx4 v11, s[32:35], s45 offen lds
    s_add_u32 s45, s45, 128
    v_mfma_f32_16x16x32_bf16 v[156:159], a[100:103], v[44:47], v[156:159]
    v_add_u32 v1, 0x4000, v1
    v_add_u32 v2, 0x4000, v2
    s_waitcnt vmcnt(8) lgkmcnt(0)
    s_barrier
    v_mfma_f32_16x16x32_bf16 v[128:131], a[104:107], v[64:67], v[128:131]
    ds_read_b128 v[32:35], v1 offset:0
    v_mfma_f32_16x16x32_bf16 v[132:135], a[108:111], v[64:67], v[132:135]
    ds_read_b128 v[36:39], v1 offset:2048
    v_mfma_f32_16x16x32_bf16 v[136:139], a[104:107], v[68:71], v[136:139]
    ds_read_b128 v[40:43], v1 offset:4096
    v_mfma_f32_16x16x32_bf16 v[140:143], a[108:111], v[68:71], v[140:143]
    ds_read_b128 v[44:47], v1 offset:6144
    v_mfma_f32_16x16x32_bf16 v[144:147], a[104:107], v[72:75], v[144:147]
    v_mfma_f32_16x16x32_bf16 v[148:151], a[108:111], v[72:75], v[148:151]
    v_mfma_f32_16x16x32_bf16 v[152:155], a[104:107], v[76:79], v[152:155]
    v_mfma_f32_16x16x32_bf16 v[156:159], a[108:111], v[76:79], v[156:159]
    s_waitcnt lgkmcnt(0)
    v_mfma_f32_16x16x32_bf16 v[128:131], a[112:115], v[32:35], v[128:131]
    ds_read_b128 v[64:67], v2 offset:0
    ds_read_b128 v[68:71], v2 offset:2048
    v_mfma_f32_16x16x32_bf16 v[132:135], a[116:119], v[32:35], v[132:135]
    ds_read_b128 v[72:75], v2 offset:4096
    ds_read_b128 v[76:79], v2 offset:6144
    v_mfma_f32_16x16x32_bf16 v[136:139], a[112:115], v[36:39], v[136:139]
    s_add_u32 s65, s49, 98304
    s_add_u32 m0, s65, 0
    v_mfma_f32_16x16x32_bf16 v[140:143], a[116:119], v[36:39], v[140:143]
    buffer_load_dwordx4 v8, s[32:35], s45 offen lds
    s_add_u32 m0, s65, 1024
    v_mfma_f32_16x16x32_bf16 v[144:147], a[112:115], v[40:43], v[144:147]
    buffer_load_dwordx4 v9, s[32:35], s45 offen lds
    s_add_u32 m0, s65, 2048
    v_mfma_f32_16x16x32_bf16 v[148:151], a[116:119], v[40:43], v[148:151]
    buffer_load_dwordx4 v10, s[32:35], s45 offen lds
    s_add_u32 m0, s65, 3072
    v_mfma_f32_16x16x32_bf16 v[152:155], a[112:115], v[44:47], v[152:155]
    buffer_load_dwordx4 v11, s[32:35], s45 offen lds
    s_add_u32 s45, s45, 128
    v_mfma_f32_16x16x32_bf16 v[156:159], a[116:119], v[44:47], v[156:159]
    v_add_u32 v1, 0x4000, v1
    v_add_u32 v2, 0x4000, v2
    s_waitcnt vmcnt(8) lgkmcnt(0)
    s_barrier
    v_mfma_f32_16x16x32_bf16 v[128:131], a[120:123], v[64:67], v[128:131]
    ds_read_b128 v[32:35], v1 offset:0
    v_mfma_f32_16x16x32_bf16 v[132:135], a[124:127], v[64:67], v[132:135]
    ds_read_b128 v[36:39], v1 offset:2048
    v_mfma_f32_16x16x32_bf16 v[136:139], a[120:123], v[68:71], v[136:139]
    ds_read_b128 v[40:43], v1 offset:4096
    v_mfma_f32_16x16x32_bf16 v[140:143], a[124:127], v[68:71], v[140:143]
    ds_read_b128 v[44:47], v1 offset:6144
    v_mfma_f32_16x16x32_bf16 v[144:147], a[120:123], v[72:75], v[144:147]
    v_mfma_f32_16x16x32_bf16 v[148:151], a[124:127], v[72:75], v[148:151]
    v_mfma_f32_16x16x32_bf16 v[152:155], a[120:123], v[76:79], v[152:155]
    v_mfma_f32_16x16x32_bf16 v[156:159], a[124:127], v[76:79], v[156:159]
    s_waitcnt lgkmcnt(0)
    v_mfma_f32_16x16x32_bf16 v[128:131], a[128:131], v[32:35], v[128:131]
    ds_read_b128 v[64:67], v2 offset:0
    ds_read_b128 v[68:71], v2 offset:2048
    v_mfma_f32_16x16x32_bf16 v[132:135], a[132:135], v[32:35], v[132:135]
    ds_read_b128 v[72:75], v2 offset:4096
    ds_read_b128 v[76:79], v2 offset:6144
    v_mfma_f32_16x16x32_bf16 v[136:139], a[128:131], v[36:39], v[136:139]
    s_add_u32 s65, s49, 114688
    s_add_u32 m0, s65, 0
    v_mfma_f32_16x16x32_bf16 v[140:143], a[132:135], v[36:39], v[140:143]
    buffer_load_dwordx4 v8, s[32:35], s45 offen lds
    s_add_u32 m0, s65, 1024
    v_mfma_f32_16x16x32_bf16 v[144:147], a[128:131], v[40:43], v[144:147]
    buffer_load_dwordx4 v9, s[32:35], s45 offen lds
    s_add_u32 m0, s65, 2048
    v_mfma_f32_16x16x32_bf16 v[148:151], a[132:135], v[40:43], v[148:151]
    buffer_load_dwordx4 v10, s[32:35], s45 offen lds
    s_add_u32 m0, s65, 3072
    v_mfma_f32_16x16x32_bf16 v[152:155], a[128:131], v[44:47], v[152:155]
    buffer_load_dwordx4 v11, s[32:35], s45 offen lds
    s_add_u32 s45, s45, 128
    v_mfma_f32_16x16x32_bf16 v[156:159], a[132:135], v[44:47], v[156:159]
    v_add_u32 v1, 0x4000, v1
    v_add_u32 v2, 0x4000, v2
    s_waitcnt vmcnt(8) lgkmcnt(0)
    s_barrier
    v_mfma_f32_16x16x32_bf16 v[128:131], a[136:139], v[64:67], v[128:131]
    ds_read_b128 v[32:35], v1 offset:0
    v_mfma_f32_16x16x32_bf16 v[132:135], a[140:143], v[64:67], v[132:135]
    ds_read_b128 v[36:39], v1 offset:2048
    v_mfma_f32_16x16x32_bf16 v[136:139], a[136:139], v[68:71], v[136:139]
    ds_read_b128 v[40:43], v1 offset:4096
    v_mfma_f32_16x16x32_bf16 v[140:143], a[140:143], v[68:71], v[140:143]
    ds_read_b128 v[44:47], v1 offset:6144
    v_mfma_f32_16x16x32_bf16 v[144:147], a[136:139], v[72:75], v[144:147]
    v_mfma_f32_16x16x32_bf16 v[148:151], a[140:143], v[72:75], v[148:151]
    v_mfma_f32_16x16x32_bf16 v[152:155], a[136:139], v[76:79], v[152:155]
    v_mfma_f32_16x16x32_bf16 v[156:159], a[140:143], v[76:79], v[156:159]
    s_waitcnt lgkmcnt(0)
    v_mfma_f32_16x16x32_bf16 v[128:131], a[144:147], v[32:35], v[128:131]
    ds_read_b128 v[64:67], v2 offset:0
    ds_read_b128 v[68:71], v2 offset:2048
    v_mfma_f32_16x16x32_bf16 v[132:135], a[148:151], v[32:35], v[132:135]
    ds_read_b128 v[72:75], v2 offset:4096
    ds_read_b128 v[76:79], v2 offset:6144
    v_mfma_f32_16x16x32_bf16 v[136:139], a[144:147], v[36:39], v[136:139]
    s_add_u32 s65, s49, 131072
    s_add_u32 m0, s65, 0
    v_mfma_f32_16x16x32_bf16 v[140:143], a[148:151], v[36:39], v[140:143]
    buffer_load_dwordx4 v8, s[32:35], s45 offen lds
    s_add_u32 m0, s65, 1024
    v_mfma_f32_16x16x32_bf16 v[144:147], a[144:147], v[40:43], v[144:147]
    buffer_load_dwordx4 v9, s[32:35], s45 offen lds
    s_add_u32 m0, s65, 2048
    v_mfma_f32_16x16x32_bf16 v[148:151], a[148:151], v[40:43], v[148:151]
    buffer_load_dwordx4 v10, s[32:35], s45 offen lds
    s_add_u32 m0, s65, 3072
    v_mfma_f32_16x16x32_bf16 v[152:155], a[144:147], v[44:47], v[152:155]
    buffer_load_dwordx4 v11, s[32:35], s45 offen lds
    s_add_u32 s45, s45, 128
    v_mfma_f32_16x16x32_bf16 v[156:159], a[148:151], v[44:47], v[156:159]
    v_add_u32 v1, 0xffff4000, v1
    v_add_u32 v2, 0xffff4000, v2
    s_waitcnt vmcnt(8) lgkmcnt(0)
    s_barrier
    v_mfma_f32_16x16x32_bf16 v[128:131], a[152:155], v[64:67], v[128:131]
    ds_read_b128 v[32:35], v1 offset:0
    v_mfma_f32_16x16x32_bf16 v[132:135], a[156:159], v[64:67], v[132:135]
    ds_read_b128 v[36:39], v1 offset:2048
    v_mfma_f32_16x16x32_bf16 v[136:139], a[152:155], v[68:71], v[136:139]
    ds_read_b128 v[40:43], v1 offset:4096
    v_mfma_f32_16x16x32_bf16 v[140:143], a[156:159], v[68:71], v[140:143]
    ds_read_b128 v[44:47], v1 offset:6144
    v_mfma_f32_16x16x32_bf16 v[144:147], a[152:155], v[72:75], v[144:147]
    v_mfma_f32_16x16x32_bf16 v[148:151], a[156:159], v[72:75], v[148:151]
    v_mfma_f32_16x16x32_bf16 v[152:155], a[152:155], v[76:79], v[152:155]
    v_mfma_f32_16x16x32_bf16 v[156:159], a[156:159], v[76:79], v[156:159]
    s_waitcnt lgkmcnt(0)
    v_mfma_f32_16x16x32_bf16 v[128:131], a[160:163], v[32:35], v[128:131]
    ds_read_b128 v[64:67], v2 offset:0
    ds_read_b128 v[68:71], v2 offset:2048
    v_mfma_f32_16x16x32_bf16 v[132:135], a[164:167], v[32:35], v[132:135]
    ds_read_b128 v[72:75], v2 offset:4096
    ds_read_b128 v[76:79], v2 offset:6144
    v_mfma_f32_16x16x32_bf16 v[136:139], a[160:163], v[36:39], v[136:139]
    s_add_u32 s65, s49, 147456
    s_add_u32 m0, s65, 0
    v_mfma_f32_16x16x32_bf16 v[140:143], a[164:167], v[36:39], v[140:143]
    buffer_load_dwordx4 v8, s[32:35], s45 offen lds
    s_add_u32 m0, s65, 1024
    v_mfma_f32_16x16x32_bf16 v[144:147], a[160:163], v[40:43], v[144:147]
    buffer_load_dwordx4 v9, s[32:35], s45 offen lds
    s_add_u32 m0, s65, 2048
    v_mfma_f32_16x16x32_bf16 v[148:151], a[164:167], v[40:43], v[148:151]
    buffer_load_dwordx4 v10, s[32:35], s45 offen lds
    s_add_u32 m0, s65, 3072
    v_mfma_f32_16x16x32_bf16 v[152:155], a[160:163], v[44:47], v[152:155]
    buffer_load_dwordx4 v11, s[32:35], s45 offen lds
    s_add_u32 s45, s45, 128
    v_mfma_f32_16x16x32_bf16 v[156:159], a[164:167], v[44:47], v[156:159]
    v_add_u32 v1, 0x4000, v1
    v_add_u32 v2, 0x4000, v2
    s_waitcnt vmcnt(8) lgkmcnt(0)
    s_barrier
    v_mfma_f32_16x16x32_bf16 v[128:131], a[168:171], v[64:67], v[128:131]
    ds_read_b128 v[32:35], v1 offset:0
    v_mfma_f32_16x16x32_bf16 v[132:135], a[172:175], v[64:67], v[132:135]
    ds_read_b128 v[36:39], v1 offset:2048
    v_mfma_f32_16x16x32_bf16 v[136:139], a[168:171], v[68:71], v[136:139]
    ds_read_b128 v[40:43], v1 offset:4096
    v_mfma_f32_16x16x32_bf16 v[140:143], a[172:175], v[68:71], v[140:143]
    ds_read_b128 v[44:47], v1 offset:6144
    v_mfma_f32_16x16x32_bf16 v[144:147], a[168:171], v[72:75], v[144:147]
    v_mfma_f32_16x16x32_bf16 v[148:151], a[172:175], v[72:75], v[148:151]
    v_mfma_f32_16x16x32_bf16 v[152:155], a[168:171], v[76:79], v[152:155]
    v_mfma_f32_16x16x32_bf16 v[156:159], a[172:175], v[76:79], v[156:159]
    s_waitcnt lgkmcnt(0)
    v_mfma_f32_16x16x32_bf16 v[128:131], a[176:179], v[32:35], v[128:131]
    ds_read_b128 v[64:67], v2 offset:0
    ds_read_b128 v[68:71], v2 offset:2048
    v_mfma_f32_16x16x32_bf16 v[132:135], a[180:183], v[32:35], v[132:135]
    ds_read_b128 v[72:75], v2 offset:4096
    ds_read_b128 v[76:79], v2 offset:6144
    v_mfma_f32_16x16x32_bf16 v[136:139], a[176:179], v[36:39], v[136:139]
    s_add_u32 s65, s49, 98304
    s_add_u32 m0, s65, 0
    v_mfma_f32_16x16x32_bf16 v[140:143], a[180:183], v[36:39], v[140:143]
    buffer_load_dwordx4 v8, s[32:35], s45 offen lds
    s_add_u32 m0, s65, 1024
    v_mfma_f32_16x16x32_bf16 v[144:147], a[176:179], v[40:43], v[144:147]
    buffer_load_dwordx4 v9, s[32:35], s45 offen lds
    s_add_u32 m0, s65, 2048
    v_mfma_f32_16x16x32_bf16 v[148:151], a[180:183], v[40:43], v[148:151]
    buffer_load_dwordx4 v10, s[32:35], s45 offen lds
    s_add_u32 m0, s65, 3072
    v_mfma_f32_16x16x32_bf16 v[152:155], a[176:179], v[44:47], v[152:155]
    buffer_load_dwordx4 v11, s[32:35], s45 offen lds
    s_add_u32 s45, s45, 128
    v_mfma_f32_16x16x32_bf16 v[156:159], a[180:183], v[44:47], v[156:159]
    v_add_u32 v1, 0x4000, v1
    v_add_u32 v2, 0x4000, v2
    s_waitcnt vmcnt(8) lgkmcnt(0)
    s_barrier
    v_mfma_f32_16x16x32_bf16 v[128:131], a[184:187], v[64:67], v[128:131]
    ds_read_b128 v[32:35], v1 offset:0
    v_mfma_f32_16x16x32_bf16 v[132:135], a[188:191], v[64:67], v[132:135]
    ds_read_b128 v[36:39], v1 offset:2048
    v_mfma_f32_16x16x32_bf16 v[136:139], a[184:187], v[68:71], v[136:139]
    ds_read_b128 v[40:43], v1 offset:4096
    v_mfma_f32_16x16x32_bf16 v[140:143], a[188:191], v[68:71], v[140:143]
    ds_read_b128 v[44:47], v1 offset:6144
    v_mfma_f32_16x16x32_bf16 v[144:147], a[184:187], v[72:75], v[144:147]
    v_mfma_f32_16x16x32_bf16 v[148:151], a[188:191], v[72:75], v[148:151]
    v_mfma_f32_16x16x32_bf16 v[152:155], a[184:187], v[76:79], v[152:155]
    v_mfma_f32_16x16x32_bf16 v[156:159], a[188:191], v[76:79], v[156:159]
    s_waitcnt lgkmcnt(0)
    v_mfma_f32_16x16x32_bf16 v[128:131], a[192:195], v[32:35], v[128:131]
    ds_read_b128 v[64:67], v2 offset:0
    ds_read_b128 v[68:71], v2 offset:2048
    v_mfma_f32_16x16x32_bf16 v[132:135], a[196:199], v[32:35], v[132:135]
    ds_read_b128 v[72:75], v2 offset:4096
    ds_read_b128 v[76:79], v2 offset:6144
    v_mfma_f32_16x16x32_bf16 v[136:139], a[192:195], v[36:39], v[136:139]
    s_add_u32 s65, s49, 114688
    s_add_u32 m0, s65, 0
    v_mfma_f32_16x16x32_bf16 v[140:143], a[196:199], v[36:39], v[140:143]
    buffer_load_dwordx4 v8, s[32:35], s45 offen lds
    s_add_u32 m0, s65, 1024
    v_mfma_f32_16x16x32_bf16 v[144:147], a[192:195], v[40:43], v[144:147]
    buffer_load_dwordx4 v9, s[32:35], s45 offen lds
    s_add_u32 m0, s65, 2048
    v_mfma_f32_16x16x32_bf16 v[148:151], a[196:199], v[40:43], v[148:151]
    buffer_load_dwordx4 v10, s[32:35], s45 offen lds
    s_add_u32 m0, s65, 3072
    v_mfma_f32_16x16x32_bf16 v[152:155], a[192:195], v[44:47], v[152:155]
    buffer_load_dwordx4 v11, s[32:35], s45 offen lds
    s_mov_b32 s45, s74
    v_mfma_f32_16x16x32_bf16 v[156:159], a[196:199], v[44:47], v[156:159]
    v_add_u32 v1, 0x4000, v1
    v_add_u32 v2, 0x4000, v2
    s_waitcnt vmcnt(8) lgkmcnt(0)
    s_barrier
    v_mfma_f32_16x16x32_bf16 v[128:131], a[200:203], v[64:67], v[128:131]
    ds_read_b128 v[32:35], v1 offset:0
    v_mfma_f32_16x16x32_bf16 v[132:135], a[204:207], v[64:67], v[132:135]
    ds_read_b128 v[36:39], v1 offset:2048
    v_mfma_f32_16x16x32_bf16 v[136:139], a[200:203], v[68:71], v[136:139]
    ds_read_b128 v[40:43], v1 offset:4096
    v_mfma_f32_16x16x32_bf16 v[140:143], a[204:207], v[68:71], v[140:143]
    ds_read_b128 v[44:47], v1 offset:6144
    v_mfma_f32_16x16x32_bf16 v[144:147], a[200:203], v[72:75], v[144:147]
    v_mfma_f32_16x16x32_bf16 v[148:151], a[204:207], v[72:75], v[148:151]
    v_mfma_f32_16x16x32_bf16 v[152:155], a[200:203], v[76:79], v[152:155]
    v_mfma_f32_16x16x32_bf16 v[156:159], a[204:207], v[76:79], v[156:159]
    s_waitcnt lgkmcnt(0)
    v_mfma_f32_16x16x32_bf16 v[128:131], a[208:211], v[32:35], v[128:131]
    ds_read_b128 v[64:67], v2 offset:0
    ds_read_b128 v[68:71], v2 offset:2048
    v_mfma_f32_16x16x32_bf16 v[132:135], a[212:215], v[32:35], v[132:135]
    ds_read_b128 v[72:75], v2 offset:4096
    ds_read_b128 v[76:79], v2 offset:6144
    v_mfma_f32_16x16x32_bf16 v[136:139], a[208:211], v[36:39], v[136:139]
    s_add_u32 s65, s49, 131072
    s_add_u32 m0, s65, 0
    v_mfma_f32_16x16x32_bf16 v[140:143], a[212:215], v[36:39], v[140:143]
    buffer_load_dwordx4 v8, s[32:35], s45 offen lds
    s_add_u32 m0, s65, 1024
    v_mfma_f32_16x16x32_bf16 v[144:147], a[208:211], v[40:43], v[144:147]
    buffer_load_dwordx4 v9, s[32:35], s45 offen lds
    s_add_u32 m0, s65, 2048
    v_mfma_f32_16x16x32_bf16 v[148:151], a[212:215], v[40:43], v[148:151]
    buffer_load_dwordx4 v10, s[32:35], s45 offen lds
    s_add_u32 m0, s65, 3072
    v_mfma_f32_16x16x32_bf16 v[152:155], a[208:211], v[44:47], v[152:155]
    buffer_load_dwordx4 v11, s[32:35], s45 offen lds
    s_add_u32 s45, s45, 128
    v_mfma_f32_16x16x32_bf16 v[156:159], a[212:215], v[44:47], v[156:159]
    v_add_u32 v1, 0xffff4000, v1
    v_add_u32 v2, 0xffff4000, v2
    s_waitcnt vmcnt(8) lgkmcnt(0)
    s_barrier
    v_mfma_f32_16x16x32_bf16 v[128:131], a[216:219], v[64:67], v[128:131]
    ds_read_b128 v[32:35], v1 offset:0
    v_mfma_f32_16x16x32_bf16 v[132:135], a[220:223], v[64:67], v[132:135]
    ds_read_b128 v[36:39], v1 offset:2048
    v_mfma_f32_16x16x32_bf16 v[136:139], a[216:219], v[68:71], v[136:139]
    ds_read_b128 v[40:43], v1 offset:4096
    v_mfma_f32_16x16x32_bf16 v[140:143], a[220:223], v[68:71], v[140:143]
    ds_read_b128 v[44:47], v1 offset:6144
    v_mfma_f32_16x16x32_bf16 v[144:147], a[216:219], v[72:75], v[144:147]
    v_mfma_f32_16x16x32_bf16 v[148:151], a[220:223], v[72:75], v[148:151]
    v_mfma_f32_16x16x32_bf16 v[152:155], a[216:219], v[76:79], v[152:155]
    v_mfma_f32_16x16x32_bf16 v[156:159], a[220:223], v[76:79], v[156:159]
    s_waitcnt lgkmcnt(0)
    v_mfma_f32_16x16x32_bf16 v[128:131], a[224:227], v[32:35], v[128:131]
    ds_read_b128 v[64:67], v2 offset:0
    ds_read_b128 v[68:71], v2 offset:2048
    v_mfma_f32_16x16x32_bf16 v[132:135], a[228:231], v[32:35], v[132:135]
    ds_read_b128 v[72:75], v2 offset:4096
    ds_read_b128 v[76:79], v2 offset:6144
    v_mfma_f32_16x16x32_bf16 v[136:139], a[224:227], v[36:39], v[136:139]
    s_add_u32 s65, s49, 147456
    s_add_u32 m0, s65, 0
    v_mfma_f32_16x16x32_bf16 v[140:143], a[228:231], v[36:39], v[140:143]
    buffer_load_dwordx4 v8, s[32:35], s45 offen lds
    s_add_u32 m0, s65, 1024
    v_mfma_f32_16x16x32_bf16 v[144:147], a[224:227], v[40:43], v[144:147]
    buffer_load_dwordx4 v9, s[32:35], s45 offen lds
    s_add_u32 m0, s65, 2048
    v_mfma_f32_16x16x32_bf16 v[148:151], a[228:231], v[40:43], v[148:151]
    buffer_load_dwordx4 v10, s[32:35], s45 offen lds
    s_add_u32 m0, s65, 3072
    v_mfma_f32_16x16x32_bf16 v[152:155], a[224:227], v[44:47], v[152:155]
    buffer_load_dwordx4 v11, s[32:35], s45 offen lds
    s_add_u32 s45, s45, 128
    v_mfma_f32_16x16x32_bf16 v[156:159], a[228:231], v[44:47], v[156:159]
    v_add_u32 v1, 0x4000, v1
    v_add_u32 v2, 0x4000, v2
    s_waitcnt vmcnt(8) lgkmcnt(0)
    s_barrier
    v_mfma_f32_16x16x32_bf16 v[128:131], a[232:235], v[64:67], v[128:131]
    ds_read_b128 v[32:35], v1 offset:0
    v_mfma_f32_16x16x32_bf16 v[132:135], a[236:239], v[64:67], v[132:135]
    ds_read_b128 v[36:39], v1 offset:2048
    v_mfma_f32_16x16x32_bf16 v[136:139], a[232:235], v[68:71], v[136:139]
    ds_read_b128 v[40:43], v1 offset:4096
    v_mfma_f32_16x16x32_bf16 v[140:143], a[236:239], v[68:71], v[140:143]
    ds_read_b128 v[44:47], v1 offset:6144
    v_mfma_f32_16x16x32_bf16 v[144:147], a[232:235], v[72:75], v[144:147]
    v_mfma_f32_16x16x32_bf16 v[148:151], a[236:239], v[72:75], v[148:151]
    v_mfma_f32_16x16x32_bf16 v[152:155], a[232:235], v[76:79], v[152:155]
    v_mfma_f32_16x16x32_bf16 v[156:159], a[236:239], v[76:79], v[156:159]
    s_waitcnt lgkmcnt(0)
    v_mfma_f32_16x16x32_bf16 v[128:131], a[240:243], v[32:35], v[128:131]
    ds_read_b128 v[64:67], v2 offset:0
    ds_read_b128 v[68:71], v2 offset:2048
    v_mfma_f32_16x16x32_bf16 v[132:135], a[244:247], v[32:35], v[132:135]
    ds_read_b128 v[72:75], v2 offset:4096
    ds_read_b128 v[76:79], v2 offset:6144
    v_mfma_f32_16x16x32_bf16 v[136:139], a[240:243], v[36:39], v[136:139]
    s_add_u32 s65, s49, 98304
    s_add_u32 m0, s65, 0
    v_mfma_f32_16x16x32_bf16 v[140:143], a[244:247], v[36:39], v[140:143]
    buffer_load_dwordx4 v8, s[32:35], s45 offen lds
    s_add_u32 m0, s65, 1024
    v_mfma_f32_16x16x32_bf16 v[144:147], a[240:243], v[40:43], v[144:147]
    buffer_load_dwordx4 v9, s[32:35], s45 offen lds
    s_add_u32 m0, s65, 2048
    v_mfma_f32_16x16x32_bf16 v[148:151], a[244:247], v[40:43], v[148:151]
    buffer_load_dwordx4 v10, s[32:35], s45 offen lds
    s_add_u32 m0, s65, 3072
    v_mfma_f32_16x16x32_bf16 v[152:155], a[240:243], v[44:47], v[152:155]
    buffer_load_dwordx4 v11, s[32:35], s45 offen lds
    s_add_u32 s45, s45, 128
    v_mfma_f32_16x16x32_bf16 v[156:159], a[244:247], v[44:47], v[156:159]
    v_add_u32 v1, 0x4000, v1
    v_add_u32 v2, 0x4000, v2
    s_waitcnt vmcnt(8) lgkmcnt(0)
    s_barrier
    v_mfma_f32_16x16x32_bf16 v[128:131], a[248:251], v[64:67], v[128:131]
    ds_read_b128 v[32:35], v1 offset:0
    v_mfma_f32_16x16x32_bf16 v[132:135], a[252:255], v[64:67], v[132:135]
    ds_read_b128 v[36:39], v1 offset:2048
    v_mfma_f32_16x16x32_bf16 v[136:139], a[248:251], v[68:71], v[136:139]
    ds_read_b128 v[40:43], v1 offset:4096
    v_mfma_f32_16x16x32_bf16 v[140:143], a[252:255], v[68:71], v[140:143]
    ds_read_b128 v[44:47], v1 offset:6144
    v_mfma_f32_16x16x32_bf16 v[144:147], a[248:251], v[72:75], v[144:147]
    v_mfma_f32_16x16x32_bf16 v[148:151], a[252:255], v[72:75], v[148:151]
    v_mfma_f32_16x16x32_bf16 v[152:155], a[248:251], v[76:79], v[152:155]
    v_mfma_f32_16x16x32_bf16 v[156:159], a[252:255], v[76:79], v[156:159]
    buffer_load_dword v21, off, s[28:31], 0 offset:128 sc1
    v_cvt_pk_bf16_f32 v96, v128, v129
    v_cvt_pk_bf16_f32 v97, v130, v131
    v_cvt_pk_bf16_f32 v98, v132, v133
    v_cvt_pk_bf16_f32 v99, v134, v135
    buffer_store_dwordx4 v[96:99], v3, s[4:7], s48 offen sc1
    s_add_u32 s48, s48, 0x20000
    v_cvt_pk_bf16_f32 v100, v136, v137
    v_cvt_pk_bf16_f32 v101, v138, v139
    v_cvt_pk_bf16_f32 v102, v140, v141
    v_cvt_pk_bf16_f32 v103, v142, v143
    buffer_store_dwordx4 v[100:103], v3, s[4:7], s48 offen sc1
    s_add_u32 s48, s48, 0x20000
    v_cvt_pk_bf16_f32 v104, v144, v145
    v_cvt_pk_bf16_f32 v105, v146, v147
    v_cvt_pk_bf16_f32 v106, v148, v149
    v_cvt_pk_bf16_f32 v107, v150, v151
    buffer_store_dwordx4 v[104:107], v3, s[4:7], s48 offen sc1
    s_add_u32 s48, s48, 0x20000
    v_cvt_pk_bf16_f32 v108, v152, v153
    v_cvt_pk_bf16_f32 v109, v154, v155
    v_cvt_pk_bf16_f32 v110, v156, v157
    v_cvt_pk_bf16_f32 v111, v158, v159
    buffer_store_dwordx4 v[108:111], v3, s[4:7], s48 offen sc1
    s_add_u32 s48, s48, 0x20000
    s_waitcnt vmcnt(0)
    s_barrier
    s_cmp_eq_u32 s71, s63
    s_cbranch_scc0 Lss_58
    v_readfirstlane_b32 s41, v21
    s_nop 0
    s_cmp_eq_u32 s41, 16
    s_cbranch_scc1 Ls0_59
    s_cmp_eq_u32 s40, 0
    s_cbranch_scc0 Lwg_61
Lwg_60:
    buffer_load_dword v20, off, s[28:31], 0 offset:128 sc1
    s_waitcnt vmcnt(0)
    v_readfirstlane_b32 s41, v20
    s_nop 0
    s_cmp_eq_u32 s41, 16
    s_cbranch_scc1 Lwg_61
    s_sleep 16
    s_sub_u32 s55, s55, 1
    s_cbranch_scc0 Lwg_60
    s_branch L_side_fail
Lwg_61:
Ls0_59:
Lss_58:
    s_cmp_eq_u32 s40, 0
    s_cbranch_scc0 Lone_62
    v_mov_b32 v20, 1
    s_mov_b64 exec, 1
    buffer_atomic_add v20, off, s[4:7], s71 offset:0 sc1
    s_mov_b64 exec, -1
Lone_62:
    s_add_u32 s48, s48, 0x80000
    s_add_u32 s72, s72, 0x80000
    s_add_u32 s71, s71, 64
    s_bitcmp1_b32 s71, 6
    s_cbranch_scc0 Lss_63
    s_barrier
    s_lshl_b32 s41, s53, 5
    s_add_u32 s41, s41, s54
    s_lshl2_add_u32 s41, s41, s40
    s_lshl_b32 s41, s41, 13
    s_lshl_b32 s42, s56, 22
    s_add_u32 s41, s41, s42
    v_lshlrev_b32 v29, 7, v0
    buffer_load_dword v22, v29, s[32:35], s41 offen
Lss_63:
    s_bitcmp1_b32 s71, 6
    s_cbranch_scc1 L_g3s
L_noshort:
    ds_read_b128 v[32:35], v1 offset:0
    ds_read_b128 v[36:39], v1 offset:2048
    ds_read_b128 v[40:43], v1 offset:4096
    ds_read_b128 v[44:47], v1 offset:6144
    ds_read_b128 v[48:51], v1 offset:8192
    ds_read_b128 v[52:55], v1 offset:10240
    ds_read_b128 v[56:59], v1 offset:12288
    ds_read_b128 v[60:63], v1 offset:14336
    s_mov_b32 s78, 0x10000000
    s_mov_b32 s71, 0x10000000
L_g3_a:
    s_mov_b32 s48, s68
    s_mov_b32 s70, s69
    s_mov_b32 s72, s73
    s_waitcnt lgkmcnt(0)
    v_mfma_f32_16x16x32_bf16 v[128:131], a[0:3], v[32:35], 0
    ds_read_b128 v[64:67], v2 offset:0
    s_add_u32 s65, s49, 114688
    v_mfma_f32_16x16x32_bf16 v[132:135], a[4:7], v[32:35], 0
    ds_read_b128 v[68:71], v2 offset:2048
    s_add_u32 m0, s65, 0
    v_mfma_f32_16x16x32_bf16 v[136:139], a[0:3], v[36:39], 0
    ds_read_b128 v[72:75], v2 offset:4096
    v_mfma_f32_16x16x32_bf16 v[140:143], a[4:7], v[36:39], 0
    buffer_load_dwordx4 v8, s[32:35], s45 offen lds
    ds_read_b128 v[76:79], v2 offset:6144
    v_mfma_f32_16x16x32_bf16 v[144:147], a[0:3], v[40:43], 0
    s_add_u32 m0, s65, 1024
    v_mfma_f32_16x16x32_bf16 v[148:151], a[4:7], v[40:43], 0
    ds_read_b128 v[80:83], v2 offset:8192
    buffer_load_dwordx4 v9, s[32:35], s45 offen lds
    v_mfma_f32_16x16x32_bf16 v[152:155], a[0:3], v[44:47], 0
    ds_read_b128 v[84:87], v2 offset:10240
    s_add_u32 m0, s65, 2048
    v_mfma_f32_16x16x32_bf16 v[156:159], a[4:7], v[44:47], 0
    ds_read_b128 v[88:91], v2 offset:12288
    v_mfma_f32_16x16x32_bf16 v[160:163], a[0:3], v[48:51], 0
    buffer_load_dwordx4 v10, s[32:35], s45 offen lds
    ds_read_b128 v[92:95], v2 offset:14336
    v_mfma_f32_16x16x32_bf16 v[164:167], a[4:7], v[48:51], 0
    s_add_u32 m0, s65, 3072
    v_mfma_f32_16x16x32_bf16 v[168:171], a[0:3], v[52:55], 0
    buffer_load_dwordx4 v11, s[32:35], s45 offen lds
    s_add_u32 s45, s45, 128
    v_mfma_f32_16x16x32_bf16 v[172:175], a[4:7], v[52:55], 0
    buffer_store_dwordx4 v[96:99], v3, s[4:7], s78 offen sc1
    s_add_u32 s78, s78, 0x20000
    v_mfma_f32_16x16x32_bf16 v[176:179], a[0:3], v[56:59], 0
    buffer_store_dwordx4 v[100:103], v3, s[4:7], s78 offen sc1
    v_mfma_f32_16x16x32_bf16 v[180:183], a[4:7], v[56:59], 0
    s_add_u32 s78, s78, 0x20000
    v_add_u32 v1, 0x4000, v1
    v_mfma_f32_16x16x32_bf16 v[184:187], a[0:3], v[60:63], 0
    v_add_u32 v2, 0x4000, v2
    v_mfma_f32_16x16x32_bf16 v[188:191], a[4:7], v[60:63], 0
    s_waitcnt vmcnt(10) lgkmcnt(0)
    s_barrier
    v_mfma_f32_16x16x32_bf16 v[128:131], a[8:11], v[64:67], v[128:131]
    ds_read_b128 v[32:35], v1 offset:0
    v_mfma_f32_16x16x32_bf16 v[132:135], a[12:15], v[64:67], v[132:135]
    ds_read_b128 v[36:39], v1 offset:2048
    v_mfma_f32_16x16x32_bf16 v[136:139], a[8:11], v[68:71], v[136:139]
    ds_read_b128 v[40:43], v1 offset:4096
    v_mfma_f32_16x16x32_bf16 v[140:143], a[12:15], v[68:71], v[140:143]
    ds_read_b128 v[44:47], v1 offset:6144
    v_mfma_f32_16x16x32_bf16 v[144:147], a[8:11], v[72:75], v[144:147]
    ds_read_b128 v[48:51], v1 offset:8192
    v_mfma_f32_16x16x32_bf16 v[148:151], a[12:15], v[72:75], v[148:151]
    ds_read_b128 v[52:55], v1 offset:10240
    v_mfma_f32_16x16x32_bf16 v[152:155], a[8:11], v[76:79], v[152:155]
    ds_read_b128 v[56:59], v1 offset:12288
    v_mfma_f32_16x16x32_bf16 v[156:159], a[12:15], v[76:79], v[156:159]
    ds_read_b128 v[60:63], v1 offset:14336
    v_mfma_f32_16x16x32_bf16 v[160:163], a[8:11], v[80:83], v[160:163]
    v_mfma_f32_16x16x32_bf16 v[164:167], a[12:15], v[80:83], v[164:167]
    v_mfma_f32_16x16x32_bf16 v[168:171], a[8:11], v[84:87], v[168:171]
    v_mfma_f32_16x16x32_bf16 v[172:175], a[12:15], v[84:87], v[172:175]
    v_mfma_f32_16x16x32_bf16 v[176:179], a[8:11], v[88:91], v[176:179]
    v_mfma_f32_16x16x32_bf16 v[180:183], a[12:15], v[88:91], v[180:183]
    v_mfma_f32_16x16x32_bf16 v[184:187], a[8:11], v[92:95], v[184:187]
    v_mfma_f32_16x16x32_bf16 v[188:191], a[12:15], v[92:95], v[188:191]
    s_waitcnt lgkmcnt(0)
    v_mfma_f32_16x16x32_bf16 v[128:131], a[16:19], v[32:35], v[128:131]
    ds_read_b128 v[64:67], v2 offset:0
    s_add_u32 s65, s49, 131072
    v_mfma_f32_16x16x32_bf16 v[132:135], a[20:23], v[32:35], v[132:135]
    ds_read_b128 v[68:71], v2 offset:2048
    s_add_u32 m0, s65, 0
    v_mfma_f32_16x16x32_bf16 v[136:139], a[16:19], v[36:39], v[136:139]
    ds_read_b128 v[72:75], v2 offset:4096
    v_mfma_f32_16x16x32_bf16 v[140:143], a[20:23], v[36:39], v[140:143]
    buffer_load_dwordx4 v8, s[32:35], s45 offen lds
    ds_read_b128 v[76:79], v2 offset:6144
    v_mfma_f32_16x16x32_bf16 v[144:147], a[16:19], v[40:43], v[144:147]
    s_add_u32 m0, s65, 1024
    v_mfma_f32_16x16x32_bf16 v[148:151], a[20:23], v[40:43], v[148:151]
    ds_read_b128 v[80:83], v2 offset:8192
    buffer_load_dwordx4 v9, s[32:35], s45 offen lds
    v_mfma_f32_16x16x32_bf16 v[152:155], a[16:19], v[44:47], v[152:155]
    ds_read_b128 v[84:87], v2 offset:10240
    s_add_u32 m0, s65, 2048
    v_mfma_f32_16x16x32_bf16 v[156:159], a[20:23], v[44:47], v[156:159]
    ds_read_b128 v[88:91], v2 offset:12288
    v_mfma_f32_16x16x32_bf16 v[160:163], a[16:19], v[48:51], v[160:163]
    buffer_load_dwordx4 v10, s[32:35], s45 offen lds
    ds_read_b128 v[92:95], v2 offset:14336
    v_mfma_f32_16x16x32_bf16 v[164:167], a[20:23], v[48:51], v[164:167]
    s_add_u32 m0, s65, 3072
    v_mfma_f32_16x16x32_bf16 v[168:171], a[16:19], v[52:55], v[168:171]
    buffer_load_dwordx4 v11, s[32:35], s45 offen lds
    s_add_u32 s45, s45, 128
    v_mfma_f32_16x16x32_bf16 v[172:175], a[20:23], v[52:55], v[172:175]
    buffer_store_dwordx4 v[104:107], v3, s[4:7], s78 offen sc1
    s_add_u32 s78, s78, 0x20000
    v_mfma_f32_16x16x32_bf16 v[176:179], a[16:19], v[56:59], v[176:179]
    buffer_store_dwordx4 v[108:111], v3, s[4:7], s78 offen sc1
    v_mfma_f32_16x16x32_bf16 v[180:183], a[20:23], v[56:59], v[180:183]
    s_add_u32 s78, s78, 0x20000
    v_add_u32 v1, 0xffff4000, v1
    v_mfma_f32_16x16x32_bf16 v[184:187], a[16:19], v[60:63], v[184:187]
    v_add_u32 v2, 0xffff4000, v2
    v_mfma_f32_16x16x32_bf16 v[188:191], a[20:23], v[60:63], v[188:191]
    s_waitcnt vmcnt(12) lgkmcnt(0)
    s_barrier
    v_mfma_f32_16x16x32_bf16 v[128:131], a[24:27], v[64:67], v[128:131]
    ds_read_b128 v[32:35], v1 offset:0
    s_lshl_b32 s74, s57, 18
    v_mfma_f32_16x16x32_bf16 v[132:135], a[28:31], v[64:67], v[132:135]
    ds_read_b128 v[36:39], v1 offset:2048
    v_mfma_f32_16x16x32_bf16 v[136:139], a[24:27], v[68:71], v[136:139]
    s_lshl_b32 s68, s57, 20
    v_mfma_f32_16x16x32_bf16 v[140:143], a[28:31], v[68:71], v[140:143]
    ds_read_b128 v[40:43], v1 offset:4096
    v_mfma_f32_16x16x32_bf16 v[144:147], a[24:27], v[72:75], v[144:147]
    s_add_u32 s68, s68, s60
    v_mfma_f32_16x16x32_bf16 v[148:151], a[28:31], v[72:75], v[148:151]
    ds_read_b128 v[44:47], v1 offset:6144
    v_mfma_f32_16x16x32_bf16 v[152:155], a[24:27], v[76:79], v[152:155]
    s_lshl_b32 s73, s57, 19
    v_mfma_f32_16x16x32_bf16 v[156:159], a[28:31], v[76:79], v[156:159]
    ds_read_b128 v[48:51], v1 offset:8192
    v_mfma_f32_16x16x32_bf16 v[160:163], a[24:27], v[80:83], v[160:163]
    s_add_u32 s73, s73, s61
    v_mfma_f32_16x16x32_bf16 v[164:167], a[28:31], v[80:83], v[164:167]
    ds_read_b128 v[52:55], v1 offset:10240
    v_mfma_f32_16x16x32_bf16 v[168:171], a[24:27], v[84:87], v[168:171]
    s_lshl_b32 s69, s57, 6
    v_mfma_f32_16x16x32_bf16 v[172:175], a[28:31], v[84:87], v[172:175]
    ds_read_b128 v[56:59], v1 offset:12288
    v_mfma_f32_16x16x32_bf16 v[176:179], a[24:27], v[88:91], v[176:179]
    s_add_u32 s69, s69, s63
    v_mfma_f32_16x16x32_bf16 v[180:183], a[28:31], v[88:91], v[180:183]
    ds_read_b128 v[60:63], v1 offset:14336
    v_mfma_f32_16x16x32_bf16 v[184:187], a[24:27], v[92:95], v[184:187]
    s_add_u32 s57, s57, s58
    v_mfma_f32_16x16x32_bf16 v[188:191], a[28:31], v[92:95], v[188:191]
    s_waitcnt lgkmcnt(0)
    v_mfma_f32_16x16x32_bf16 v[128:131], a[32:35], v[32:35], v[128:131]
    ds_read_b128 v[64:67], v2 offset:0
    s_add_u32 s65, s49, 147456
    v_mfma_f32_16x16x32_bf16 v[132:135], a[36:39], v[32:35], v[132:135]
    ds_read_b128 v[68:71], v2 offset:2048
    s_add_u32 m0, s65, 0
    v_mfma_f32_16x16x32_bf16 v[136:139], a[32:35], v[36:39], v[136:139]
    ds_read_b128 v[72:75], v2 offset:4096
    v_mfma_f32_16x16x32_bf16 v[140:143], a[36:39], v[36:39], v[140:143]
    buffer_load_dwordx4 v8, s[32:35], s45 offen lds
    ds_read_b128 v[76:79], v2 offset:6144
    v_mfma_f32_16x16x32_bf16 v[144:147], a[32:35], v[40:43], v[144:147]
    s_add_u32 m0, s65, 1024
    v_mfma_f32_16x16x32_bf16 v[148:151], a[36:39], v[40:43], v[148:151]
    ds_read_b128 v[80:83], v2 offset:8192
    buffer_load_dwordx4 v9, s[32:35], s45 offen lds
    v_mfma_f32_16x16x32_bf16 v[152:155], a[32:35], v[44:47], v[152:155]
    ds_read_b128 v[84:87], v2 offset:10240
    s_add_u32 m0, s65, 2048
    v_mfma_f32_16x16x32_bf16 v[156:159], a[36:39], v[44:47], v[156:159]
    ds_read_b128 v[88:91], v2 offset:12288
    v_mfma_f32_16x16x32_bf16 v[160:163], a[32:35], v[48:51], v[160:163]
    buffer_load_dwordx4 v10, s[32:35], s45 offen lds
    ds_read_b128 v[92:95], v2 offset:14336
    v_mfma_f32_16x16x32_bf16 v[164:167], a[36:39], v[48:51], v[164:167]
    s_add_u32 m0, s65, 3072
    v_mfma_f32_16x16x32_bf16 v[168:171], a[32:35], v[52:55], v[168:171]
    buffer_load_dwordx4 v11, s[32:35], s45 offen lds
    s_add_u32 s45, s45, 128
    v_mfma_f32_16x16x32_bf16 v[172:175], a[36:39], v[52:55], v[172:175]
    buffer_store_dwordx4 v[112:115], v3, s[4:7], s78 offen sc1
    s_add_u32 s78, s78, 0x20000
    v_mfma_f32_16x16x32_bf16 v[176:179], a[32:35], v[56:59], v[176:179]
    buffer_store_dwordx4 v[116:119], v3, s[4:7], s78 offen sc1
    v_mfma_f32_16x16x32_bf16 v[180:183], a[36:39], v[56:59], v[180:183]
    s_add_u32 s78, s78, 0x20000
    v_add_u32 v1, 0x4000, v1
    v_mfma_f32_16x16x32_bf16 v[184:187], a[32:35], v[60:63], v[184:187]
    v_add_u32 v2, 0x4000, v2
    v_mfma_f32_16x16x32_bf16 v[188:191], a[36:39], v[60:63], v[188:191]
    s_waitcnt vmcnt(14) lgkmcnt(0)
    s_barrier
    v_mfma_f32_16x16x32_bf16 v[128:131], a[40:43], v[64:67], v[128:131]
    ds_read_b128 v[32:35], v1 offset:0
    v_mfma_f32_16x16x32_bf16 v[132:135], a[44:47], v[64:67], v[132:135]
    ds_read_b128 v[36:39], v1 offset:2048
    v_mfma_f32_16x16x32_bf16 v[136:139], a[40:43], v[68:71], v[136:139]
    ds_read_b128 v[40:43], v1 offset:4096
    v_mfma_f32_16x16x32_bf16 v[140:143], a[44:47], v[68:71], v[140:143]
    ds_read_b128 v[44:47], v1 offset:6144
    v_mfma_f32_16x16x32_bf16 v[144:147], a[40:43], v[72:75], v[144:147]
    ds_read_b128 v[48:51], v1 offset:8192
    v_mfma_f32_16x16x32_bf16 v[148:151], a[44:47], v[72:75], v[148:151]
    ds_read_b128 v[52:55], v1 offset:10240
    v_mfma_f32_16x16x32_bf16 v[152:155], a[40:43], v[76:79], v[152:155]
    ds_read_b128 v[56:59], v1 offset:12288
    v_mfma_f32_16x16x32_bf16 v[156:159], a[44:47], v[76:79], v[156:159]
    ds_read_b128 v[60:63], v1 offset:14336
    v_mfma_f32_16x16x32_bf16 v[160:163], a[40:43], v[80:83], v[160:163]
    v_mfma_f32_16x16x32_bf16 v[164:167], a[44:47], v[80:83], v[164:167]
    v_mfma_f32_16x16x32_bf16 v[168:171], a[40:43], v[84:87], v[168:171]
    v_mfma_f32_16x16x32_bf16 v[172:175], a[44:47], v[84:87], v[172:175]
    v_mfma_f32_16x16x32_bf16 v[176:179], a[40:43], v[88:91], v[176:179]
    v_mfma_f32_16x16x32_bf16 v[180:183], a[44:47], v[88:91], v[180:183]
    v_mfma_f32_16x16x32_bf16 v[184:187], a[40:43], v[92:95], v[184:187]
    v_mfma_f32_16x16x32_bf16 v[188:191], a[44:47], v[92:95], v[188:191]
    s_waitcnt lgkmcnt(0)
    v_mfma_f32_16x16x32_bf16 v[128:131], a[48:51], v[32:35], v[128:131]
    ds_read_b128 v[64:67], v2 offset:0
    s_add_u32 s65, s49, 98304
    v_mfma_f32_16x16x32_bf16 v[132:135], a[52:55], v[32:35], v[132:135]
    ds_read_b128 v[68:71], v2 offset:2048
    s_add_u32 m0, s65, 0
    v_mfma_f32_16x16x32_bf16 v[136:139], a[48:51], v[36:39], v[136:139]
    ds_read_b128 v[72:75], v2 offset:4096
    v_mfma_f32_16x16x32_bf16 v[140:143], a[52:55], v[36:39], v[140:143]
    buffer_load_dwordx4 v8, s[32:35], s45 offen lds
    ds_read_b128 v[76:79], v2 offset:6144
    v_mfma_f32_16x16x32_bf16 v[144:147], a[48:51], v[40:43], v[144:147]
    s_add_u32 m0, s65, 1024
    v_mfma_f32_16x16x32_bf16 v[148:151], a[52:55], v[40:43], v[148:151]
    ds_read_b128 v[80:83], v2 offset:8192
    buffer_load_dwordx4 v9, s[32:35], s45 offen lds
    v_mfma_f32_16x16x32_bf16 v[152:155], a[48:51], v[44:47], v[152:155]
    ds_read_b128 v[84:87], v2 offset:10240
    s_add_u32 m0, s65, 2048
    v_mfma_f32_16x16x32_bf16 v[156:159], a[52:55], v[44:47], v[156:159]
    ds_read_b128 v[88:91], v2 offset:12288
    v_mfma_f32_16x16x32_bf16 v[160:163], a[48:51], v[48:51], v[160:163]
    buffer_load_dwordx4 v10, s[32:35], s45 offen lds
    ds_read_b128 v[92:95], v2 offset:14336
    v_mfma_f32_16x16x32_bf16 v[164:167], a[52:55], v[48:51], v[164:167]
    s_add_u32 m0, s65, 3072
    v_mfma_f32_16x16x32_bf16 v[168:171], a[48:51], v[52:55], v[168:171]
    buffer_load_dwordx4 v11, s[32:35], s45 offen lds
    s_add_u32 s45, s45, 128
    v_mfma_f32_16x16x32_bf16 v[172:175], a[52:55], v[52:55], v[172:175]
    buffer_store_dwordx4 v[120:123], v3, s[4:7], s78 offen sc1
    s_add_u32 s78, s78, 0x20000
    v_mfma_f32_16x16x32_bf16 v[176:179], a[48:51], v[56:59], v[176:179]
    buffer_store_dwordx4 v[124:127], v3, s[4:7], s78 offen sc1
    v_mfma_f32_16x16x32_bf16 v[180:183], a[52:55], v[56:59], v[180:183]
    s_add_u32 s78, s78, 0x20000
    v_add_u32 v1, 0x4000, v1
    v_mfma_f32_16x16x32_bf16 v[184:187], a[48:51], v[60:63], v[184:187]
    v_add_u32 v2, 0x4000, v2
    v_mfma_f32_16x16x32_bf16 v[188:191], a[52:55], v[60:63], v[188:191]
    s_waitcnt vmcnt(14) lgkmcnt(0)
    s_barrier
    v_mfma_f32_16x16x32_bf16 v[128:131], a[56:59], v[64:67], v[128:131]
    ds_read_b128 v[32:35], v1 offset:0
    v_mfma_f32_16x16x32_bf16 v[132:135], a[60:63], v[64:67], v[132:135]
    ds_read_b128 v[36:39], v1 offset:2048
    v_mfma_f32_16x16x32_bf16 v[136:139], a[56:59], v[68:71], v[136:139]
    ds_read_b128 v[40:43], v1 offset:4096
    v_mfma_f32_16x16x32_bf16 v[140:143], a[60:63], v[68:71], v[140:143]
    ds_read_b128 v[44:47], v1 offset:6144
    v_mfma_f32_16x16x32_bf16 v[144:147], a[56:59], v[72:75], v[144:147]
    ds_read_b128 v[48:51], v1 offset:8192
    v_mfma_f32_16x16x32_bf16 v[148:151], a[60:63], v[72:75], v[148:151]
    ds_read_b128 v[52:55], v1 offset:10240
    v_mfma_f32_16x16x32_bf16 v[152:155], a[56:59], v[76:79], v[152:155]
    ds_read_b128 v[56:59], v1 offset:12288
    v_mfma_f32_16x16x32_bf16 v[156:159], a[60:63], v[76:79], v[156:159]
    ds_read_b128 v[60:63], v1 offset:14336
    v_mfma_f32_16x16x32_bf16 v[160:163], a[56:59], v[80:83], v[160:163]
    v_mfma_f32_16x16x32_bf16 v[164:167], a[60:63], v[80:83], v[164:167]
    v_mfma_f32_16x16x32_bf16 v[168:171], a[56:59], v[84:87], v[168:171]
    v_mfma_f32_16x16x32_bf16 v[172:175], a[60:63], v[84:87], v[172:175]
    v_mfma_f32_16x16x32_bf16 v[176:179], a[56:59], v[88:91], v[176:179]
    v_mfma_f32_16x16x32_bf16 v[180:183], a[60:63], v[88:91], v[180:183]
    v_mfma_f32_16x16x32_bf16 v[184:187], a[56:59], v[92:95], v[184:187]
    v_mfma_f32_16x16x32_bf16 v[188:191], a[60:63], v[92:95], v[188:191]
    s_waitcnt lgkmcnt(0)
    v_mfma_f32_16x16x32_bf16 v[128:131], a[64:67], v[32:35], v[128:131]
    ds_read_b128 v[64:67], v2 offset:0
    s_add_u32 s65, s49, 114688
    v_mfma_f32_16x16x32_bf16 v[132:135], a[68:71], v[32:35], v[132:135]
    ds_read_b128 v[68:71], v2 offset:2048
    v_mfma_f32_16x16x32_bf16 v[136:139], a[64:67], v[36:39], v[136:139]
    s_add_u32 m0, s65, 0
    v_mfma_f32_16x16x32_bf16 v[140:143], a[68:71], v[36:39], v[140:143]
    ds_read_b128 v[72:75], v2 offset:4096
    buffer_load_dwordx4 v8, s[32:35], s45 offen lds
    v_mfma_f32_16x16x32_bf16 v[144:147], a[64:67], v[40:43], v[144:147]
    ds_read_b128 v[76:79], v2 offset:6144
    v_mfma_f32_16x16x32_bf16 v[148:151], a[68:71], v[40:43], v[148:151]
    s_add_u32 m0, s65, 1024
    v_mfma_f32_16x16x32_bf16 v[152:155], a[64:67], v[44:47], v[152:155]
    ds_read_b128 v[80:83], v2 offset:8192
    buffer_load_dwordx4 v9, s[32:35], s45 offen lds
    v_mfma_f32_16x16x32_bf16 v[156:159], a[68:71], v[44:47], v[156:159]
    ds_read_b128 v[84:87], v2 offset:10240
    v_mfma_f32_16x16x32_bf16 v[160:163], a[64:67], v[48:51], v[160:163]
    s_add_u32 m0, s65, 2048
    v_mfma_f32_16x16x32_bf16 v[164:167], a[68:71], v[48:51], v[164:167]
    ds_read_b128 v[88:91], v2 offset:12288
    buffer_load_dwordx4 v10, s[32:35], s45 offen lds
    v_mfma_f32_16x16x32_bf16 v[168:171], a[64:67], v[52:55], v[168:171]
    ds_read_b128 v[92:95], v2 offset:14336
    v_mfma_f32_16x16x32_bf16 v[172:175], a[68:71], v[52:55], v[172:175]
    s_add_u32 m0, s65, 3072
    v_mfma_f32_16x16x32_bf16 v[176:179], a[64:67], v[56:59], v[176:179]
    buffer_load_dwordx4 v11, s[32:35], s45 offen lds
    s_add_u32 s45, s45, 128
    v_mfma_f32_16x16x32_bf16 v[180:183], a[68:71], v[56:59], v[180:183]
    v_add_u32 v1, 0x4000, v1
    v_mfma_f32_16x16x32_bf16 v[184:187], a[64:67], v[60:63], v[184:187]
    v_add_u32 v2, 0x4000, v2
    v_mfma_f32_16x16x32_bf16 v[188:191], a[68:71], v[60:63], v[188:191]
    s_waitcnt vmcnt(12) lgkmcnt(0)
    s_barrier
    v_mfma_f32_16x16x32_bf16 v[128:131], a[72:75], v[64:67], v[128:131]
    ds_read_b128 v[32:35], v1 offset:0
    v_mfma_f32_16x16x32_bf16 v[132:135], a[76:79], v[64:67], v[132:135]
    ds_read_b128 v[36:39], v1 offset:2048
    v_mfma_f32_16x16x32_bf16 v[136:139], a[72:75], v[68:71], v[136:139]
    ds_read_b128 v[40:43], v1 offset:4096
    v_mfma_f32_16x16x32_bf16 v[140:143], a[76:79], v[68:71], v[140:143]
    ds_read_b128 v[44:47], v1 offset:6144
    v_mfma_f32_16x16x32_bf16 v[144:147], a[72:75], v[72:75], v[144:147]
    ds_read_b128 v[48:51], v1 offset:8192
    v_mfma_f32_16x16x32_bf16 v[148:151], a[76:79], v[72:75], v[148:151]
    ds_read_b128 v[52:55], v1 offset:10240
    v_mfma_f32_16x16x32_bf16 v[152:155], a[72:75], v[76:79], v[152:155]
    ds_read_b128 v[56:59], v1 offset:12288
    v_mfma_f32_16x16x32_bf16 v[156:159], a[76:79], v[76:79], v[156:159]
    ds_read_b128 v[60:63], v1 offset:14336
    v_mfma_f32_16x16x32_bf16 v[160:163], a[72:75], v[80:83], v[160:163]
    v_mfma_f32_16x16x32_bf16 v[164:167], a[76:79], v[80:83], v[164:167]
    v_mfma_f32_16x16x32_bf16 v[168:171], a[72:75], v[84:87], v[168:171]
    v_mfma_f32_16x16x32_bf16 v[172:175], a[76:79], v[84:87], v[172:175]
    v_mfma_f32_16x16x32_bf16 v[176:179], a[72:75], v[88:91], v[176:179]
    v_mfma_f32_16x16x32_bf16 v[180:183], a[76:79], v[88:91], v[180:183]
    v_mfma_f32_16x16x32_bf16 v[184:187], a[72:75], v[92:95], v[184:187]
    v_mfma_f32_16x16x32_bf16 v[188:191], a[76:79], v[92:95], v[188:191]
    s_waitcnt lgkmcnt(0)
    v_mfma_f32_16x16x32_bf16 v[128:131], a[80:83], v[32:35], v[128:131]
    ds_read_b128 v[64:67], v2 offset:0
    s_add_u32 s65, s49, 131072
    v_mfma_f32_16x16x32_bf16 v[132:135], a[84:87], v[32:35], v[132:135]
    ds_read_b128 v[68:71], v2 offset:2048
    v_mfma_f32_16x16x32_bf16 v[136:139], a[80:83], v[36:39], v[136:139]
    s_add_u32 m0, s65, 0
    v_mfma_f32_16x16x32_bf16 v[140:143], a[84:87], v[36:39], v[140:143]
    ds_read_b128 v[72:75], v2 offset:4096
    buffer_load_dwordx4 v8, s[32:35], s45 offen lds
    v_mfma_f32_16x16x32_bf16 v[144:147], a[80:83], v[40:43], v[144:147]
    ds_read_b128 v[76:79], v2 offset:6144
    v_mfma_f32_16x16x32_bf16 v[148:151], a[84:87], v[40:43], v[148:151]
    s_add_u32 m0, s65, 1024
    v_mfma_f32_16x16x32_bf16 v[152:155], a[80:83], v[44:47], v[152:155]
    ds_read_b128 v[80:83], v2 offset:8192
    buffer_load_dwordx4 v9, s[32:35], s45 offen lds
    v_mfma_f32_16x16x32_bf16 v[156:159], a[84:87], v[44:47], v[156:159]
    ds_read_b128 v[84:87], v2 offset:10240
    v_mfma_f32_16x16x32_bf16 v[160:163], a[80:83], v[48:51], v[160:163]
    s_add_u32 m0, s65, 2048
    v_mfma_f32_16x16x32_bf16 v[164:167], a[84:87], v[48:51], v[164:167]
    ds_read_b128 v[88:91], v2 offset:12288
    buffer_load_dwordx4 v10, s[32:35], s45 offen lds
    v_mfma_f32_16x16x32_bf16 v[168:171], a[80:83], v[52:55], v[168:171]
    ds_read_b128 v[92:95], v2 offset:14336
    v_mfma_f32_16x16x32_bf16 v[172:175], a[84:87], v[52:55], v[172:175]
    s_add_u32 m0, s65, 3072
    v_mfma_f32_16x16x32_bf16 v[176:179], a[80:83], v[56:59], v[176:179]
    buffer_load_dwordx4 v11, s[32:35], s45 offen lds
    s_add_u32 s45, s45, 128
    v_mfma_f32_16x16x32_bf16 v[180:183], a[84:87], v[56:59], v[180:183]
    v_add_u32 v1, 0xffff4000, v1
    v_mfma_f32_16x16x32_bf16 v[184:187], a[80:83], v[60:63], v[184:187]
    v_add_u32 v2, 0xffff4000, v2
    v_mfma_f32_16x16x32_bf16 v[188:191], a[84:87], v[60:63], v[188:191]
    s_waitcnt vmcnt(10) lgkmcnt(0)
    s_barrier
    v_mfma_f32_16x16x32_bf16 v[128:131], a[88:91], v[64:67], v[128:131]
    ds_read_b128 v[32:35], v1 offset:0
    v_mfma_f32_16x16x32_bf16 v[132:135], a[92:95], v[64:67], v[132:135]
    ds_read_b128 v[36:39], v1 offset:2048
    v_mfma_f32_16x16x32_bf16 v[136:139], a[88:91], v[68:71], v[136:139]
    ds_read_b128 v[40:43], v1 offset:4096
    v_mfma_f32_16x16x32_bf16 v[140:143], a[92:95], v[68:71], v[140:143]
    ds_read_b128 v[44:47], v1 offset:6144
    v_mfma_f32_16x16x32_bf16 v[144:147], a[88:91], v[72:75], v[144:147]
    ds_read_b128 v[48:51], v1 offset:8192
    v_mfma_f32_16x16x32_bf16 v[148:151], a[92:95], v[72:75], v[148:151]
    ds_read_b128 v[52:55], v1 offset:10240
    v_mfma_f32_16x16x32_bf16 v[152:155], a[88:91], v[76:79], v[152:155]
    ds_read_b128 v[56:59], v1 offset:12288
    v_mfma_f32_16x16x32_bf16 v[156:159], a[92:95], v[76:79], v[156:159]
    ds_read_b128 v[60:63], v1 offset:14336
    v_mfma_f32_16x16x32_bf16 v[160:163], a[88:91], v[80:83], v[160:163]
    v_mfma_f32_16x16x32_bf16 v[164:167], a[92:95], v[80:83], v[164:167]
    v_mfma_f32_16x16x32_bf16 v[168:171], a[88:91], v[84:87], v[168:171]
    v_mfma_f32_16x16x32_bf16 v[172:175], a[92:95], v[84:87], v[172:175]
    v_mfma_f32_16x16x32_bf16 v[176:179], a[88:91], v[88:91], v[176:179]
    v_mfma_f32_16x16x32_bf16 v[180:183], a[92:95], v[88:91], v[180:183]
    v_mfma_f32_16x16x32_bf16 v[184:187], a[88:91], v[92:95], v[184:187]
    v_mfma_f32_16x16x32_bf16 v[188:191], a[92:95], v[92:95], v[188:191]
    s_waitcnt lgkmcnt(0)
    v_mfma_f32_16x16x32_bf16 v[128:131], a[96:99], v[32:35], v[128:131]
    ds_read_b128 v[64:67], v2 offset:0
    s_add_u32 s65, s49, 147456
    v_mfma_f32_16x16x32_bf16 v[132:135], a[100:103], v[32:35], v[132:135]
    ds_read_b128 v[68:71], v2 offset:2048
    v_mfma_f32_16x16x32_bf16 v[136:139], a[96:99], v[36:39], v[136:139]
    s_add_u32 m0, s65, 0
    v_mfma_f32_16x16x32_bf16 v[140:143], a[100:103], v[36:39], v[140:143]
    ds_read_b128 v[72:75], v2 offset:4096
    buffer_load_dwordx4 v8, s[32:35], s45 offen lds
    v_mfma_f32_16x16x32_bf16 v[144:147], a[96:99], v[40:43], v[144:147]
    ds_read_b128 v[76:79], v2 offset:6144
    v_mfma_f32_16x16x32_bf16 v[148:151], a[100:103], v[40:43], v[148:151]
    s_add_u32 m0, s65, 1024
    v_mfma_f32_16x16x32_bf16 v[152:155], a[96:99], v[44:47], v[152:155]
    ds_read_b128 v[80:83], v2 offset:8192
    buffer_load_dwordx4 v9, s[32:35], s45 offen lds
    v_mfma_f32_16x16x32_bf16 v[156:159], a[100:103], v[44:47], v[156:159]
    ds_read_b128 v[84:87], v2 offset:10240
    v_mfma_f32_16x16x32_bf16 v[160:163], a[96:99], v[48:51], v[160:163]
    s_add_u32 m0, s65, 2048
    v_mfma_f32_16x16x32_bf16 v[164:167], a[100:103], v[48:51], v[164:167]
    ds_read_b128 v[88:91], v2 offset:12288
    buffer_load_dwordx4 v10, s[32:35], s45 offen lds
    v_mfma_f32_16x16x32_bf16 v[168:171], a[96:99], v[52:55], v[168:171]
    ds_read_b128 v[92:95], v2 offset:14336
    v_mfma_f32_16x16x32_bf16 v[172:175], a[100:103], v[52:55], v[172:175]
    s_add_u32 m0, s65, 3072
    v_mfma_f32_16x16x32_bf16 v[176:179], a[96:99], v[56:59], v[176:179]
    buffer_load_dwordx4 v11, s[32:35], s45 offen lds
    s_add_u32 s45, s45, 128
    v_mfma_f32_16x16x32_bf16 v[180:183], a[100:103], v[56:59], v[180:183]
    v_add_u32 v1, 0x4000, v1
    v_mfma_f32_16x16x32_bf16 v[184:187], a[96:99], v[60:63], v[184:187]
    v_add_u32 v2, 0x4000, v2
    v_mfma_f32_16x16x32_bf16 v[188:191], a[100:103], v[60:63], v[188:191]
    s_waitcnt vmcnt(8) lgkmcnt(0)
    s_barrier
    s_cmp_eq_u32 s40, 0
    s_cbranch_scc0 Lone_64
    v_mov_b32 v20, 2
    s_mov_b64 exec, 1
    buffer_atomic_add v20, off, s[4:7], s71 offset:0 sc1
    s_mov_b64 exec, -1
Lone_64:
    v_mfma_f32_16x16x32_bf16 v[128:131], a[104:107], v[64:67], v[128:131]
    ds_read_b128 v[32:35], v1 offset:0
    v_mfma_f32_16x16x32_bf16 v[132:135], a[108:111], v[64:67], v[132:135]
    ds_read_b128 v[36:39], v1 offset:2048
    v_mfma_f32_16x16x32_bf16 v[136:139], a[104:107], v[68:71], v[136:139]
    ds_read_b128 v[40:43], v1 offset:4096
    v_mfma_f32_16x16x32_bf16 v[140:143], a[108:111], v[68:71], v[140:143]
    ds_read_b128 v[44:47], v1 offset:6144
    v_mfma_f32_16x16x32_bf16 v[144:147], a[104:107], v[72:75], v[144:147]
    ds_read_b128 v[48:51], v1 offset:8192
    v_mfma_f32_16x16x32_bf16 v[148:151], a[108:111], v[72:75], v[148:151]
    ds_read_b128 v[52:55], v1 offset:10240
    v_mfma_f32_16x16x32_bf16 v[152:155], a[104:107], v[76:79], v[152:155]
    ds_read_b128 v[56:59], v1 offset:12288
    v_mfma_f32_16x16x32_bf16 v[156:159], a[108:111], v[76:79], v[156:159]
    ds_read_b128 v[60:63], v1 offset:14336
    v_mfma_f32_16x16x32_bf16 v[160:163], a[104:107], v[80:83], v[160:163]
    v_mfma_f32_16x16x32_bf16 v[164:167], a[108:111], v[80:83], v[164:167]
    v_mfma_f32_16x16x32_bf16 v[168:171], a[104:107], v[84:87], v[168:171]
    v_mfma_f32_16x16x32_bf16 v[172:175], a[108:111], v[84:87], v[172:175]
    v_mfma_f32_16x16x32_bf16 v[176:179], a[104:107], v[88:91], v[176:179]
    v_mfma_f32_16x16x32_bf16 v[180:183], a[108:111], v[88:91], v[180:183]
    v_mfma_f32_16x16x32_bf16 v[184:187], a[104:107], v[92:95], v[184:187]
    v_mfma_f32_16x16x32_bf16 v[188:191], a[108:111], v[92:95], v[188:191]
    s_waitcnt lgkmcnt(0)
    v_mfma_f32_16x16x32_bf16 v[128:131], a[112:115], v[32:35], v[128:131]
    ds_read_b128 v[64:67], v2 offset:0
    s_add_u32 s65, s49, 98304
    v_mfma_f32_16x16x32_bf16 v[132:135], a[116:119], v[32:35], v[132:135]
    ds_read_b128 v[68:71], v2 offset:2048
    v_mfma_f32_16x16x32_bf16 v[136:139], a[112:115], v[36:39], v[136:139]
    s_add_u32 m0, s65, 0
    v_mfma_f32_16x16x32_bf16 v[140:143], a[116:119], v[36:39], v[140:143]
    ds_read_b128 v[72:75], v2 offset:4096
    buffer_load_dwordx4 v8, s[32:35], s45 offen lds
    v_mfma_f32_16x16x32_bf16 v[144:147], a[112:115], v[40:43], v[144:147]
    ds_read_b128 v[76:79], v2 offset:6144
    v_mfma_f32_16x16x32_bf16 v[148:151], a[116:119], v[40:43], v[148:151]
    s_add_u32 m0, s65, 1024
    v_mfma_f32_16x16x32_bf16 v[152:155], a[112:115], v[44:47], v[152:155]
    ds_read_b128 v[80:83], v2 offset:8192
    buffer_load_dwordx4 v9, s[32:35], s45 offen lds
    v_mfma_f32_16x16x32_bf16 v[156:159], a[116:119], v[44:47], v[156:159]
    ds_read_b128 v[84:87], v2 offset:10240
    v_mfma_f32_16x16x32_bf16 v[160:163], a[112:115], v[48:51], v[160:163]
    s_add_u32 m0, s65, 2048
    v_mfma_f32_16x16x32_bf16 v[164:167], a[116:119], v[48:51], v[164:167]
    ds_read_b128 v[88:91], v2 offset:12288
    buffer_load_dwordx4 v10, s[32:35], s45 offen lds
    v_mfma_f32_16x16x32_bf16 v[168:171], a[112:115], v[52:55], v[168:171]
    ds_read_b128 v[92:95], v2 offset:14336
    v_mfma_f32_16x16x32_bf16 v[172:175], a[116:119], v[52:55], v[172:175]
    s_add_u32 m0, s65, 3072
    v_mfma_f32_16x16x32_bf16 v[176:179], a[112:115], v[56:59], v[176:179]
    buffer_load_dwordx4 v11, s[32:35], s45 offen lds
    s_add_u32 s45, s45, 128
    v_mfma_f32_16x16x32_bf16 v[180:183], a[116:119], v[56:59], v[180:183]
    v_add_u32 v1, 0x4000, v1
    v_mfma_f32_16x16x32_bf16 v[184:187], a[112:115], v[60:63], v[184:187]
    v_add_u32 v2, 0x4000, v2
    v_mfma_f32_16x16x32_bf16 v[188:191], a[116:119], v[60:63], v[188:191]
    s_waitcnt vmcnt(8) lgkmcnt(0)
    s_barrier
    v_mfma_f32_16x16x32_bf16 v[128:131], a[120:123], v[64:67], v[128:131]
    ds_read_b128 v[32:35], v1 offset:0
    v_mfma_f32_16x16x32_bf16 v[132:135], a[124:127], v[64:67], v[132:135]
    ds_read_b128 v[36:39], v1 offset:2048
    v_mfma_f32_16x16x32_bf16 v[136:139], a[120:123], v[68:71], v[136:139]
    ds_read_b128 v[40:43], v1 offset:4096
    v_mfma_f32_16x16x32_bf16 v[140:143], a[124:127], v[68:71], v[140:143]
    ds_read_b128 v[44:47], v1 offset:6144
    v_mfma_f32_16x16x32_bf16 v[144:147], a[120:123], v[72:75], v[144:147]
    ds_read_b128 v[48:51], v1 offset:8192
    v_mfma_f32_16x16x32_bf16 v[148:151], a[124:127], v[72:75], v[148:151]
    ds_read_b128 v[52:55], v1 offset:10240
    v_mfma_f32_16x16x32_bf16 v[152:155], a[120:123], v[76:79], v[152:155]
    ds_read_b128 v[56:59], v1 offset:12288
    v_mfma_f32_16x16x32_bf16 v[156:159], a[124:127], v[76:79], v[156:159]
    ds_read_b128 v[60:63], v1 offset:14336
    v_mfma_f32_16x16x32_bf16 v[160:163], a[120:123], v[80:83], v[160:163]
    v_mfma_f32_16x16x32_bf16 v[164:167], a[124:127], v[80:83], v[164:167]
    v_mfma_f32_16x16x32_bf16 v[168:171], a[120:123], v[84:87], v[168:171]
    v_mfma_f32_16x16x32_bf16 v[172:175], a[124:127], v[84:87], v[172:175]
    v_mfma_f32_16x16x32_bf16 v[176:179], a[120:123], v[88:91], v[176:179]
    v_mfma_f32_16x16x32_bf16 v[180:183], a[124:127], v[88:91], v[180:183]
    v_mfma_f32_16x16x32_bf16 v[184:187], a[120:123], v[92:95], v[184:187]
    v_mfma_f32_16x16x32_bf16 v[188:191], a[124:127], v[92:95], v[188:191]
    s_waitcnt lgkmcnt(0)
    v_mfma_f32_16x16x32_bf16 v[128:131], a[128:131], v[32:35], v[128:131]
    ds_read_b128 v[64:67], v2 offset:0
    s_add_u32 s65, s49, 114688
    v_mfma_f32_16x16x32_bf16 v[132:135], a[132:135], v[32:35], v[132:135]
    ds_read_b128 v[68:71], v2 offset:2048
    v_mfma_f32_16x16x32_bf16 v[136:139], a[128:131], v[36:39], v[136:139]
    s_add_u32 m0, s65, 0
    ds_read_b128 v[72:75], v2 offset:4096
    v_mfma_f32_16x16x32_bf16 v[140:143], a[132:135], v[36:39], v[140:143]
    buffer_load_dwordx4 v8, s[32:35], s45 offen lds
    v_mfma_f32_16x16x32_bf16 v[144:147], a[128:131], v[40:43], v[144:147]
    ds_read_b128 v[76:79], v2 offset:6144
    s_add_u32 m0, s65, 1024
    v_mfma_f32_16x16x32_bf16 v[148:151], a[132:135], v[40:43], v[148:151]
    ds_read_b128 v[80:83], v2 offset:8192
    v_mfma_f32_16x16x32_bf16 v[152:155], a[128:131], v[44:47], v[152:155]
    buffer_load_dwordx4 v9, s[32:35], s45 offen lds
    ds_read_b128 v[84:87], v2 offset:10240
    v_mfma_f32_16x16x32_bf16 v[156:159], a[132:135], v[44:47], v[156:159]
    s_add_u32 m0, s65, 2048
    v_mfma_f32_16x16x32_bf16 v[160:163], a[128:131], v[48:51], v[160:163]
    ds_read_b128 v[88:91], v2 offset:12288
    buffer_load_dwordx4 v10, s[32:35], s45 offen lds
    v_mfma_f32_16x16x32_bf16 v[164:167], a[132:135], v[48:51], v[164:167]
    ds_read_b128 v[92:95], v2 offset:14336
    v_mfma_f32_16x16x32_bf16 v[168:171], a[128:131], v[52:55], v[168:171]
    s_add_u32 m0, s65, 3072
    s_nop 0
    buffer_load_dwordx4 v11, s[32:35], s45 offen lds
    v_mfma_f32_16x16x32_bf16 v[172:175], a[132:135], v[52:55], v[172:175]
    s_add_u32 s45, s45, 128
    v_mfma_f32_16x16x32_bf16 v[176:179], a[128:131], v[56:59], v[176:179]
    buffer_store_dwordx4 v[24:27], v3, s[4:7], s72 offen sc1
    s_add_u32 s72, s72, 0x40000
    v_mfma_f32_16x16x32_bf16 v[180:183], a[132:135], v[56:59], v[180:183]
    v_add_u32 v1, 0x4000, v1
    v_mfma_f32_16x16x32_bf16 v[184:187], a[128:131], v[60:63], v[184:187]
    v_add_u32 v2, 0x4000, v2
    v_mfma_f32_16x16x32_bf16 v[188:191], a[132:135], v[60:63], v[188:191]
    s_waitcnt vmcnt(9) lgkmcnt(0)
    s_barrier
    v_mfma_f32_16x16x32_bf16 v[128:131], a[136:139], v[64:67], v[128:131]
    ds_read_b128 v[32:35], v1 offset:0
    v_mfma_f32_16x16x32_bf16 v[132:135], a[140:143], v[64:67], v[132:135]
    ds_read_b128 v[36:39], v1 offset:2048
    v_mfma_f32_16x16x32_bf16 v[136:139], a[136:139], v[68:71], v[136:139]
    ds_read_b128 v[40:43], v1 offset:4096
    v_mfma_f32_16x16x32_bf16 v[140:143], a[140:143], v[68:71], v[140:143]
    ds_read_b128 v[44:47], v1 offset:6144
    v_mfma_f32_16x16x32_bf16 v[144:147], a[136:139], v[72:75], v[144:147]
    ds_read_b128 v[48:51], v1 offset:8192
    v_mfma_f32_16x16x32_bf16 v[148:151], a[140:143], v[72:75], v[148:151]
    ds_read_b128 v[52:55], v1 offset:10240
    v_mfma_f32_16x16x32_bf16 v[152:155], a[136:139], v[76:79], v[152:155]
    ds_read_b128 v[56:59], v1 offset:12288
    v_mfma_f32_16x16x32_bf16 v[156:159], a[140:143], v[76:79], v[156:159]
    ds_read_b128 v[60:63], v1 offset:14336
    v_mfma_f32_16x16x32_bf16 v[160:163], a[136:139], v[80:83], v[160:163]
    v_mfma_f32_16x16x32_bf16 v[164:167], a[140:143], v[80:83], v[164:167]
    v_mfma_f32_16x16x32_bf16 v[168:171], a[136:139], v[84:87], v[168:171]
    v_mfma_f32_16x16x32_bf16 v[172:175], a[140:143], v[84:87], v[172:175]
    v_mfma_f32_16x16x32_bf16 v[176:179], a[136:139], v[88:91], v[176:179]
    v_mfma_f32_16x16x32_bf16 v[180:183], a[140:143], v[88:91], v[180:183]
    v_mfma_f32_16x16x32_bf16 v[184:187], a[136:139], v[92:95], v[184:187]
    v_mfma_f32_16x16x32_bf16 v[188:191], a[140:143], v[92:95], v[188:191]
    s_waitcnt lgkmcnt(0)
    v_mfma_f32_16x16x32_bf16 v[128:131], a[144:147], v[32:35], v[128:131]
    ds_read_b128 v[64:67], v2 offset:0
    s_add_u32 s65, s49, 131072
    v_mfma_f32_16x16x32_bf16 v[132:135], a[148:151], v[32:35], v[132:135]
    ds_read_b128 v[68:71], v2 offset:2048
    v_mfma_f32_16x16x32_bf16 v[136:139], a[144:147], v[36:39], v[136:139]
    s_add_u32 m0, s65, 0
    ds_read_b128 v[72:75], v2 offset:4096
    v_mfma_f32_16x16x32_bf16 v[140:143], a[148:151], v[36:39], v[140:143]
    buffer_load_dwordx4 v8, s[32:35], s45 offen lds
    v_mfma_f32_16x16x32_bf16 v[144:147], a[144:147], v[40:43], v[144:147]
    ds_read_b128 v[76:79], v2 offset:6144
    s_add_u32 m0, s65, 1024
    v_mfma_f32_16x16x32_bf16 v[148:151], a[148:151], v[40:43], v[148:151]
    ds_read_b128 v[80:83], v2 offset:8192
    v_mfma_f32_16x16x32_bf16 v[152:155], a[144:147], v[44:47], v[152:155]
    buffer_load_dwordx4 v9, s[32:35], s45 offen lds
    ds_read_b128 v[84:87], v2 offset:10240
    v_mfma_f32_16x16x32_bf16 v[156:159], a[148:151], v[44:47], v[156:159]
    s_add_u32 m0, s65, 2048
    v_mfma_f32_16x16x32_bf16 v[160:163], a[144:147], v[48:51], v[160:163]
    ds_read_b128 v[88:91], v2 offset:12288
    buffer_load_dwordx4 v10, s[32:35], s45 offen lds
    v_mfma_f32_16x16x32_bf16 v[164:167], a[148:151], v[48:51], v[164:167]
    ds_read_b128 v[92:95], v2 offset:14336
    v_mfma_f32_16x16x32_bf16 v[168:171], a[144:147], v[52:55], v[168:171]
    s_add_u32 m0, s65, 3072
    s_nop 0
    buffer_load_dwordx4 v11, s[32:35], s45 offen lds
    v_mfma_f32_16x16x32_bf16 v[172:175], a[148:151], v[52:55], v[172:175]
    s_add_u32 s45, s45, 128
    v_mfma_f32_16x16x32_bf16 v[176:179], a[144:147], v[56:59], v[176:179]
    buffer_store_dwordx4 v[24:27], v3, s[4:7], s72 offen sc1
    s_add_u32 s72, s72, 0x40000
    v_mfma_f32_16x16x32_bf16 v[180:183], a[148:151], v[56:59], v[180:183]
    v_add_u32 v1, 0xffff4000, v1
    v_mfma_f32_16x16x32_bf16 v[184:187], a[144:147], v[60:63], v[184:187]
    v_add_u32 v2, 0xffff4000, v2
    v_mfma_f32_16x16x32_bf16 v[188:191], a[148:151], v[60:63], v[188:191]
    s_waitcnt vmcnt(10) lgkmcnt(0)
    s_barrier
    v_mfma_f32_16x16x32_bf16 v[128:131], a[152:155], v[64:67], v[128:131]
    ds_read_b128 v[32:35], v1 offset:0
    v_mfma_f32_16x16x32_bf16 v[132:135], a[156:159], v[64:67], v[132:135]
    ds_read_b128 v[36:39], v1 offset:2048
    v_mfma_f32_16x16x32_bf16 v[136:139], a[152:155], v[68:71], v[136:139]
    ds_read_b128 v[40:43], v1 offset:4096
    v_mfma_f32_16x16x32_bf16 v[140:143], a[156:159], v[68:71], v[140:143]
    ds_read_b128 v[44:47], v1 offset:6144
    v_mfma_f32_16x16x32_bf16 v[144:147], a[152:155], v[72:75], v[144:147]
    ds_read_b128 v[48:51], v1 offset:8192
    v_mfma_f32_16x16x32_bf16 v[148:151], a[156:159], v[72:75], v[148:151]
    ds_read_b128 v[52:55], v1 offset:10240
    v_mfma_f32_16x16x32_bf16 v[152:155], a[152:155], v[76:79], v[152:155]
    ds_read_b128 v[56:59], v1 offset:12288
    v_mfma_f32_16x16x32_bf16 v[156:159], a[156:159], v[76:79], v[156:159]
    ds_read_b128 v[60:63], v1 offset:14336
    v_mfma_f32_16x16x32_bf16 v[160:163], a[152:155], v[80:83], v[160:163]
    v_mfma_f32_16x16x32_bf16 v[164:167], a[156:159], v[80:83], v[164:167]
    v_mfma_f32_16x16x32_bf16 v[168:171], a[152:155], v[84:87], v[168:171]
    v_mfma_f32_16x16x32_bf16 v[172:175], a[156:159], v[84:87], v[172:175]
    v_mfma_f32_16x16x32_bf16 v[176:179], a[152:155], v[88:91], v[176:179]
    v_mfma_f32_16x16x32_bf16 v[180:183], a[156:159], v[88:91], v[180:183]
    v_mfma_f32_16x16x32_bf16 v[184:187], a[152:155], v[92:95], v[184:187]
    v_mfma_f32_16x16x32_bf16 v[188:191], a[156:159], v[92:95], v[188:191]
    s_waitcnt lgkmcnt(0)
    v_mfma_f32_16x16x32_bf16 v[128:131], a[160:163], v[32:35], v[128:131]
    ds_read_b128 v[64:67], v2 offset:0
    s_add_u32 s65, s49, 147456
    v_mfma_f32_16x16x32_bf16 v[132:135], a[164:167], v[32:35], v[132:135]
    ds_read_b128 v[68:71], v2 offset:2048
    v_mfma_f32_16x16x32_bf16 v[136:139], a[160:163], v[36:39], v[136:139]
    s_add_u32 m0, s65, 0
    v_mfma_f32_16x16x32_bf16 v[140:143], a[164:167], v[36:39], v[140:143]
    ds_read_b128 v[72:75], v2 offset:4096
    buffer_load_dwordx4 v8, s[32:35], s45 offen lds
    v_mfma_f32_16x16x32_bf16 v[144:147], a[160:163], v[40:43], v[144:147]
    ds_read_b128 v[76:79], v2 offset:6144
    v_mfma_f32_16x16x32_bf16 v[148:151], a[164:167], v[40:43], v[148:151]
    s_add_u32 m0, s65, 1024
    v_mfma_f32_16x16x32_bf16 v[152:155], a[160:163], v[44:47], v[152:155]
    ds_read_b128 v[80:83], v2 offset:8192
    buffer_load_dwordx4 v9, s[32:35], s45 offen lds
    v_mfma_f32_16x16x32_bf16 v[156:159], a[164:167], v[44:47], v[156:159]
    ds_read_b128 v[84:87], v2 offset:10240
    v_mfma_f32_16x16x32_bf16 v[160:163], a[160:163], v[48:51], v[160:163]
    s_add_u32 m0, s65, 2048
    v_mfma_f32_16x16x32_bf16 v[164:167], a[164:167], v[48:51], v[164:167]
    ds_read_b128 v[88:91], v2 offset:12288
    buffer_load_dwordx4 v10, s[32:35], s45 offen lds
    v_mfma_f32_16x16x32_bf16 v[168:171], a[160:163], v[52:55], v[168:171]
    ds_read_b128 v[92:95], v2 offset:14336
    v_mfma_f32_16x16x32_bf16 v[172:175], a[164:167], v[52:55], v[172:175]
    s_add_u32 m0, s65, 3072
    v_mfma_f32_16x16x32_bf16 v[176:179], a[160:163], v[56:59], v[176:179]
    buffer_load_dwordx4 v11, s[32:35], s45 offen lds
    s_add_u32 s45, s45, 128
    v_mfma_f32_16x16x32_bf16 v[180:183], a[164:167], v[56:59], v[180:183]
    v_add_u32 v1, 0x4000, v1
    v_mfma_f32_16x16x32_bf16 v[184:187], a[160:163], v[60:63], v[184:187]
    v_add_u32 v2, 0x4000, v2
    v_mfma_f32_16x16x32_bf16 v[188:191], a[164:167], v[60:63], v[188:191]
    s_waitcnt vmcnt(10) lgkmcnt(0)
    s_barrier
    v_mfma_f32_16x16x32_bf16 v[128:131], a[168:171], v[64:67], v[128:131]
    ds_read_b128 v[32:35], v1 offset:0
    v_mfma_f32_16x16x32_bf16 v[132:135], a[172:175], v[64:67], v[132:135]
    ds_read_b128 v[36:39], v1 offset:2048
    v_mfma_f32_16x16x32_bf16 v[136:139], a[168:171], v[68:71], v[136:139]
    ds_read_b128 v[40:43], v1 offset:4096
    v_mfma_f32_16x16x32_bf16 v[140:143], a[172:175], v[68:71], v[140:143]
    ds_read_b128 v[44:47], v1 offset:6144
    v_mfma_f32_16x16x32_bf16 v[144:147], a[168:171], v[72:75], v[144:147]
    ds_read_b128 v[48:51], v1 offset:8192
    v_mfma_f32_16x16x32_bf16 v[148:151], a[172:175], v[72:75], v[148:151]
    ds_read_b128 v[52:55], v1 offset:10240
    v_mfma_f32_16x16x32_bf16 v[152:155], a[168:171], v[76:79], v[152:155]
    ds_read_b128 v[56:59], v1 offset:12288
    v_mfma_f32_16x16x32_bf16 v[156:159], a[172:175], v[76:79], v[156:159]
    ds_read_b128 v[60:63], v1 offset:14336
    v_mfma_f32_16x16x32_bf16 v[160:163], a[168:171], v[80:83], v[160:163]
    v_mfma_f32_16x16x32_bf16 v[164:167], a[172:175], v[80:83], v[164:167]
    v_mfma_f32_16x16x32_bf16 v[168:171], a[168:171], v[84:87], v[168:171]
    v_mfma_f32_16x16x32_bf16 v[172:175], a[172:175], v[84:87], v[172:175]
    v_mfma_f32_16x16x32_bf16 v[176:179], a[168:171], v[88:91], v[176:179]
    v_mfma_f32_16x16x32_bf16 v[180:183], a[172:175], v[88:91], v[180:183]
    v_mfma_f32_16x16x32_bf16 v[184:187], a[168:171], v[92:95], v[184:187]
    v_mfma_f32_16x16x32_bf16 v[188:191], a[172:175], v[92:95], v[188:191]
    s_waitcnt lgkmcnt(0)
    v_mfma_f32_16x16x32_bf16 v[128:131], a[176:179], v[32:35], v[128:131]
    ds_read_b128 v[64:67], v2 offset:0
    s_add_u32 s65, s49, 98304
    v_mfma_f32_16x16x32_bf16 v[132:135], a[180:183], v[32:35], v[132:135]
    ds_read_b128 v[68:71], v2 offset:2048
    v_mfma_f32_16x16x32_bf16 v[136:139], a[176:179], v[36:39], v[136:139]
    s_add_u32 m0, s65, 0
    v_mfma_f32_16x16x32_bf16 v[140:143], a[180:183], v[36:39], v[140:143]
    ds_read_b128 v[72:75], v2 offset:4096
    buffer_load_dwordx4 v8, s[32:35], s45 offen lds
    v_mfma_f32_16x16x32_bf16 v[144:147], a[176:179], v[40:43], v[144:147]
    ds_read_b128 v[76:79], v2 offset:6144
    v_mfma_f32_16x16x32_bf16 v[148:151], a[180:183], v[40:43], v[148:151]
    s_add_u32 m0, s65, 1024
    v_mfma_f32_16x16x32_bf16 v[152:155], a[176:179], v[44:47], v[152:155]
    ds_read_b128 v[80:83], v2 offset:8192
    buffer_load_dwordx4 v9, s[32:35], s45 offen lds
    v_mfma_f32_16x16x32_bf16 v[156:159], a[180:183], v[44:47], v[156:159]
    ds_read_b128 v[84:87], v2 offset:10240
    v_mfma_f32_16x16x32_bf16 v[160:163], a[176:179], v[48:51], v[160:163]
    s_add_u32 m0, s65, 2048
    v_mfma_f32_16x16x32_bf16 v[164:167], a[180:183], v[48:51], v[164:167]
    ds_read_b128 v[88:91], v2 offset:12288
    buffer_load_dwordx4 v10, s[32:35], s45 offen lds
    v_mfma_f32_16x16x32_bf16 v[168:171], a[176:179], v[52:55], v[168:171]
    ds_read_b128 v[92:95], v2 offset:14336
    v_mfma_f32_16x16x32_bf16 v[172:175], a[180:183], v[52:55], v[172:175]
    s_add_u32 m0, s65, 3072
    v_mfma_f32_16x16x32_bf16 v[176:179], a[176:179], v[56:59], v[176:179]
    buffer_load_dwordx4 v11, s[32:35], s45 offen lds
    s_add_u32 s45, s45, 128
    v_mfma_f32_16x16x32_bf16 v[180:183], a[180:183], v[56:59], v[180:183]
    v_add_u32 v1, 0x4000, v1
    v_mfma_f32_16x16x32_bf16 v[184:187], a[176:179], v[60:63], v[184:187]
    v_add_u32 v2, 0x4000, v2
    v_mfma_f32_16x16x32_bf16 v[188:191], a[180:183], v[60:63], v[188:191]
    s_waitcnt vmcnt(9) lgkmcnt(0)
    s_barrier
    v_mfma_f32_16x16x32_bf16 v[128:131], a[184:187], v[64:67], v[128:131]
    ds_read_b128 v[32:35], v1 offset:0
    v_mfma_f32_16x16x32_bf16 v[132:135], a[188:191], v[64:67], v[132:135]
    ds_read_b128 v[36:39], v1 offset:2048
    v_mfma_f32_16x16x32_bf16 v[136:139], a[184:187], v[68:71], v[136:139]
    ds_read_b128 v[40:43], v1 offset:4096
    v_mfma_f32_16x16x32_bf16 v[140:143], a[188:191], v[68:71], v[140:143]
    ds_read_b128 v[44:47], v1 offset:6144
    v_mfma_f32_16x16x32_bf16 v[144:147], a[184:187], v[72:75], v[144:147]
    ds_read_b128 v[48:51], v1 offset:8192
    v_mfma_f32_16x16x32_bf16 v[148:151], a[188:191], v[72:75], v[148:151]
    ds_read_b128 v[52:55], v1 offset:10240
    v_mfma_f32_16x16x32_bf16 v[152:155], a[184:187], v[76:79], v[152:155]
    ds_read_b128 v[56:59], v1 offset:12288
    v_mfma_f32_16x16x32_bf16 v[156:159], a[188:191], v[76:79], v[156:159]
    ds_read_b128 v[60:63], v1 offset:14336
    v_mfma_f32_16x16x32_bf16 v[160:163], a[184:187], v[80:83], v[160:163]
    v_mfma_f32_16x16x32_bf16 v[164:167], a[188:191], v[80:83], v[164:167]
    v_mfma_f32_16x16x32_bf16 v[168:171], a[184:187], v[84:87], v[168:171]
    v_mfma_f32_16x16x32_bf16 v[172:175], a[188:191], v[84:87], v[172:175]
    v_mfma_f32_16x16x32_bf16 v[176:179], a[184:187], v[88:91], v[176:179]
    v_mfma_f32_16x16x32_bf16 v[180:183], a[188:191], v[88:91], v[180:183]
    v_mfma_f32_16x16x32_bf16 v[184:187], a[184:187], v[92:95], v[184:187]
    v_mfma_f32_16x16x32_bf16 v[188:191], a[188:191], v[92:95], v[188:191]
    s_waitcnt lgkmcnt(0)
    v_mfma_f32_16x16x32_bf16 v[128:131], a[192:195], v[32:35], v[128:131]
    ds_read_b128 v[64:67], v2 offset:0
    s_add_u32 s65, s49, 114688
    v_mfma_f32_16x16x32_bf16 v[132:135], a[196:199], v[32:35], v[132:135]
    ds_read_b128 v[68:71], v2 offset:2048
    v_mfma_f32_16x16x32_bf16 v[136:139], a[192:195], v[36:39], v[136:139]
    s_add_u32 m0, s65, 0
    v_mfma_f32_16x16x32_bf16 v[140:143], a[196:199], v[36:39], v[140:143]
    ds_read_b128 v[72:75], v2 offset:4096
    buffer_load_dwordx4 v8, s[32:35], s45 offen lds
    v_mfma_f32_16x16x32_bf16 v[144:147], a[192:195], v[40:43], v[144:147]
    ds_read_b128 v[76:79], v2 offset:6144
    v_mfma_f32_16x16x32_bf16 v[148:151], a[196:199], v[40:43], v[148:151]
    s_add_u32 m0, s65, 1024
    v_mfma_f32_16x16x32_bf16 v[152:155], a[192:195], v[44:47], v[152:155]
    ds_read_b128 v[80:83], v2 offset:8192
    buffer_load_dwordx4 v9, s[32:35], s45 offen lds
    v_mfma_f32_16x16x32_bf16 v[156:159], a[196:199], v[44:47], v[156:159]
    ds_read_b128 v[84:87], v2 offset:10240
    v_mfma_f32_16x16x32_bf16 v[160:163], a[192:195], v[48:51], v[160:163]
    s_add_u32 m0, s65, 2048
    v_mfma_f32_16x16x32_bf16 v[164:167], a[196:199], v[48:51], v[164:167]
    ds_read_b128 v[88:91], v2 offset:12288
    buffer_load_dwordx4 v10, s[32:35], s45 offen lds
    v_mfma_f32_16x16x32_bf16 v[168:171], a[192:195], v[52:55], v[168:171]
    ds_read_b128 v[92:95], v2 offset:14336
    v_mfma_f32_16x16x32_bf16 v[172:175], a[196:199], v[52:55], v[172:175]
    s_add_u32 m0, s65, 3072
    v_mfma_f32_16x16x32_bf16 v[176:179], a[192:195], v[56:59], v[176:179]
    buffer_load_dwordx4 v11, s[32:35], s45 offen lds
    s_mov_b32 s45, s74
    v_mfma_f32_16x16x32_bf16 v[180:183], a[196:199], v[56:59], v[180:183]
    v_add_u32 v1, 0x4000, v1
    v_mfma_f32_16x16x32_bf16 v[184:187], a[192:195], v[60:63], v[184:187]
    v_add_u32 v2, 0x4000, v2
    v_mfma_f32_16x16x32_bf16 v[188:191], a[196:199], v[60:63], v[188:191]
    s_waitcnt vmcnt(8) lgkmcnt(0)
    s_barrier
    v_mfma_f32_16x16x32_bf16 v[128:131], a[200:203], v[64:67], v[128:131]
    ds_read_b128 v[32:35], v1 offset:0
    v_mfma_f32_16x16x32_bf16 v[132:135], a[204:207], v[64:67], v[132:135]
    ds_read_b128 v[36:39], v1 offset:2048
    v_mfma_f32_16x16x32_bf16 v[136:139], a[200:203], v[68:71], v[136:139]
    ds_read_b128 v[40:43], v1 offset:4096
    v_mfma_f32_16x16x32_bf16 v[140:143], a[204:207], v[68:71], v[140:143]
    ds_read_b128 v[44:47], v1 offset:6144
    v_mfma_f32_16x16x32_bf16 v[144:147], a[200:203], v[72:75], v[144:147]
    ds_read_b128 v[48:51], v1 offset:8192
    v_mfma_f32_16x16x32_bf16 v[148:151], a[204:207], v[72:75], v[148:151]
    ds_read_b128 v[52:55], v1 offset:10240
    v_mfma_f32_16x16x32_bf16 v[152:155], a[200:203], v[76:79], v[152:155]
    ds_read_b128 v[56:59], v1 offset:12288
    v_mfma_f32_16x16x32_bf16 v[156:159], a[204:207], v[76:79], v[156:159]
    ds_read_b128 v[60:63], v1 offset:14336
    v_mfma_f32_16x16x32_bf16 v[160:163], a[200:203], v[80:83], v[160:163]
    v_mfma_f32_16x16x32_bf16 v[164:167], a[204:207], v[80:83], v[164:167]
    v_mfma_f32_16x16x32_bf16 v[168:171], a[200:203], v[84:87], v[168:171]
    v_mfma_f32_16x16x32_bf16 v[172:175], a[204:207], v[84:87], v[172:175]
    v_mfma_f32_16x16x32_bf16 v[176:179], a[200:203], v[88:91], v[176:179]
    v_mfma_f32_16x16x32_bf16 v[180:183], a[204:207], v[88:91], v[180:183]
    v_mfma_f32_16x16x32_bf16 v[184:187], a[200:203], v[92:95], v[184:187]
    v_mfma_f32_16x16x32_bf16 v[188:191], a[204:207], v[92:95], v[188:191]
    s_waitcnt lgkmcnt(0)
    v_mfma_f32_16x16x32_bf16 v[128:131], a[208:211], v[32:35], v[128:131]
    ds_read_b128 v[64:67], v2 offset:0
    s_add_u32 s65, s49, 131072
    v_mfma_f32_16x16x32_bf16 v[132:135], a[212:215], v[32:35], v[132:135]
    ds_read_b128 v[68:71], v2 offset:2048
    v_mfma_f32_16x16x32_bf16 v[136:139], a[208:211], v[36:39], v[136:139]
    s_add_u32 m0, s65, 0
    v_mfma_f32_16x16x32_bf16 v[140:143], a[212:215], v[36:39], v[140:143]
    ds_read_b128 v[72:75], v2 offset:4096
    buffer_load_dwordx4 v8, s[32:35], s45 offen lds
    v_mfma_f32_16x16x32_bf16 v[144:147], a[208:211], v[40:43], v[144:147]
    ds_read_b128 v[76:79], v2 offset:6144
    v_mfma_f32_16x16x32_bf16 v[148:151], a[212:215], v[40:43], v[148:151]
    s_add_u32 m0, s65, 1024
    v_mfma_f32_16x16x32_bf16 v[152:155], a[208:211], v[44:47], v[152:155]
    ds_read_b128 v[80:83], v2 offset:8192
    buffer_load_dwordx4 v9, s[32:35], s45 offen lds
    v_mfma_f32_16x16x32_bf16 v[156:159], a[212:215], v[44:47], v[156:159]
    ds_read_b128 v[84:87], v2 offset:10240
    v_mfma_f32_16x16x32_bf16 v[160:163], a[208:211], v[48:51], v[160:163]
    s_add_u32 m0, s65, 2048
    v_mfma_f32_16x16x32_bf16 v[164:167], a[212:215], v[48:51], v[164:167]
    ds_read_b128 v[88:91], v2 offset:12288
    buffer_load_dwordx4 v10, s[32:35], s45 offen lds
    v_mfma_f32_16x16x32_bf16 v[168:171], a[208:211], v[52:55], v[168:171]
    ds_read_b128 v[92:95], v2 offset:14336
    v_mfma_f32_16x16x32_bf16 v[172:175], a[212:215], v[52:55], v[172:175]
    s_add_u32 m0, s65, 3072
    v_mfma_f32_16x16x32_bf16 v[176:179], a[208:211], v[56:59], v[176:179]
    buffer_load_dwordx4 v11, s[32:35], s45 offen lds
    s_add_u32 s45, s45, 128
    v_mfma_f32_16x16x32_bf16 v[180:183], a[212:215], v[56:59], v[180:183]
    v_add_u32 v1, 0xffff4000, v1
    v_mfma_f32_16x16x32_bf16 v[184:187], a[208:211], v[60:63], v[184:187]
    v_add_u32 v2, 0xffff4000, v2
    v_mfma_f32_16x16x32_bf16 v[188:191], a[212:215], v[60:63], v[188:191]
    s_waitcnt vmcnt(8) lgkmcnt(0)
    s_barrier
    v_mfma_f32_16x16x32_bf16 v[128:131], a[216:219], v[64:67], v[128:131]
    ds_read_b128 v[32:35], v1 offset:0
    v_mfma_f32_16x16x32_bf16 v[132:135], a[220:223], v[64:67], v[132:135]
    ds_read_b128 v[36:39], v1 offset:2048
    v_mfma_f32_16x16x32_bf16 v[136:139], a[216:219], v[68:71], v[136:139]
    ds_read_b128 v[40:43], v1 offset:4096
    v_mfma_f32_16x16x32_bf16 v[140:143], a[220:223], v[68:71], v[140:143]
    ds_read_b128 v[44:47], v1 offset:6144
    v_mfma_f32_16x16x32_bf16 v[144:147], a[216:219], v[72:75], v[144:147]
    ds_read_b128 v[48:51], v1 offset:8192
    v_mfma_f32_16x16x32_bf16 v[148:151], a[220:223], v[72:75], v[148:151]
    ds_read_b128 v[52:55], v1 offset:10240
    v_mfma_f32_16x16x32_bf16 v[152:155], a[216:219], v[76:79], v[152:155]
    ds_read_b128 v[56:59], v1 offset:12288
    v_mfma_f32_16x16x32_bf16 v[156:159], a[220:223], v[76:79], v[156:159]
    ds_read_b128 v[60:63], v1 offset:14336
    v_mfma_f32_16x16x32_bf16 v[160:163], a[216:219], v[80:83], v[160:163]
    v_mfma_f32_16x16x32_bf16 v[164:167], a[220:223], v[80:83], v[164:167]
    v_mfma_f32_16x16x32_bf16 v[168:171], a[216:219], v[84:87], v[168:171]
    v_mfma_f32_16x16x32_bf16 v[172:175], a[220:223], v[84:87], v[172:175]
    v_mfma_f32_16x16x32_bf16 v[176:179], a[216:219], v[88:91], v[176:179]
    v_mfma_f32_16x16x32_bf16 v[180:183], a[220:223], v[88:91], v[180:183]
    v_mfma_f32_16x16x32_bf16 v[184:187], a[216:219], v[92:95], v[184:187]
    v_mfma_f32_16x16x32_bf16 v[188:191], a[220:223], v[92:95], v[188:191]
    s_waitcnt lgkmcnt(0)
    v_mfma_f32_16x16x32_bf16 v[128:131], a[224:227], v[32:35], v[128:131]
    ds_read_b128 v[64:67], v2 offset:0
    s_add_u32 s65, s49, 147456
    v_mfma_f32_16x16x32_bf16 v[132:135], a[228:231], v[32:35], v[132:135]
    ds_read_b128 v[68:71], v2 offset:2048
    v_mfma_f32_16x16x32_bf16 v[136:139], a[224:227], v[36:39], v[136:139]
    s_add_u32 m0, s65, 0
    v_mfma_f32_16x16x32_bf16 v[140:143], a[228:231], v[36:39], v[140:143]
    ds_read_b128 v[72:75], v2 offset:4096
    buffer_load_dwordx4 v8, s[32:35], s45 offen lds
    v_mfma_f32_16x16x32_bf16 v[144:147], a[224:227], v[40:43], v[144:147]
    ds_read_b128 v[76:79], v2 offset:6144
    v_mfma_f32_16x16x32_bf16 v[148:151], a[228:231], v[40:43], v[148:151]
    s_add_u32 m0, s65, 1024
    v_mfma_f32_16x16x32_bf16 v[152:155], a[224:227], v[44:47], v[152:155]
    ds_read_b128 v[80:83], v2 offset:8192
    buffer_load_dwordx4 v9, s[32:35], s45 offen lds
    v_mfma_f32_16x16x32_bf16 v[156:159], a[228:231], v[44:47], v[156:159]
    ds_read_b128 v[84:87], v2 offset:10240
    v_mfma_f32_16x16x32_bf16 v[160:163], a[224:227], v[48:51], v[160:163]
    s_add_u32 m0, s65, 2048
    v_mfma_f32_16x16x32_bf16 v[164:167], a[228:231], v[48:51], v[164:167]
    ds_read_b128 v[88:91], v2 offset:12288
    buffer_load_dwordx4 v10, s[32:35], s45 offen lds
    v_mfma_f32_16x16x32_bf16 v[168:171], a[224:227], v[52:55], v[168:171]
    ds_read_b128 v[92:95], v2 offset:14336
    v_mfma_f32_16x16x32_bf16 v[172:175], a[228:231], v[52:55], v[172:175]
    s_add_u32 m0, s65, 3072
    v_mfma_f32_16x16x32_bf16 v[176:179], a[224:227], v[56:59], v[176:179]
    buffer_load_dwordx4 v11, s[32:35], s45 offen lds
    s_add_u32 s45, s45, 128
    v_mfma_f32_16x16x32_bf16 v[180:183], a[228:231], v[56:59], v[180:183]
    v_add_u32 v1, 0x4000, v1
    v_mfma_f32_16x16x32_bf16 v[184:187], a[224:227], v[60:63], v[184:187]
    v_add_u32 v2, 0x4000, v2
    v_mfma_f32_16x16x32_bf16 v[188:191], a[228:231], v[60:63], v[188:191]
    s_waitcnt vmcnt(8) lgkmcnt(0)
    s_barrier
    v_mfma_f32_16x16x32_bf16 v[128:131], a[232:235], v[64:67], v[128:131]
    ds_read_b128 v[32:35], v1 offset:0
    v_mfma_f32_16x16x32_bf16 v[132:135], a[236:239], v[64:67], v[132:135]
    ds_read_b128 v[36:39], v1 offset:2048
    v_mfma_f32_16x16x32_bf16 v[136:139], a[232:235], v[68:71], v[136:139]
    ds_read_b128 v[40:43], v1 offset:4096
    v_mfma_f32_16x16x32_bf16 v[140:143], a[236:239], v[68:71], v[140:143]
    ds_read_b128 v[44:47], v1 offset:6144
    v_mfma_f32_16x16x32_bf16 v[144:147], a[232:235], v[72:75], v[144:147]
    ds_read_b128 v[48:51], v1 offset:8192
    v_mfma_f32_16x16x32_bf16 v[148:151], a[236:239], v[72:75], v[148:151]
    ds_read_b128 v[52:55], v1 offset:10240
    v_mfma_f32_16x16x32_bf16 v[152:155], a[232:235], v[76:79], v[152:155]
    ds_read_b128 v[56:59], v1 offset:12288
    v_mfma_f32_16x16x32_bf16 v[156:159], a[236:239], v[76:79], v[156:159]
    ds_read_b128 v[60:63], v1 offset:14336
    v_mfma_f32_16x16x32_bf16 v[160:163], a[232:235], v[80:83], v[160:163]
    v_mfma_f32_16x16x32_bf16 v[164:167], a[236:239], v[80:83], v[164:167]
    v_mfma_f32_16x16x32_bf16 v[168:171], a[232:235], v[84:87], v[168:171]
    v_mfma_f32_16x16x32_bf16 v[172:175], a[236:239], v[84:87], v[172:175]
    v_mfma_f32_16x16x32_bf16 v[176:179], a[232:235], v[88:91], v[176:179]
    v_mfma_f32_16x16x32_bf16 v[180:183], a[236:239], v[88:91], v[180:183]
    v_mfma_f32_16x16x32_bf16 v[184:187], a[232:235], v[92:95], v[184:187]
    v_mfma_f32_16x16x32_bf16 v[188:191], a[236:239], v[92:95], v[188:191]
    s_waitcnt lgkmcnt(0)
    v_mfma_f32_16x16x32_bf16 v[128:131], a[240:243], v[32:35], v[128:131]
    ds_read_b128 v[64:67], v2 offset:0
    s_add_u32 s65, s49, 98304
    v_mfma_f32_16x16x32_bf16 v[132:135], a[244:247], v[32:35], v[132:135]
    ds_read_b128 v[68:71], v2 offset:2048
    v_mfma_f32_16x16x32_bf16 v[136:139], a[240:243], v[36:39], v[136:139]
    s_add_u32 m0, s65, 0
    v_mfma_f32_16x16x32_bf16 v[140:143], a[244:247], v[36:39], v[140:143]
    ds_read_b128 v[72:75], v2 offset:4096
    buffer_load_dwordx4 v8, s[32:35], s45 offen lds
    v_mfma_f32_16x16x32_bf16 v[144:147], a[240:243], v[40:43], v[144:147]
    ds_read_b128 v[76:79], v2 offset:6144
    v_mfma_f32_16x16x32_bf16 v[148:151], a[244:247], v[40:43], v[148:151]
    s_add_u32 m0, s65, 1024
    v_mfma_f32_16x16x32_bf16 v[152:155], a[240:243], v[44:47], v[152:155]
    ds_read_b128 v[80:83], v2 offset:8192
    buffer_load_dwordx4 v9, s[32:35], s45 offen lds
    v_mfma_f32_16x16x32_bf16 v[156:159], a[244:247], v[44:47], v[156:159]
    ds_read_b128 v[84:87], v2 offset:10240
    v_mfma_f32_16x16x32_bf16 v[160:163], a[240:243], v[48:51], v[160:163]
    s_add_u32 m0, s65, 2048
    v_mfma_f32_16x16x32_bf16 v[164:167], a[244:247], v[48:51], v[164:167]
    ds_read_b128 v[88:91], v2 offset:12288
    buffer_load_dwordx4 v10, s[32:35], s45 offen lds
    v_mfma_f32_16x16x32_bf16 v[168:171], a[240:243], v[52:55], v[168:171]
    ds_read_b128 v[92:95], v2 offset:14336
    v_mfma_f32_16x16x32_bf16 v[172:175], a[244:247], v[52:55], v[172:175]
    s_add_u32 m0, s65, 3072
    v_mfma_f32_16x16x32_bf16 v[176:179], a[240:243], v[56:59], v[176:179]
    buffer_load_dwordx4 v11, s[32:35], s45 offen lds
    s_add_u32 s45, s45, 128
    v_mfma_f32_16x16x32_bf16 v[180:183], a[244:247], v[56:59], v[180:183]
    v_add_u32 v1, 0x4000, v1
    v_mfma_f32_16x16x32_bf16 v[184:187], a[240:243], v[60:63], v[184:187]
    v_add_u32 v2, 0x4000, v2
    v_mfma_f32_16x16x32_bf16 v[188:191], a[244:247], v[60:63], v[188:191]
    s_waitcnt vmcnt(8) lgkmcnt(0)
    s_barrier
    v_mfma_f32_16x16x32_bf16 v[128:131], a[248:251], v[64:67], v[128:131]
    ds_read_b128 v[32:35], v1 offset:0
    v_mfma_f32_16x16x32_bf16 v[132:135], a[252:255], v[64:67], v[132:135]
    ds_read_b128 v[36:39], v1 offset:2048
    v_mfma_f32_16x16x32_bf16 v[136:139], a[248:251], v[68:71], v[136:139]
    ds_read_b128 v[40:43], v1 offset:4096
    v_mfma_f32_16x16x32_bf16 v[140:143], a[252:255], v[68:71], v[140:143]
    ds_read_b128 v[44:47], v1 offset:6144
    v_mfma_f32_16x16x32_bf16 v[144:147], a[248:251], v[72:75], v[144:147]
    ds_read_b128 v[48:51], v1 offset:8192
    v_cvt_pk_bf16_f32 v96, v128, v129
    v_cvt_pk_bf16_f32 v97, v130, v131
    v_mfma_f32_16x16x32_bf16 v[148:151], a[252:255], v[72:75], v[148:151]
    ds_read_b128 v[52:55], v1 offset:10240
    v_cvt_pk_bf16_f32 v98, v132, v133
    v_cvt_pk_bf16_f32 v99, v134, v135
    v_mfma_f32_16x16x32_bf16 v[152:155], a[248:251], v[76:79], v[152:155]
    ds_read_b128 v[56:59], v1 offset:12288
    v_cvt_pk_bf16_f32 v100, v136, v137
    v_cvt_pk_bf16_f32 v101, v138, v139
    v_mfma_f32_16x16x32_bf16 v[156:159], a[252:255], v[76:79], v[156:159]
    ds_read_b128 v[60:63], v1 offset:14336
    v_cvt_pk_bf16_f32 v102, v140, v141
    v_cvt_pk_bf16_f32 v103, v142, v143
    v_mfma_f32_16x16x32_bf16 v[160:163], a[248:251], v[80:83], v[160:163]
    v_cvt_pk_bf16_f32 v104, v144, v145
    v_cvt_pk_bf16_f32 v105, v146, v147
    v_mfma_f32_16x16x32_bf16 v[164:167], a[252:255], v[80:83], v[164:167]
    v_cvt_pk_bf16_f32 v106, v148, v149
    v_cvt_pk_bf16_f32 v107, v150, v151
    v_mfma_f32_16x16x32_bf16 v[168:171], a[248:251], v[84:87], v[168:171]
    v_cvt_pk_bf16_f32 v108, v152, v153
    v_cvt_pk_bf16_f32 v109, v154, v155
    v_mfma_f32_16x16x32_bf16 v[172:175], a[252:255], v[84:87], v[172:175]
    v_cvt_pk_bf16_f32 v110, v156, v157
    v_cvt_pk_bf16_f32 v111, v158, v159
    v_mfma_f32_16x16x32_bf16 v[176:179], a[248:251], v[88:91], v[176:179]
    v_cvt_pk_bf16_f32 v112, v160, v161
    v_cvt_pk_bf16_f32 v113, v162, v163
    v_mfma_f32_16x16x32_bf16 v[180:183], a[252:255], v[88:91], v[180:183]
    v_cvt_pk_bf16_f32 v114, v164, v165
    v_cvt_pk_bf16_f32 v115, v166, v167
    v_mfma_f32_16x16x32_bf16 v[184:187], a[248:251], v[92:95], v[184:187]
    v_cvt_pk_bf16_f32 v116, v168, v169
    v_cvt_pk_bf16_f32 v117, v170, v171
    v_mfma_f32_16x16x32_bf16 v[188:191], a[252:255], v[92:95], v[188:191]
    v_cvt_pk_bf16_f32 v118, v172, v173
    v_cvt_pk_bf16_f32 v119, v174, v175
    v_cvt_pk_bf16_f32 v120, v176, v177
    v_cvt_pk_bf16_f32 v121, v178, v179
    v_cvt_pk_bf16_f32 v122, v180, v181
    v_cvt_pk_bf16_f32 v123, v182, v183
    v_cvt_pk_bf16_f32 v124, v184, v185
    v_cvt_pk_bf16_f32 v125, v186, v187
    v_cvt_pk_bf16_f32 v126, v188, v189
    v_cvt_pk_bf16_f32 v127, v190, v191
    s_mov_b32 s71, s70
    s_mov_b32 s78, s48
    s_cmp_lt_u32 s74, 0x400000
    s_cbranch_scc1 L_g3_a
    s_waitcnt vmcnt(0) lgkmcnt(0)
    s_cmp_eq_u32 s56, 1
    s_cbranch_scc1 L_phase_end
    buffer_store_dwordx4 v[96:99], v3, s[4:7], s78 offen sc1
    s_add_u32 s78, s78, 0x20000
    buffer_store_dwordx4 v[100:103], v3, s[4:7], s78 offen sc1
    s_add_u32 s78, s78, 0x20000
    buffer_store_dwordx4 v[104:107], v3, s[4:7], s78 offen sc1
    s_add_u32 s78, s78, 0x20000
    buffer_store_dwordx4 v[108:111], v3, s[4:7], s78 offen sc1
    s_add_u32 s78, s78, 0x20000
    buffer_store_dwordx4 v[112:115], v3, s[4:7], s78 offen sc1
    s_add_u32 s78, s78, 0x20000
    buffer_store_dwordx4 v[116:119], v3, s[4:7], s78 offen sc1
    s_add_u32 s78, s78, 0x20000
    buffer_store_dwordx4 v[120:123], v3, s[4:7], s78 offen sc1
    s_add_u32 s78, s78, 0x20000
    buffer_store_dwordx4 v[124:127], v3, s[4:7], s78 offen sc1
    s_add_u32 s78, s78, 0x20000
    s_load_dwordx2 s[24:25], s[0:1], 24
    s_mov_b32 s26, 8192
    s_waitcnt lgkmcnt(0)
    s_lshl_b32 s43, s53, 5
    s_add_u32 s43, s43, s54
    s_lshr_b32 s44, s43, 3
    s_and_b32 s43, s43, 7
    s_lshl_b32 s43, s43, 2
    s_add_u32 s43, s43, s40
    s_lshl_b32 s41, s43, 17
    s_lshl_b32 s42, s44, 7
    s_add_u32 s41, s41, s42
    v_mov_b32 v20, s41
    v_bfe_u32 v31, v0, 3, 3
    v_lshl_add_u32 v20, v31, 14, v20
    v_bfe_u32 v31, v0, 0, 3
    v_lshl_add_u32 v20, v31, 4, v20
    s_lshl_b32 s41, s44, 9
    v_mov_b32 v22, s41
    v_bfe_u32 v31, v0, 0, 3
    v_lshl_add_u32 v22, v31, 6, v22
    buffer_load_dwordx4 v[48:51], v22, s[24:27], 0 offen offset:0
    buffer_load_dwordx4 v[52:55], v22, s[24:27], 0 offen offset:16
    buffer_load_dwordx4 v[56:59], v22, s[24:27], 0 offen offset:32
    buffer_load_dwordx4 v[60:63], v22, s[24:27], 0 offen offset:48
    v_add_u32 v23, 0xffffe800, v20
    buffer_load_dwordx4 v[64:67], v23, s[88:91], 0 offen nt
    v_add_u32 v23, 0xfffff000, v20
    buffer_load_dwordx4 v[68:71], v23, s[88:91], 0 offen nt
    v_add_u32 v23, 0xfffff800, v20
    buffer_load_dwordx4 v[72:75], v23, s[88:91], 0 offen nt
    v_add_u32 v23, 0x0, v20
    buffer_load_dwordx4 v[76:79], v23, s[88:91], 0 offen nt
    v_add_u32 v23, 0x800, v20
    buffer_load_dwordx4 v[80:83], v23, s[88:91], 0 offen nt
    v_add_u32 v23, 0x1000, v20
    buffer_load_dwordx4 v[84:87], v23, s[88:91], 0 offen nt
    v_add_u32 v23, 0x1800, v20
    buffer_load_dwordx4 v[88:91], v23, s[88:91], 0 offen nt
    v_add_u32 v23, 0x2000, v20
    buffer_load_dwordx4 v[92:95], v23, s[88:91], 0 offen nt
    v_add_u32 v23, 0x2800, v20
    buffer_load_dwordx4 v[96:99], v23, s[88:91], 0 offen nt
    v_add_u32 v23, 0x3000, v20
    buffer_load_dwordx4 v[100:103], v23, s[88:91], 0 offen nt
    v_add_u32 v23, 0x3800, v20
    buffer_load_dwordx4 v[104:107], v23, s[88:91], 0 offen nt
    v_add_u32 v23, 0x0, v20
    buffer_load_dwordx4 v[108:111], v23, s[92:95], 0 offen nt
    v_add_u32 v23, 0x800, v20
    buffer_load_dwordx4 v[112:115], v23, s[92:95], 0 offen nt
    v_add_u32 v23, 0x1000, v20
    buffer_load_dwordx4 v[116:119], v23, s[92:95], 0 offen nt
    v_add_u32 v23, 0x1800, v20
    buffer_load_dwordx4 v[120:123], v23, s[92:95], 0 offen nt
    v_add_u32 v23, 0x2000, v20
    buffer_load_dwordx4 v[124:127], v23, s[92:95], 0 offen nt
    v_add_u32 v23, 0x2800, v20
    buffer_load_dwordx4 v[128:131], v23, s[92:95], 0 offen nt
    v_add_u32 v23, 0x3000, v20
    buffer_load_dwordx4 v[132:135], v23, s[92:95], 0 offen nt
    v_add_u32 v23, 0x3800, v20
    buffer_load_dwordx4 v[136:139], v23, s[92:95], 0 offen nt
    s_lshl_b32 s41, s44, 18
    s_lshl_b32 s42, s43, 7
    s_add_u32 s41, s41, s42
    s_add_u32 s59, s41, 0x9200000
    v_bfe_u32 v31, v0, 3, 3
    v_lshlrev_b32 v21, 15, v31
    v_bfe_u32 v31, v0, 0, 3
    v_lshl_add_u32 v21, v31, 4, v21
    s_waitcnt vmcnt(28)
    s_mov_b64 s[36:37], s[8:9]
    s_lshr_b32 s62, s54, 2
    s_lshl3_add_u32 s62, s53, s62
    s_add_u32 s62, s62, 64
    s_and_b32 s41, s62, 31
    s_lshl_b32 s46, s41, 8
    s_lshl_b32 s41, s41, 12
    s_lshr_b32 s42, s62, 5
    s_lshl_b32 s60, s42, 24
    s_add_u32 s60, s60, s41
    s_lshl_b32 s42, s42, 11
    s_add_u32 s61, s41, s42
    s_lshl_b32 s41, s40, 10
    s_add_u32 s60, s60, s41
    s_and_b32 s41, s41, 1024
    s_add_u32 s61, s61, s41
    s_lshr_b32 s41, s40, 1
    s_lshl_b32 s41, s41, 17
    s_add_u32 s61, s61, s41
    s_mov_b32 s61, 0x10000000
    s_mov_b32 s63, 0x10000000
    s_and_b32 s57, s54, 3
    s_mov_b32 s58, 4
    s_mov_b32 s56, 1
    s_branch L_phase
L_phase_end:
    buffer_store_dwordx4 v[96:99], v3, s[4:7], s78 offen sc1
    s_add_u32 s78, s78, 0x20000
    buffer_store_dwordx4 v[100:103], v3, s[4:7], s78 offen sc1
    s_add_u32 s78, s78, 0x20000
    buffer_store_dwordx4 v[104:107], v3, s[4:7], s78 offen sc1
    s_add_u32 s78, s78, 0x20000
    buffer_store_dwordx4 v[108:111], v3, s[4:7], s78 offen sc1
    s_add_u32 s78, s78, 0x20000
    buffer_store_dwordx4 v[112:115], v3, s[4:7], s78 offen sc1
    s_add_u32 s78, s78, 0x20000
    buffer_store_dwordx4 v[116:119], v3, s[4:7], s78 offen sc1
    s_add_u32 s78, s78, 0x20000
    buffer_store_dwordx4 v[120:123], v3, s[4:7], s78 offen sc1
    s_add_u32 s78, s78, 0x20000
    buffer_store_dwordx4 v[124:127], v3, s[4:7], s78 offen sc1
    s_add_u32 s78, s78, 0x20000
    s_lshl_b32 s52, s53, 5
    s_add_u32 s52, s52, s54
    s_lshr_b32 s41, s54, 3
    s_and_b32 s54, s54, 7
    s_lshl3_add_u32 s54, s53, s54
    s_mov_b32 s53, s41
    s_lshr_b32 s78, s54, 3
    s_and_b32 s79, s54, 7
    s_lshr_b32 s47, s52, 3
    s_lshl_b32 s47, s47, 10
    s_add_u32 s47, s47, 0x4dc0020
    s_and_b32 s41, s40, 1
    s_lshl_b32 s41, s41, 2
    v_mov_b32 v10, s41
    v_bfe_u32 v31, v0, 4, 2
    v_lshl_add_u32 v10, v31, 0, v10
    v_lshlrev_b32 v11, 1, v10
    v_xor_b32 v11, v0, v11
    v_and_b32 v11, 15, v11
    v_lshlrev_b32 v11, 4, v11
    v_lshl_add_u32 v8, v10, 11, v11
    s_lshl_b32 s44, s40, 10
    s_lshl_b32 s41, s78, 21
    s_lshl_b32 s42, s79, 8
    s_add_u32 s41, s41, s42
    s_lshr_b32 s42, s40, 1
    s_lshl_b32 s42, s42, 14
    s_add_u32 s41, s41, s42
    v_bfe_u32 v31, v0, 2, 3
    v_lshlrev_b32 v10, 0, v31
    s_lshl_b32 s42, s40, 1
    v_xor_b32 v10, s42, v10
    v_bfe_u32 v31, v0, 2, 4
    v_lshlrev_b32 v11, 8, v31
    v_bfe_u32 v31, v0, 0, 2
    v_lshl_add_u32 v11, v31, 3, v11
    v_xor_b32 v12, 0, v10
    v_lshl_add_u32 v13, v12, 5, v11
    v_add_u32 v15, 0x10000, v13
    v_xor_b32 v12, 1, v10
    v_lshl_add_u32 v14, v12, 5, v11
    v_add_u32 v16, 0x10000, v14
    s_barrier
    s_add_u32 m0, s44, 0
    s_nop 0
    buffer_load_dwordx4 v8, s[20:23], s41 offen lds
    s_add_u32 s41, s41, 0x8000
    s_add_u32 m0, s44, 4096
    s_nop 0
    buffer_load_dwordx4 v8, s[20:23], s41 offen lds
    s_add_u32 s41, s41, 0x8000
    s_add_u32 m0, s44, 8192
    s_nop 0
    buffer_load_dwordx4 v8, s[20:23], s41 offen lds
    s_add_u32 s41, s41, 0x8000
    s_add_u32 m0, s44, 12288
    s_nop 0
    buffer_load_dwordx4 v8, s[20:23], s41 offen lds
    s_add_u32 s41, s41, 0x8000
    s_add_u32 m0, s44, 16384
    s_nop 0
    buffer_load_dwordx4 v8, s[20:23], s41 offen lds
    s_add_u32 s41, s41, 0x8000
    s_add_u32 m0, s44, 20480
    s_nop 0
    buffer_load_dwordx4 v8, s[20:23], s41 offen lds
    s_add_u32 s41, s41, 0x8000
    s_add_u32 m0, s44, 24576
    s_nop 0
    buffer_load_dwordx4 v8, s[20:23], s41 offen lds
    s_add_u32 s41, s41, 0x8000
    s_add_u32 m0, s44, 28672
    s_nop 0
    buffer_load_dwordx4 v8, s[20:23], s41 offen lds
    s_add_u32 s41, s41, 0x8000
    s_add_u32 m0, s44, 32768
    s_nop 0
    buffer_load_dwordx4 v8, s[20:23], s41 offen lds
    s_add_u32 s41, s41, 0x8000
    s_add_u32 m0, s44, 36864
    s_nop 0
    buffer_load_dwordx4 v8, s[20:23], s41 offen lds
    s_add_u32 s41, s41, 0x8000
    s_add_u32 m0, s44, 40960
    s_nop 0
    buffer_load_dwordx4 v8, s[20:23], s41 offen lds
    s_add_u32 s41, s41, 0x8000
    s_add_u32 m0, s44, 45056
    s_nop 0
    buffer_load_dwordx4 v8, s[20:23], s41 offen lds
    s_add_u32 s41, s41, 0x8000
    s_add_u32 m0, s44, 49152
    s_nop 0
    buffer_load_dwordx4 v8, s[20:23], s41 offen lds
    s_add_u32 s41, s41, 0x8000
    s_add_u32 m0, s44, 53248
    s_nop 0
    buffer_load_dwordx4 v8, s[20:23], s41 offen lds
    s_add_u32 s41, s41, 0x8000
    s_add_u32 m0, s44, 57344
    s_nop 0
    buffer_load_dwordx4 v8, s[20:23], s41 offen lds
    s_add_u32 s41, s41, 0x8000
    s_add_u32 m0, s44, 61440
    s_nop 0
    buffer_load_dwordx4 v8, s[20:23], s41 offen lds
    s_add_u32 s41, s41, 0x8000
    s_add_u32 m0, s44, 65536
    s_nop 0
    buffer_load_dwordx4 v8, s[20:23], s41 offen lds
    s_add_u32 s41, s41, 0x8000
    s_add_u32 m0, s44, 69632
    s_nop 0
    buffer_load_dwordx4 v8, s[20:23], s41 offen lds
    s_add_u32 s41, s41, 0x8000
    s_add_u32 m0, s44, 73728
    s_nop 0
    buffer_load_dwordx4 v8, s[20:23], s41 offen lds
    s_add_u32 s41, s41, 0x8000
    s_add_u32 m0, s44, 77824
    s_nop 0
    buffer_load_dwordx4 v8, s[20:23], s41 offen lds
    s_add_u32 s41, s41, 0x8000
    s_add_u32 m0, s44, 81920
    s_nop 0
    buffer_load_dwordx4 v8, s[20:23], s41 offen lds
    s_add_u32 s41, s41, 0x8000
    s_add_u32 m0, s44, 86016
    s_nop 0
    buffer_load_dwordx4 v8, s[20:23], s41 offen lds
    s_add_u32 s41, s41, 0x8000
    s_add_u32 m0, s44, 90112
    s_nop 0
    buffer_load_dwordx4 v8, s[20:23], s41 offen lds
    s_add_u32 s41, s41, 0x8000
    s_add_u32 m0, s44, 94208
    s_nop 0
    buffer_load_dwordx4 v8, s[20:23], s41 offen lds
    s_add_u32 s41, s41, 0x8000
    s_add_u32 m0, s44, 98304
    s_nop 0
    buffer_load_dwordx4 v8, s[20:23], s41 offen lds
    s_add_u32 s41, s41, 0x8000
    s_add_u32 m0, s44, 102400
    s_nop 0
    buffer_load_dwordx4 v8, s[20:23], s41 offen lds
    s_add_u32 s41, s41, 0x8000
    s_add_u32 m0, s44, 106496
    s_nop 0
    buffer_load_dwordx4 v8, s[20:23], s41 offen lds
    s_add_u32 s41, s41, 0x8000
    s_add_u32 m0, s44, 110592
    s_nop 0
    buffer_load_dwordx4 v8, s[20:23], s41 offen lds
    s_add_u32 s41, s41, 0x8000
    s_add_u32 m0, s44, 114688
    s_nop 0
    buffer_load_dwordx4 v8, s[20:23], s41 offen lds
    s_add_u32 s41, s41, 0x8000
    s_add_u32 m0, s44, 118784
    s_nop 0
    buffer_load_dwordx4 v8, s[20:23], s41 offen lds
    s_add_u32 s41, s41, 0x8000
    s_add_u32 m0, s44, 122880
    s_nop 0
    buffer_load_dwordx4 v8, s[20:23], s41 offen lds
    s_add_u32 s41, s41, 0x8000
    s_add_u32 m0, s44, 126976
    s_nop 0
    buffer_load_dwordx4 v8, s[20:23], s41 offen lds
    s_add_u32 s41, s41, 0x8000
    buffer_load_dword v20, off, s[4:7], s47 sc1
    s_waitcnt vmcnt(17)
    s_barrier
    ds_read_b64_tr_b16 a[0:1], v13 offset:0
    ds_read_b64_tr_b16 a[2:3], v13 offset:4096
    ds_read_b64_tr_b16 a[4:5], v14 offset:0
    ds_read_b64_tr_b16 a[6:7], v14 offset:4096
    s_waitcnt lgkmcnt(8)
    ds_read_b64_tr_b16 a[8:9], v13 offset:8192
    ds_read_b64_tr_b16 a[10:11], v13 offset:12288
    ds_read_b64_tr_b16 a[12:13], v14 offset:8192
    ds_read_b64_tr_b16 a[14:15], v14 offset:12288
    s_waitcnt lgkmcnt(8)
    ds_read_b64_tr_b16 a[16:17], v13 offset:16384
    ds_read_b64_tr_b16 a[18:19], v13 offset:20480
    ds_read_b64_tr_b16 a[20:21], v14 offset:16384
    ds_read_b64_tr_b16 a[22:23], v14 offset:20480
    s_waitcnt lgkmcnt(8)
    ds_read_b64_tr_b16 a[24:25], v13 offset:24576
    ds_read_b64_tr_b16 a[26:27], v13 offset:28672
    ds_read_b64_tr_b16 a[28:29], v14 offset:24576
    ds_read_b64_tr_b16 a[30:31], v14 offset:28672
    s_waitcnt lgkmcnt(8)
    ds_read_b64_tr_b16 a[32:33], v13 offset:32768
    ds_read_b64_tr_b16 a[34:35], v13 offset:36864
    ds_read_b64_tr_b16 a[36:37], v14 offset:32768
    ds_read_b64_tr_b16 a[38:39], v14 offset:36864
    s_waitcnt lgkmcnt(8)
    ds_read_b64_tr_b16 a[40:41], v13 offset:40960
    ds_read_b64_tr_b16 a[42:43], v13 offset:45056
    ds_read_b64_tr_b16 a[44:45], v14 offset:40960
    ds_read_b64_tr_b16 a[46:47], v14 offset:45056
    s_waitcnt lgkmcnt(8)
    ds_read_b64_tr_b16 a[48:49], v13 offset:49152
    ds_read_b64_tr_b16 a[50:51], v13 offset:53248
    ds_read_b64_tr_b16 a[52:53], v14 offset:49152
    ds_read_b64_tr_b16 a[54:55], v14 offset:53248
    s_waitcnt lgkmcnt(8)
    ds_read_b64_tr_b16 a[56:57], v13 offset:57344
    ds_read_b64_tr_b16 a[58:59], v13 offset:61440
    ds_read_b64_tr_b16 a[60:61], v14 offset:57344
    ds_read_b64_tr_b16 a[62:63], v14 offset:61440
    s_waitcnt lgkmcnt(8)
    s_waitcnt lgkmcnt(0)
    s_barrier
    s_add_u32 m0, s44, 0
    s_nop 0
    buffer_load_dwordx4 v8, s[20:23], s41 offen lds
    s_add_u32 s41, s41, 0x8000
    s_add_u32 m0, s44, 4096
    s_nop 0
    buffer_load_dwordx4 v8, s[20:23], s41 offen lds
    s_add_u32 s41, s41, 0x8000
    s_add_u32 m0, s44, 8192
    s_nop 0
    buffer_load_dwordx4 v8, s[20:23], s41 offen lds
    s_add_u32 s41, s41, 0x8000
    s_add_u32 m0, s44, 12288
    s_nop 0
    buffer_load_dwordx4 v8, s[20:23], s41 offen lds
    s_add_u32 s41, s41, 0x8000
    s_add_u32 m0, s44, 16384
    s_nop 0
    buffer_load_dwordx4 v8, s[20:23], s41 offen lds
    s_add_u32 s41, s41, 0x8000
    s_add_u32 m0, s44, 20480
    s_nop 0
    buffer_load_dwordx4 v8, s[20:23], s41 offen lds
    s_add_u32 s41, s41, 0x8000
    s_add_u32 m0, s44, 24576
    s_nop 0
    buffer_load_dwordx4 v8, s[20:23], s41 offen lds
    s_add_u32 s41, s41, 0x8000
    s_add_u32 m0, s44, 28672
    s_nop 0
    buffer_load_dwordx4 v8, s[20:23], s41 offen lds
    s_add_u32 s41, s41, 0x8000
    s_add_u32 m0, s44, 32768
    s_nop 0
    buffer_load_dwordx4 v8, s[20:23], s41 offen lds
    s_add_u32 s41, s41, 0x8000
    s_add_u32 m0, s44, 36864
    s_nop 0
    buffer_load_dwordx4 v8, s[20:23], s41 offen lds
    s_add_u32 s41, s41, 0x8000
    s_add_u32 m0, s44, 40960
    s_nop 0
    buffer_load_dwordx4 v8, s[20:23], s41 offen lds
    s_add_u32 s41, s41, 0x8000
    s_add_u32 m0, s44, 45056
    s_nop 0
    buffer_load_dwordx4 v8, s[20:23], s41 offen lds
    s_add_u32 s41, s41, 0x8000
    s_add_u32 m0, s44, 49152
    s_nop 0
    buffer_load_dwordx4 v8, s[20:23], s41 offen lds
    s_add_u32 s41, s41, 0x8000
    s_add_u32 m0, s44, 53248
    s_nop 0
    buffer_load_dwordx4 v8, s[20:23], s41 offen lds
    s_add_u32 s41, s41, 0x8000
    s_add_u32 m0, s44, 57344
    s_nop 0
    buffer_load_dwordx4 v8, s[20:23], s41 offen lds
    s_add_u32 s41, s41, 0x8000
    s_add_u32 m0, s44, 61440
    s_nop 0
    buffer_load_dwordx4 v8, s[20:23], s41 offen lds
    s_add_u32 s41, s41, 0x8000
    s_waitcnt vmcnt(16)
    s_barrier
Lwp_66:
    v_readfirstlane_b32 s42, v20
    s_nop 0
    s_cmp_eq_u32 s42, 8
    s_cbranch_scc1 Lwp_67
    s_sleep 8
    buffer_load_dword v20, off, s[4:7], s47 sc1
    s_waitcnt vmcnt(0)
    s_sub_u32 s55, s55, 1
    s_cbranch_scc0 Lwp_66
    s_endpgm
Lwp_67:
    s_cmp_eq_u32 s40, 0
    s_cbranch_scc0 Lone_68
    v_mov_b32 v20, 1
    s_mov_b64 exec, 1
    buffer_atomic_add v20, off, s[28:31], 0 offset:64 sc1
    s_mov_b64 exec, -1
Lone_68:
    ds_read_b64_tr_b16 a[64:65], v15 offset:0
    ds_read_b64_tr_b16 a[66:67], v15 offset:4096
    ds_read_b64_tr_b16 a[68:69], v16 offset:0
    ds_read_b64_tr_b16 a[70:71], v16 offset:4096
    s_waitcnt lgkmcnt(8)
    ds_read_b64_tr_b16 a[72:73], v15 offset:8192
    ds_read_b64_tr_b16 a[74:75], v15 offset:12288
    ds_read_b64_tr_b16 a[76:77], v16 offset:8192
    ds_read_b64_tr_b16 a[78:79], v16 offset:12288
    s_waitcnt lgkmcnt(8)
    ds_read_b64_tr_b16 a[80:81], v15 offset:16384
    ds_read_b64_tr_b16 a[82:83], v15 offset:20480
    ds_read_b64_tr_b16 a[84:85], v16 offset:16384
    ds_read_b64_tr_b16 a[86:87], v16 offset:20480
    s_waitcnt lgkmcnt(8)
    ds_read_b64_tr_b16 a[88:89], v15 offset:24576
    ds_read_b64_tr_b16 a[90:91], v15 offset:28672
    ds_read_b64_tr_b16 a[92:93], v16 offset:24576
    ds_read_b64_tr_b16 a[94:95], v16 offset:28672
    s_waitcnt lgkmcnt(8)
    ds_read_b64_tr_b16 a[96:97], v15 offset:32768
    ds_read_b64_tr_b16 a[98:99], v15 offset:36864
    ds_read_b64_tr_b16 a[100:101], v16 offset:32768
    ds_read_b64_tr_b16 a[102:103], v16 offset:36864
    s_waitcnt lgkmcnt(8)
    ds_read_b64_tr_b16 a[104:105], v15 offset:40960
    ds_read_b64_tr_b16 a[106:107], v15 offset:45056
    ds_read_b64_tr_b16 a[108:109], v16 offset:40960
    ds_read_b64_tr_b16 a[110:111], v16 offset:45056
    s_waitcnt lgkmcnt(8)
    ds_read_b64_tr_b16 a[112:113], v15 offset:49152
    ds_read_b64_tr_b16 a[114:115], v15 offset:53248
    ds_read_b64_tr_b16 a[116:117], v16 offset:49152
    ds_read_b64_tr_b16 a[118:119], v16 offset:53248
    s_waitcnt lgkmcnt(8)
    ds_read_b64_tr_b16 a[120:121], v15 offset:57344
    ds_read_b64_tr_b16 a[122:123], v15 offset:61440
    ds_read_b64_tr_b16 a[124:125], v16 offset:57344
    ds_read_b64_tr_b16 a[126:127], v16 offset:61440
    s_waitcnt lgkmcnt(8)
    s_waitcnt lgkmcnt(0)
    s_barrier
    s_add_u32 m0, s44, 65536
    s_nop 0
    buffer_load_dwordx4 v8, s[20:23], s41 offen lds
    s_add_u32 s41, s41, 0x8000
    s_add_u32 m0, s44, 69632
    s_nop 0
    buffer_load_dwordx4 v8, s[20:23], s41 offen lds
    s_add_u32 s41, s41, 0x8000
    s_add_u32 m0, s44, 73728
    s_nop 0
    buffer_load_dwordx4 v8, s[20:23], s41 offen lds
    s_add_u32 s41, s41, 0x8000
    s_add_u32 m0, s44, 77824
    s_nop 0
    buffer_load_dwordx4 v8, s[20:23], s41 offen lds
    s_add_u32 s41, s41, 0x8000
    s_add_u32 m0, s44, 81920
    s_nop 0
    buffer_load_dwordx4 v8, s[20:23], s41 offen lds
    s_add_u32 s41, s41, 0x8000
    s_add_u32 m0, s44, 86016
    s_nop 0
    buffer_load_dwordx4 v8, s[20:23], s41 offen lds
    s_add_u32 s41, s41, 0x8000
    s_add_u32 m0, s44, 90112
    s_nop 0
    buffer_load_dwordx4 v8, s[20:23], s41 offen lds
    s_add_u32 s41, s41, 0x8000
    s_add_u32 m0, s44, 94208
    s_nop 0
    buffer_load_dwordx4 v8, s[20:23], s41 offen lds
    s_add_u32 s41, s41, 0x8000
    s_add_u32 m0, s44, 98304
    s_nop 0
    buffer_load_dwordx4 v8, s[20:23], s41 offen lds
    s_add_u32 s41, s41, 0x8000
    s_add_u32 m0, s44, 102400
    s_nop 0
    buffer_load_dwordx4 v8, s[20:23], s41 offen lds
    s_add_u32 s41, s41, 0x8000
    s_add_u32 m0, s44, 106496
    s_nop 0
    buffer_load_dwordx4 v8, s[20:23], s41 offen lds
    s_add_u32 s41, s41, 0x8000
    s_add_u32 m0, s44, 110592
    s_nop 0
    buffer_load_dwordx4 v8, s[20:23], s41 offen lds
    s_add_u32 s41, s41, 0x8000
    s_add_u32 m0, s44, 114688
    s_nop 0
    buffer_load_dwordx4 v8, s[20:23], s41 offen lds
    s_add_u32 s41, s41, 0x8000
    s_add_u32 m0, s44, 118784
    s_nop 0
    buffer_load_dwordx4 v8, s[20:23], s41 offen lds
    s_add_u32 s41, s41, 0x8000
    s_add_u32 m0, s44, 122880
    s_nop 0
    buffer_load_dwordx4 v8, s[20:23], s41 offen lds
    s_add_u32 s41, s41, 0x8000
    s_add_u32 m0, s44, 126976
    s_nop 0
    buffer_load_dwordx4 v8, s[20:23], s41 offen lds
    s_add_u32 s41, s41, 0x8000
    s_lshl_b32 s42, s52, 15
    s_lshl_b32 s43, s40, 13
    s_add_u32 s42, s42, s43
    v_mov_b32 v6, s42
    v_bfe_u32 v31, v0, 0, 6
    v_lshl_add_u32 v6, v31, 4, v6
    v_subrev_u32 v7, 8, v6
    buffer_load_dwordx2 v[208:209], v7, s[96:99], 0 offen offset:0
    buffer_load_dwordx4 v[210:213], v6, s[96:99], 0 offen offset:0
    buffer_load_dwordx2 v[214:215], v6, s[96:99], 0 offen offset:1016
    buffer_load_dwordx4 v[216:219], v6, s[96:99], 0 offen offset:1024
    buffer_load_dwordx2 v[220:221], v6, s[96:99], 0 offen offset:2040
    buffer_load_dwordx4 v[222:225], v6, s[96:99], 0 offen offset:2048
    buffer_load_dwordx2 v[226:227], v6, s[96:99], 0 offen offset:3064
    buffer_load_dwordx4 v[228:231], v6, s[96:99], 0 offen offset:3072
    v_add_u32 v6, 4096, v6
    v_subrev_u32 v7, 8, v6
    buffer_load_dwordx2 v[232:233], v7, s[96:99], 0 offen offset:0
    buffer_load_dwordx4 v[234:237], v6, s[96:99], 0 offen offset:0
    buffer_load_dwordx2 v[238:239], v6, s[96:99], 0 offen offset:1016
    buffer_load_dwordx4 v[240:243], v6, s[96:99], 0 offen offset:1024
    buffer_load_dwordx2 v[244:245], v6, s[96:99], 0 offen offset:2040
    buffer_load_dwordx4 v[246:249], v6, s[96:99], 0 offen offset:2048
    buffer_load_dwordx2 v[250:251], v6, s[96:99], 0 offen offset:3064
    buffer_load_dwordx4 v[252:255], v6, s[96:99], 0 offen offset:3072
    s_lshl_b32 s43, s52, 15
    s_lshl_b32 s42, s40, 10
    s_add_u32 s43, s43, s42
    s_add_u32 s43, s43, 0x9200000
    v_lshlrev_b32 v7, 4, v0
    buffer_load_dwordx4 v[32:35], v7, s[4:7], s43 offen sc1
    s_add_u32 s43, s43, 4096
    buffer_load_dwordx4 v[36:39], v7, s[4:7], s43 offen sc1
    s_add_u32 s43, s43, 4096
    buffer_load_dwordx4 v[40:43], v7, s[4:7], s43 offen sc1
    s_add_u32 s43, s43, 4096
    buffer_load_dwordx4 v[44:47], v7, s[4:7], s43 offen sc1
    s_add_u32 s43, s43, 4096
    buffer_load_dwordx4 v[48:51], v7, s[4:7], s43 offen sc1
    s_add_u32 s43, s43, 4096
    buffer_load_dwordx4 v[52:55], v7, s[4:7], s43 offen sc1
    s_add_u32 s43, s43, 4096
    buffer_load_dwordx4 v[56:59], v7, s[4:7], s43 offen sc1
    s_add_u32 s43, s43, 4096
    buffer_load_dwordx4 v[60:63], v7, s[4:7], s43 offen sc1
    s_add_u32 s43, s43, 4096
    s_waitcnt vmcnt(40)
    s_barrier
    ds_read_b64_tr_b16 a[128:129], v13 offset:0
    ds_read_b64_tr_b16 a[130:131], v13 offset:4096
    ds_read_b64_tr_b16 a[132:133], v14 offset:0
    ds_read_b64_tr_b16 a[134:135], v14 offset:4096
    s_waitcnt lgkmcnt(8)
    ds_read_b64_tr_b16 a[136:137], v13 offset:8192
    ds_read_b64_tr_b16 a[138:139], v13 offset:12288
    ds_read_b64_tr_b16 a[140:141], v14 offset:8192
    ds_read_b64_tr_b16 a[142:143], v14 offset:12288
    s_waitcnt lgkmcnt(8)
    ds_read_b64_tr_b16 a[144:145], v13 offset:16384
    ds_read_b64_tr_b16 a[146:147], v13 offset:20480
    ds_read_b64_tr_b16 a[148:149], v14 offset:16384
    ds_read_b64_tr_b16 a[150:151], v14 offset:20480
    s_waitcnt lgkmcnt(8)
    ds_read_b64_tr_b16 a[152:153], v13 offset:24576
    ds_read_b64_tr_b16 a[154:155], v13 offset:28672
    ds_read_b64_tr_b16 a[156:157], v14 offset:24576
    ds_read_b64_tr_b16 a[158:159], v14 offset:28672
    s_waitcnt lgkmcnt(8)
    ds_read_b64_tr_b16 a[160:161], v13 offset:32768
    ds_read_b64_tr_b16 a[162:163], v13 offset:36864
    ds_read_b64_tr_b16 a[164:165], v14 offset:32768
    ds_read_b64_tr_b16 a[166:167], v14 offset:36864
    s_waitcnt lgkmcnt(8)
    ds_read_b64_tr_b16 a[168:169], v13 offset:40960
    ds_read_b64_tr_b16 a[170:171], v13 offset:45056
    ds_read_b64_tr_b16 a[172:173], v14 offset:40960
    ds_read_b64_tr_b16 a[174:175], v14 offset:45056
    s_waitcnt lgkmcnt(8)
    ds_read_b64_tr_b16 a[176:177], v13 offset:49152
    ds_read_b64_tr_b16 a[178:179], v13 offset:53248
    ds_read_b64_tr_b16 a[180:181], v14 offset:49152
    ds_read_b64_tr_b16 a[182:183], v14 offset:53248
    s_waitcnt lgkmcnt(8)
    ds_read_b64_tr_b16 a[184:185], v13 offset:57344
    ds_read_b64_tr_b16 a[186:187], v13 offset:61440
    ds_read_b64_tr_b16 a[188:189], v14 offset:57344
    ds_read_b64_tr_b16 a[190:191], v14 offset:61440
    s_waitcnt lgkmcnt(8)
    s_waitcnt lgkmcnt(0)
    s_waitcnt vmcnt(24)
    s_barrier
    ds_read_b64_tr_b16 a[192:193], v15 offset:0
    ds_read_b64_tr_b16 a[194:195], v15 offset:4096
    ds_read_b64_tr_b16 a[196:197], v16 offset:0
    ds_read_b64_tr_b16 a[198:199], v16 offset:4096
    s_waitcnt lgkmcnt(8)
    ds_read_b64_tr_b16 a[200:201], v15 offset:8192
    ds_read_b64_tr_b16 a[202:203], v15 offset:12288
    ds_read_b64_tr_b16 a[204:205], v16 offset:8192
    ds_read_b64_tr_b16 a[206:207], v16 offset:12288
    s_waitcnt lgkmcnt(8)
    ds_read_b64_tr_b16 a[208:209], v15 offset:16384
    ds_read_b64_tr_b16 a[210:211], v15 offset:20480
    ds_read_b64_tr_b16 a[212:213], v16 offset:16384
    ds_read_b64_tr_b16 a[214:215], v16 offset:20480
    s_waitcnt lgkmcnt(8)
    ds_read_b64_tr_b16 a[216:217], v15 offset:24576
    ds_read_b64_tr_b16 a[218:219], v15 offset:28672
    ds_read_b64_tr_b16 a[220:221], v16 offset:24576
    ds_read_b64_tr_b16 a[222:223], v16 offset:28672
    s_waitcnt lgkmcnt(8)
    ds_read_b64_tr_b16 a[224:225], v15 offset:32768
    ds_read_b64_tr_b16 a[226:227], v15 offset:36864
    ds_read_b64_tr_b16 a[228:229], v16 offset:32768
    ds_read_b64_tr_b16 a[230:231], v16 offset:36864
    s_waitcnt lgkmcnt(8)
    ds_read_b64_tr_b16 a[232:233], v15 offset:40960
    ds_read_b64_tr_b16 a[234:235], v15 offset:45056
    ds_read_b64_tr_b16 a[236:237], v16 offset:40960
    ds_read_b64_tr_b16 a[238:239], v16 offset:45056
    s_waitcnt lgkmcnt(8)
    ds_read_b64_tr_b16 a[240:241], v15 offset:49152
    ds_read_b64_tr_b16 a[242:243], v15 offset:53248
    ds_read_b64_tr_b16 a[244:245], v16 offset:49152
    ds_read_b64_tr_b16 a[246:247], v16 offset:53248
    s_waitcnt lgkmcnt(8)
    ds_read_b64_tr_b16 a[248:249], v15 offset:57344
    ds_read_b64_tr_b16 a[250:251], v15 offset:61440
    ds_read_b64_tr_b16 a[252:253], v16 offset:57344
    ds_read_b64_tr_b16 a[254:255], v16 offset:61440
    s_waitcnt lgkmcnt(8)
    s_waitcnt lgkmcnt(0)
    s_mov_b32 s45, s52
    s_load_dwordx2 s[74:75], s[0:1], 40
    s_lshl_b32 s42, s45, 4
    s_waitcnt lgkmcnt(0)
    s_load_dwordx4 s[48:51], s[74:75], s42
    s_lshl_b32 s41, s40, 19
    s_add_u32 s41, s41, s42
    s_add_u32 s41, s41, 0x200000
    v_mov_b32 v1, s41
    v_bfe_u32 v31, v0, 0, 6
    v_lshl_add_u32 v1, v31, 13, v1
    s_barrier
    v_mov_b32 v14, 0
    v_mov_b32 v15, 0
    v_mov_b32 v16, 0
    v_mov_b32 v17, 0
    s_lshl_b32 s41, s40, 10
    v_mov_b32 v10, s41
    v_bfe_u32 v31, v0, 0, 6
    v_lshl_add_u32 v10, v31, 4, v10
    v_cmp_gt_u32 vcc, 2480, v10
    s_nop 0
    s_and_saveexec_b64 s[72:73], vcc
    ds_write_b128 v10, v[14:17] offset:0
    ds_write_b128 v10, v[14:17] offset:7600
    ds_write_b128 v10, v[14:17] offset:15200
    ds_write_b128 v10, v[14:17] offset:22800
    ds_write_b128 v10, v[14:17] offset:30400
    ds_write_b128 v10, v[14:17] offset:38000
    ds_write_b128 v10, v[14:17] offset:45600
    ds_write_b128 v10, v[14:17] offset:53200
    s_mov_b64 exec, 0xffff
    s_mul_i32 s43, s40, 16640
    s_add_u32 s43, s43, 60800
    s_add_u32 s41, s43, 4096
    v_mov_b32 v10, s41
    v_bfe_u32 v31, v0, 2, 2
    v_lshl_add_u32 v10, v31, 12, v10
    v_bfe_u32 v31, v0, 2, 2
    v_lshl_add_u32 v10, v31, 6, v10
    v_bfe_u32 v31, v0, 0, 2
    v_lshl_add_u32 v10, v31, 4, v10
    ds_write_b128 v10, v[14:17]
    s_mov_b64 exec, -1
    s_mul_i32 s41, s40, 1280
    s_add_u32 s41, s41, 2480
    v_mov_b32 v2, s41
    v_bfe_u32 v31, v0, 2, 4
    v_lshl_add_u32 v2, v31, 6, v2
    v_bfe_u32 v31, v0, 2, 4
    v_lshl_add_u32 v2, v31, 4, v2
    v_bfe_u32 v31, v0, 0, 2
    v_lshl_add_u32 v2, v31, 4, v2
    s_mul_i32 s41, s40, 640
    s_add_u32 s41, s41, 5040
    v_mov_b32 v8, s41
    v_bfe_u32 v31, v0, 3, 3
    v_lshl_add_u32 v8, v31, 6, v8
    v_bfe_u32 v31, v0, 3, 3
    v_lshl_add_u32 v8, v31, 4, v8
    v_bfe_u32 v31, v0, 0, 3
    v_lshl_add_u32 v8, v31, 3, v8
    v_and_b32 v10, 31, v0
    v_sub_u32 v10, 31, v10
    v_and_b32 v11, 3, v10
    v_and_b32 v10, 28, v10
    v_mul_u32_u24 v11, 4160, v11
    v_lshl_add_u32 v10, v10, 1, v11
    v_mov_b32 v3, s43
    v_bfe_u32 v31, v0, 5, 1
    v_lshl_add_u32 v3, v31, 4, v3
    v_add_u32 v3, v3, v10
    v_sub_u32 v10, 63, v0
    v_lshlrev_b32 v10, 4, v10
    v_add_u32 v7, s43, v10
    s_mul_i32 s42, s40, 15200
    v_mov_b32 v4, s42
    v_bfe_u32 v31, v0, 0, 5
    v_lshl_add_u32 v4, v31, 6, v4
    v_bfe_u32 v31, v0, 0, 5
    v_lshl_add_u32 v4, v31, 4, v4
    v_bfe_u32 v31, v0, 5, 1
    v_lshl_add_u32 v4, v31, 4, v4
    s_add_u32 s42, s42, 5040
    v_mov_b32 v5, s42
    v_bfe_u32 v31, v0, 0, 5
    v_lshl_add_u32 v5, v31, 6, v5
    v_bfe_u32 v31, v0, 0, 5
    v_lshl_add_u32 v5, v31, 4, v5
    v_bfe_u32 v31, v0, 5, 1
    v_lshl_add_u32 v5, v31, 3, v5
    s_mov_b32 s72, 0xffff
    s_waitcnt vmcnt(0) lgkmcnt(0)
    ds_write_b128 v2, v[32:35] offset:0
    ds_write_b128 v2, v[36:39] offset:7600
    ds_write_b128 v2, v[40:43] offset:15200
    ds_write_b128 v2, v[44:47] offset:22800
    ds_write_b128 v2, v[48:51] offset:30400
    ds_write_b128 v2, v[52:55] offset:38000
    ds_write_b128 v2, v[56:59] offset:45600
    ds_write_b128 v2, v[60:63] offset:53200
    v_lshlrev_b32 v64, 16, s48
    s_and_b32 s41, s48, 0xffff0000
    v_mov_b32 v65, s41
    v_lshlrev_b32 v66, 16, s49
    s_and_b32 s41, s49, 0xffff0000
    v_mov_b32 v67, s41
    v_lshlrev_b32 v68, 16, s50
    s_and_b32 s41, s50, 0xffff0000
    v_mov_b32 v69, s41
    v_lshlrev_b32 v70, 16, s51
    s_and_b32 s41, s51, 0xffff0000
    v_mov_b32 v71, s41
    s_waitcnt lgkmcnt(0)
    s_barrier
    ds_read_b64 v[32:33], v8 offset:0
    ds_read_b64 v[34:35], v8 offset:7600
    ds_read_b64 v[36:37], v8 offset:15200
    ds_read_b64 v[38:39], v8 offset:22800
    ds_read_b64 v[40:41], v8 offset:30400
    ds_read_b64 v[42:43], v8 offset:38000
    ds_read_b64 v[44:45], v8 offset:45600
    ds_read_b64 v[46:47], v8 offset:53200
    s_mov_b32 s56, 0
L_cv2h:
    v_cmp_ne_u32 vcc, 0, v0
    s_nop 1
    v_cndmask_b32 v208, 0, v208, vcc
    v_cndmask_b32 v209, 0, v209, vcc
    v_alignbit_b32 v136, v213, v213, 16
    v_alignbit_b32 v137, v212, v212, 16
    v_alignbit_b32 v138, v211, v211, 16
    v_alignbit_b32 v139, v210, v210, 16
    ds_write_b128 v7, v[136:139] offset:3072
    v_bfi_b32 v140, s72, v213, v212
    v_bfi_b32 v141, s72, v212, v211
    v_bfi_b32 v142, s72, v211, v210
    v_bfi_b32 v143, s72, v210, v209
    ds_write_b128 v7, v[140:143] offset:7232
    v_alignbit_b32 v144, v212, v212, 16
    v_alignbit_b32 v145, v211, v211, 16
    v_alignbit_b32 v146, v210, v210, 16
    v_alignbit_b32 v147, v209, v209, 16
    ds_write_b128 v7, v[144:147] offset:11392
    v_bfi_b32 v148, s72, v212, v211
    v_bfi_b32 v149, s72, v211, v210
    v_bfi_b32 v150, s72, v210, v209
    v_bfi_b32 v151, s72, v209, v208
    ds_write_b128 v7, v[148:151] offset:15552
    s_waitcnt lgkmcnt(4)
    v_alignbit_b32 v152, v219, v219, 16
    v_alignbit_b32 v153, v218, v218, 16
    v_alignbit_b32 v154, v217, v217, 16
    v_alignbit_b32 v155, v216, v216, 16
    ds_write_b128 v7, v[152:155] offset:2048
    v_bfi_b32 v156, s72, v219, v218
    v_bfi_b32 v157, s72, v218, v217
    v_bfi_b32 v158, s72, v217, v216
    v_bfi_b32 v159, s72, v216, v215
    ds_write_b128 v7, v[156:159] offset:6208
    v_alignbit_b32 v160, v218, v218, 16
    v_alignbit_b32 v161, v217, v217, 16
    v_alignbit_b32 v162, v216, v216, 16
    v_alignbit_b32 v163, v215, v215, 16
    ds_write_b128 v7, v[160:163] offset:10368
    v_bfi_b32 v164, s72, v218, v217
    v_bfi_b32 v165, s72, v217, v216
    v_bfi_b32 v166, s72, v216, v215
    v_bfi_b32 v167, s72, v215, v214
    ds_write_b128 v7, v[164:167] offset:14528
    s_waitcnt lgkmcnt(4)
    v_alignbit_b32 v136, v225, v225, 16
    v_alignbit_b32 v137, v224, v224, 16
    v_alignbit_b32 v138, v223, v223, 16
    v_alignbit_b32 v139, v222, v222, 16
    ds_write_b128 v7, v[136:139] offset:1024
    v_bfi_b32 v140, s72, v225, v224
    v_bfi_b32 v141, s72, v224, v223
    v_bfi_b32 v142, s72, v223, v222
    v_bfi_b32 v143, s72, v222, v221
    ds_write_b128 v7, v[140:143] offset:5184
    v_alignbit_b32 v144, v224, v224, 16
    v_alignbit_b32 v145, v223, v223, 16
    v_alignbit_b32 v146, v222, v222, 16
    v_alignbit_b32 v147, v221, v221, 16
    ds_write_b128 v7, v[144:147] offset:9344
    v_bfi_b32 v148, s72, v224, v223
    v_bfi_b32 v149, s72, v223, v222
    v_bfi_b32 v150, s72, v222, v221
    v_bfi_b32 v151, s72, v221, v220
    ds_write_b128 v7, v[148:151] offset:13504
    s_waitcnt lgkmcnt(4)
    v_alignbit_b32 v152, v231, v231, 16
    v_alignbit_b32 v153, v230, v230, 16
    v_alignbit_b32 v154, v229, v229, 16
    v_alignbit_b32 v155, v228, v228, 16
    ds_write_b128 v7, v[152:155] offset:0
    v_bfi_b32 v156, s72, v231, v230
    v_bfi_b32 v157, s72, v230, v229
    v_bfi_b32 v158, s72, v229, v228
    v_bfi_b32 v159, s72, v228, v227
    ds_write_b128 v7, v[156:159] offset:4160
    v_alignbit_b32 v160, v230, v230, 16
    v_alignbit_b32 v161, v229, v229, 16
    v_alignbit_b32 v162, v228, v228, 16
    v_alignbit_b32 v163, v227, v227, 16
    ds_write_b128 v7, v[160:163] offset:8320
    v_bfi_b32 v164, s72, v230, v229
    v_bfi_b32 v165, s72, v229, v228
    v_bfi_b32 v166, s72, v228, v227
    v_bfi_b32 v167, s72, v227, v226
    ds_write_b128 v7, v[164:167] offset:12480
    s_waitcnt lgkmcnt(4)
    s_waitcnt lgkmcnt(0)
    s_barrier
    ds_read_b64 v[136:137], v3 offset:4032
    ds_read_b64 v[138:139], v3 offset:4040
    ds_read_b128 v[140:143], v4 offset:5040
    ds_read_b64 v[144:145], v3 offset:4064
    ds_read_b64 v[146:147], v3 offset:4072
    ds_read_b128 v[148:151], v4 offset:5072
    ds_read_b64 v[152:153], v3 offset:3968
    ds_read_b64 v[154:155], v3 offset:3976
    ds_read_b128 v[156:159], v4 offset:4960
    ds_read_b64 v[160:161], v3 offset:4000
    ds_read_b64 v[162:163], v3 offset:4008
    ds_read_b128 v[164:167], v4 offset:4992
    s_waitcnt lgkmcnt(9)
    v_mfma_f32_32x32x16_bf16 v[104:119], v[136:139], v[140:143], 0
    ds_read_b64 v[168:169], v3 offset:3904
    ds_read_b64 v[170:171], v3 offset:3912
    ds_read_b128 v[172:175], v4 offset:4880
    v_mov_b32 v208, v232
    s_waitcnt lgkmcnt(9)
    v_mfma_f32_32x32x16_bf16 v[104:119], v[144:147], v[148:151], v[104:119]
    ds_read_b64 v[176:177], v3 offset:3936
    ds_read_b64 v[178:179], v3 offset:3944
    ds_read_b128 v[180:183], v4 offset:4912
    v_mov_b32 v209, v233
    s_waitcnt lgkmcnt(9)
    v_mfma_f32_32x32x16_bf16 v[104:119], v[152:155], v[156:159], v[104:119]
    ds_read_b64 v[136:137], v3 offset:3840
    ds_read_b64 v[138:139], v3 offset:3848
    ds_read_b128 v[140:143], v4 offset:4800
    v_mov_b32 v210, v234
    s_cmp_eq_u32 s56, 1
    s_cbranch_scc1 Lq_69
    buffer_load_dwordx4 v[72:75], v1, s[84:87], 0 offen
    v_add_u32 v1, 2048, v1
Lq_69:
    s_waitcnt lgkmcnt(9)
    v_mfma_f32_32x32x16_bf16 v[104:119], v[160:163], v[164:167], v[104:119]
    ds_read_b64 v[144:145], v3 offset:3872
    ds_read_b64 v[146:147], v3 offset:3880
    ds_read_b128 v[148:151], v4 offset:4832
    v_mov_b32 v211, v235
    s_waitcnt lgkmcnt(9)
    v_mfma_f32_32x32x16_bf16 v[104:119], v[168:171], v[172:175], v[104:119]
    ds_read_b64 v[152:153], v3 offset:3776
    ds_read_b64 v[154:155], v3 offset:3784
    ds_read_b128 v[156:159], v4 offset:4720
    v_mov_b32 v212, v236
    s_waitcnt lgkmcnt(9)
    v_mfma_f32_32x32x16_bf16 v[104:119], v[176:179], v[180:183], v[104:119]
    ds_read_b64 v[160:161], v3 offset:3808
    ds_read_b64 v[162:163], v3 offset:3816
    ds_read_b128 v[164:167], v4 offset:4752
    v_mov_b32 v213, v237
    s_waitcnt lgkmcnt(9)
    v_mfma_f32_32x32x16_bf16 v[104:119], v[136:139], v[140:143], v[104:119]
    ds_read_b64 v[168:169], v3 offset:3712
    ds_read_b64 v[170:171], v3 offset:3720
    ds_read_b128 v[172:175], v4 offset:4640
    v_mov_b32 v214, v238
    s_waitcnt lgkmcnt(9)
    v_mfma_f32_32x32x16_bf16 v[104:119], v[144:147], v[148:151], v[104:119]
    ds_read_b64 v[176:177], v3 offset:3744
    ds_read_b64 v[178:179], v3 offset:3752
    ds_read_b128 v[180:183], v4 offset:4672
    v_mov_b32 v215, v239
    s_waitcnt lgkmcnt(9)
    v_mfma_f32_32x32x16_bf16 v[104:119], v[152:155], v[156:159], v[104:119]
    ds_read_b64 v[136:137], v3 offset:3648
    ds_read_b64 v[138:139], v3 offset:3656
    ds_read_b128 v[140:143], v4 offset:4560
    v_mov_b32 v216, v240
    s_waitcnt lgkmcnt(9)
    v_mfma_f32_32x32x16_bf16 v[104:119], v[160:163], v[164:167], v[104:119]
    ds_read_b64 v[144:145], v3 offset:3680
    ds_read_b64 v[146:147], v3 offset:3688
    ds_read_b128 v[148:151], v4 offset:4592
    v_mov_b32 v217, v241
    s_waitcnt lgkmcnt(9)
    v_mfma_f32_32x32x16_bf16 v[104:119], v[168:171], v[172:175], v[104:119]
    ds_read_b64 v[152:153], v3 offset:3584
    ds_read_b64 v[154:155], v3 offset:3592
    ds_read_b128 v[156:159], v4 offset:4480
    v_mov_b32 v218, v242
    s_cmp_eq_u32 s56, 1
    s_cbranch_scc1 Lq_70
    buffer_load_dwordx4 v[76:79], v1, s[84:87], 0 offen
    v_add_u32 v1, 2048, v1
Lq_70:
    s_waitcnt lgkmcnt(9)
    v_mfma_f32_32x32x16_bf16 v[104:119], v[176:179], v[180:183], v[104:119]
    ds_read_b64 v[160:161], v3 offset:3616
    ds_read_b64 v[162:163], v3 offset:3624
    ds_read_b128 v[164:167], v4 offset:4512
    v_mov_b32 v219, v243
    s_waitcnt lgkmcnt(9)
    v_mfma_f32_32x32x16_bf16 v[104:119], v[136:139], v[140:143], v[104:119]
    ds_read_b64 v[168:169], v3 offset:3520
    ds_read_b64 v[170:171], v3 offset:3528
    ds_read_b128 v[172:175], v4 offset:4400
    v_mov_b32 v220, v244
    s_waitcnt lgkmcnt(9)
    v_mfma_f32_32x32x16_bf16 v[104:119], v[144:147], v[148:151], v[104:119]
    ds_read_b64 v[176:177], v3 offset:3552
    ds_read_b64 v[178:179], v3 offset:3560
    ds_read_b128 v[180:183], v4 offset:4432
    v_mov_b32 v221, v245
    s_waitcnt lgkmcnt(9)
    v_mfma_f32_32x32x16_bf16 v[104:119], v[152:155], v[156:159], v[104:119]
    ds_read_b64 v[136:137], v3 offset:3456
    ds_read_b64 v[138:139], v3 offset:3464
    ds_read_b128 v[140:143], v4 offset:4320
    v_mov_b32 v222, v246
    s_waitcnt lgkmcnt(9)
    v_mfma_f32_32x32x16_bf16 v[104:119], v[160:163], v[164:167], v[104:119]
    ds_read_b64 v[144:145], v3 offset:3488
    ds_read_b64 v[146:147], v3 offset:3496
    ds_read_b128 v[148:151], v4 offset:4352
    v_mov_b32 v223, v247
    s_waitcnt lgkmcnt(9)
    v_mfma_f32_32x32x16_bf16 v[104:119], v[168:171], v[172:175], v[104:119]
    ds_read_b64 v[152:153], v3 offset:3392
    ds_read_b64 v[154:155], v3 offset:3400
    ds_read_b128 v[156:159], v4 offset:4240
    v_mov_b32 v224, v248
    s_waitcnt lgkmcnt(9)
    v_mfma_f32_32x32x16_bf16 v[104:119], v[176:179], v[180:183], v[104:119]
    ds_read_b64 v[160:161], v3 offset:3424
    ds_read_b64 v[162:163], v3 offset:3432
    ds_read_b128 v[164:167], v4 offset:4272
    v_mov_b32 v225, v249
    s_waitcnt lgkmcnt(9)
    v_mfma_f32_32x32x16_bf16 v[104:119], v[136:139], v[140:143], v[104:119]
    ds_read_b64 v[168:169], v3 offset:3328
    ds_read_b64 v[170:171], v3 offset:3336
    ds_read_b128 v[172:175], v4 offset:4160
    v_mov_b32 v226, v250
    s_cmp_eq_u32 s56, 1
    s_cbranch_scc1 Lq_71
    buffer_load_dwordx4 v[80:83], v1, s[84:87], 0 offen
    v_add_u32 v1, 2048, v1
Lq_71:
    s_waitcnt lgkmcnt(9)
    v_mfma_f32_32x32x16_bf16 v[104:119], v[144:147], v[148:151], v[104:119]
    ds_read_b64 v[176:177], v3 offset:3360
    ds_read_b64 v[178:179], v3 offset:3368
    ds_read_b128 v[180:183], v4 offset:4192
    v_mov_b32 v227, v251
    s_waitcnt lgkmcnt(9)
    v_mfma_f32_32x32x16_bf16 v[104:119], v[152:155], v[156:159], v[104:119]
    ds_read_b64 v[136:137], v3 offset:3264
    ds_read_b64 v[138:139], v3 offset:3272
    ds_read_b128 v[140:143], v4 offset:4080
    v_mov_b32 v228, v252
    s_waitcnt lgkmcnt(9)
    v_mfma_f32_32x32x16_bf16 v[104:119], v[160:163], v[164:167], v[104:119]
    ds_read_b64 v[144:145], v3 offset:3296
    ds_read_b64 v[146:147], v3 offset:3304
    ds_read_b128 v[148:151], v4 offset:4112
    v_mov_b32 v229, v253
    s_waitcnt lgkmcnt(9)
    v_mfma_f32_32x32x16_bf16 v[104:119], v[168:171], v[172:175], v[104:119]
    ds_read_b64 v[152:153], v3 offset:3200
    ds_read_b64 v[154:155], v3 offset:3208
    ds_read_b128 v[156:159], v4 offset:4000
    v_mov_b32 v230, v254
    s_waitcnt lgkmcnt(9)
    v_mfma_f32_32x32x16_bf16 v[104:119], v[176:179], v[180:183], v[104:119]
    ds_read_b64 v[160:161], v3 offset:3232
    ds_read_b64 v[162:163], v3 offset:3240
    ds_read_b128 v[164:167], v4 offset:4032
    v_mov_b32 v231, v255
    s_waitcnt lgkmcnt(9)
    v_mfma_f32_32x32x16_bf16 v[104:119], v[136:139], v[140:143], v[104:119]
    ds_read_b64 v[168:169], v3 offset:3136
    ds_read_b64 v[170:171], v3 offset:3144
    ds_read_b128 v[172:175], v4 offset:3920
    s_waitcnt lgkmcnt(9)
    v_mfma_f32_32x32x16_bf16 v[104:119], v[144:147], v[148:151], v[104:119]
    ds_read_b64 v[176:177], v3 offset:3168
    ds_read_b64 v[178:179], v3 offset:3176
    ds_read_b128 v[180:183], v4 offset:3952
    s_waitcnt lgkmcnt(9)
    v_mfma_f32_32x32x16_bf16 v[104:119], v[152:155], v[156:159], v[104:119]
    ds_read_b64 v[136:137], v3 offset:3072
    ds_read_b64 v[138:139], v3 offset:3080
    ds_read_b128 v[140:143], v4 offset:3840
    s_cmp_eq_u32 s56, 1
    s_cbranch_scc1 Lq_72
    buffer_load_dwordx4 v[84:87], v1, s[84:87], 0 offen
    v_add_u32 v1, 2048, v1
Lq_72:
    s_waitcnt lgkmcnt(9)
    v_mfma_f32_32x32x16_bf16 v[104:119], v[160:163], v[164:167], v[104:119]
    ds_read_b64 v[144:145], v3 offset:3104
    ds_read_b64 v[146:147], v3 offset:3112
    ds_read_b128 v[148:151], v4 offset:3872
    s_waitcnt lgkmcnt(9)
    v_mfma_f32_32x32x16_bf16 v[104:119], v[168:171], v[172:175], v[104:119]
    ds_read_b64 v[152:153], v3 offset:3008
    ds_read_b64 v[154:155], v3 offset:3016
    ds_read_b128 v[156:159], v4 offset:3760
    s_waitcnt lgkmcnt(9)
    v_mfma_f32_32x32x16_bf16 v[104:119], v[176:179], v[180:183], v[104:119]
    ds_read_b64 v[160:161], v3 offset:3040
    ds_read_b64 v[162:163], v3 offset:3048
    ds_read_b128 v[164:167], v4 offset:3792
    s_waitcnt lgkmcnt(9)
    v_mfma_f32_32x32x16_bf16 v[104:119], v[136:139], v[140:143], v[104:119]
    ds_read_b64 v[168:169], v3 offset:2944
    ds_read_b64 v[170:171], v3 offset:2952
    ds_read_b128 v[172:175], v4 offset:3680
    s_waitcnt lgkmcnt(9)
    v_mfma_f32_32x32x16_bf16 v[104:119], v[144:147], v[148:151], v[104:119]
    ds_read_b64 v[176:177], v3 offset:2976
    ds_read_b64 v[178:179], v3 offset:2984
    ds_read_b128 v[180:183], v4 offset:3712
    s_waitcnt lgkmcnt(9)
    v_mfma_f32_32x32x16_bf16 v[104:119], v[152:155], v[156:159], v[104:119]
    ds_read_b64 v[136:137], v3 offset:2880
    ds_read_b64 v[138:139], v3 offset:2888
    ds_read_b128 v[140:143], v4 offset:3600
    s_waitcnt lgkmcnt(9)
    v_mfma_f32_32x32x16_bf16 v[104:119], v[160:163], v[164:167], v[104:119]
    ds_read_b64 v[144:145], v3 offset:2912
    ds_read_b64 v[146:147], v3 offset:2920
    ds_read_b128 v[148:151], v4 offset:3632
    s_waitcnt lgkmcnt(9)
    v_mfma_f32_32x32x16_bf16 v[104:119], v[168:171], v[172:175], v[104:119]
    ds_read_b64 v[152:153], v3 offset:2816
    ds_read_b64 v[154:155], v3 offset:2824
    ds_read_b128 v[156:159], v4 offset:3520
    s_waitcnt lgkmcnt(9)
    v_mfma_f32_32x32x16_bf16 v[104:119], v[176:179], v[180:183], v[104:119]
    ds_read_b64 v[160:161], v3 offset:2848
    ds_read_b64 v[162:163], v3 offset:2856
    ds_read_b128 v[164:167], v4 offset:3552
    s_waitcnt lgkmcnt(9)
    v_mfma_f32_32x32x16_bf16 v[104:119], v[136:139], v[140:143], v[104:119]
    ds_read_b64 v[168:169], v3 offset:2752
    ds_read_b64 v[170:171], v3 offset:2760
    ds_read_b128 v[172:175], v4 offset:3440
    s_waitcnt lgkmcnt(9)
    v_mfma_f32_32x32x16_bf16 v[104:119], v[144:147], v[148:151], v[104:119]
    ds_read_b64 v[176:177], v3 offset:2784
    ds_read_b64 v[178:179], v3 offset:2792
    ds_read_b128 v[180:183], v4 offset:3472
    s_waitcnt lgkmcnt(9)
    v_mfma_f32_32x32x16_bf16 v[104:119], v[152:155], v[156:159], v[104:119]
    ds_read_b64 v[136:137], v3 offset:2688
    ds_read_b64 v[138:139], v3 offset:2696
    ds_read_b128 v[140:143], v4 offset:3360
    s_waitcnt lgkmcnt(9)
    v_mfma_f32_32x32x16_bf16 v[104:119], v[160:163], v[164:167], v[104:119]
    ds_read_b64 v[144:145], v3 offset:2720
    ds_read_b64 v[146:147], v3 offset:2728
    ds_read_b128 v[148:151], v4 offset:3392
    s_waitcnt lgkmcnt(9)
    v_mfma_f32_32x32x16_bf16 v[104:119], v[168:171], v[172:175], v[104:119]
    ds_read_b64 v[152:153], v3 offset:2624
    ds_read_b64 v[154:155], v3 offset:2632
    ds_read_b128 v[156:159], v4 offset:3280
    s_waitcnt lgkmcnt(9)
    v_mfma_f32_32x32x16_bf16 v[104:119], v[176:179], v[180:183], v[104:119]
    ds_read_b64 v[160:161], v3 offset:2656
    ds_read_b64 v[162:163], v3 offset:2664
    ds_read_b128 v[164:167], v4 offset:3312
    s_waitcnt lgkmcnt(9)
    v_mfma_f32_32x32x16_bf16 v[104:119], v[136:139], v[140:143], v[104:119]
    ds_read_b64 v[168:169], v3 offset:2560
    ds_read_b64 v[170:171], v3 offset:2568
    ds_read_b128 v[172:175], v4 offset:3200
    s_waitcnt lgkmcnt(9)
    v_mfma_f32_32x32x16_bf16 v[104:119], v[144:147], v[148:151], v[104:119]
    ds_read_b64 v[176:177], v3 offset:2592
    ds_read_b64 v[178:179], v3 offset:2600
    ds_read_b128 v[180:183], v4 offset:3232
    s_waitcnt lgkmcnt(9)
    v_mfma_f32_32x32x16_bf16 v[104:119], v[152:155], v[156:159], v[104:119]
    ds_read_b64 v[136:137], v3 offset:2496
    ds_read_b64 v[138:139], v3 offset:2504
    ds_read_b128 v[140:143], v4 offset:3120
    s_waitcnt lgkmcnt(9)
    v_mfma_f32_32x32x16_bf16 v[104:119], v[160:163], v[164:167], v[104:119]
    ds_read_b64 v[144:145], v3 offset:2528
    ds_read_b64 v[146:147], v3 offset:2536
    ds_read_b128 v[148:151], v4 offset:3152
    s_waitcnt lgkmcnt(9)
    v_mfma_f32_32x32x16_bf16 v[104:119], v[168:171], v[172:175], v[104:119]
    ds_read_b64 v[152:153], v3 offset:2432
    ds_read_b64 v[154:155], v3 offset:2440
    ds_read_b128 v[156:159], v4 offset:3040
    s_waitcnt lgkmcnt(9)
    v_mfma_f32_32x32x16_bf16 v[104:119], v[176:179], v[180:183], v[104:119]
    ds_read_b64 v[160:161], v3 offset:2464
    ds_read_b64 v[162:163], v3 offset:2472
    ds_read_b128 v[164:167], v4 offset:3072
    s_waitcnt lgkmcnt(9)
    v_mfma_f32_32x32x16_bf16 v[104:119], v[136:139], v[140:143], v[104:119]
    ds_read_b64 v[168:169], v3 offset:2368
    ds_read_b64 v[170:171], v3 offset:2376
    ds_read_b128 v[172:175], v4 offset:2960
    s_waitcnt lgkmcnt(9)
    v_mfma_f32_32x32x16_bf16 v[104:119], v[144:147], v[148:151], v[104:119]
    ds_read_b64 v[176:177], v3 offset:2400
    ds_read_b64 v[178:179], v3 offset:2408
    ds_read_b128 v[180:183], v4 offset:2992
    s_waitcnt lgkmcnt(9)
    v_mfma_f32_32x32x16_bf16 v[104:119], v[152:155], v[156:159], v[104:119]
    ds_read_b64 v[136:137], v3 offset:2304
    ds_read_b64 v[138:139], v3 offset:2312
    ds_read_b128 v[140:143], v4 offset:2880
    s_waitcnt lgkmcnt(9)
    v_mfma_f32_32x32x16_bf16 v[104:119], v[160:163], v[164:167], v[104:119]
    ds_read_b64 v[144:145], v3 offset:2336
    ds_read_b64 v[146:147], v3 offset:2344
    ds_read_b128 v[148:151], v4 offset:2912
    s_waitcnt lgkmcnt(9)
    v_mfma_f32_32x32x16_bf16 v[104:119], v[168:171], v[172:175], v[104:119]
    ds_read_b64 v[152:153], v3 offset:2240
    ds_read_b64 v[154:155], v3 offset:2248
    ds_read_b128 v[156:159], v4 offset:2800
    s_waitcnt lgkmcnt(9)
    v_mfma_f32_32x32x16_bf16 v[104:119], v[176:179], v[180:183], v[104:119]
    ds_read_b64 v[160:161], v3 offset:2272
    ds_read_b64 v[162:163], v3 offset:2280
    ds_read_b128 v[164:167], v4 offset:2832
    s_waitcnt lgkmcnt(9)
    v_mfma_f32_32x32x16_bf16 v[104:119], v[136:139], v[140:143], v[104:119]
    ds_read_b64 v[168:169], v3 offset:2176
    ds_read_b64 v[170:171], v3 offset:2184
    ds_read_b128 v[172:175], v4 offset:2720
    s_waitcnt lgkmcnt(9)
    v_mfma_f32_32x32x16_bf16 v[104:119], v[144:147], v[148:151], v[104:119]
    ds_read_b64 v[176:177], v3 offset:2208
    ds_read_b64 v[178:179], v3 offset:2216
    ds_read_b128 v[180:183], v4 offset:2752
    s_waitcnt lgkmcnt(9)
    v_mfma_f32_32x32x16_bf16 v[104:119], v[152:155], v[156:159], v[104:119]
    ds_read_b64 v[136:137], v3 offset:2112
    ds_read_b64 v[138:139], v3 offset:2120
    ds_read_b128 v[140:143], v4 offset:2640
    s_waitcnt lgkmcnt(9)
    v_mfma_f32_32x32x16_bf16 v[104:119], v[160:163], v[164:167], v[104:119]
    ds_read_b64 v[144:145], v3 offset:2144
    ds_read_b64 v[146:147], v3 offset:2152
    ds_read_b128 v[148:151], v4 offset:2672
    s_waitcnt lgkmcnt(9)
    v_mfma_f32_32x32x16_bf16 v[104:119], v[168:171], v[172:175], v[104:119]
    ds_read_b64 v[152:153], v3 offset:2048
    ds_read_b64 v[154:155], v3 offset:2056
    ds_read_b128 v[156:159], v4 offset:2560
    s_waitcnt lgkmcnt(9)
    v_mfma_f32_32x32x16_bf16 v[104:119], v[176:179], v[180:183], v[104:119]
    ds_read_b64 v[160:161], v3 offset:2080
    ds_read_b64 v[162:163], v3 offset:2088
    ds_read_b128 v[164:167], v4 offset:2592
    s_waitcnt lgkmcnt(9)
    v_mfma_f32_32x32x16_bf16 v[104:119], v[136:139], v[140:143], v[104:119]
    ds_read_b64 v[168:169], v3 offset:1984
    ds_read_b64 v[170:171], v3 offset:1992
    ds_read_b128 v[172:175], v4 offset:2480
    s_waitcnt lgkmcnt(9)
    v_mfma_f32_32x32x16_bf16 v[104:119], v[144:147], v[148:151], v[104:119]
    ds_read_b64 v[176:177], v3 offset:2016
    ds_read_b64 v[178:179], v3 offset:2024
    ds_read_b128 v[180:183], v4 offset:2512
    s_waitcnt lgkmcnt(9)
    v_mfma_f32_32x32x16_bf16 v[104:119], v[152:155], v[156:159], v[104:119]
    ds_read_b64 v[136:137], v3 offset:1920
    ds_read_b64 v[138:139], v3 offset:1928
    ds_read_b128 v[140:143], v4 offset:2400
    s_waitcnt lgkmcnt(9)
    v_mfma_f32_32x32x16_bf16 v[104:119], v[160:163], v[164:167], v[104:119]
    ds_read_b64 v[144:145], v3 offset:1952
    ds_read_b64 v[146:147], v3 offset:1960
    ds_read_b128 v[148:151], v4 offset:2432
    s_waitcnt lgkmcnt(9)
    v_mfma_f32_32x32x16_bf16 v[104:119], v[168:171], v[172:175], v[104:119]
    ds_read_b64 v[152:153], v3 offset:1856
    ds_read_b64 v[154:155], v3 offset:1864
    ds_read_b128 v[156:159], v4 offset:2320
    s_waitcnt lgkmcnt(9)
    v_mfma_f32_32x32x16_bf16 v[104:119], v[176:179], v[180:183], v[104:119]
    ds_read_b64 v[160:161], v3 offset:1888
    ds_read_b64 v[162:163], v3 offset:1896
    ds_read_b128 v[164:167], v4 offset:2352
    s_waitcnt lgkmcnt(9)
    v_mfma_f32_32x32x16_bf16 v[104:119], v[136:139], v[140:143], v[104:119]
    ds_read_b64 v[168:169], v3 offset:1792
    ds_read_b64 v[170:171], v3 offset:1800
    ds_read_b128 v[172:175], v4 offset:2240
    s_waitcnt lgkmcnt(9)
    v_mfma_f32_32x32x16_bf16 v[104:119], v[144:147], v[148:151], v[104:119]
    ds_read_b64 v[176:177], v3 offset:1824
    ds_read_b64 v[178:179], v3 offset:1832
    ds_read_b128 v[180:183], v4 offset:2272
    s_waitcnt lgkmcnt(9)
    v_mfma_f32_32x32x16_bf16 v[104:119], v[152:155], v[156:159], v[104:119]
    ds_read_b64 v[136:137], v3 offset:1728
    ds_read_b64 v[138:139], v3 offset:1736
    ds_read_b128 v[140:143], v4 offset:2160
    s_waitcnt lgkmcnt(9)
    v_mfma_f32_32x32x16_bf16 v[104:119], v[160:163], v[164:167], v[104:119]
    ds_read_b64 v[144:145], v3 offset:1760
    ds_read_b64 v[146:147], v3 offset:1768
    ds_read_b128 v[148:151], v4 offset:2192
    s_waitcnt lgkmcnt(9)
    v_mfma_f32_32x32x16_bf16 v[104:119], v[168:171], v[172:175], v[104:119]
    ds_read_b64 v[152:153], v3 offset:1664
    ds_read_b64 v[154:155], v3 offset:1672
    ds_read_b128 v[156:159], v4 offset:2080
    s_waitcnt lgkmcnt(9)
    v_mfma_f32_32x32x16_bf16 v[104:119], v[176:179], v[180:183], v[104:119]
    ds_read_b64 v[160:161], v3 offset:1696
    ds_read_b64 v[162:163], v3 offset:1704
    ds_read_b128 v[164:167], v4 offset:2112
    s_waitcnt lgkmcnt(9)
    v_mfma_f32_32x32x16_bf16 v[104:119], v[136:139], v[140:143], v[104:119]
    ds_read_b64 v[168:169], v3 offset:1600
    ds_read_b64 v[170:171], v3 offset:1608
    ds_read_b128 v[172:175], v4 offset:2000
    s_waitcnt lgkmcnt(9)
    v_mfma_f32_32x32x16_bf16 v[104:119], v[144:147], v[148:151], v[104:119]
    ds_read_b64 v[176:177], v3 offset:1632
    ds_read_b64 v[178:179], v3 offset:1640
    ds_read_b128 v[180:183], v4 offset:2032
    s_waitcnt lgkmcnt(9)
    v_mfma_f32_32x32x16_bf16 v[104:119], v[152:155], v[156:159], v[104:119]
    ds_read_b64 v[136:137], v3 offset:1536
    ds_read_b64 v[138:139], v3 offset:1544
    ds_read_b128 v[140:143], v4 offset:1920
    s_waitcnt lgkmcnt(9)
    v_mfma_f32_32x32x16_bf16 v[104:119], v[160:163], v[164:167], v[104:119]
    ds_read_b64 v[144:145], v3 offset:1568
    ds_read_b64 v[146:147], v3 offset:1576
    ds_read_b128 v[148:151], v4 offset:1952
    s_waitcnt lgkmcnt(9)
    v_mfma_f32_32x32x16_bf16 v[104:119], v[168:171], v[172:175], v[104:119]
    ds_read_b64 v[152:153], v3 offset:1472
    ds_read_b64 v[154:155], v3 offset:1480
    ds_read_b128 v[156:159], v4 offset:1840
    s_waitcnt lgkmcnt(9)
    v_mfma_f32_32x32x16_bf16 v[104:119], v[176:179], v[180:183], v[104:119]
    ds_read_b64 v[160:161], v3 offset:1504
    ds_read_b64 v[162:163], v3 offset:1512
    ds_read_b128 v[164:167], v4 offset:1872
    s_waitcnt lgkmcnt(9)
    v_mfma_f32_32x32x16_bf16 v[104:119], v[136:139], v[140:143], v[104:119]
    ds_read_b64 v[168:169], v3 offset:1408
    ds_read_b64 v[170:171], v3 offset:1416
    ds_read_b128 v[172:175], v4 offset:1760
    s_waitcnt lgkmcnt(9)
    v_mfma_f32_32x32x16_bf16 v[104:119], v[144:147], v[148:151], v[104:119]
    ds_read_b64 v[176:177], v3 offset:1440
    ds_read_b64 v[178:179], v3 offset:1448
    ds_read_b128 v[180:183], v4 offset:1792
    s_waitcnt lgkmcnt(9)
    v_mfma_f32_32x32x16_bf16 v[104:119], v[152:155], v[156:159], v[104:119]
    ds_read_b64 v[136:137], v3 offset:1344
    ds_read_b64 v[138:139], v3 offset:1352
    ds_read_b128 v[140:143], v4 offset:1680
    s_waitcnt lgkmcnt(9)
    v_mfma_f32_32x32x16_bf16 v[104:119], v[160:163], v[164:167], v[104:119]
    ds_read_b64 v[144:145], v3 offset:1376
    ds_read_b64 v[146:147], v3 offset:1384
    ds_read_b128 v[148:151], v4 offset:1712
    s_waitcnt lgkmcnt(9)
    v_mfma_f32_32x32x16_bf16 v[104:119], v[168:171], v[172:175], v[104:119]
    ds_read_b64 v[152:153], v3 offset:1280
    ds_read_b64 v[154:155], v3 offset:1288
    ds_read_b128 v[156:159], v4 offset:1600
    s_waitcnt lgkmcnt(9)
    v_mfma_f32_32x32x16_bf16 v[104:119], v[176:179], v[180:183], v[104:119]
    ds_read_b64 v[160:161], v3 offset:1312
    ds_read_b64 v[162:163], v3 offset:1320
    ds_read_b128 v[164:167], v4 offset:1632
    s_waitcnt lgkmcnt(9)
    v_mfma_f32_32x32x16_bf16 v[104:119], v[136:139], v[140:143], v[104:119]
    ds_read_b64 v[168:169], v3 offset:1216
    ds_read_b64 v[170:171], v3 offset:1224
    ds_read_b128 v[172:175], v4 offset:1520
    s_waitcnt lgkmcnt(9)
    v_mfma_f32_32x32x16_bf16 v[104:119], v[144:147], v[148:151], v[104:119]
    ds_read_b64 v[176:177], v3 offset:1248
    ds_read_b64 v[178:179], v3 offset:1256
    ds_read_b128 v[180:183], v4 offset:1552
    s_waitcnt lgkmcnt(9)
    v_mfma_f32_32x32x16_bf16 v[104:119], v[152:155], v[156:159], v[104:119]
    ds_read_b64 v[136:137], v3 offset:1152
    ds_read_b64 v[138:139], v3 offset:1160
    ds_read_b128 v[140:143], v4 offset:1440
    s_waitcnt lgkmcnt(9)
    v_mfma_f32_32x32x16_bf16 v[104:119], v[160:163], v[164:167], v[104:119]
    ds_read_b64 v[144:145], v3 offset:1184
    ds_read_b64 v[146:147], v3 offset:1192
    ds_read_b128 v[148:151], v4 offset:1472
    s_waitcnt lgkmcnt(9)
    v_mfma_f32_32x32x16_bf16 v[104:119], v[168:171], v[172:175], v[104:119]
    ds_read_b64 v[152:153], v3 offset:1088
    ds_read_b64 v[154:155], v3 offset:1096
    ds_read_b128 v[156:159], v4 offset:1360
    buffer_load_dword v21, off, s[28:31], 0 offset:64 sc1
    s_waitcnt lgkmcnt(9)
    v_mfma_f32_32x32x16_bf16 v[104:119], v[176:179], v[180:183], v[104:119]
    ds_read_b64 v[160:161], v3 offset:1120
    ds_read_b64 v[162:163], v3 offset:1128
    ds_read_b128 v[164:167], v4 offset:1392
    s_waitcnt lgkmcnt(9)
    v_mfma_f32_32x32x16_bf16 v[104:119], v[136:139], v[140:143], v[104:119]
    ds_read_b64 v[168:169], v3 offset:1024
    ds_read_b64 v[170:171], v3 offset:1032
    ds_read_b128 v[172:175], v4 offset:1280
    s_waitcnt lgkmcnt(9)
    v_mfma_f32_32x32x16_bf16 v[104:119], v[144:147], v[148:151], v[104:119]
    ds_read_b64 v[176:177], v3 offset:1056
    ds_read_b64 v[178:179], v3 offset:1064
    ds_read_b128 v[180:183], v4 offset:1312
    s_waitcnt lgkmcnt(9)
    v_mfma_f32_32x32x16_bf16 v[104:119], v[152:155], v[156:159], v[104:119]
    ds_read_b64 v[136:137], v3 offset:960
    ds_read_b64 v[138:139], v3 offset:968
    ds_read_b128 v[140:143], v4 offset:1200
    s_waitcnt lgkmcnt(9)
    v_mfma_f32_32x32x16_bf16 v[104:119], v[160:163], v[164:167], v[104:119]
    ds_read_b64 v[144:145], v3 offset:992
    ds_read_b64 v[146:147], v3 offset:1000
    ds_read_b128 v[148:151], v4 offset:1232
    s_waitcnt lgkmcnt(9)
    v_mfma_f32_32x32x16_bf16 v[104:119], v[168:171], v[172:175], v[104:119]
    ds_read_b64 v[152:153], v3 offset:896
    ds_read_b64 v[154:155], v3 offset:904
    ds_read_b128 v[156:159], v4 offset:1120
    s_waitcnt lgkmcnt(9)
    v_mfma_f32_32x32x16_bf16 v[104:119], v[176:179], v[180:183], v[104:119]
    ds_read_b64 v[160:161], v3 offset:928
    ds_read_b64 v[162:163], v3 offset:936
    ds_read_b128 v[164:167], v4 offset:1152
    s_waitcnt lgkmcnt(9)
    v_mfma_f32_32x32x16_bf16 v[104:119], v[136:139], v[140:143], v[104:119]
    ds_read_b64 v[168:169], v3 offset:832
    ds_read_b64 v[170:171], v3 offset:840
    ds_read_b128 v[172:175], v4 offset:1040
    s_waitcnt lgkmcnt(9)
    v_mfma_f32_32x32x16_bf16 v[104:119], v[144:147], v[148:151], v[104:119]
    ds_read_b64 v[176:177], v3 offset:864
    ds_read_b64 v[178:179], v3 offset:872
    ds_read_b128 v[180:183], v4 offset:1072
    s_waitcnt lgkmcnt(9)
    v_mfma_f32_32x32x16_bf16 v[104:119], v[152:155], v[156:159], v[104:119]
    ds_read_b64 v[136:137], v3 offset:768
    ds_read_b64 v[138:139], v3 offset:776
    ds_read_b128 v[140:143], v4 offset:960
    s_waitcnt lgkmcnt(9)
    v_mfma_f32_32x32x16_bf16 v[104:119], v[160:163], v[164:167], v[104:119]
    ds_read_b64 v[144:145], v3 offset:800
    ds_read_b64 v[146:147], v3 offset:808
    ds_read_b128 v[148:151], v4 offset:992
    s_waitcnt lgkmcnt(9)
    v_mfma_f32_32x32x16_bf16 v[104:119], v[168:171], v[172:175], v[104:119]
    ds_read_b64 v[152:153], v3 offset:704
    ds_read_b64 v[154:155], v3 offset:712
    ds_read_b128 v[156:159], v4 offset:880
    s_waitcnt lgkmcnt(9)
    v_mfma_f32_32x32x16_bf16 v[104:119], v[176:179], v[180:183], v[104:119]
    ds_read_b64 v[160:161], v3 offset:736
    ds_read_b64 v[162:163], v3 offset:744
    ds_read_b128 v[164:167], v4 offset:912
    s_waitcnt lgkmcnt(9)
    v_mfma_f32_32x32x16_bf16 v[104:119], v[136:139], v[140:143], v[104:119]
    ds_read_b64 v[168:169], v3 offset:640
    ds_read_b64 v[170:171], v3 offset:648
    ds_read_b128 v[172:175], v4 offset:800
    s_waitcnt lgkmcnt(9)
    v_mfma_f32_32x32x16_bf16 v[104:119], v[144:147], v[148:151], v[104:119]
    ds_read_b64 v[176:177], v3 offset:672
    ds_read_b64 v[178:179], v3 offset:680
    ds_read_b128 v[180:183], v4 offset:832
    s_waitcnt lgkmcnt(9)
    v_mfma_f32_32x32x16_bf16 v[104:119], v[152:155], v[156:159], v[104:119]
    ds_read_b64 v[136:137], v3 offset:576
    ds_read_b64 v[138:139], v3 offset:584
    ds_read_b128 v[140:143], v4 offset:720
    s_waitcnt lgkmcnt(9)
    v_mfma_f32_32x32x16_bf16 v[104:119], v[160:163], v[164:167], v[104:119]
    ds_read_b64 v[144:145], v3 offset:608
    ds_read_b64 v[146:147], v3 offset:616
    ds_read_b128 v[148:151], v4 offset:752
    s_waitcnt lgkmcnt(9)
    v_mfma_f32_32x32x16_bf16 v[104:119], v[168:171], v[172:175], v[104:119]
    ds_read_b64 v[152:153], v3 offset:512
    ds_read_b64 v[154:155], v3 offset:520
    ds_read_b128 v[156:159], v4 offset:640
    s_waitcnt lgkmcnt(9)
    v_mfma_f32_32x32x16_bf16 v[104:119], v[176:179], v[180:183], v[104:119]
    ds_read_b64 v[160:161], v3 offset:544
    ds_read_b64 v[162:163], v3 offset:552
    ds_read_b128 v[164:167], v4 offset:672
    s_waitcnt lgkmcnt(9)
    v_mfma_f32_32x32x16_bf16 v[104:119], v[136:139], v[140:143], v[104:119]
    ds_read_b64 v[168:169], v3 offset:448
    ds_read_b64 v[170:171], v3 offset:456
    ds_read_b128 v[172:175], v4 offset:560
    s_waitcnt lgkmcnt(9)
    v_mfma_f32_32x32x16_bf16 v[104:119], v[144:147], v[148:151], v[104:119]
    ds_read_b64 v[176:177], v3 offset:480
    ds_read_b64 v[178:179], v3 offset:488
    ds_read_b128 v[180:183], v4 offset:592
    s_waitcnt lgkmcnt(9)
    v_mfma_f32_32x32x16_bf16 v[104:119], v[152:155], v[156:159], v[104:119]
    ds_read_b64 v[136:137], v3 offset:384
    ds_read_b64 v[138:139], v3 offset:392
    ds_read_b128 v[140:143], v4 offset:480
    s_waitcnt lgkmcnt(9)
    v_mfma_f32_32x32x16_bf16 v[104:119], v[160:163], v[164:167], v[104:119]
    ds_read_b64 v[144:145], v3 offset:416
    ds_read_b64 v[146:147], v3 offset:424
    ds_read_b128 v[148:151], v4 offset:512
    s_waitcnt lgkmcnt(9)
    v_mfma_f32_32x32x16_bf16 v[104:119], v[168:171], v[172:175], v[104:119]
    ds_read_b64 v[152:153], v3 offset:320
    ds_read_b64 v[154:155], v3 offset:328
    ds_read_b128 v[156:159], v4 offset:400
    s_waitcnt lgkmcnt(9)
    v_mfma_f32_32x32x16_bf16 v[104:119], v[176:179], v[180:183], v[104:119]
    ds_read_b64 v[160:161], v3 offset:352
    ds_read_b64 v[162:163], v3 offset:360
    ds_read_b128 v[164:167], v4 offset:432
    s_waitcnt lgkmcnt(9)
    v_mfma_f32_32x32x16_bf16 v[104:119], v[136:139], v[140:143], v[104:119]
    ds_read_b64 v[168:169], v3 offset:256
    ds_read_b64 v[170:171], v3 offset:264
    ds_read_b128 v[172:175], v4 offset:320
    s_waitcnt lgkmcnt(9)
    v_mfma_f32_32x32x16_bf16 v[104:119], v[144:147], v[148:151], v[104:119]
    ds_read_b64 v[176:177], v3 offset:288
    ds_read_b64 v[178:179], v3 offset:296
    ds_read_b128 v[180:183], v4 offset:352
    s_waitcnt lgkmcnt(9)
    v_mfma_f32_32x32x16_bf16 v[104:119], v[152:155], v[156:159], v[104:119]
    ds_read_b64 v[136:137], v3 offset:192
    ds_read_b64 v[138:139], v3 offset:200
    ds_read_b128 v[140:143], v4 offset:240
    s_waitcnt lgkmcnt(9)
    v_mfma_f32_32x32x16_bf16 v[104:119], v[160:163], v[164:167], v[104:119]
    ds_read_b64 v[144:145], v3 offset:224
    ds_read_b64 v[146:147], v3 offset:232
    ds_read_b128 v[148:151], v4 offset:272
    s_waitcnt lgkmcnt(9)
    v_mfma_f32_32x32x16_bf16 v[104:119], v[168:171], v[172:175], v[104:119]
    ds_read_b64 v[152:153], v3 offset:128
    ds_read_b64 v[154:155], v3 offset:136
    ds_read_b128 v[156:159], v4 offset:160
    s_waitcnt lgkmcnt(9)
    v_mfma_f32_32x32x16_bf16 v[104:119], v[176:179], v[180:183], v[104:119]
    ds_read_b64 v[160:161], v3 offset:160
    ds_read_b64 v[162:163], v3 offset:168
    ds_read_b128 v[164:167], v4 offset:192
    s_waitcnt lgkmcnt(9)
    v_mfma_f32_32x32x16_bf16 v[104:119], v[136:139], v[140:143], v[104:119]
    ds_read_b64 v[168:169], v3 offset:64
    ds_read_b64 v[170:171], v3 offset:72
    ds_read_b128 v[172:175], v4 offset:80
    s_waitcnt lgkmcnt(9)
    v_mfma_f32_32x32x16_bf16 v[104:119], v[144:147], v[148:151], v[104:119]
    ds_read_b64 v[176:177], v3 offset:96
    ds_read_b64 v[178:179], v3 offset:104
    ds_read_b128 v[180:183], v4 offset:112
    s_waitcnt lgkmcnt(9)
    v_mfma_f32_32x32x16_bf16 v[104:119], v[152:155], v[156:159], v[104:119]
    ds_read_b64 v[136:137], v3 offset:0
    ds_read_b64 v[138:139], v3 offset:8
    ds_read_b128 v[140:143], v4 offset:0
    s_waitcnt lgkmcnt(9)
    v_mfma_f32_32x32x16_bf16 v[104:119], v[160:163], v[164:167], v[104:119]
    ds_read_b64 v[144:145], v3 offset:32
    ds_read_b64 v[146:147], v3 offset:40
    ds_read_b128 v[148:151], v4 offset:32
    s_waitcnt lgkmcnt(9)
    v_mfma_f32_32x32x16_bf16 v[104:119], v[168:171], v[172:175], v[104:119]
    s_waitcnt lgkmcnt(6)
    v_mfma_f32_32x32x16_bf16 v[104:119], v[176:179], v[180:183], v[104:119]
    s_waitcnt lgkmcnt(3)
    v_mfma_f32_32x32x16_bf16 v[104:119], v[136:139], v[140:143], v[104:119]
    s_waitcnt lgkmcnt(0)
    v_mfma_f32_32x32x16_bf16 v[104:119], v[144:147], v[148:151], v[104:119]
    s_nop 11
    v_cvt_pk_bf16_f32 v104, v104, v105
    v_cvt_pk_bf16_f32 v105, v106, v107
    ds_write_b64 v5, v[104:105] offset:0
    v_cvt_pk_bf16_f32 v108, v108, v109
    v_cvt_pk_bf16_f32 v109, v110, v111
    ds_write_b64 v5, v[108:109] offset:16
    v_cvt_pk_bf16_f32 v112, v112, v113
    v_cvt_pk_bf16_f32 v113, v114, v115
    ds_write_b64 v5, v[112:113] offset:32
    v_cvt_pk_bf16_f32 v116, v116, v117
    v_cvt_pk_bf16_f32 v117, v118, v119
    ds_write_b64 v5, v[116:117] offset:48
    v_add_u32 v4, 7600, v4
    v_add_u32 v5, 7600, v5
    s_add_u32 s56, s56, 1
    s_cmp_lt_u32 s56, 2
    s_cbranch_scc1 L_cv2h
    s_waitcnt vmcnt(0)
    v_readfirstlane_b32 s41, v21
    s_nop 0
    s_cmp_eq_u32 s41, 128
    s_cbranch_scc1 Lpf_73
Lwg_74:
    buffer_load_dword v20, off, s[28:31], 0 offset:64 sc1
    s_waitcnt vmcnt(0)
    v_readfirstlane_b32 s41, v20
    s_nop 0
    s_cmp_eq_u32 s41, 128
    s_cbranch_scc1 Lwg_75
    s_sleep 16
    s_sub_u32 s55, s55, 1
    s_cbranch_scc0 Lwg_74
    s_branch L_side_fail
Lwg_75:
Lpf_73:
    s_mov_b32 s46, s53
    s_mov_b32 s47, 131072
    v_lshlrev_b32 v1, 4, v0
    s_lshl_b32 s41, s46, 18
    s_lshl_b32 s42, s54, 12
    s_add_u32 s41, s41, s42
    s_lshl_b32 s42, s40, 10
    s_add_u32 s41, s41, s42
    s_add_u32 s42, s42, s47
    s_add_u32 m0, s42, 0
    s_add_u32 s43, s41, 0x2000000
    buffer_load_dwordx4 v1, s[4:7], s43 offen sc1 lds
    s_add_u32 m0, s42, 4096
    s_add_u32 s43, s41, 0x2020000
    buffer_load_dwordx4 v1, s[4:7], s43 offen sc1 lds
    s_add_u32 m0, s42, 8192
    s_add_u32 s43, s41, 0x0
    buffer_load_dwordx4 v1, s[4:7], s43 offen sc1 lds
    s_add_u32 m0, s42, 12288
    s_add_u32 s43, s41, 0x20000
    buffer_load_dwordx4 v1, s[4:7], s43 offen sc1 lds
    s_add_u32 m0, s42, 16384
    s_add_u32 s43, s41, 0x1000000
    buffer_load_dwordx4 v1, s[4:7], s43 offen sc1 lds
    s_add_u32 m0, s42, 20480
    s_add_u32 s43, s41, 0x1020000
    buffer_load_dwordx4 v1, s[4:7], s43 offen sc1 lds
    s_lshl_b32 s43, s40, 10
    v_add_u32 v10, s43, v1
    s_lshl_b32 s41, s53, 17
    s_lshl_b32 s42, s54, 12
    s_add_u32 s41, s41, s42
    s_add_u32 s41, s41, 0x4000000
    buffer_load_dwordx4 v[24:27], v10, s[4:7], s41 offen sc1
    s_waitcnt lgkmcnt(0)
    s_barrier
    ds_read_b64 v[104:105], v8 offset:0
    ds_read_b64 v[106:107], v8 offset:7600
    ds_read_b64 v[108:109], v8 offset:15200
    ds_read_b64 v[110:111], v8 offset:22800
    ds_read_b64 v[112:113], v8 offset:30400
    ds_read_b64 v[114:115], v8 offset:38000
    ds_read_b64 v[116:117], v8 offset:45600
    ds_read_b64 v[118:119], v8 offset:53200
    s_lshl_b32 s41, s40, 20
    s_lshl_b32 s42, s45, 4
    s_add_u32 s41, s41, s42
    s_add_u32 s41, s41, 0x400000
    v_bfe_u32 v31, v0, 0, 6
    v_lshlrev_b32 v1, 14, v31
    s_waitcnt vmcnt(7) lgkmcnt(0)
    v_lshlrev_b32 v136, 16, v104
    v_and_b32 v137, 0xffff0000, v104
    v_lshlrev_b32 v138, 16, v32
    v_and_b32 v139, 0xffff0000, v32
    v_fma_f32 v136, v138, v64, v136
    v_fma_f32 v137, v139, v64, v137
    v_lshlrev_b32 v140, 16, v106
    v_and_b32 v141, 0xffff0000, v106
    v_lshlrev_b32 v142, 16, v34
    v_and_b32 v143, 0xffff0000, v34
    v_fma_f32 v140, v142, v65, v140
    v_fma_f32 v141, v143, v65, v141
    v_lshlrev_b32 v144, 16, v72
    v_and_b32 v145, 0xffff0000, v72
    v_mul_f32 v144, v144, v136
    v_mul_f32 v145, v145, v140
    v_cvt_pk_bf16_f32 v72, v144, v145
    v_lshlrev_b32 v144, 16, v76
    v_and_b32 v145, 0xffff0000, v76
    v_mul_f32 v144, v144, v137
    v_mul_f32 v145, v145, v141
    v_cvt_pk_bf16_f32 v76, v144, v145
    v_lshlrev_b32 v148, 16, v108
    v_and_b32 v149, 0xffff0000, v108
    v_lshlrev_b32 v150, 16, v36
    v_and_b32 v151, 0xffff0000, v36
    v_fma_f32 v148, v150, v66, v148
    v_fma_f32 v149, v151, v66, v149
    v_lshlrev_b32 v152, 16, v110
    v_and_b32 v153, 0xffff0000, v110
    v_lshlrev_b32 v154, 16, v38
    v_and_b32 v155, 0xffff0000, v38
    v_fma_f32 v152, v154, v67, v152
    v_fma_f32 v153, v155, v67, v153
    v_lshlrev_b32 v156, 16, v73
    v_and_b32 v157, 0xffff0000, v73
    v_mul_f32 v156, v156, v148
    v_mul_f32 v157, v157, v152
    v_cvt_pk_bf16_f32 v73, v156, v157
    v_lshlrev_b32 v156, 16, v77
    v_and_b32 v157, 0xffff0000, v77
    v_mul_f32 v156, v156, v149
    v_mul_f32 v157, v157, v153
    v_cvt_pk_bf16_f32 v77, v156, v157
    v_lshlrev_b32 v136, 16, v112
    v_and_b32 v137, 0xffff0000, v112
    v_lshlrev_b32 v138, 16, v40
    v_and_b32 v139, 0xffff0000, v40
    v_fma_f32 v136, v138, v68, v136
    v_fma_f32 v137, v139, v68, v137
    v_lshlrev_b32 v140, 16, v114
    v_and_b32 v141, 0xffff0000, v114
    v_lshlrev_b32 v142, 16, v42
    v_and_b32 v143, 0xffff0000, v42
    v_fma_f32 v140, v142, v69, v140
    v_fma_f32 v141, v143, v69, v141
    v_lshlrev_b32 v144, 16, v74
    v_and_b32 v145, 0xffff0000, v74
    v_mul_f32 v144, v144, v136
    v_mul_f32 v145, v145, v140
    v_cvt_pk_bf16_f32 v74, v144, v145
    v_lshlrev_b32 v144, 16, v78
    v_and_b32 v145, 0xffff0000, v78
    v_mul_f32 v144, v144, v137
    v_mul_f32 v145, v145, v141
    v_cvt_pk_bf16_f32 v78, v144, v145
    v_lshlrev_b32 v148, 16, v116
    v_and_b32 v149, 0xffff0000, v116
    v_lshlrev_b32 v150, 16, v44
    v_and_b32 v151, 0xffff0000, v44
    v_fma_f32 v148, v150, v70, v148
    v_fma_f32 v149, v151, v70, v149
    v_lshlrev_b32 v152, 16, v118
    v_and_b32 v153, 0xffff0000, v118
    v_lshlrev_b32 v154, 16, v46
    v_and_b32 v155, 0xffff0000, v46
    v_fma_f32 v152, v154, v71, v152
    v_fma_f32 v153, v155, v71, v153
    v_lshlrev_b32 v156, 16, v75
    v_and_b32 v157, 0xffff0000, v75
    v_mul_f32 v156, v156, v148
    v_mul_f32 v157, v157, v152
    v_cvt_pk_bf16_f32 v75, v156, v157
    v_lshlrev_b32 v156, 16, v79
    v_and_b32 v157, 0xffff0000, v79
    v_mul_f32 v156, v156, v149
    v_mul_f32 v157, v157, v153
    v_cvt_pk_bf16_f32 v79, v156, v157
    buffer_store_dwordx4 v[72:75], v1, s[80:83], s41 offen
    s_add_u32 s41, s41, 4096
    buffer_store_dwordx4 v[76:79], v1, s[80:83], s41 offen
    s_add_u32 s41, s41, 4096
    v_lshlrev_b32 v136, 16, v105
    v_and_b32 v137, 0xffff0000, v105
    v_lshlrev_b32 v138, 16, v33
    v_and_b32 v139, 0xffff0000, v33
    v_fma_f32 v136, v138, v64, v136
    v_fma_f32 v137, v139, v64, v137
    v_lshlrev_b32 v140, 16, v107
    v_and_b32 v141, 0xffff0000, v107
    v_lshlrev_b32 v142, 16, v35
    v_and_b32 v143, 0xffff0000, v35
    v_fma_f32 v140, v142, v65, v140
    v_fma_f32 v141, v143, v65, v141
    v_lshlrev_b32 v144, 16, v80
    v_and_b32 v145, 0xffff0000, v80
    v_mul_f32 v144, v144, v136
    v_mul_f32 v145, v145, v140
    v_cvt_pk_bf16_f32 v80, v144, v145
    v_lshlrev_b32 v144, 16, v84
    v_and_b32 v145, 0xffff0000, v84
    v_mul_f32 v144, v144, v137
    v_mul_f32 v145, v145, v141
    v_cvt_pk_bf16_f32 v84, v144, v145
    v_lshlrev_b32 v148, 16, v109
    v_and_b32 v149, 0xffff0000, v109
    v_lshlrev_b32 v150, 16, v37
    v_and_b32 v151, 0xffff0000, v37
    v_fma_f32 v148, v150, v66, v148
    v_fma_f32 v149, v151, v66, v149
    v_lshlrev_b32 v152, 16, v111
    v_and_b32 v153, 0xffff0000, v111
    v_lshlrev_b32 v154, 16, v39
    v_and_b32 v155, 0xffff0000, v39
    v_fma_f32 v152, v154, v67, v152
    v_fma_f32 v153, v155, v67, v153
    v_lshlrev_b32 v156, 16, v81
    v_and_b32 v157, 0xffff0000, v81
    v_mul_f32 v156, v156, v148
    v_mul_f32 v157, v157, v152
    v_cvt_pk_bf16_f32 v81, v156, v157
    v_lshlrev_b32 v156, 16, v85
    v_and_b32 v157, 0xffff0000, v85
    v_mul_f32 v156, v156, v149
    v_mul_f32 v157, v157, v153
    v_cvt_pk_bf16_f32 v85, v156, v157
    v_lshlrev_b32 v136, 16, v113
    v_and_b32 v137, 0xffff0000, v113
    v_lshlrev_b32 v138, 16, v41
    v_and_b32 v139, 0xffff0000, v41
    v_fma_f32 v136, v138, v68, v136
    v_fma_f32 v137, v139, v68, v137
    v_lshlrev_b32 v140, 16, v115
    v_and_b32 v141, 0xffff0000, v115
    v_lshlrev_b32 v142, 16, v43
    v_and_b32 v143, 0xffff0000, v43
    v_fma_f32 v140, v142, v69, v140
    v_fma_f32 v141, v143, v69, v141
    v_lshlrev_b32 v144, 16, v82
    v_and_b32 v145, 0xffff0000, v82
    v_mul_f32 v144, v144, v136
    v_mul_f32 v145, v145, v140
    v_cvt_pk_bf16_f32 v82, v144, v145
    v_lshlrev_b32 v144, 16, v86
    v_and_b32 v145, 0xffff0000, v86
    v_mul_f32 v144, v144, v137
    v_mul_f32 v145, v145, v141
    v_cvt_pk_bf16_f32 v86, v144, v145
    v_lshlrev_b32 v148, 16, v117
    v_and_b32 v149, 0xffff0000, v117
    v_lshlrev_b32 v150, 16, v45
    v_and_b32 v151, 0xffff0000, v45
    v_fma_f32 v148, v150, v70, v148
    v_fma_f32 v149, v151, v70, v149
    v_lshlrev_b32 v152, 16, v119
    v_and_b32 v153, 0xffff0000, v119
    v_lshlrev_b32 v154, 16, v47
    v_and_b32 v155, 0xffff0000, v47
    v_fma_f32 v152, v154, v71, v152
    v_fma_f32 v153, v155, v71, v153
    v_lshlrev_b32 v156, 16, v83
    v_and_b32 v157, 0xffff0000, v83
    v_mul_f32 v156, v156, v148
    v_mul_f32 v157, v157, v152
    v_cvt_pk_bf16_f32 v83, v156, v157
    v_lshlrev_b32 v156, 16, v87
    v_and_b32 v157, 0xffff0000, v87
    v_mul_f32 v156, v156, v149
    v_mul_f32 v157, v157, v153
    v_cvt_pk_bf16_f32 v87, v156, v157
    buffer_store_dwordx4 v[80:83], v1, s[80:83], s41 offen
    s_add_u32 s41, s41, 4096
    buffer_store_dwordx4 v[84:87], v1, s[80:83], s41 offen
    s_add_u32 s41, s41, 4096
    v_lshlrev_b32 v1, 4, v0
    v_add_u32 v8, 32768, v1
    v_lshlrev_b32 v11, 7, v0
    s_and_b32 s41, s40, 1
    s_lshr_b32 s42, s40, 1
    s_lshl_b32 s43, s41, 12
    v_add_u32 v2, s43, v1
    v_add_u32 v3, 8192, v1
    s_lshl_b32 s43, s42, 11
    s_add_u32 s43, s43, 16384
    v_mov_b32 v4, s43
    v_bfe_u32 v31, v0, 0, 2
    v_lshl_add_u32 v4, v31, 8, v4
    v_bfe_u32 v31, v0, 2, 4
    v_lshl_add_u32 v4, v31, 4, v4
    s_lshl_b32 s43, s42, 10
    s_add_u32 s43, s43, 26624
    v_mov_b32 v5, s43
    v_bfe_u32 v31, v0, 3, 1
    v_lshl_add_u32 v5, v31, 8, v5
    v_bfe_u32 v31, v0, 4, 2
    v_lshl_add_u32 v5, v31, 6, v5
    v_bfe_u32 v31, v0, 1, 1
    v_lshl_add_u32 v5, v31, 5, v5
    v_bfe_u32 v31, v0, 2, 1
    v_lshl_add_u32 v5, v31, 3, v5
    v_bfe_u32 v31, v0, 0, 1
    v_lshl_add_u32 v5, v31, 1, v5
    s_mov_b32 s74, 0xcccccccc
    s_mov_b32 s75, 0xcccccccc
    v_mov_b32 v12, 0x4444
    v_mov_b32 v13, 0xeeee
    v_cndmask_b32 v6, v12, v13, s[74:75]
    v_mov_b32 v7, 0xd028965f
    s_mov_b32 s48, 0x3e0293ee
    s_lshl_b32 s43, s41, 4
    v_mov_b32 v12, s43
    v_bfe_u32 v31, v0, 0, 4
    v_lshl_add_u32 v12, v31, 0, v12
    v_bfe_u32 v31, v0, 4, 2
    v_lshlrev_b32 v13, 2, v31
    v_sub_u32 v12, v12, v13
    v_cmp_le_i32 s[58:59], 0, v12
    v_cmp_le_i32 s[60:61], 1, v12
    v_cmp_le_i32 s[62:63], 2, v12
    v_cmp_le_i32 s[64:65], 3, v12
    v_cmp_le_i32 s[66:67], 16, v12
    v_cmp_le_i32 s[68:69], 17, v12
    v_cmp_le_i32 s[70:71], 18, v12
    v_cmp_le_i32 s[72:73], 19, v12
    s_lshl_b32 s43, s40, 10
    v_add_u32 v10, s43, v1
    s_lshl_b32 s43, s42, 16
    s_lshl_b32 s44, s41, 5
    s_add_u32 s43, s43, s44
    s_lshl_b32 s44, s78, 6
    s_add_u32 s43, s43, s44
    s_lshl_b32 s44, s79, 8
    s_add_u32 s43, s43, s44
    s_add_u32 s43, s43, 2048
    v_mov_b32 v9, s43
    v_bfe_u32 v31, v0, 0, 4
    v_lshl_add_u32 v9, v31, 12, v9
    v_bfe_u32 v31, v0, 4, 2
    v_lshl_add_u32 v9, v31, 3, v9
    v_mov_b32 v105, 0
    v_mov_b32 v111, 0
    v_mov_b32 v117, 0
    v_mov_b32 v123, 0
    s_lshl_b32 s43, s79, 16
    s_add_u32 s43, s43, 0x7000000
    s_lshl_b32 s33, s40, 14
    s_lshl_b32 s44, s78, 10
    s_add_u32 s33, s33, s44
    s_add_u32 s33, s33, s43
    s_lshl_b32 s34, s78, 14
    s_lshl_b32 s44, s40, 12
    s_add_u32 s34, s34, s44
    s_add_u32 s34, s34, s43
    s_lshl_b32 s41, s54, 12
    s_add_u32 s39, s41, 0x4000000
    s_and_b32 s42, s40, 1
    s_lshl_b32 s42, s42, 17
    s_add_u32 s42, s42, 0x3000000
    s_lshr_b32 s43, s40, 1
    s_add_u32 s84, s42, s41
    s_lshl_b32 s41, s43, 11
    s_add_u32 s84, s84, s41
    s_lshl_b32 s41, s78, 15
    s_add_u32 s85, s42, s41
    s_lshl_b32 s41, s43, 14
    s_add_u32 s85, s85, s41
    s_lshl_b32 s41, s78, 7
    s_add_u32 s86, s41, 0x4d80000
    s_lshl_b32 s41, s79, 7
    s_add_u32 s87, s41, 0x4d80200
    v_xor_b32 v2, 0x20000, v2
    v_xor_b32 v3, 0x20000, v3
    v_xor_b32 v4, 0x20000, v4
    s_barrier
    s_mov_b32 s88, 0x7fff
    s_mov_b32 s89, 0xfffe
    s_mov_b32 s90, 0x3fff8
    s_mov_b32 s91, 0x1fffc
    s_mov_b32 s92, 16
    s_mov_b32 s45, s53
    s_mov_b32 s56, s53
    s_mov_b32 s57, s53
    s_mov_b32 s32, s53
    s_mov_b32 s46, s53
    s_mov_b32 s52, -1
    s_mov_b32 s35, 0
    v_mov_b32 v140, -1
    v_mov_b32 v141, -1
    v_mov_b32 v142, -1
    v_mov_b32 v143, -1
    s_add_u32 s41, s53, 60
    s_lshl_b32 s41, s41, 19
    s_add_u32 s41, s41, s33
    buffer_store_dwordx4 v[140:143], v1, s[4:7], s41 offen sc1
    s_add_u32 s41, s41, 4096
    buffer_store_dwordx4 v[140:143], v1, s[4:7], s41 offen sc1
    s_add_u32 s41, s41, 4096
    buffer_store_dwordx4 v[140:143], v1, s[4:7], s41 offen sc1
    s_add_u32 s41, s41, 4096
    buffer_store_dwordx4 v[140:143], v1, s[4:7], s41 offen sc1
    s_add_u32 s41, s41, 4096
    s_add_u32 s41, s53, 60
    s_lshl_b32 s41, s41, 18
    s_add_u32 s41, s41, s84
    buffer_store_dwordx4 v[140:143], v1, s[4:7], s41 offen offset:0 sc1
    buffer_store_dwordx4 v[140:143], v1, s[4:7], s41 offen offset:1024 sc1
    s_bfe_u32 s41, s35, 0x10000
    s_lshl2_add_u32 s45, s41, s45
    s_bfe_u32 s41, s35, 0x10001
    s_lshl2_add_u32 s56, s41, s56
    s_bfe_u32 s41, s35, 0x10002
    s_lshl2_add_u32 s57, s41, s57
    s_bfe_u32 s41, s35, 0x10003
    s_lshl2_add_u32 s32, s41, s32
    s_add_u32 s52, s52, 1
    s_lshr_b32 s41, s88, s52
    s_and_b32 s36, s41, 1
    s_lshr_b32 s41, s89, s52
    s_and_b32 s41, s41, 1
    s_lshl_b32 s41, s41, 1
    s_or_b32 s36, s36, s41
    s_lshr_b32 s41, s90, s52
    s_and_b32 s41, s41, 1
    s_lshl_b32 s41, s41, 2
    s_or_b32 s36, s36, s41
    s_lshr_b32 s41, s91, s52
    s_and_b32 s41, s41, 1
    s_lshl_b32 s41, s41, 3
    s_or_b32 s36, s36, s41
    s_lshl_b32 s49, s45, 17
    s_add_u32 s49, s49, s39
    s_lshl_b32 s76, s56, 11
    s_add_u32 s76, s76, s86
    s_lshl_b32 s50, s45, 18
    s_add_u32 s50, s50, s84
    s_lshl_b32 s51, s56, 18
    s_add_u32 s51, s51, s85
    s_lshl_b32 s77, s57, 11
    s_add_u32 s77, s77, s87
    v_mov_b32 v29, 0
    s_waitcnt vmcnt(10)
L_ao_loop:
    s_mov_b32 s35, s36
    s_bitcmp1_b32 s35, 1
    s_cselect_b32 s51, s51, 0x10000000
    s_cbranch_scc0 L_ao_2
Lsp_76:
    v_readfirstlane_b32 s41, v28
    s_nop 0
    s_cmp_eq_u32 s41, 8
    s_cbranch_scc1 Lsp_77
    s_sleep 2
    buffer_load_dword v28, off, s[4:7], s76 sc1
    s_waitcnt vmcnt(0)
    s_sub_u32 s55, s55, 1
    s_cbranch_scc0 Lsp_76
    s_branch L_side_fail
Lsp_77:
L_ao_2:
    s_bitcmp1_b32 s35, 0
    s_cbranch_scc0 L_ao_noA
Lsp_78:
    v_max3_u32 v12, v24, v25, v26
    v_max_u32 v12, v12, v27
    v_cmp_eq_u32 vcc, -1, v12
    s_nop 0
    s_cbranch_vccz Lsp_79
    s_sleep 2
    buffer_load_dwordx4 v[24:27], v10, s[4:7], s49 offen sc1
    s_waitcnt vmcnt(0)
    s_sub_u32 s55, s55, 1
    s_cbranch_scc0 Lsp_78
    s_branch L_side_fail
Lsp_79:
    ds_write_b128 v10, v[24:27] offset:24576
    s_add_u32 s46, s45, 4
    s_cmp_lt_u32 s46, 64
    s_cselect_b32 s46, s46, 1024
    s_xor_b32 s47, s47, 0x20000
    s_waitcnt lgkmcnt(0)
    s_barrier
    v_mov_b32 v96, 0
    v_mov_b32 v97, 0
    v_mov_b32 v98, 0
    s_and_b32 s44, s40, 1
    s_lshl_b32 s44, s44, 15
    s_lshr_b32 s43, s40, 1
    s_lshl_b32 s43, s43, 14
    s_add_u32 s44, s44, s43
    s_add_u32 s44, s44, 32768
    s_add_u32 m0, s44, 0
    s_add_u32 s43, s51, 0
    buffer_load_dwordx4 v1, s[4:7], s43 offen offset:0 sc1 lds
    v_mov_b32 v99, 0
    ds_read_b128 v[32:35], v2 offset:0
    ds_read_b128 v[36:39], v2 offset:1024
    buffer_load_dwordx4 v1, s[4:7], s43 offen offset:1024 sc1 lds
    ds_read_b128 v[40:43], v2 offset:2048
    ds_read_b128 v[44:47], v2 offset:3072
    ds_read_b128 v[48:51], v3 offset:0
    buffer_load_dwordx4 v1, s[4:7], s43 offen offset:2048 sc1 lds
    ds_read_b128 v[52:55], v3 offset:1024
    ds_read_b128 v[56:59], v3 offset:2048
    ds_read_b128 v[60:63], v3 offset:3072
    buffer_load_dwordx4 v1, s[4:7], s43 offen offset:3072 sc1 lds
    ds_read_b128 v[64:67], v3 offset:4096
    ds_read_b128 v[68:71], v3 offset:5120
    ds_read_b128 v[72:75], v3 offset:6144
    s_add_u32 m0, s44, 4096
    s_add_u32 s43, s51, 4096
    buffer_load_dwordx4 v1, s[4:7], s43 offen offset:0 sc1 lds
    ds_read_b128 v[76:79], v3 offset:7168
    ds_read_b128 v[80:83], v1 offset:24576
    ds_read_b128 v[84:87], v1 offset:25600
    buffer_load_dwordx4 v1, s[4:7], s43 offen offset:1024 sc1 lds
    s_waitcnt lgkmcnt(0)
    ds_read_b64_tr_b16 v[100:101], v4 offset:0
    ds_read_b64_tr_b16 v[102:103], v4 offset:4096
    buffer_load_dwordx4 v1, s[4:7], s43 offen offset:2048 sc1 lds
    ds_read_b64_tr_b16 v[106:107], v4 offset:8
    ds_read_b64_tr_b16 v[108:109], v4 offset:4104
    ds_read_b64_tr_b16 v[112:113], v4 offset:1024
    buffer_load_dwordx4 v1, s[4:7], s43 offen offset:3072 sc1 lds
    ds_read_b64_tr_b16 v[114:115], v4 offset:5120
    ds_read_b64_tr_b16 v[118:119], v4 offset:1032
    ds_read_b64_tr_b16 v[120:121], v4 offset:5128
    s_add_u32 m0, s44, 8192
    s_add_u32 s43, s51, 8192
    buffer_load_dwordx4 v1, s[4:7], s43 offen offset:0 sc1 lds
    v_mfma_f32_16x16x32_bf16 v[88:91], v[48:51], v[32:35], 0
    v_mfma_f32_16x16x32_bf16 v[92:95], v[64:67], v[32:35], 0
    v_mfma_f32_16x16x32_bf16 v[88:91], v[52:55], v[36:39], v[88:91]
    buffer_load_dwordx4 v1, s[4:7], s43 offen offset:1024 sc1 lds
    v_mfma_f32_16x16x32_bf16 v[92:95], v[68:71], v[36:39], v[92:95]
    v_mfma_f32_16x16x32_bf16 v[88:91], v[56:59], v[40:43], v[88:91]
    v_mfma_f32_16x16x32_bf16 v[92:95], v[72:75], v[40:43], v[92:95]
    buffer_load_dwordx4 v1, s[4:7], s43 offen offset:2048 sc1 lds
    v_mfma_f32_16x16x32_bf16 v[88:91], v[60:63], v[44:47], v[88:91]
    v_mfma_f32_16x16x32_bf16 v[92:95], v[76:79], v[44:47], v[92:95]
    v_smfmac_f32_16x16x64_bf16 v[96:99], v[80:83], v[32:39], v6
    buffer_load_dwordx4 v1, s[4:7], s43 offen offset:3072 sc1 lds
    v_smfmac_f32_16x16x64_bf16 v[96:99], v[84:87], v[40:47], v6
    s_waitcnt lgkmcnt(0)
    ds_read_u16 v104, v5 offset:0
    s_add_u32 m0, s44, 12288
    s_add_u32 s43, s51, 12288
    buffer_load_dwordx4 v1, s[4:7], s43 offen offset:0 sc1 lds
    ds_read_u16 v20, v5 offset:16
    ds_read_u16 v110, v5 offset:4
    ds_read_u16 v21, v5 offset:20
    buffer_load_dwordx4 v1, s[4:7], s43 offen offset:1024 sc1 lds
    ds_read_u16 v116, v5 offset:512
    ds_read_u16 v22, v5 offset:528
    ds_read_u16 v122, v5 offset:516
    buffer_load_dwordx4 v1, s[4:7], s43 offen offset:2048 sc1 lds
    ds_read_u16 v23, v5 offset:532
    v_cndmask_b32 v88, v7, v88, s[58:59]
    v_cndmask_b32 v89, v7, v89, s[60:61]
    buffer_load_dwordx4 v1, s[4:7], s43 offen offset:3072 sc1 lds
    v_cndmask_b32 v90, v7, v90, s[62:63]
    v_cndmask_b32 v91, v7, v91, s[64:65]
    v_cndmask_b32 v92, v7, v92, s[66:67]
    s_lshl_b32 s41, s46, 18
    s_lshl_b32 s42, s54, 12
    s_add_u32 s41, s41, s42
    s_lshl_b32 s42, s40, 10
    s_add_u32 s41, s41, s42
    s_add_u32 s42, s42, s47
    v_cndmask_b32 v93, v7, v93, s[68:69]
    v_cndmask_b32 v94, v7, v94, s[70:71]
    v_cndmask_b32 v95, v7, v95, s[72:73]
    s_add_u32 m0, s42, 0
    s_add_u32 s43, s41, 0x2000000
    buffer_load_dwordx4 v1, s[4:7], s43 offen sc1 lds
    v_pk_add_f32 v[96:97], v[96:97], v[98:99]
    v_max3_f32 v12, v88, v89, v90
    v_max3_f32 v12, v12, v91, v92
    s_add_u32 m0, s42, 4096
    s_add_u32 s43, s41, 0x2020000
    buffer_load_dwordx4 v1, s[4:7], s43 offen sc1 lds
    v_max3_f32 v12, v12, v93, v94
    v_max3_f32 v12, v12, v95, v96
    v_max_f32 v12, v12, v97
    s_add_u32 m0, s42, 8192
    s_add_u32 s43, s41, 0x0
    buffer_load_dwordx4 v1, s[4:7], s43 offen sc1 lds
    v_mov_b32 v13, v12
    s_nop 1
    v_permlane16_swap_b32 v12, v13
    v_max_f32 v12, v12, v13
    s_add_u32 m0, s42, 12288
    s_add_u32 s43, s41, 0x20000
    buffer_load_dwordx4 v1, s[4:7], s43 offen sc1 lds
    v_mov_b32 v13, v12
    s_nop 1
    v_permlane32_swap_b32 v12, v13
    v_max_f32 v12, v12, v13
    s_add_u32 m0, s42, 16384
    s_add_u32 s43, s41, 0x1000000
    buffer_load_dwordx4 v1, s[4:7], s43 offen sc1 lds
    v_mul_f32 v12, s48, v12
    v_fma_f32 v88, v88, s48, -v12
    v_fma_f32 v89, v89, s48, -v12
    s_add_u32 m0, s42, 20480
    s_add_u32 s43, s41, 0x1020000
    buffer_load_dwordx4 v1, s[4:7], s43 offen sc1 lds
    v_fma_f32 v90, v90, s48, -v12
    v_fma_f32 v91, v91, s48, -v12
    v_fma_f32 v92, v92, s48, -v12
    buffer_load_dword v29, off, s[4:7], s77 sc1
    v_fma_f32 v93, v93, s48, -v12
    v_fma_f32 v94, v94, s48, -v12
    v_fma_f32 v95, v95, s48, -v12
    v_fma_f32 v96, v96, s48, -v12
    v_fma_f32 v97, v97, s48, -v12
    v_exp_f32 v88, v88
    v_exp_f32 v89, v89
    v_exp_f32 v90, v90
    v_exp_f32 v91, v91
    v_exp_f32 v92, v92
    v_exp_f32 v93, v93
    v_exp_f32 v94, v94
    v_exp_f32 v95, v95
    v_exp_f32 v96, v96
    v_exp_f32 v97, v97
    v_pk_add_f32 v[12:13], v[88:89], v[90:91]
    v_pk_add_f32 v[12:13], v[12:13], v[92:93]
    v_pk_add_f32 v[12:13], v[12:13], v[94:95]
    v_pk_add_f32 v[12:13], v[12:13], v[96:97]
    v_add_f32 v12, v12, v13
    v_mov_b32 v13, v12
    s_nop 1
    v_permlane16_swap_b32 v12, v13
    v_add_f32 v12, v12, v13
    v_mov_b32 v13, v12
    s_nop 1
    v_permlane32_swap_b32 v12, v13
    v_add_f32 v12, v12, v13
    v_rcp_f32 v12, v12
    s_nop 0
    v_mul_f32 v88, v88, v12
    v_mul_f32 v89, v89, v12
    v_mul_f32 v90, v90, v12
    v_mul_f32 v91, v91, v12
    v_mul_f32 v92, v92, v12
    v_mul_f32 v93, v93, v12
    v_mul_f32 v94, v94, v12
    v_mul_f32 v95, v95, v12
    v_mul_f32 v96, v96, v12
    v_mul_f32 v97, v97, v12
    v_cvt_pk_bf16_f32 v14, v88, v89
    v_cvt_pk_bf16_f32 v15, v90, v91
    v_cvt_pk_bf16_f32 v16, v92, v93
    v_cvt_pk_bf16_f32 v17, v94, v95
    v_cvt_pk_bf16_f32 v18, v96, v97
    v_mov_b32 v19, 0
    s_waitcnt lgkmcnt(0)
    v_lshl_or_b32 v104, v20, 16, v104
    v_lshl_or_b32 v110, v21, 16, v110
    v_lshl_or_b32 v116, v22, 16, v116
    v_lshl_or_b32 v122, v23, 16, v122
    v_mfma_f32_16x16x32_bf16 v[124:127], v[100:103], v[14:17], 0
    v_mfma_f32_16x16x32_bf16 v[128:131], v[106:109], v[14:17], 0
    v_mfma_f32_16x16x32_bf16 v[132:135], v[112:115], v[14:17], 0
    v_mfma_f32_16x16x32_bf16 v[136:139], v[118:121], v[14:17], 0
    s_nop 2
    v_mfma_f32_16x16x16_bf16 v[124:127], v[104:105], v[18:19], v[124:127]
    v_mfma_f32_16x16x16_bf16 v[128:131], v[110:111], v[18:19], v[128:131]
    v_mfma_f32_16x16x16_bf16 v[132:135], v[116:117], v[18:19], v[132:135]
    v_mfma_f32_16x16x16_bf16 v[136:139], v[122:123], v[18:19], v[136:139]
    s_nop 4
    v_cvt_pk_bf16_f32 v124, v124, v125
    v_cvt_pk_bf16_f32 v125, v126, v127
    v_cvt_pk_bf16_f32 v126, v128, v129
    v_cvt_pk_bf16_f32 v127, v130, v131
    buffer_store_dwordx4 v[124:127], v1, s[4:7], s50 offen offset:0 sc1
    v_cvt_pk_bf16_f32 v132, v132, v133
    v_cvt_pk_bf16_f32 v133, v134, v135
    v_cvt_pk_bf16_f32 v134, v136, v137
    v_cvt_pk_bf16_f32 v135, v138, v139
    buffer_store_dwordx4 v[132:135], v1, s[4:7], s50 offen offset:1024 sc1
    v_xor_b32 v2, 0x20000, v2
    v_xor_b32 v3, 0x20000, v3
    v_xor_b32 v4, 0x20000, v4
    s_bitcmp1_b32 s35, 1
    s_cbranch_scc0 L_ao_noO
    s_waitcnt vmcnt(9)
    s_branch L_ao_3
L_ao_noA:
    s_bitcmp1_b32 s35, 1
    s_cbranch_scc0 L_ao_noO
    s_barrier
    s_and_b32 s44, s40, 1
    s_lshl_b32 s44, s44, 15
    s_lshr_b32 s43, s40, 1
    s_lshl_b32 s43, s43, 14
    s_add_u32 s44, s44, s43
    s_add_u32 s44, s44, 32768
    s_add_u32 m0, s44, 0
    s_add_u32 s43, s51, 0
    buffer_load_dwordx4 v1, s[4:7], s43 offen offset:0 sc1 lds
    buffer_load_dwordx4 v1, s[4:7], s43 offen offset:1024 sc1 lds
    buffer_load_dwordx4 v1, s[4:7], s43 offen offset:2048 sc1 lds
    buffer_load_dwordx4 v1, s[4:7], s43 offen offset:3072 sc1 lds
    s_add_u32 m0, s44, 4096
    s_add_u32 s43, s51, 4096
    buffer_load_dwordx4 v1, s[4:7], s43 offen offset:0 sc1 lds
    buffer_load_dwordx4 v1, s[4:7], s43 offen offset:1024 sc1 lds
    buffer_load_dwordx4 v1, s[4:7], s43 offen offset:2048 sc1 lds
    buffer_load_dwordx4 v1, s[4:7], s43 offen offset:3072 sc1 lds
    s_add_u32 m0, s44, 8192
    s_add_u32 s43, s51, 8192
    buffer_load_dwordx4 v1, s[4:7], s43 offen offset:0 sc1 lds
    buffer_load_dwordx4 v1, s[4:7], s43 offen offset:1024 sc1 lds
    buffer_load_dwordx4 v1, s[4:7], s43 offen offset:2048 sc1 lds
    buffer_load_dwordx4 v1, s[4:7], s43 offen offset:3072 sc1 lds
    s_add_u32 m0, s44, 12288
    s_add_u32 s43, s51, 12288
    buffer_load_dwordx4 v1, s[4:7], s43 offen offset:0 sc1 lds
    buffer_load_dwordx4 v1, s[4:7], s43 offen offset:1024 sc1 lds
    buffer_load_dwordx4 v1, s[4:7], s43 offen offset:2048 sc1 lds
    buffer_load_dwordx4 v1, s[4:7], s43 offen offset:3072 sc1 lds
    s_waitcnt vmcnt(0)
L_ao_3:
    s_barrier
    ds_read_b128 v[156:159], v8 offset:0
    ds_read_b128 v[160:163], v8 offset:32768
    ds_read_b128 v[164:167], v8 offset:1024
    ds_read_b128 v[168:171], v8 offset:33792
    ds_read_b128 v[172:175], v8 offset:2048
    ds_read_b128 v[176:179], v8 offset:34816
    ds_read_b128 v[180:183], v8 offset:3072
    ds_read_b128 v[184:187], v8 offset:35840
    ds_read_b128 v[188:191], v8 offset:4096
    ds_read_b128 v[192:195], v8 offset:36864
    s_lshl_b32 s37, s56, 19
    s_add_u32 s37, s37, s33
    ds_read_b128 v[196:199], v8 offset:5120
    s_waitcnt lgkmcnt(9)
    v_mfma_f32_16x16x32_bf16 v[124:127], a[0:3], v[156:159], 0
    v_mfma_f32_16x16x32_bf16 v[128:131], a[4:7], v[156:159], 0
    ds_read_b128 v[200:203], v8 offset:37888
    v_mfma_f32_16x16x32_bf16 v[132:135], a[0:3], v[160:163], 0
    v_mfma_f32_16x16x32_bf16 v[136:139], a[4:7], v[160:163], 0
    ds_read_b128 v[156:159], v8 offset:6144
    s_waitcnt lgkmcnt(9)
    v_mfma_f32_16x16x32_bf16 v[124:127], a[8:11], v[164:167], v[124:127]
    v_mfma_f32_16x16x32_bf16 v[128:131], a[12:15], v[164:167], v[128:131]
    ds_read_b128 v[160:163], v8 offset:38912
    v_mfma_f32_16x16x32_bf16 v[132:135], a[8:11], v[168:171], v[132:135]
    v_mfma_f32_16x16x32_bf16 v[136:139], a[12:15], v[168:171], v[136:139]
    ds_read_b128 v[164:167], v8 offset:7168
    s_waitcnt lgkmcnt(9)
    v_mfma_f32_16x16x32_bf16 v[124:127], a[16:19], v[172:175], v[124:127]
    v_mfma_f32_16x16x32_bf16 v[128:131], a[20:23], v[172:175], v[128:131]
    ds_read_b128 v[168:171], v8 offset:39936
    v_mfma_f32_16x16x32_bf16 v[132:135], a[16:19], v[176:179], v[132:135]
    v_mfma_f32_16x16x32_bf16 v[136:139], a[20:23], v[176:179], v[136:139]
    ds_read_b128 v[172:175], v8 offset:8192
    s_waitcnt lgkmcnt(9)
    v_mfma_f32_16x16x32_bf16 v[124:127], a[24:27], v[180:183], v[124:127]
    v_mfma_f32_16x16x32_bf16 v[128:131], a[28:31], v[180:183], v[128:131]
    ds_read_b128 v[176:179], v8 offset:40960
    v_mfma_f32_16x16x32_bf16 v[132:135], a[24:27], v[184:187], v[132:135]
    v_mfma_f32_16x16x32_bf16 v[136:139], a[28:31], v[184:187], v[136:139]
    ds_read_b128 v[180:183], v8 offset:9216
    s_waitcnt lgkmcnt(9)
    v_mfma_f32_16x16x32_bf16 v[124:127], a[32:35], v[188:191], v[124:127]
    v_mfma_f32_16x16x32_bf16 v[128:131], a[36:39], v[188:191], v[128:131]
    ds_read_b128 v[184:187], v8 offset:41984
    v_mfma_f32_16x16x32_bf16 v[132:135], a[32:35], v[192:195], v[132:135]
    v_mfma_f32_16x16x32_bf16 v[136:139], a[36:39], v[192:195], v[136:139]
    ds_read_b128 v[188:191], v8 offset:10240
    s_waitcnt lgkmcnt(9)
    v_mfma_f32_16x16x32_bf16 v[124:127], a[40:43], v[196:199], v[124:127]
    v_mfma_f32_16x16x32_bf16 v[128:131], a[44:47], v[196:199], v[128:131]
    ds_read_b128 v[192:195], v8 offset:43008
    v_mfma_f32_16x16x32_bf16 v[132:135], a[40:43], v[200:203], v[132:135]
    v_mfma_f32_16x16x32_bf16 v[136:139], a[44:47], v[200:203], v[136:139]
    ds_read_b128 v[196:199], v8 offset:11264
    s_waitcnt lgkmcnt(9)
    v_mfma_f32_16x16x32_bf16 v[124:127], a[48:51], v[156:159], v[124:127]
    v_mfma_f32_16x16x32_bf16 v[128:131], a[52:55], v[156:159], v[128:131]
    ds_read_b128 v[200:203], v8 offset:44032
    v_mfma_f32_16x16x32_bf16 v[132:135], a[48:51], v[160:163], v[132:135]
    v_mfma_f32_16x16x32_bf16 v[136:139], a[52:55], v[160:163], v[136:139]
    ds_read_b128 v[156:159], v8 offset:12288
    s_waitcnt lgkmcnt(9)
    v_mfma_f32_16x16x32_bf16 v[124:127], a[56:59], v[164:167], v[124:127]
    v_mfma_f32_16x16x32_bf16 v[128:131], a[60:63], v[164:167], v[128:131]
    ds_read_b128 v[160:163], v8 offset:45056
    v_mfma_f32_16x16x32_bf16 v[132:135], a[56:59], v[168:171], v[132:135]
    v_mfma_f32_16x16x32_bf16 v[136:139], a[60:63], v[168:171], v[136:139]
    ds_read_b128 v[164:167], v8 offset:13312
    s_waitcnt lgkmcnt(9)
    v_mfma_f32_16x16x32_bf16 v[124:127], a[64:67], v[172:175], v[124:127]
    v_mfma_f32_16x16x32_bf16 v[128:131], a[68:71], v[172:175], v[128:131]
    s_waitcnt vmcnt(0)
    s_barrier
    s_cmp_eq_u32 s40, 0
    s_cbranch_scc0 Lsig_80
    v_mov_b32 v14, 1
    s_mov_b64 exec, 1
    s_lshl_b32 s41, s45, 11
    s_add_u32 s41, s41, s86
    s_bitcmp1_b32 s35, 0
    s_cselect_b32 s41, s41, 0x10000000
    buffer_atomic_add v14, off, s[4:7], s41 sc1
    s_lshl_b32 s41, s32, 11
    s_add_u32 s41, s41, s87
    s_bitcmp1_b32 s35, 3
    s_cselect_b32 s41, s41, 0x10000000
    buffer_atomic_add v14, off, s[4:7], s41 sc1
    s_mov_b64 exec, -1
Lsig_80:
    s_bitcmp1_b32 s35, 2
    s_cbranch_scc0 Lf_81
Lsp_82:
    v_readfirstlane_b32 s41, v29
    s_nop 0
    s_cmp_eq_u32 s41, 4
    s_cbranch_scc1 Lsp_83
    s_sleep 2
    buffer_load_dword v29, off, s[4:7], s77 sc1
    s_waitcnt vmcnt(0)
    s_sub_u32 s55, s55, 1
    s_cbranch_scc0 Lsp_82
    s_branch L_side_fail
Lsp_83:
    s_lshl_b32 s41, s57, 19
    s_add_u32 s41, s41, s34
    buffer_load_dwordx4 v[140:143], v1, s[4:7], s41 offen offset:0 sc1
    buffer_load_dwordx4 v[144:147], v1, s[4:7], s41 offen offset:1024 sc1
    buffer_load_dwordx4 v[148:151], v1, s[4:7], s41 offen offset:2048 sc1
    buffer_load_dwordx4 v[152:155], v1, s[4:7], s41 offen offset:3072 sc1
Lf_81:
    s_lshl_b32 s38, s57, 17
    s_bitcmp1_b32 s35, 2
    s_cselect_b32 s38, s38, 0x10000000
    ds_read_b128 v[168:171], v8 offset:46080
    v_mfma_f32_16x16x32_bf16 v[132:135], a[64:67], v[176:179], v[132:135]
    v_mfma_f32_16x16x32_bf16 v[136:139], a[68:71], v[176:179], v[136:139]
    ds_read_b128 v[172:175], v8 offset:14336
    s_waitcnt lgkmcnt(9)
    v_mfma_f32_16x16x32_bf16 v[124:127], a[72:75], v[180:183], v[124:127]
    v_mfma_f32_16x16x32_bf16 v[128:131], a[76:79], v[180:183], v[128:131]
    ds_read_b128 v[176:179], v8 offset:47104
    v_mfma_f32_16x16x32_bf16 v[132:135], a[72:75], v[184:187], v[132:135]
    v_mfma_f32_16x16x32_bf16 v[136:139], a[76:79], v[184:187], v[136:139]
    ds_read_b128 v[180:183], v8 offset:15360
    s_waitcnt lgkmcnt(9)
    v_mfma_f32_16x16x32_bf16 v[124:127], a[80:83], v[188:191], v[124:127]
    v_mfma_f32_16x16x32_bf16 v[128:131], a[84:87], v[188:191], v[128:131]
    ds_read_b128 v[184:187], v8 offset:48128
    v_mfma_f32_16x16x32_bf16 v[132:135], a[80:83], v[192:195], v[132:135]
    v_mfma_f32_16x16x32_bf16 v[136:139], a[84:87], v[192:195], v[136:139]
    ds_read_b128 v[188:191], v8 offset:16384
    s_waitcnt lgkmcnt(9)
    v_mfma_f32_16x16x32_bf16 v[124:127], a[88:91], v[196:199], v[124:127]
    v_mfma_f32_16x16x32_bf16 v[128:131], a[92:95], v[196:199], v[128:131]
    ds_read_b128 v[192:195], v8 offset:49152
    v_mfma_f32_16x16x32_bf16 v[132:135], a[88:91], v[200:203], v[132:135]
    v_mfma_f32_16x16x32_bf16 v[136:139], a[92:95], v[200:203], v[136:139]
    ds_read_b128 v[196:199], v8 offset:17408
    s_waitcnt lgkmcnt(9)
    v_mfma_f32_16x16x32_bf16 v[124:127], a[96:99], v[156:159], v[124:127]
    v_mfma_f32_16x16x32_bf16 v[128:131], a[100:103], v[156:159], v[128:131]
    ds_read_b128 v[200:203], v8 offset:50176
    v_mfma_f32_16x16x32_bf16 v[132:135], a[96:99], v[160:163], v[132:135]
    v_mfma_f32_16x16x32_bf16 v[136:139], a[100:103], v[160:163], v[136:139]
    ds_read_b128 v[156:159], v8 offset:18432
    s_waitcnt lgkmcnt(9)
    v_mfma_f32_16x16x32_bf16 v[124:127], a[104:107], v[164:167], v[124:127]
    v_mfma_f32_16x16x32_bf16 v[128:131], a[108:111], v[164:167], v[128:131]
    ds_read_b128 v[160:163], v8 offset:51200
    v_mfma_f32_16x16x32_bf16 v[132:135], a[104:107], v[168:171], v[132:135]
    v_mfma_f32_16x16x32_bf16 v[136:139], a[108:111], v[168:171], v[136:139]
    ds_read_b128 v[164:167], v8 offset:19456
    s_waitcnt lgkmcnt(9)
    v_mfma_f32_16x16x32_bf16 v[124:127], a[112:115], v[172:175], v[124:127]
    v_mfma_f32_16x16x32_bf16 v[128:131], a[116:119], v[172:175], v[128:131]
    ds_read_b128 v[168:171], v8 offset:52224
    v_mfma_f32_16x16x32_bf16 v[132:135], a[112:115], v[176:179], v[132:135]
    v_mfma_f32_16x16x32_bf16 v[136:139], a[116:119], v[176:179], v[136:139]
    ds_read_b128 v[172:175], v8 offset:20480
    s_waitcnt lgkmcnt(9)
    v_mfma_f32_16x16x32_bf16 v[124:127], a[120:123], v[180:183], v[124:127]
    v_mfma_f32_16x16x32_bf16 v[128:131], a[124:127], v[180:183], v[128:131]
    ds_read_b128 v[176:179], v8 offset:53248
    v_mfma_f32_16x16x32_bf16 v[132:135], a[120:123], v[184:187], v[132:135]
    v_mfma_f32_16x16x32_bf16 v[136:139], a[124:127], v[184:187], v[136:139]
    ds_read_b128 v[180:183], v8 offset:21504
    s_waitcnt lgkmcnt(9)
    v_mfma_f32_16x16x32_bf16 v[124:127], a[128:131], v[188:191], v[124:127]
    v_mfma_f32_16x16x32_bf16 v[128:131], a[132:135], v[188:191], v[128:131]
    ds_read_b128 v[184:187], v8 offset:54272
    v_mfma_f32_16x16x32_bf16 v[132:135], a[128:131], v[192:195], v[132:135]
    v_mfma_f32_16x16x32_bf16 v[136:139], a[132:135], v[192:195], v[136:139]
    ds_read_b128 v[188:191], v8 offset:22528
    s_waitcnt lgkmcnt(9)
    v_mfma_f32_16x16x32_bf16 v[124:127], a[136:139], v[196:199], v[124:127]
    v_mfma_f32_16x16x32_bf16 v[128:131], a[140:143], v[196:199], v[128:131]
    ds_read_b128 v[192:195], v8 offset:55296
    v_mfma_f32_16x16x32_bf16 v[132:135], a[136:139], v[200:203], v[132:135]
    v_mfma_f32_16x16x32_bf16 v[136:139], a[140:143], v[200:203], v[136:139]
    ds_read_b128 v[196:199], v8 offset:23552
    s_waitcnt lgkmcnt(9)
    v_mfma_f32_16x16x32_bf16 v[124:127], a[144:147], v[156:159], v[124:127]
    v_mfma_f32_16x16x32_bf16 v[128:131], a[148:151], v[156:159], v[128:131]
    ds_read_b128 v[200:203], v8 offset:56320
    v_mfma_f32_16x16x32_bf16 v[132:135], a[144:147], v[160:163], v[132:135]
    v_mfma_f32_16x16x32_bf16 v[136:139], a[148:151], v[160:163], v[136:139]
    ds_read_b128 v[156:159], v8 offset:24576
    s_waitcnt lgkmcnt(9)
    v_mfma_f32_16x16x32_bf16 v[124:127], a[152:155], v[164:167], v[124:127]
    s_bfe_u32 s41, s35, 0x10000
    v_mfma_f32_16x16x32_bf16 v[128:131], a[156:159], v[164:167], v[128:131]
    s_lshl2_add_u32 s45, s41, s45
    ds_read_b128 v[160:163], v8 offset:57344
    v_mfma_f32_16x16x32_bf16 v[132:135], a[152:155], v[168:171], v[132:135]
    s_bfe_u32 s41, s35, 0x10001
    v_mfma_f32_16x16x32_bf16 v[136:139], a[156:159], v[168:171], v[136:139]
    s_lshl2_add_u32 s56, s41, s56
    ds_read_b128 v[164:167], v8 offset:25600
    s_waitcnt lgkmcnt(9)
    v_mfma_f32_16x16x32_bf16 v[124:127], a[160:163], v[172:175], v[124:127]
    s_bfe_u32 s41, s35, 0x10002
    v_mfma_f32_16x16x32_bf16 v[128:131], a[164:167], v[172:175], v[128:131]
    s_lshl2_add_u32 s57, s41, s57
    ds_read_b128 v[168:171], v8 offset:58368
    v_mfma_f32_16x16x32_bf16 v[132:135], a[160:163], v[176:179], v[132:135]
    s_bfe_u32 s41, s35, 0x10003
    v_mfma_f32_16x16x32_bf16 v[136:139], a[164:167], v[176:179], v[136:139]
    s_lshl2_add_u32 s32, s41, s32
    ds_read_b128 v[172:175], v8 offset:26624
    s_waitcnt lgkmcnt(9)
    v_mfma_f32_16x16x32_bf16 v[124:127], a[168:171], v[180:183], v[124:127]
    s_add_u32 s52, s52, 1
    v_mfma_f32_16x16x32_bf16 v[128:131], a[172:175], v[180:183], v[128:131]
    s_lshr_b32 s41, s88, s52
    ds_read_b128 v[176:179], v8 offset:59392
    v_mfma_f32_16x16x32_bf16 v[132:135], a[168:171], v[184:187], v[132:135]
    s_and_b32 s36, s41, 1
    v_mfma_f32_16x16x32_bf16 v[136:139], a[172:175], v[184:187], v[136:139]
    s_lshr_b32 s41, s89, s52
    ds_read_b128 v[180:183], v8 offset:27648
    s_waitcnt lgkmcnt(9)
    v_mfma_f32_16x16x32_bf16 v[124:127], a[176:179], v[188:191], v[124:127]
    s_and_b32 s41, s41, 1
    v_mfma_f32_16x16x32_bf16 v[128:131], a[180:183], v[188:191], v[128:131]
    s_lshl_b32 s41, s41, 1
    ds_read_b128 v[184:187], v8 offset:60416
    v_mfma_f32_16x16x32_bf16 v[132:135], a[176:179], v[192:195], v[132:135]
    s_or_b32 s36, s36, s41
    v_mfma_f32_16x16x32_bf16 v[136:139], a[180:183], v[192:195], v[136:139]
    s_lshr_b32 s41, s90, s52
    ds_read_b128 v[188:191], v8 offset:28672
    s_waitcnt lgkmcnt(9)
    v_mfma_f32_16x16x32_bf16 v[124:127], a[184:187], v[196:199], v[124:127]
    s_and_b32 s41, s41, 1
    v_mfma_f32_16x16x32_bf16 v[128:131], a[188:191], v[196:199], v[128:131]
    s_lshl_b32 s41, s41, 2
    ds_read_b128 v[192:195], v8 offset:61440
    v_mfma_f32_16x16x32_bf16 v[132:135], a[184:187], v[200:203], v[132:135]
    s_or_b32 s36, s36, s41
    v_mfma_f32_16x16x32_bf16 v[136:139], a[188:191], v[200:203], v[136:139]
    s_lshr_b32 s41, s91, s52
    ds_read_b128 v[196:199], v8 offset:29696
    s_waitcnt lgkmcnt(9)
    v_mfma_f32_16x16x32_bf16 v[124:127], a[192:195], v[156:159], v[124:127]
    s_and_b32 s41, s41, 1
    v_mfma_f32_16x16x32_bf16 v[128:131], a[196:199], v[156:159], v[128:131]
    s_lshl_b32 s41, s41, 3
    ds_read_b128 v[200:203], v8 offset:62464
    v_mfma_f32_16x16x32_bf16 v[132:135], a[192:195], v[160:163], v[132:135]
    s_or_b32 s36, s36, s41
    v_mfma_f32_16x16x32_bf16 v[136:139], a[196:199], v[160:163], v[136:139]
    s_lshl_b32 s49, s45, 17
    ds_read_b128 v[156:159], v8 offset:30720
    s_waitcnt lgkmcnt(9)
    v_mfma_f32_16x16x32_bf16 v[124:127], a[200:203], v[164:167], v[124:127]
    s_add_u32 s49, s49, s39
    v_mfma_f32_16x16x32_bf16 v[128:131], a[204:207], v[164:167], v[128:131]
    s_lshl_b32 s76, s56, 11
    ds_read_b128 v[160:163], v8 offset:63488
    v_mfma_f32_16x16x32_bf16 v[132:135], a[200:203], v[168:171], v[132:135]
    s_add_u32 s76, s76, s86
    v_mfma_f32_16x16x32_bf16 v[136:139], a[204:207], v[168:171], v[136:139]
    buffer_load_dwordx4 v[24:27], v10, s[4:7], s49 offen sc1
    ds_read_b128 v[164:167], v8 offset:31744
    s_waitcnt lgkmcnt(9)
    v_mfma_f32_16x16x32_bf16 v[124:127], a[208:211], v[172:175], v[124:127]
    buffer_load_dword v28, off, s[4:7], s76 sc1
    v_mfma_f32_16x16x32_bf16 v[128:131], a[212:215], v[172:175], v[128:131]
    s_lshl_b32 s50, s45, 18
    ds_read_b128 v[168:171], v8 offset:64512
    v_mfma_f32_16x16x32_bf16 v[132:135], a[208:211], v[176:179], v[132:135]
    s_add_u32 s50, s50, s84
    v_mfma_f32_16x16x32_bf16 v[136:139], a[212:215], v[176:179], v[136:139]
    s_lshl_b32 s51, s56, 18
    s_waitcnt lgkmcnt(8)
    v_mfma_f32_16x16x32_bf16 v[124:127], a[216:219], v[180:183], v[124:127]
    s_add_u32 s51, s51, s85
    v_mfma_f32_16x16x32_bf16 v[128:131], a[220:223], v[180:183], v[128:131]
    s_lshl_b32 s77, s57, 11
    v_mfma_f32_16x16x32_bf16 v[132:135], a[216:219], v[184:187], v[132:135]
    s_add_u32 s77, s77, s87
    v_mfma_f32_16x16x32_bf16 v[136:139], a[220:223], v[184:187], v[136:139]
    v_mov_b32 v29, 0
    s_waitcnt lgkmcnt(6)
    v_mfma_f32_16x16x32_bf16 v[124:127], a[224:227], v[188:191], v[124:127]
    v_mfma_f32_16x16x32_bf16 v[128:131], a[228:231], v[188:191], v[128:131]
    v_mfma_f32_16x16x32_bf16 v[132:135], a[224:227], v[192:195], v[132:135]
    v_mfma_f32_16x16x32_bf16 v[136:139], a[228:231], v[192:195], v[136:139]
    s_waitcnt lgkmcnt(4)
    v_mfma_f32_16x16x32_bf16 v[124:127], a[232:235], v[196:199], v[124:127]
    v_mfma_f32_16x16x32_bf16 v[128:131], a[236:239], v[196:199], v[128:131]
    v_mfma_f32_16x16x32_bf16 v[132:135], a[232:235], v[200:203], v[132:135]
    v_mfma_f32_16x16x32_bf16 v[136:139], a[236:239], v[200:203], v[136:139]
    s_waitcnt lgkmcnt(2)
    v_mfma_f32_16x16x32_bf16 v[124:127], a[240:243], v[156:159], v[124:127]
    v_mfma_f32_16x16x32_bf16 v[128:131], a[244:247], v[156:159], v[128:131]
    v_mfma_f32_16x16x32_bf16 v[132:135], a[240:243], v[160:163], v[132:135]
    v_mfma_f32_16x16x32_bf16 v[136:139], a[244:247], v[160:163], v[136:139]
    s_waitcnt lgkmcnt(0)
    v_mfma_f32_16x16x32_bf16 v[124:127], a[248:251], v[164:167], v[124:127]
    v_mfma_f32_16x16x32_bf16 v[128:131], a[252:255], v[164:167], v[128:131]
    v_mfma_f32_16x16x32_bf16 v[132:135], a[248:251], v[168:171], v[132:135]
    v_mfma_f32_16x16x32_bf16 v[136:139], a[252:255], v[168:171], v[136:139]
    s_waitcnt vmcnt(2)
    s_nop 3
    buffer_store_dwordx4 v[124:127], v1, s[4:7], s37 offen sc1
    s_add_u32 s37, s37, 4096
    buffer_store_dwordx4 v[128:131], v1, s[4:7], s37 offen sc1
    s_add_u32 s37, s37, 4096
    buffer_store_dwordx4 v[132:135], v1, s[4:7], s37 offen sc1
    s_add_u32 s37, s37, 4096
    buffer_store_dwordx4 v[136:139], v1, s[4:7], s37 offen sc1
    s_add_u32 s37, s37, 4096
    s_branch L_ao_6
L_ao_noO:
    s_waitcnt vmcnt(0)
    s_barrier
    s_cmp_eq_u32 s40, 0
    s_cbranch_scc0 Lsig_84
    v_mov_b32 v14, 1
    s_mov_b64 exec, 1
    s_lshl_b32 s41, s45, 11
    s_add_u32 s41, s41, s86
    s_bitcmp1_b32 s35, 0
    s_cselect_b32 s41, s41, 0x10000000
    buffer_atomic_add v14, off, s[4:7], s41 sc1
    s_lshl_b32 s41, s32, 11
    s_add_u32 s41, s41, s87
    s_bitcmp1_b32 s35, 3
    s_cselect_b32 s41, s41, 0x10000000
    buffer_atomic_add v14, off, s[4:7], s41 sc1
    s_mov_b64 exec, -1
Lsig_84:
    s_bitcmp1_b32 s35, 2
    s_cbranch_scc0 Lf_85
Lsp_86:
    v_readfirstlane_b32 s41, v29
    s_nop 0
    s_cmp_eq_u32 s41, 4
    s_cbranch_scc1 Lsp_87
    s_sleep 2
    buffer_load_dword v29, off, s[4:7], s77 sc1
    s_waitcnt vmcnt(0)
    s_sub_u32 s55, s55, 1
    s_cbranch_scc0 Lsp_86
    s_branch L_side_fail
Lsp_87:
    s_lshl_b32 s41, s57, 19
    s_add_u32 s41, s41, s34
    buffer_load_dwordx4 v[140:143], v1, s[4:7], s41 offen offset:0 sc1
    buffer_load_dwordx4 v[144:147], v1, s[4:7], s41 offen offset:1024 sc1
    buffer_load_dwordx4 v[148:151], v1, s[4:7], s41 offen offset:2048 sc1
    buffer_load_dwordx4 v[152:155], v1, s[4:7], s41 offen offset:3072 sc1
Lf_85:
    s_lshl_b32 s38, s57, 17
    s_bitcmp1_b32 s35, 2
    s_cselect_b32 s38, s38, 0x10000000
    s_bfe_u32 s41, s35, 0x10000
    s_lshl2_add_u32 s45, s41, s45
    s_bfe_u32 s41, s35, 0x10001
    s_lshl2_add_u32 s56, s41, s56
    s_bfe_u32 s41, s35, 0x10002
    s_lshl2_add_u32 s57, s41, s57
    s_bfe_u32 s41, s35, 0x10003
    s_lshl2_add_u32 s32, s41, s32
    s_add_u32 s52, s52, 1
    s_lshr_b32 s41, s88, s52
    s_and_b32 s36, s41, 1
    s_lshr_b32 s41, s89, s52
    s_and_b32 s41, s41, 1
    s_lshl_b32 s41, s41, 1
    s_or_b32 s36, s36, s41
    s_lshr_b32 s41, s90, s52
    s_and_b32 s41, s41, 1
    s_lshl_b32 s41, s41, 2
    s_or_b32 s36, s36, s41
    s_lshr_b32 s41, s91, s52
    s_and_b32 s41, s41, 1
    s_lshl_b32 s41, s41, 3
    s_or_b32 s36, s36, s41
    s_lshl_b32 s49, s45, 17
    s_add_u32 s49, s49, s39
    s_lshl_b32 s76, s56, 11
    s_add_u32 s76, s76, s86
    buffer_load_dwordx4 v[24:27], v10, s[4:7], s49 offen sc1
    buffer_load_dword v28, off, s[4:7], s76 sc1
    s_lshl_b32 s50, s45, 18
    s_add_u32 s50, s50, s84
    s_lshl_b32 s51, s56, 18
    s_add_u32 s51, s51, s85
    s_lshl_b32 s77, s57, 11
    s_add_u32 s77, s77, s87
    v_mov_b32 v29, 0
    s_waitcnt vmcnt(0)
L_ao_6:
    v_pk_add_f32 v[140:141], v[140:141], v[144:145]
    v_pk_add_f32 v[148:149], v[148:149], v[152:153]
    v_pk_add_f32 v[140:141], v[140:141], v[148:149]
    v_cvt_pk_bf16_f32 v12, v140, v141
    v_pk_add_f32 v[142:143], v[142:143], v[146:147]
    v_pk_add_f32 v[150:151], v[150:151], v[154:155]
    v_pk_add_f32 v[142:143], v[142:143], v[150:151]
    v_cvt_pk_bf16_f32 v13, v142, v143
    buffer_store_dwordx2 v[12:13], v9, s[80:83], s38 offen
    s_waitcnt vmcnt(5)
    s_cmp_lt_u32 s52, s92
    s_cbranch_scc1 L_ao_loop
    s_waitcnt vmcnt(0)
    s_barrier
    s_mov_b32 s35, 8
    s_cmp_eq_u32 s40, 0
    s_cbranch_scc0 Lsig_88
    v_mov_b32 v14, 1
    s_mov_b64 exec, 1
    s_lshl_b32 s41, s45, 11
    s_add_u32 s41, s41, s86
    s_bitcmp1_b32 s35, 0
    s_cselect_b32 s41, s41, 0x10000000
    buffer_atomic_add v14, off, s[4:7], s41 sc1
    s_lshl_b32 s41, s32, 11
    s_add_u32 s41, s41, s87
    s_bitcmp1_b32 s35, 3
    s_cselect_b32 s41, s41, 0x10000000
    buffer_atomic_add v14, off, s[4:7], s41 sc1
    s_mov_b64 exec, -1
Lsig_88:
    s_mov_b32 s35, 1
    v_mov_b32 v96, 0
    v_mov_b32 v97, 0
    v_mov_b32 v98, 0
    v_mov_b32 v99, 0
    ds_read_b128 v[32:35], v2 offset:0
    ds_read_b128 v[36:39], v2 offset:1024
    ds_read_b128 v[40:43], v2 offset:2048
    ds_read_b128 v[44:47], v2 offset:3072
    ds_read_b128 v[48:51], v3 offset:0
    ds_read_b128 v[52:55], v3 offset:1024
    ds_read_b128 v[56:59], v3 offset:2048
    ds_read_b128 v[60:63], v3 offset:3072
    ds_read_b128 v[64:67], v3 offset:4096
    ds_read_b128 v[68:71], v3 offset:5120
    ds_read_b128 v[72:75], v3 offset:6144
    ds_read_b128 v[76:79], v3 offset:7168
    s_waitcnt lgkmcnt(0)
    ds_read_b64_tr_b16 v[100:101], v4 offset:0
    ds_read_b64_tr_b16 v[102:103], v4 offset:4096
    ds_read_b64_tr_b16 v[106:107], v4 offset:8
    ds_read_b64_tr_b16 v[108:109], v4 offset:4104
    ds_read_b64_tr_b16 v[112:113], v4 offset:1024
    ds_read_b64_tr_b16 v[114:115], v4 offset:5120
    ds_read_b64_tr_b16 v[118:119], v4 offset:1032
    ds_read_b64_tr_b16 v[120:121], v4 offset:5128
    v_mfma_f32_16x16x32_bf16 v[88:91], v[48:51], v[32:35], 0
    v_mfma_f32_16x16x32_bf16 v[92:95], v[64:67], v[32:35], 0
    v_mfma_f32_16x16x32_bf16 v[88:91], v[52:55], v[36:39], v[88:91]
    v_mfma_f32_16x16x32_bf16 v[92:95], v[68:71], v[36:39], v[92:95]
    v_mfma_f32_16x16x32_bf16 v[88:91], v[56:59], v[40:43], v[88:91]
    v_mfma_f32_16x16x32_bf16 v[92:95], v[72:75], v[40:43], v[92:95]
    v_mfma_f32_16x16x32_bf16 v[88:91], v[60:63], v[44:47], v[88:91]
    v_mfma_f32_16x16x32_bf16 v[92:95], v[76:79], v[44:47], v[92:95]
    s_nop 6
    v_cndmask_b32 v88, v7, v88, s[58:59]
    v_cndmask_b32 v89, v7, v89, s[60:61]
    v_cndmask_b32 v90, v7, v90, s[62:63]
    v_cndmask_b32 v91, v7, v91, s[64:65]
    v_cndmask_b32 v92, v7, v92, s[66:67]
    v_cndmask_b32 v93, v7, v93, s[68:69]
    v_cndmask_b32 v94, v7, v94, s[70:71]
    v_cndmask_b32 v95, v7, v95, s[72:73]
Lsp_89:
    v_max3_u32 v12, v24, v25, v26
    v_max_u32 v12, v12, v27
    v_cmp_eq_u32 vcc, -1, v12
    s_nop 0
    s_cbranch_vccz Lsp_90
    s_sleep 2
    buffer_load_dwordx4 v[24:27], v10, s[4:7], s49 offen sc1
    s_waitcnt vmcnt(0)
    s_sub_u32 s55, s55, 1
    s_cbranch_scc0 Lsp_89
    s_branch L_side_fail
Lsp_90:
    ds_write_b128 v10, v[24:27] offset:24576
    s_waitcnt lgkmcnt(0)
    s_barrier
    ds_read_b128 v[80:83], v1 offset:24576
    ds_read_b128 v[84:87], v1 offset:25600
    ds_read_u16 v104, v5 offset:0
    ds_read_u16 v20, v5 offset:16
    ds_read_u16 v110, v5 offset:4
    ds_read_u16 v21, v5 offset:20
    ds_read_u16 v116, v5 offset:512
    ds_read_u16 v22, v5 offset:528
    ds_read_u16 v122, v5 offset:516
    ds_read_u16 v23, v5 offset:532
    s_waitcnt lgkmcnt(8)
    v_smfmac_f32_16x16x64_bf16 v[96:99], v[80:83], v[32:39], v6
    v_smfmac_f32_16x16x64_bf16 v[96:99], v[84:87], v[40:47], v6
    s_nop 7
    v_pk_add_f32 v[96:97], v[96:97], v[98:99]
    v_max3_f32 v12, v88, v89, v90
    v_max3_f32 v12, v12, v91, v92
    v_max3_f32 v12, v12, v93, v94
    v_max3_f32 v12, v12, v95, v96
    v_max_f32 v12, v12, v97
    v_mov_b32 v13, v12
    s_nop 1
    v_permlane16_swap_b32 v12, v13
    v_max_f32 v12, v12, v13
    v_mov_b32 v13, v12
    s_nop 1
    v_permlane32_swap_b32 v12, v13
    v_max_f32 v12, v12, v13
    v_mul_f32 v12, s48, v12
    v_fma_f32 v88, v88, s48, -v12
    v_fma_f32 v89, v89, s48, -v12
    v_fma_f32 v90, v90, s48, -v12
    v_fma_f32 v91, v91, s48, -v12
    v_fma_f32 v92, v92, s48, -v12
    v_fma_f32 v93, v93, s48, -v12
    v_fma_f32 v94, v94, s48, -v12
    v_fma_f32 v95, v95, s48, -v12
    v_fma_f32 v96, v96, s48, -v12
    v_fma_f32 v97, v97, s48, -v12
    v_exp_f32 v88, v88
    v_exp_f32 v89, v89
    v_exp_f32 v90, v90
    v_exp_f32 v91, v91
    v_exp_f32 v92, v92
    v_exp_f32 v93, v93
    v_exp_f32 v94, v94
    v_exp_f32 v95, v95
    v_exp_f32 v96, v96
    v_exp_f32 v97, v97
    v_pk_add_f32 v[12:13], v[88:89], v[90:91]
    v_pk_add_f32 v[12:13], v[12:13], v[92:93]
    v_pk_add_f32 v[12:13], v[12:13], v[94:95]
    v_pk_add_f32 v[12:13], v[12:13], v[96:97]
    v_add_f32 v12, v12, v13
    v_mov_b32 v13, v12
    s_nop 1
    v_permlane16_swap_b32 v12, v13
    v_add_f32 v12, v12, v13
    v_mov_b32 v13, v12
    s_nop 1
    v_permlane32_swap_b32 v12, v13
    v_add_f32 v12, v12, v13
    v_rcp_f32 v12, v12
    s_nop 0
    v_mul_f32 v88, v88, v12
    v_mul_f32 v89, v89, v12
    v_mul_f32 v90, v90, v12
    v_mul_f32 v91, v91, v12
    v_mul_f32 v92, v92, v12
    v_mul_f32 v93, v93, v12
    v_mul_f32 v94, v94, v12
    v_mul_f32 v95, v95, v12
    v_mul_f32 v96, v96, v12
    v_mul_f32 v97, v97, v12
    v_cvt_pk_bf16_f32 v14, v88, v89
    v_cvt_pk_bf16_f32 v15, v90, v91
    v_cvt_pk_bf16_f32 v16, v92, v93
    v_cvt_pk_bf16_f32 v17, v94, v95
    v_cvt_pk_bf16_f32 v18, v96, v97
    v_mov_b32 v19, 0
    s_waitcnt lgkmcnt(0)
    v_lshl_or_b32 v104, v20, 16, v104
    v_lshl_or_b32 v110, v21, 16, v110
    v_lshl_or_b32 v116, v22, 16, v116
    v_lshl_or_b32 v122, v23, 16, v122
    v_mfma_f32_16x16x32_bf16 v[124:127], v[100:103], v[14:17], 0
    v_mfma_f32_16x16x32_bf16 v[128:131], v[106:109], v[14:17], 0
    v_mfma_f32_16x16x32_bf16 v[132:135], v[112:115], v[14:17], 0
    v_mfma_f32_16x16x32_bf16 v[136:139], v[118:121], v[14:17], 0
    s_nop 2
    v_mfma_f32_16x16x16_bf16 v[124:127], v[104:105], v[18:19], v[124:127]
    v_mfma_f32_16x16x16_bf16 v[128:131], v[110:111], v[18:19], v[128:131]
    v_mfma_f32_16x16x16_bf16 v[132:135], v[116:117], v[18:19], v[132:135]
    v_mfma_f32_16x16x16_bf16 v[136:139], v[122:123], v[18:19], v[136:139]
    s_nop 4
    v_cvt_pk_bf16_f32 v124, v124, v125
    v_cvt_pk_bf16_f32 v125, v126, v127
    v_cvt_pk_bf16_f32 v126, v128, v129
    v_cvt_pk_bf16_f32 v127, v130, v131
    buffer_store_dwordx4 v[124:127], v1, s[4:7], s50 offen offset:0 sc1
    v_cvt_pk_bf16_f32 v132, v132, v133
    v_cvt_pk_bf16_f32 v133, v134, v135
    v_cvt_pk_bf16_f32 v134, v136, v137
    v_cvt_pk_bf16_f32 v135, v138, v139
    buffer_store_dwordx4 v[132:135], v1, s[4:7], s50 offen offset:1024 sc1
    buffer_load_dword v27, off, s[4:7], s77 sc1
    s_add_u32 s77, s77, 8192
    buffer_load_dword v29, off, s[4:7], s77 sc1
    s_waitcnt vmcnt(0)
    s_and_b32 s44, s40, 1
    s_lshl_b32 s44, s44, 15
    s_lshr_b32 s43, s40, 1
    s_lshl_b32 s43, s43, 14
    s_add_u32 s44, s44, s43
    s_add_u32 s44, s44, 32768
    s_add_u32 m0, s44, 0
    s_add_u32 s43, s51, 0
    buffer_load_dwordx4 v1, s[4:7], s43 offen offset:0 sc1 lds
    buffer_load_dwordx4 v1, s[4:7], s43 offen offset:1024 sc1 lds
    buffer_load_dwordx4 v1, s[4:7], s43 offen offset:2048 sc1 lds
    buffer_load_dwordx4 v1, s[4:7], s43 offen offset:3072 sc1 lds
    s_add_u32 m0, s44, 4096
    s_add_u32 s43, s51, 4096
    buffer_load_dwordx4 v1, s[4:7], s43 offen offset:0 sc1 lds
    buffer_load_dwordx4 v1, s[4:7], s43 offen offset:1024 sc1 lds
    buffer_load_dwordx4 v1, s[4:7], s43 offen offset:2048 sc1 lds
    buffer_load_dwordx4 v1, s[4:7], s43 offen offset:3072 sc1 lds
    s_add_u32 m0, s44, 8192
    s_add_u32 s43, s51, 8192
    buffer_load_dwordx4 v1, s[4:7], s43 offen offset:0 sc1 lds
    buffer_load_dwordx4 v1, s[4:7], s43 offen offset:1024 sc1 lds
    buffer_load_dwordx4 v1, s[4:7], s43 offen offset:2048 sc1 lds
    buffer_load_dwordx4 v1, s[4:7], s43 offen offset:3072 sc1 lds
    s_add_u32 m0, s44, 12288
    s_add_u32 s43, s51, 12288
    buffer_load_dwordx4 v1, s[4:7], s43 offen offset:0 sc1 lds
    buffer_load_dwordx4 v1, s[4:7], s43 offen offset:1024 sc1 lds
    buffer_load_dwordx4 v1, s[4:7], s43 offen offset:2048 sc1 lds
    buffer_load_dwordx4 v1, s[4:7], s43 offen offset:3072 sc1 lds
Lsp_91:
    v_readfirstlane_b32 s41, v29
    s_nop 0
    s_cmp_eq_u32 s41, 4
    s_cbranch_scc1 Lsp_92
    s_sleep 2
    buffer_load_dword v29, off, s[4:7], s77 sc1
    s_waitcnt vmcnt(0)
    s_sub_u32 s55, s55, 1
    s_cbranch_scc0 Lsp_91
    s_branch L_side_fail
Lsp_92:
    s_sub_u32 s77, s77, 8192
    v_mov_b32 v29, v27
Lsp_93:
    s_nop 0
    v_readfirstlane_b32 s41, v29
    s_nop 0
    s_cmp_eq_u32 s41, 4
    s_cbranch_scc1 Lsp_94
    s_sleep 2
    buffer_load_dword v29, off, s[4:7], s77 sc1
    s_waitcnt vmcnt(0)
    s_sub_u32 s55, s55, 1
    s_cbranch_scc0 Lsp_93
    s_branch L_side_fail
Lsp_94:
    s_lshl_b32 s77, s57, 19
    s_add_u32 s77, s77, s34
    buffer_load_dwordx4 v[32:35], v1, s[4:7], s77 offen offset:0 sc1
    buffer_load_dwordx4 v[36:39], v1, s[4:7], s77 offen offset:1024 sc1
    buffer_load_dwordx4 v[40:43], v1, s[4:7], s77 offen offset:2048 sc1
    buffer_load_dwordx4 v[44:47], v1, s[4:7], s77 offen offset:3072 sc1
    s_add_u32 s77, s77, 0x200000
    buffer_load_dwordx4 v[48:51], v1, s[4:7], s77 offen offset:0 sc1
    buffer_load_dwordx4 v[52:55], v1, s[4:7], s77 offen offset:1024 sc1
    buffer_load_dwordx4 v[56:59], v1, s[4:7], s77 offen offset:2048 sc1
    buffer_load_dwordx4 v[60:63], v1, s[4:7], s77 offen offset:3072 sc1
    s_add_u32 s77, s77, 0x200000
    s_lshl_b32 s38, s57, 17
    s_waitcnt vmcnt(8)
    v_add_u32 v13, s44, v1
Lsp_95:
    ds_read_b128 v[156:159], v13 offset:0
    ds_read_b128 v[160:163], v13 offset:1024
    ds_read_b128 v[164:167], v13 offset:2048
    ds_read_b128 v[168:171], v13 offset:3072
    ds_read_b128 v[172:175], v13 offset:4096
    ds_read_b128 v[176:179], v13 offset:5120
    ds_read_b128 v[180:183], v13 offset:6144
    ds_read_b128 v[184:187], v13 offset:7168
    s_waitcnt lgkmcnt(7)
    v_max3_u32 v12, v156, v156, v157
    v_max3_u32 v12, v12, v158, v159
    s_waitcnt lgkmcnt(6)
    v_max3_u32 v12, v12, v160, v161
    v_max3_u32 v12, v12, v162, v163
    s_waitcnt lgkmcnt(5)
    v_max3_u32 v12, v12, v164, v165
    v_max3_u32 v12, v12, v166, v167
    s_waitcnt lgkmcnt(4)
    v_max3_u32 v12, v12, v168, v169
    v_max3_u32 v12, v12, v170, v171
    s_waitcnt lgkmcnt(3)
    v_max3_u32 v12, v12, v172, v173
    v_max3_u32 v12, v12, v174, v175
    s_waitcnt lgkmcnt(2)
    v_max3_u32 v12, v12, v176, v177
    v_max3_u32 v12, v12, v178, v179
    s_waitcnt lgkmcnt(1)
    v_max3_u32 v12, v12, v180, v181
    v_max3_u32 v12, v12, v182, v183
    s_waitcnt lgkmcnt(0)
    v_max3_u32 v12, v12, v184, v185
    v_max3_u32 v12, v12, v186, v187
    ds_read_b128 v[156:159], v13 offset:8192
    ds_read_b128 v[160:163], v13 offset:9216
    ds_read_b128 v[164:167], v13 offset:10240
    ds_read_b128 v[168:171], v13 offset:11264
    ds_read_b128 v[172:175], v13 offset:12288
    ds_read_b128 v[176:179], v13 offset:13312
    ds_read_b128 v[180:183], v13 offset:14336
    ds_read_b128 v[184:187], v13 offset:15360
    s_waitcnt lgkmcnt(7)
    v_max3_u32 v12, v12, v156, v157
    v_max3_u32 v12, v12, v158, v159
    s_waitcnt lgkmcnt(6)
    v_max3_u32 v12, v12, v160, v161
    v_max3_u32 v12, v12, v162, v163
    s_waitcnt lgkmcnt(5)
    v_max3_u32 v12, v12, v164, v165
    v_max3_u32 v12, v12, v166, v167
    s_waitcnt lgkmcnt(4)
    v_max3_u32 v12, v12, v168, v169
    v_max3_u32 v12, v12, v170, v171
    s_waitcnt lgkmcnt(3)
    v_max3_u32 v12, v12, v172, v173
    v_max3_u32 v12, v12, v174, v175
    s_waitcnt lgkmcnt(2)
    v_max3_u32 v12, v12, v176, v177
    v_max3_u32 v12, v12, v178, v179
    s_waitcnt lgkmcnt(1)
    v_max3_u32 v12, v12, v180, v181
    v_max3_u32 v12, v12, v182, v183
    s_waitcnt lgkmcnt(0)
    v_max3_u32 v12, v12, v184, v185
    v_max3_u32 v12, v12, v186, v187
    v_cmp_eq_u32 vcc, -1, v12
    s_nop 0
    s_cbranch_vccz Lsp_96
    s_and_b32 s44, s40, 1
    s_lshl_b32 s44, s44, 15
    s_lshr_b32 s43, s40, 1
    s_lshl_b32 s43, s43, 14
    s_add_u32 s44, s44, s43
    s_add_u32 s44, s44, 32768
    s_add_u32 m0, s44, 0
    s_add_u32 s43, s51, 0
    buffer_load_dwordx4 v1, s[4:7], s43 offen offset:0 sc1 lds
    buffer_load_dwordx4 v1, s[4:7], s43 offen offset:1024 sc1 lds
    buffer_load_dwordx4 v1, s[4:7], s43 offen offset:2048 sc1 lds
    buffer_load_dwordx4 v1, s[4:7], s43 offen offset:3072 sc1 lds
    s_add_u32 m0, s44, 4096
    s_add_u32 s43, s51, 4096
    buffer_load_dwordx4 v1, s[4:7], s43 offen offset:0 sc1 lds
    buffer_load_dwordx4 v1, s[4:7], s43 offen offset:1024 sc1 lds
    buffer_load_dwordx4 v1, s[4:7], s43 offen offset:2048 sc1 lds
    buffer_load_dwordx4 v1, s[4:7], s43 offen offset:3072 sc1 lds
    s_add_u32 m0, s44, 8192
    s_add_u32 s43, s51, 8192
    buffer_load_dwordx4 v1, s[4:7], s43 offen offset:0 sc1 lds
    buffer_load_dwordx4 v1, s[4:7], s43 offen offset:1024 sc1 lds
    buffer_load_dwordx4 v1, s[4:7], s43 offen offset:2048 sc1 lds
    buffer_load_dwordx4 v1, s[4:7], s43 offen offset:3072 sc1 lds
    s_add_u32 m0, s44, 12288
    s_add_u32 s43, s51, 12288
    buffer_load_dwordx4 v1, s[4:7], s43 offen offset:0 sc1 lds
    buffer_load_dwordx4 v1, s[4:7], s43 offen offset:1024 sc1 lds
    buffer_load_dwordx4 v1, s[4:7], s43 offen offset:2048 sc1 lds
    buffer_load_dwordx4 v1, s[4:7], s43 offen offset:3072 sc1 lds
    s_waitcnt vmcnt(0)
    s_sub_u32 s55, s55, 1
    s_cbranch_scc0 Lsp_95
    s_branch L_side_fail
Lsp_96:
    s_barrier
    ds_read_b128 v[156:159], v8 offset:0
    ds_read_b128 v[160:163], v8 offset:32768
    ds_read_b128 v[164:167], v8 offset:1024
    ds_read_b128 v[168:171], v8 offset:33792
    ds_read_b128 v[172:175], v8 offset:2048
    ds_read_b128 v[176:179], v8 offset:34816
    ds_read_b128 v[180:183], v8 offset:3072
    ds_read_b128 v[184:187], v8 offset:35840
    ds_read_b128 v[188:191], v8 offset:4096
    ds_read_b128 v[192:195], v8 offset:36864
    s_lshl_b32 s37, s56, 19
    s_add_u32 s37, s37, s33
    ds_read_b128 v[196:199], v8 offset:5120
    s_waitcnt lgkmcnt(9)
    v_mfma_f32_16x16x32_bf16 v[124:127], a[0:3], v[156:159], 0
    v_mfma_f32_16x16x32_bf16 v[128:131], a[4:7], v[156:159], 0
    ds_read_b128 v[200:203], v8 offset:37888
    v_mfma_f32_16x16x32_bf16 v[132:135], a[0:3], v[160:163], 0
    v_mfma_f32_16x16x32_bf16 v[136:139], a[4:7], v[160:163], 0
    ds_read_b128 v[156:159], v8 offset:6144
    s_waitcnt lgkmcnt(9)
    v_mfma_f32_16x16x32_bf16 v[124:127], a[8:11], v[164:167], v[124:127]
    v_mfma_f32_16x16x32_bf16 v[128:131], a[12:15], v[164:167], v[128:131]
    ds_read_b128 v[160:163], v8 offset:38912
    v_mfma_f32_16x16x32_bf16 v[132:135], a[8:11], v[168:171], v[132:135]
    v_mfma_f32_16x16x32_bf16 v[136:139], a[12:15], v[168:171], v[136:139]
    ds_read_b128 v[164:167], v8 offset:7168
    s_waitcnt lgkmcnt(9)
    v_mfma_f32_16x16x32_bf16 v[124:127], a[16:19], v[172:175], v[124:127]
    v_mfma_f32_16x16x32_bf16 v[128:131], a[20:23], v[172:175], v[128:131]
    ds_read_b128 v[168:171], v8 offset:39936
    v_mfma_f32_16x16x32_bf16 v[132:135], a[16:19], v[176:179], v[132:135]
    v_mfma_f32_16x16x32_bf16 v[136:139], a[20:23], v[176:179], v[136:139]
    ds_read_b128 v[172:175], v8 offset:8192
    s_waitcnt lgkmcnt(9)
    v_mfma_f32_16x16x32_bf16 v[124:127], a[24:27], v[180:183], v[124:127]
    v_mfma_f32_16x16x32_bf16 v[128:131], a[28:31], v[180:183], v[128:131]
    ds_read_b128 v[176:179], v8 offset:40960
    v_mfma_f32_16x16x32_bf16 v[132:135], a[24:27], v[184:187], v[132:135]
    v_mfma_f32_16x16x32_bf16 v[136:139], a[28:31], v[184:187], v[136:139]
    ds_read_b128 v[180:183], v8 offset:9216
    s_waitcnt lgkmcnt(9)
    v_mfma_f32_16x16x32_bf16 v[124:127], a[32:35], v[188:191], v[124:127]
    v_mfma_f32_16x16x32_bf16 v[128:131], a[36:39], v[188:191], v[128:131]
    ds_read_b128 v[184:187], v8 offset:41984
    v_mfma_f32_16x16x32_bf16 v[132:135], a[32:35], v[192:195], v[132:135]
    v_mfma_f32_16x16x32_bf16 v[136:139], a[36:39], v[192:195], v[136:139]
    ds_read_b128 v[188:191], v8 offset:10240
    s_waitcnt lgkmcnt(9)
    v_mfma_f32_16x16x32_bf16 v[124:127], a[40:43], v[196:199], v[124:127]
    v_mfma_f32_16x16x32_bf16 v[128:131], a[44:47], v[196:199], v[128:131]
    ds_read_b128 v[192:195], v8 offset:43008
    v_mfma_f32_16x16x32_bf16 v[132:135], a[40:43], v[200:203], v[132:135]
    v_mfma_f32_16x16x32_bf16 v[136:139], a[44:47], v[200:203], v[136:139]
    ds_read_b128 v[196:199], v8 offset:11264
    s_waitcnt lgkmcnt(9)
    v_mfma_f32_16x16x32_bf16 v[124:127], a[48:51], v[156:159], v[124:127]
    v_mfma_f32_16x16x32_bf16 v[128:131], a[52:55], v[156:159], v[128:131]
    ds_read_b128 v[200:203], v8 offset:44032
    v_mfma_f32_16x16x32_bf16 v[132:135], a[48:51], v[160:163], v[132:135]
    v_mfma_f32_16x16x32_bf16 v[136:139], a[52:55], v[160:163], v[136:139]
    ds_read_b128 v[156:159], v8 offset:12288
    s_waitcnt lgkmcnt(9)
    v_mfma_f32_16x16x32_bf16 v[124:127], a[56:59], v[164:167], v[124:127]
    v_mfma_f32_16x16x32_bf16 v[128:131], a[60:63], v[164:167], v[128:131]
    ds_read_b128 v[160:163], v8 offset:45056
    v_mfma_f32_16x16x32_bf16 v[132:135], a[56:59], v[168:171], v[132:135]
    v_mfma_f32_16x16x32_bf16 v[136:139], a[60:63], v[168:171], v[136:139]
    ds_read_b128 v[164:167], v8 offset:13312
    s_waitcnt lgkmcnt(9)
    v_mfma_f32_16x16x32_bf16 v[124:127], a[64:67], v[172:175], v[124:127]
    v_mfma_f32_16x16x32_bf16 v[128:131], a[68:71], v[172:175], v[128:131]
    ds_read_b128 v[168:171], v8 offset:46080
    v_mfma_f32_16x16x32_bf16 v[132:135], a[64:67], v[176:179], v[132:135]
    v_mfma_f32_16x16x32_bf16 v[136:139], a[68:71], v[176:179], v[136:139]
    ds_read_b128 v[172:175], v8 offset:14336
    s_waitcnt lgkmcnt(9)
    v_mfma_f32_16x16x32_bf16 v[124:127], a[72:75], v[180:183], v[124:127]
    v_mfma_f32_16x16x32_bf16 v[128:131], a[76:79], v[180:183], v[128:131]
    ds_read_b128 v[176:179], v8 offset:47104
    v_mfma_f32_16x16x32_bf16 v[132:135], a[72:75], v[184:187], v[132:135]
    v_mfma_f32_16x16x32_bf16 v[136:139], a[76:79], v[184:187], v[136:139]
    ds_read_b128 v[180:183], v8 offset:15360
    s_waitcnt lgkmcnt(9)
    v_mfma_f32_16x16x32_bf16 v[124:127], a[80:83], v[188:191], v[124:127]
    v_mfma_f32_16x16x32_bf16 v[128:131], a[84:87], v[188:191], v[128:131]
    ds_read_b128 v[184:187], v8 offset:48128
    v_mfma_f32_16x16x32_bf16 v[132:135], a[80:83], v[192:195], v[132:135]
    v_mfma_f32_16x16x32_bf16 v[136:139], a[84:87], v[192:195], v[136:139]
    ds_read_b128 v[188:191], v8 offset:16384
    s_waitcnt lgkmcnt(9)
    v_mfma_f32_16x16x32_bf16 v[124:127], a[88:91], v[196:199], v[124:127]
    v_mfma_f32_16x16x32_bf16 v[128:131], a[92:95], v[196:199], v[128:131]
    ds_read_b128 v[192:195], v8 offset:49152
    v_mfma_f32_16x16x32_bf16 v[132:135], a[88:91], v[200:203], v[132:135]
    v_mfma_f32_16x16x32_bf16 v[136:139], a[92:95], v[200:203], v[136:139]
    ds_read_b128 v[196:199], v8 offset:17408
    s_waitcnt lgkmcnt(9)
    v_mfma_f32_16x16x32_bf16 v[124:127], a[96:99], v[156:159], v[124:127]
    v_mfma_f32_16x16x32_bf16 v[128:131], a[100:103], v[156:159], v[128:131]
    ds_read_b128 v[200:203], v8 offset:50176
    v_mfma_f32_16x16x32_bf16 v[132:135], a[96:99], v[160:163], v[132:135]
    v_mfma_f32_16x16x32_bf16 v[136:139], a[100:103], v[160:163], v[136:139]
    ds_read_b128 v[156:159], v8 offset:18432
    s_waitcnt lgkmcnt(9)
    v_mfma_f32_16x16x32_bf16 v[124:127], a[104:107], v[164:167], v[124:127]
    v_mfma_f32_16x16x32_bf16 v[128:131], a[108:111], v[164:167], v[128:131]
    ds_read_b128 v[160:163], v8 offset:51200
    v_mfma_f32_16x16x32_bf16 v[132:135], a[104:107], v[168:171], v[132:135]
    v_mfma_f32_16x16x32_bf16 v[136:139], a[108:111], v[168:171], v[136:139]
    ds_read_b128 v[164:167], v8 offset:19456
    s_waitcnt lgkmcnt(9)
    v_mfma_f32_16x16x32_bf16 v[124:127], a[112:115], v[172:175], v[124:127]
    v_mfma_f32_16x16x32_bf16 v[128:131], a[116:119], v[172:175], v[128:131]
    ds_read_b128 v[168:171], v8 offset:52224
    v_mfma_f32_16x16x32_bf16 v[132:135], a[112:115], v[176:179], v[132:135]
    v_mfma_f32_16x16x32_bf16 v[136:139], a[116:119], v[176:179], v[136:139]
    ds_read_b128 v[172:175], v8 offset:20480
    s_waitcnt lgkmcnt(9)
    v_mfma_f32_16x16x32_bf16 v[124:127], a[120:123], v[180:183], v[124:127]
    v_mfma_f32_16x16x32_bf16 v[128:131], a[124:127], v[180:183], v[128:131]
    ds_read_b128 v[176:179], v8 offset:53248
    v_mfma_f32_16x16x32_bf16 v[132:135], a[120:123], v[184:187], v[132:135]
    v_mfma_f32_16x16x32_bf16 v[136:139], a[124:127], v[184:187], v[136:139]
    ds_read_b128 v[180:183], v8 offset:21504
    s_waitcnt lgkmcnt(9)
    v_mfma_f32_16x16x32_bf16 v[124:127], a[128:131], v[188:191], v[124:127]
    v_mfma_f32_16x16x32_bf16 v[128:131], a[132:135], v[188:191], v[128:131]
    ds_read_b128 v[184:187], v8 offset:54272
    v_mfma_f32_16x16x32_bf16 v[132:135], a[128:131], v[192:195], v[132:135]
    v_mfma_f32_16x16x32_bf16 v[136:139], a[132:135], v[192:195], v[136:139]
    ds_read_b128 v[188:191], v8 offset:22528
    s_waitcnt lgkmcnt(9)
    v_mfma_f32_16x16x32_bf16 v[124:127], a[136:139], v[196:199], v[124:127]
    v_mfma_f32_16x16x32_bf16 v[128:131], a[140:143], v[196:199], v[128:131]
    ds_read_b128 v[192:195], v8 offset:55296
    v_mfma_f32_16x16x32_bf16 v[132:135], a[136:139], v[200:203], v[132:135]
    v_mfma_f32_16x16x32_bf16 v[136:139], a[140:143], v[200:203], v[136:139]
    ds_read_b128 v[196:199], v8 offset:23552
    s_waitcnt lgkmcnt(9)
    v_mfma_f32_16x16x32_bf16 v[124:127], a[144:147], v[156:159], v[124:127]
    v_mfma_f32_16x16x32_bf16 v[128:131], a[148:151], v[156:159], v[128:131]
    ds_read_b128 v[200:203], v8 offset:56320
    v_mfma_f32_16x16x32_bf16 v[132:135], a[144:147], v[160:163], v[132:135]
    v_mfma_f32_16x16x32_bf16 v[136:139], a[148:151], v[160:163], v[136:139]
    ds_read_b128 v[156:159], v8 offset:24576
    s_waitcnt lgkmcnt(9)
    v_mfma_f32_16x16x32_bf16 v[124:127], a[152:155], v[164:167], v[124:127]
    v_mfma_f32_16x16x32_bf16 v[128:131], a[156:159], v[164:167], v[128:131]
    ds_read_b128 v[160:163], v8 offset:57344
    v_mfma_f32_16x16x32_bf16 v[132:135], a[152:155], v[168:171], v[132:135]
    v_mfma_f32_16x16x32_bf16 v[136:139], a[156:159], v[168:171], v[136:139]
    ds_read_b128 v[164:167], v8 offset:25600
    s_waitcnt lgkmcnt(9)
    v_mfma_f32_16x16x32_bf16 v[124:127], a[160:163], v[172:175], v[124:127]
    v_mfma_f32_16x16x32_bf16 v[128:131], a[164:167], v[172:175], v[128:131]
    ds_read_b128 v[168:171], v8 offset:58368
    v_mfma_f32_16x16x32_bf16 v[132:135], a[160:163], v[176:179], v[132:135]
    v_mfma_f32_16x16x32_bf16 v[136:139], a[164:167], v[176:179], v[136:139]
    ds_read_b128 v[172:175], v8 offset:26624
    s_waitcnt lgkmcnt(9)
    v_mfma_f32_16x16x32_bf16 v[124:127], a[168:171], v[180:183], v[124:127]
    v_mfma_f32_16x16x32_bf16 v[128:131], a[172:175], v[180:183], v[128:131]
    ds_read_b128 v[176:179], v8 offset:59392
    v_mfma_f32_16x16x32_bf16 v[132:135], a[168:171], v[184:187], v[132:135]
    v_mfma_f32_16x16x32_bf16 v[136:139], a[172:175], v[184:187], v[136:139]
    ds_read_b128 v[180:183], v8 offset:27648
    s_waitcnt lgkmcnt(9)
    v_mfma_f32_16x16x32_bf16 v[124:127], a[176:179], v[188:191], v[124:127]
    v_mfma_f32_16x16x32_bf16 v[128:131], a[180:183], v[188:191], v[128:131]
    ds_read_b128 v[184:187], v8 offset:60416
    v_mfma_f32_16x16x32_bf16 v[132:135], a[176:179], v[192:195], v[132:135]
    v_mfma_f32_16x16x32_bf16 v[136:139], a[180:183], v[192:195], v[136:139]
    ds_read_b128 v[188:191], v8 offset:28672
    s_waitcnt lgkmcnt(9)
    v_mfma_f32_16x16x32_bf16 v[124:127], a[184:187], v[196:199], v[124:127]
    v_mfma_f32_16x16x32_bf16 v[128:131], a[188:191], v[196:199], v[128:131]
    ds_read_b128 v[192:195], v8 offset:61440
    v_mfma_f32_16x16x32_bf16 v[132:135], a[184:187], v[200:203], v[132:135]
    v_mfma_f32_16x16x32_bf16 v[136:139], a[188:191], v[200:203], v[136:139]
    ds_read_b128 v[196:199], v8 offset:29696
    s_waitcnt lgkmcnt(9)
    v_mfma_f32_16x16x32_bf16 v[124:127], a[192:195], v[156:159], v[124:127]
    v_mfma_f32_16x16x32_bf16 v[128:131], a[196:199], v[156:159], v[128:131]
    ds_read_b128 v[200:203], v8 offset:62464
    v_mfma_f32_16x16x32_bf16 v[132:135], a[192:195], v[160:163], v[132:135]
    v_mfma_f32_16x16x32_bf16 v[136:139], a[196:199], v[160:163], v[136:139]
    ds_read_b128 v[156:159], v8 offset:30720
    s_waitcnt lgkmcnt(9)
    v_mfma_f32_16x16x32_bf16 v[124:127], a[200:203], v[164:167], v[124:127]
    v_mfma_f32_16x16x32_bf16 v[128:131], a[204:207], v[164:167], v[128:131]
    ds_read_b128 v[160:163], v8 offset:63488
    v_mfma_f32_16x16x32_bf16 v[132:135], a[200:203], v[168:171], v[132:135]
    v_mfma_f32_16x16x32_bf16 v[136:139], a[204:207], v[168:171], v[136:139]
    ds_read_b128 v[164:167], v8 offset:31744
    s_waitcnt lgkmcnt(9)
    v_mfma_f32_16x16x32_bf16 v[124:127], a[208:211], v[172:175], v[124:127]
    v_mfma_f32_16x16x32_bf16 v[128:131], a[212:215], v[172:175], v[128:131]
    ds_read_b128 v[168:171], v8 offset:64512
    v_mfma_f32_16x16x32_bf16 v[132:135], a[208:211], v[176:179], v[132:135]
    v_mfma_f32_16x16x32_bf16 v[136:139], a[212:215], v[176:179], v[136:139]
    s_waitcnt lgkmcnt(8)
    v_mfma_f32_16x16x32_bf16 v[124:127], a[216:219], v[180:183], v[124:127]
    v_mfma_f32_16x16x32_bf16 v[128:131], a[220:223], v[180:183], v[128:131]
    v_mfma_f32_16x16x32_bf16 v[132:135], a[216:219], v[184:187], v[132:135]
    v_mfma_f32_16x16x32_bf16 v[136:139], a[220:223], v[184:187], v[136:139]
    s_waitcnt lgkmcnt(6)
    v_mfma_f32_16x16x32_bf16 v[124:127], a[224:227], v[188:191], v[124:127]
    v_mfma_f32_16x16x32_bf16 v[128:131], a[228:231], v[188:191], v[128:131]
    v_mfma_f32_16x16x32_bf16 v[132:135], a[224:227], v[192:195], v[132:135]
    v_mfma_f32_16x16x32_bf16 v[136:139], a[228:231], v[192:195], v[136:139]
    s_waitcnt lgkmcnt(4)
    v_mfma_f32_16x16x32_bf16 v[124:127], a[232:235], v[196:199], v[124:127]
    v_mfma_f32_16x16x32_bf16 v[128:131], a[236:239], v[196:199], v[128:131]
    v_mfma_f32_16x16x32_bf16 v[132:135], a[232:235], v[200:203], v[132:135]
    v_mfma_f32_16x16x32_bf16 v[136:139], a[236:239], v[200:203], v[136:139]
    s_waitcnt lgkmcnt(2)
    v_mfma_f32_16x16x32_bf16 v[124:127], a[240:243], v[156:159], v[124:127]
    v_mfma_f32_16x16x32_bf16 v[128:131], a[244:247], v[156:159], v[128:131]
    v_mfma_f32_16x16x32_bf16 v[132:135], a[240:243], v[160:163], v[132:135]
    v_mfma_f32_16x16x32_bf16 v[136:139], a[244:247], v[160:163], v[136:139]
    s_waitcnt lgkmcnt(0)
    v_mfma_f32_16x16x32_bf16 v[124:127], a[248:251], v[164:167], v[124:127]
    v_mfma_f32_16x16x32_bf16 v[128:131], a[252:255], v[164:167], v[128:131]
    v_mfma_f32_16x16x32_bf16 v[132:135], a[248:251], v[168:171], v[132:135]
    v_mfma_f32_16x16x32_bf16 v[136:139], a[252:255], v[168:171], v[136:139]
    s_nop 4
    buffer_store_dwordx4 v[124:127], v1, s[4:7], s37 offen sc1
    s_add_u32 s37, s37, 4096
    buffer_store_dwordx4 v[128:131], v1, s[4:7], s37 offen sc1
    s_add_u32 s37, s37, 4096
    buffer_store_dwordx4 v[132:135], v1, s[4:7], s37 offen sc1
    s_add_u32 s37, s37, 4096
    buffer_store_dwordx4 v[136:139], v1, s[4:7], s37 offen sc1
    s_add_u32 s37, s37, 4096
    s_waitcnt vmcnt(4)
    v_pk_add_f32 v[32:33], v[32:33], v[36:37]
    v_pk_add_f32 v[40:41], v[40:41], v[44:45]
    v_pk_add_f32 v[32:33], v[32:33], v[40:41]
    v_cvt_pk_bf16_f32 v14, v32, v33
    v_pk_add_f32 v[34:35], v[34:35], v[38:39]
    v_pk_add_f32 v[42:43], v[42:43], v[46:47]
    v_pk_add_f32 v[34:35], v[34:35], v[42:43]
    v_cvt_pk_bf16_f32 v15, v34, v35
    buffer_store_dwordx2 v[14:15], v9, s[80:83], s38 offen
    s_add_u32 s38, s38, 0x80000
    v_pk_add_f32 v[48:49], v[48:49], v[52:53]
    v_pk_add_f32 v[56:57], v[56:57], v[60:61]
    v_pk_add_f32 v[48:49], v[48:49], v[56:57]
    v_cvt_pk_bf16_f32 v16, v48, v49
    v_pk_add_f32 v[50:51], v[50:51], v[54:55]
    v_pk_add_f32 v[58:59], v[58:59], v[62:63]
    v_pk_add_f32 v[50:51], v[50:51], v[58:59]
    v_cvt_pk_bf16_f32 v17, v50, v51
    buffer_store_dwordx2 v[16:17], v9, s[80:83], s38 offen
    s_add_u32 s38, s38, 0x80000
    s_waitcnt vmcnt(2)
    buffer_load_dwordx4 v[140:143], v1, s[4:7], s77 offen offset:0 sc1
    buffer_load_dwordx4 v[144:147], v1, s[4:7], s77 offen offset:1024 sc1
    buffer_load_dwordx4 v[148:151], v1, s[4:7], s77 offen offset:2048 sc1
    buffer_load_dwordx4 v[152:155], v1, s[4:7], s77 offen offset:3072 sc1
    s_waitcnt vmcnt(0)
Lsp_97:
    v_max3_u32 v12, v140, v141, v142
    v_max3_u32 v12, v12, v143, v144
    v_max3_u32 v12, v12, v145, v146
    v_max3_u32 v12, v12, v147, v148
    v_max3_u32 v12, v12, v149, v150
    v_max3_u32 v12, v12, v151, v152
    v_max3_u32 v12, v12, v153, v154
    v_max_u32 v12, v12, v155
    v_cmp_eq_u32 vcc, -1, v12
    s_nop 0
    s_cbranch_vccz Lsp_98
    s_sleep 1
    buffer_load_dwordx4 v[140:143], v1, s[4:7], s77 offen offset:0 sc1
    buffer_load_dwordx4 v[144:147], v1, s[4:7], s77 offen offset:1024 sc1
    buffer_load_dwordx4 v[148:151], v1, s[4:7], s77 offen offset:2048 sc1
    buffer_load_dwordx4 v[152:155], v1, s[4:7], s77 offen offset:3072 sc1
    s_waitcnt vmcnt(0)
    s_sub_u32 s55, s55, 1
    s_cbranch_scc0 Lsp_97
    s_branch L_side_fail
Lsp_98:
    v_pk_add_f32 v[140:141], v[140:141], v[144:145]
    v_pk_add_f32 v[148:149], v[148:149], v[152:153]
    v_pk_add_f32 v[140:141], v[140:141], v[148:149]
    v_cvt_pk_bf16_f32 v12, v140, v141
    v_pk_add_f32 v[142:143], v[142:143], v[146:147]
    v_pk_add_f32 v[150:151], v[150:151], v[154:155]
    v_pk_add_f32 v[142:143], v[142:143], v[150:151]
    v_cvt_pk_bf16_f32 v13, v142, v143
    buffer_store_dwordx2 v[12:13], v9, s[80:83], s38 offen
L_side_fail:
L_exit:
    s_endpgm
L_code_end:
.section .rodata,"a"
.p2align 6
.amdhsa_kernel concat_heads__ssm_conv_h3__memory_aug_recurrent_mem_tr__prompt_kernel
  .amdhsa_next_free_vgpr 512
  .amdhsa_next_free_sgpr 102
  .amdhsa_accum_offset 256
  .amdhsa_group_segment_fixed_size 0
  .amdhsa_kernarg_size 128
  .amdhsa_user_sgpr_count 2
  .amdhsa_user_sgpr_kernarg_segment_ptr 1
  .amdhsa_system_sgpr_workgroup_id_x 1
  .amdhsa_float_denorm_mode_32 3
  .amdhsa_float_denorm_mode_16_64 3
.end_amdhsa_kernel
```
